```python
import torch

def _softmax(x, axis=-1):
    return torch.softmax(x, dim=axis)
def _gelu(x):
    return torch.nn.functional.gelu(x, approximate="tanh")
def _silu(x):
    return torch.nn.functional.silu(x)
def _sigmoid(x):
    return torch.sigmoid(x)
def _layernorm(x, axis=-1, eps=1e-5):
    m = x.mean(dim=axis, keepdim=True)
    v = x.var(dim=axis, keepdim=True, unbiased=False)
    return (x - m) / torch.sqrt(v + eps)
def _scatter_add(tgt, idx, src, axis=0):
    return tgt.clone().index_add_(axis, idx, src)
def _segment_sum(src, seg, n):
    out = torch.zeros((n,) + src.shape[1:], dtype=src.dtype)
    return out.index_add_(0, seg, src)
def _pad(x, pw):
    flat = tuple(v for pair in reversed(pw) for v in pair)
    return torch.nn.functional.pad(x, flat)

kernel_name = 'parallel_sum__ssm_conv_s5__mixer_channel_mlp__prompt'

def setup_inputs():

    _w = (lambda a: (lambda t: t.to(torch.bfloat16) if t.is_floating_point() else t)(torch.as_tensor(a)))
    def _A_setup():
        B, S, D = 1, 2048, 576
        P = D
        Lambda_re = -0.5 * (lambda _x: torch.exp(torch.as_tensor(_x)))((lambda *s: torch.randn(*s, dtype=torch.bfloat16) * 0.2)(P))
        Lambda_im = (lambda *s: torch.randn(*s, dtype=torch.bfloat16) * 0.8)(P) * 1.0
        B_re = (lambda *s: torch.randn(*s, dtype=torch.bfloat16) * 0.2)(P, D) * (D ** -0.5)
        B_im = (lambda *s: torch.randn(*s, dtype=torch.bfloat16) * 0.2)(P, D) * (D ** -0.5)
        C_re = (lambda *s: torch.randn(*s, dtype=torch.bfloat16) * 0.2)(D, P) * (P ** -0.5)
        C_im = (lambda *s: torch.randn(*s, dtype=torch.bfloat16) * 0.2)(D, P) * (P ** -0.5)
        log_dt = (lambda *s: torch.randn(*s, dtype=torch.bfloat16) * 0.2)(P) * 0.3 - 2.0
        Dskip = (lambda *s: torch.randn(*s, dtype=torch.bfloat16) * 0.05)(D)
        return {
            "x": _w((lambda *s: torch.randn(*s, dtype=torch.bfloat16) * 0.05)(B, S, D)),
            "Lambda_re": _w(Lambda_re),
            "Lambda_im": _w(Lambda_im),
            "B_re": _w(B_re),
            "B_im": _w(B_im),
            "C_re": _w(C_re),
            "C_im": _w(C_im),
            "log_dt": _w(log_dt),
            "Dskip": _w(Dskip),
        }
    _A_in = _A_setup()

    def _B_setup():
        B, S, D, F = 1, 2048, 576, 4608
        return {
            "x": _w((lambda *s: torch.randn(*s, dtype=torch.bfloat16) * 0.05)(B, S, D)),
            "w1": _w((lambda *s: torch.randn(*s, dtype=torch.bfloat16) * 1.6)(D, F) * (D ** -0.5)),
            "b1": _w((lambda *s: torch.randn(*s, dtype=torch.bfloat16) * 0.8)(F)),
            "w2": _w((lambda *s: torch.randn(*s, dtype=torch.bfloat16) * 0.05)(F, D) * (F ** -0.5)),
            "b2": _w((lambda *s: torch.randn(*s, dtype=torch.bfloat16) * 0.05)(D)),
        }
    _B_in = _B_setup()

    return {
        "A_x": _A_in["x"],
        "A_Lambda_re": _A_in["Lambda_re"],
        "A_Lambda_im": _A_in["Lambda_im"],
        "A_B_re": _A_in["B_re"],
        "A_B_im": _A_in["B_im"],
        "A_C_re": _A_in["C_re"],
        "A_C_im": _A_in["C_im"],
        "A_log_dt": _A_in["log_dt"],
        "A_Dskip": _A_in["Dskip"],
        "B_x": _B_in["x"],
        "B_w1": _B_in["w1"],
        "B_b1": _B_in["b1"],
        "B_w2": _B_in["w2"],
        "B_b2": _B_in["b2"],
    }

def reference(A_x, A_Lambda_re, A_Lambda_im, A_B_re, A_B_im, A_C_re, A_C_im, A_log_dt, A_Dskip, B_x, B_w1, B_b1, B_w2, B_b2):
    def _A_ref(x, Lambda_re, Lambda_im, B_re, B_im, C_re, C_im, log_dt, Dskip):
        Bsz, L, H = x.shape
        Lam = Lambda_re + 1j * Lambda_im
        Bmat = B_re + 1j * B_im
        Cmat = C_re + 1j * C_im
        dt = torch.exp(log_dt)
        Lam_bar = torch.exp(dt * Lam)
        B_bar = ((Lam_bar - 1.0) / Lam)[:, None] * Bmat
        Bu = torch.einsum("bld,pd->blp", x + 0j, B_bar)
        h = torch.zeros_like(Bu[:, 0, :])
        hs = []
        for t in range(L):
            h = Lam_bar[None, :] * h + Bu[:, t, :]
            hs.append(h)
        hseq = torch.stack(hs, 1)
        y = 2.0 * torch.einsum("blp,dp->bld", hseq, Cmat).real + x * Dskip[None, None, :]
        return y

    def _B_ref(x, w1, b1, w2, b2):
        y = _layernorm(x, axis=-1)
        h = _gelu(torch.einsum("bsd,df->bsf", y, w1) + b1)
        return torch.einsum("bsf,fd->bsd", h, w2) + b2

    x = A_x
    xn = _layernorm(x, axis=-1)
    return x + _A_ref(xn, A_Lambda_re, A_Lambda_im, A_B_re, A_B_im, A_C_re, A_C_im, A_log_dt, A_Dskip) + _B_ref(xn, B_w1, B_b1, B_w2, B_b2)
```

```asm
; @launch grid=(256,1,1) block=(256,1,1) lds=163840
.amdgcn_target "amdgcn-amd-amdhsa--gfx950"
.text
.p2align 12
.globl parallel_sum__ssm_conv_s5__mixer_channel_mlp__prompt_kernel
.p2align 8
.type parallel_sum__ssm_conv_s5__mixer_channel_mlp__prompt_kernel,@function
parallel_sum__ssm_conv_s5__mixer_channel_mlp__prompt_kernel:
s_cmp_ge_u32 s2, 256
s_cbranch_scc1 L_end
s_load_dwordx16 s[64:79], s[0:1], 0
s_load_dwordx16 s[80:95], s[0:1], 64
s_load_dwordx2 s[96:97], s[0:1], 128
v_lshrrev_b32 v1, 6, v0
v_and_b32 v0, 63, v0
v_readfirstlane_b32 s44, v1
v_lshlrev_b32 v1, 4, v0
s_getpc_b64 s[100:101]
L_pc:
s_lshr_b32 s61, s2, 3
s_lshl_b32 s61, s61, 2
s_add_u32 s61, s61, s44
s_lshl_b32 s61, s61, 7
v_and_b32 v2, 7, v0
v_lshlrev_b32 v2, 14, v2
v_add_u32 v2, s61, v2
v_min_u32 v2, L_end-L_pc, v2
global_load_dword v67, v2, s[100:101]
s_and_b32 s49, s2, 7
s_lshr_b32 s61, s2, 3
s_cmp_ge_u32 s61, 30
s_cbranch_scc1 L_helper
s_mul_i32 s62, s61, 43
s_lshr_b32 s62, s62, 8
s_mul_i32 s63, s62, 6
s_sub_u32 s48, s61, s63
s_mul_i32 s49, s49, 5
s_add_u32 s49, s49, s62
s_lshr_b32 s47, s49, 3
s_and_b32 s46, s49, 7
s_sub_u32 s63, 7, s46
s_bitcmp1_b32 s47, 0
s_cselect_b32 s46, s63, s46
s_add_u32 s50, s48, s62
s_mul_i32 s63, s50, 86
s_lshr_b32 s63, s63, 8
s_mul_i32 s63, s63, 3
s_sub_u32 s50, s50, s63
s_mov_b32 s60, 1985229328
s_mov_b32 s59, 8
s_cmp_eq_u32 s50, 1
s_cselect_b32 s60, 2268413985, s60
s_cselect_b32 s59, 6, s59
s_cmp_eq_u32 s50, 2
s_cselect_b32 s60, 1749242114, s60
s_cselect_b32 s59, 7, s59
s_mul_i32 s40, s46, 294912
s_mul_i32 s43, s44, 16384
s_lshl_b32 s3, s44, 11
s_cmp_lt_u32 s47, 4
s_cselect_b32 s51, 4, 2
s_mul_i32 s42, s47, 6
s_add_u32 s42, s42, s48
s_lshl_b32 s42, s42, 7
s_add_u32 s101, s42, 5376
s_lshl_b32 s98, s47, 2
s_add_u32 s98, s98, s48
v_bfe_u32 v150, v0, 3, 2
v_and_b32 v151, 32, v0
v_add_u32 v150, v150, v151
s_lshl_b32 s61, s44, 6
v_add_u32 v150, s61, v150
v_mul_u32_u24 v150, 1152, v150
v_bfe_u32 v151, v0, 4, 2
v_and_b32 v152, 7, v0
v_xor_b32 v151, v151, v152
v_lshlrev_b32 v151, 4, v151
v_add_u32 v72, v150, v151
v_xor_b32 v73, 64, v151
v_add_u32 v73, v73, v150
v_add_u32 v74, 7168, v72
v_add_u32 v75, 10752, v73
v_add_u32 v73, 3584, v73
s_and_b32 s61, s44, 1
s_lshl_b32 s61, s61, 4
s_lshl_b32 s62, s98, 5
s_add_u32 s61, s61, s62
v_lshrrev_b32 v150, 3, v0
v_add_u32 v150, s61, v150
v_mul_u32_u24 v150, 1152, v150
v_add_u32 v16, v150, v151
v_xor_b32 v17, 64, v151
v_add_u32 v17, v17, v150
v_add_u32 v17, 8192, v17
v_lshrrev_b32 v150, 3, v0
s_lshl_b32 s61, s44, 4
v_add_u32 v150, s61, v150
v_bfe_u32 v151, v0, 4, 1
v_lshlrev_b32 v151, 2, v151
v_xor_b32 v151, v151, v152
v_lshlrev_b32 v151, 4, v151
v_mul_u32_u24 v12, 9216, v150
v_add_u32 v12, v12, v151
v_add_u32 v13, 72704, v12
s_bfe_u32 s50, s60, 262144
s_bfe_u32 s52, s60, 262148
s_waitcnt lgkmcnt(0)
s_mov_b32 s4, s64
s_mov_b32 s5, s65
s_mov_b32 s6, 2359296
s_mov_b32 s7, 0x20000
s_mov_b32 s8, s84
s_mov_b32 s9, s85
s_mov_b32 s10, 5308416
s_mov_b32 s11, 0x20000
s_load_dword s45, s[96:97], 0
s_cmp_lt_u32 s44, 2
s_cselect_b32 s24, s70, s72
s_cselect_b32 s25, s71, s73
s_mov_b32 s26, 663552
s_mov_b32 s27, 0x20000
s_add_u32 m0, s43, 0
s_lshl_b32 s99, s50, 7
s_add_u32 s99, s99, s40
buffer_load_dwordx4 v72, s[4:7], s99 offen offset:0 lds
buffer_load_dwordx4 v73, s[4:7], s99 offen offset:1024 lds
buffer_load_dwordx4 v74, s[4:7], s99 offen offset:2048 lds
buffer_load_dwordx4 v75, s[4:7], s99 offen offset:3072 lds
s_add_u32 m0, s43, 4096
s_add_u32 s99, s99, 18432
buffer_load_dwordx4 v72, s[4:7], s99 offen offset:0 lds
buffer_load_dwordx4 v73, s[4:7], s99 offen offset:1024 lds
buffer_load_dwordx4 v74, s[4:7], s99 offen offset:2048 lds
buffer_load_dwordx4 v75, s[4:7], s99 offen offset:3072 lds
s_add_u32 m0, s3, 65536
s_mul_i32 s61, s50, 589824
s_add_u32 s61, s61, s42
buffer_load_dwordx4 v12, s[8:11], s61 offen lds
buffer_load_dwordx4 v13, s[8:11], s61 offen offset:1024 lds
s_cmp_lt_u32 s48, s51
s_cbranch_scc0 L_M
L_S:
v_lshrrev_b32 v233, 5, v0
s_lshl_b32 s63, s2, 2
s_add_u32 s63, s63, s44
s_lshl_b32 s63, s63, 1
v_add_u32 v233, s63, v233
v_mul_u32_u24 v251, 1152, v233
v_and_b32 v234, 31, v0
v_lshl_add_u32 v251, v234, 2, v251
buffer_load_dword v224, v251, s[4:7], 0 offen offset:0
buffer_load_dword v225, v251, s[4:7], 0 offen offset:128
buffer_load_dword v226, v251, s[4:7], 0 offen offset:256
buffer_load_dword v227, v251, s[4:7], 0 offen offset:384
buffer_load_dword v228, v251, s[4:7], 0 offen offset:512
buffer_load_dword v229, v251, s[4:7], 0 offen offset:640
buffer_load_dword v230, v251, s[4:7], 0 offen offset:768
buffer_load_dword v231, v251, s[4:7], 0 offen offset:896
buffer_load_dword v232, v251, s[4:7], 0 offen offset:1024
s_cmp_lt_u32 s2, 72
s_cselect_b32 s36, s70, s72
s_cselect_b32 s37, s71, s73
s_mov_b32 s38, 663552
s_mov_b32 s39, 0x20000
s_cmp_lt_u32 s2, 72
s_cselect_b32 s63, 0, 663552
v_subrev_u32 v251, s63, v251
buffer_load_dword v36, v251, s[36:39], 0 offen offset:0
buffer_load_dword v37, v251, s[36:39], 0 offen offset:128
buffer_load_dword v38, v251, s[36:39], 0 offen offset:256
buffer_load_dword v39, v251, s[36:39], 0 offen offset:384
buffer_load_dword v40, v251, s[36:39], 0 offen offset:512
buffer_load_dword v41, v251, s[36:39], 0 offen offset:640
buffer_load_dword v42, v251, s[36:39], 0 offen offset:768
buffer_load_dword v43, v251, s[36:39], 0 offen offset:896
buffer_load_dword v44, v251, s[36:39], 0 offen offset:1024
s_mov_b32 s16, s96
s_mov_b32 s17, s97
s_mov_b32 s18, 268435456
s_mov_b32 s19, 0x20000
s_mov_b32 s12, s88
s_mov_b32 s13, s89
s_mov_b32 s14, 5308416
s_mov_b32 s15, 0x20000
s_mov_b32 s20, s92
s_mov_b32 s21, s93
s_mov_b32 s22, 4718592
s_mov_b32 s23, 0x20000
s_mov_b32 s28, s74
s_mov_b32 s29, s75
s_mov_b32 s30, 663552
s_mov_b32 s31, 0x20000
s_mov_b32 s32, s76
s_mov_b32 s33, s77
s_mov_b32 s34, 663552
s_mov_b32 s35, 0x20000
s_mov_b32 s39, 0x20000
v_cmp_eq_u32 vcc, 0, v0
v_mov_b32 v26, 0x80000000
s_nop 0
v_cndmask_b32 v26, v26, v0, vcc
v_and_b32 v150, 31, v0
s_lshl_b32 s61, s98, 5
v_add_u32 v150, s61, v150
v_lshlrev_b32 v150, 1, v150
global_load_ushort v239, v150, s[66:67]
global_load_ushort v240, v150, s[68:69]
global_load_ushort v241, v150, s[78:79]
s_bfe_u32 s53, s60, 262152
s_bfe_u32 s54, s60, 262156
s_bfe_u32 s55, s60, 262160
s_bfe_u32 s56, s60, 262164
s_bfe_u32 s57, s60, 262168
s_bfe_u32 s58, s60, 262172
v_lshrrev_b32 v150, 5, v0
v_lshlrev_b32 v150, 3, v150
v_bfe_u32 v151, v0, 2, 2
v_add_u32 v150, v150, v151
v_lshlrev_b32 v150, 7, v150
v_bfe_u32 v151, v0, 3, 1
v_lshl_add_u32 v150, v151, 6, v150
v_bfe_u32 v151, v0, 4, 1
v_lshl_add_u32 v150, v151, 5, v150
v_and_b32 v151, 3, v0
v_lshl_add_u32 v2, v151, 3, v150
v_xor_b32 v5, 64, v2
v_add_u32 v3, 65536, v2
v_add_u32 v4, 131072, v2
v_add_u32 v6, 65536, v5
v_add_u32 v7, 131072, v5
v_and_b32 v150, 31, v0
v_lshlrev_b32 v150, 7, v150
v_bfe_u32 v151, v0, 1, 3
v_lshrrev_b32 v152, 5, v0
v_xor_b32 v151, v151, v152
v_lshl_add_u32 v150, v151, 4, v150
v_xor_b32 v151, 0, v150
v_add_u32 v76, s43, v151
v_add_u32 v8, 106496, v151
v_xor_b32 v151, 32, v150
v_add_u32 v77, s43, v151
v_add_u32 v9, 106496, v151
v_xor_b32 v151, 64, v150
v_add_u32 v78, s43, v151
v_add_u32 v10, 106496, v151
v_xor_b32 v151, 96, v150
v_add_u32 v79, s43, v151
v_add_u32 v11, 106496, v151
v_lshl_add_u32 v150, v0, 1, s42
global_load_ushort v66, v150, s[86:87]
v_lshl_add_u32 v150, v0, 1, s101
global_load_ushort v35, v150, s[86:87]
s_waitcnt lgkmcnt(0)
s_add_u32 s45, s45, 16
s_mov_b64 exec, 0
s_cmp_eq_u32 s44, 0
s_cbranch_scc1 L_stub6
s_cmp_eq_u32 s44, 1
s_cbranch_scc1 L_stub7
s_cmp_eq_u32 s44, 2
s_cbranch_scc1 L_stub8
s_branch L_stub9
L_M:
s_lshl_b32 s100, s47, 1
s_add_u32 s100, s100, s48
s_sub_u32 s100, s100, s51
s_add_u32 s100, s100, 30
s_lshl_b32 s100, s100, 7
v_lshrrev_b32 v233, 5, v0
s_lshl_b32 s63, s2, 2
s_add_u32 s63, s63, s44
s_lshl_b32 s63, s63, 1
v_add_u32 v233, s63, v233
v_mul_u32_u24 v251, 1152, v233
v_and_b32 v234, 31, v0
v_lshl_add_u32 v251, v234, 2, v251
buffer_load_dword v224, v251, s[4:7], 0 offen offset:0
buffer_load_dword v225, v251, s[4:7], 0 offen offset:128
buffer_load_dword v226, v251, s[4:7], 0 offen offset:256
buffer_load_dword v227, v251, s[4:7], 0 offen offset:384
buffer_load_dword v228, v251, s[4:7], 0 offen offset:512
buffer_load_dword v229, v251, s[4:7], 0 offen offset:640
buffer_load_dword v230, v251, s[4:7], 0 offen offset:768
buffer_load_dword v231, v251, s[4:7], 0 offen offset:896
buffer_load_dword v232, v251, s[4:7], 0 offen offset:1024
s_cmp_lt_u32 s2, 72
s_cselect_b32 s36, s70, s72
s_cselect_b32 s37, s71, s73
s_mov_b32 s38, 663552
s_mov_b32 s39, 0x20000
s_cmp_lt_u32 s2, 72
s_cselect_b32 s63, 0, 663552
v_subrev_u32 v251, s63, v251
buffer_load_dword v36, v251, s[36:39], 0 offen offset:0
buffer_load_dword v37, v251, s[36:39], 0 offen offset:128
buffer_load_dword v38, v251, s[36:39], 0 offen offset:256
buffer_load_dword v39, v251, s[36:39], 0 offen offset:384
buffer_load_dword v40, v251, s[36:39], 0 offen offset:512
buffer_load_dword v41, v251, s[36:39], 0 offen offset:640
buffer_load_dword v42, v251, s[36:39], 0 offen offset:768
buffer_load_dword v43, v251, s[36:39], 0 offen offset:896
buffer_load_dword v44, v251, s[36:39], 0 offen offset:1024
s_mov_b32 s16, s96
s_mov_b32 s17, s97
s_mov_b32 s18, 268435456
s_mov_b32 s19, 0x20000
s_mov_b32 s12, s88
s_mov_b32 s13, s89
s_mov_b32 s14, 5308416
s_mov_b32 s15, 0x20000
s_mov_b32 s20, s92
s_mov_b32 s21, s93
s_mov_b32 s22, 4718592
s_mov_b32 s23, 0x20000
s_mov_b32 s28, s74
s_mov_b32 s29, s75
s_mov_b32 s30, 663552
s_mov_b32 s31, 0x20000
s_mov_b32 s32, s76
s_mov_b32 s33, s77
s_mov_b32 s34, 663552
s_mov_b32 s35, 0x20000
s_mov_b32 s39, 0x20000
v_cmp_eq_u32 vcc, 0, v0
v_mov_b32 v26, 0x80000000
s_nop 0
v_cndmask_b32 v26, v26, v0, vcc
s_bfe_u32 s53, s60, 262152
s_bfe_u32 s54, s60, 262156
s_bfe_u32 s55, s60, 262160
s_bfe_u32 s56, s60, 262164
s_bfe_u32 s57, s60, 262168
s_bfe_u32 s58, s60, 262172
v_lshrrev_b32 v150, 5, v0
v_lshlrev_b32 v150, 3, v150
v_bfe_u32 v151, v0, 2, 2
v_add_u32 v150, v150, v151
v_lshlrev_b32 v150, 7, v150
v_bfe_u32 v151, v0, 3, 1
v_lshl_add_u32 v150, v151, 6, v150
v_bfe_u32 v151, v0, 4, 1
v_lshl_add_u32 v150, v151, 5, v150
v_and_b32 v151, 3, v0
v_lshl_add_u32 v2, v151, 3, v150
v_xor_b32 v5, 64, v2
v_add_u32 v3, 65536, v2
v_add_u32 v4, 131072, v2
v_add_u32 v6, 65536, v5
v_add_u32 v7, 131072, v5
v_and_b32 v150, 31, v0
v_lshlrev_b32 v150, 7, v150
v_bfe_u32 v151, v0, 1, 3
v_lshrrev_b32 v152, 5, v0
v_xor_b32 v151, v151, v152
v_lshl_add_u32 v150, v151, 4, v150
v_xor_b32 v151, 0, v150
v_add_u32 v76, s43, v151
v_add_u32 v8, 106496, v151
v_xor_b32 v151, 32, v150
v_add_u32 v77, s43, v151
v_add_u32 v9, 106496, v151
v_xor_b32 v151, 64, v150
v_add_u32 v78, s43, v151
v_add_u32 v10, 106496, v151
v_xor_b32 v151, 96, v150
v_add_u32 v79, s43, v151
v_add_u32 v11, 106496, v151
v_lshl_add_u32 v150, v0, 1, s42
global_load_ushort v66, v150, s[86:87]
v_lshl_add_u32 v150, v0, 1, s100
global_load_ushort v64, v150, s[86:87]
v_lshl_add_u32 v150, v0, 1, s101
global_load_ushort v35, v150, s[86:87]
s_waitcnt lgkmcnt(0)
s_add_u32 s45, s45, 16
s_mov_b64 exec, 0
s_cmp_eq_u32 s44, 0
s_cbranch_scc1 L_stub0
s_cmp_eq_u32 s44, 1
s_cbranch_scc1 L_stub1
s_cmp_eq_u32 s44, 2
s_cbranch_scc1 L_stub2
s_branch L_stub3
L_visit_end:
s_cmp_lt_u32 s48, s51
s_cbranch_scc1 L_backS
L_backM:
s_mov_b64 exec, -1
s_add_u32 m0, s43, 8192
s_lshl_b32 s99, s52, 7
s_add_u32 s99, s99, s40
buffer_load_dwordx4 v72, s[4:7], s99 offen offset:0 lds
buffer_load_dwordx4 v73, s[4:7], s99 offen offset:1024 lds
buffer_load_dwordx4 v74, s[4:7], s99 offen offset:2048 lds
buffer_load_dwordx4 v75, s[4:7], s99 offen offset:3072 lds
s_add_u32 m0, s43, 12288
s_add_u32 s99, s99, 18432
buffer_load_dwordx4 v72, s[4:7], s99 offen offset:0 lds
buffer_load_dwordx4 v73, s[4:7], s99 offen offset:1024 lds
buffer_load_dwordx4 v74, s[4:7], s99 offen offset:2048 lds
buffer_load_dwordx4 v75, s[4:7], s99 offen offset:3072 lds
s_add_u32 m0, s3, 73728
s_mul_i32 s61, s52, 589824
s_add_u32 s61, s61, s42
buffer_load_dwordx4 v12, s[8:11], s61 offen lds
buffer_load_dwordx4 v13, s[8:11], s61 offen offset:1024 lds
s_waitcnt vmcnt(31)
s_barrier
ds_read_b128 a[0:3], v76 offset:0
ds_read_b128 a[4:7], v76 offset:4096
ds_read_b128 a[8:11], v77 offset:0
ds_read_b128 a[12:15], v77 offset:4096
ds_read_b128 a[16:19], v78 offset:0
ds_read_b128 a[20:23], v78 offset:4096
ds_read_b128 a[24:27], v79 offset:0
ds_read_b128 a[28:31], v79 offset:4096
ds_read_b64_tr_b16 v[80:81], v3 offset:0
ds_read_b64_tr_b16 v[82:83], v3 offset:512
s_waitcnt lgkmcnt(0)
v_mfma_f32_32x32x16_bf16 v[160:175], v[80:83], a[0:3], 0
s_add_u32 m0, s43, 0
s_lshl_b32 s99, s53, 7
s_add_u32 s99, s99, s40
buffer_load_dwordx4 v72, s[4:7], s99 offen offset:0 lds
v_mfma_f32_32x32x16_bf16 v[176:191], v[80:83], a[4:7], 0
buffer_load_dwordx4 v73, s[4:7], s99 offen offset:1024 lds
ds_read_b64_tr_b16 v[84:85], v6 offset:0
ds_read_b64_tr_b16 v[86:87], v6 offset:512
s_waitcnt vmcnt(32)
v_lshlrev_b32 v242, 16, v224
v_and_b32 v224, 0xffff0000, v224
s_waitcnt lgkmcnt(0)
v_mfma_f32_32x32x16_bf16 v[192:207], v[84:87], a[0:3], 0
buffer_load_dwordx4 v74, s[4:7], s99 offen offset:2048 lds
s_waitcnt vmcnt(32)
v_lshlrev_b32 v243, 16, v225
v_and_b32 v225, 0xffff0000, v225
s_waitcnt vmcnt(31)
v_lshlrev_b32 v244, 16, v226
v_and_b32 v226, 0xffff0000, v226
v_mfma_f32_32x32x16_bf16 v[208:223], v[84:87], a[4:7], 0
buffer_load_dwordx4 v75, s[4:7], s99 offen offset:3072 lds
ds_read_b64_tr_b16 v[88:89], v3 offset:2048
ds_read_b64_tr_b16 v[90:91], v3 offset:2560
s_waitcnt vmcnt(31)
v_lshlrev_b32 v245, 16, v227
v_and_b32 v227, 0xffff0000, v227
s_waitcnt vmcnt(30)
v_lshlrev_b32 v246, 16, v228
s_waitcnt lgkmcnt(0)
v_mfma_f32_32x32x16_bf16 v[160:175], v[88:91], a[8:11], v[160:175]
v_and_b32 v228, 0xffff0000, v228
s_waitcnt vmcnt(29)
v_lshlrev_b32 v247, 16, v229
v_and_b32 v229, 0xffff0000, v229
s_waitcnt vmcnt(28)
v_lshlrev_b32 v248, 16, v230
v_and_b32 v230, 0xffff0000, v230
s_waitcnt vmcnt(27)
v_lshlrev_b32 v249, 16, v231
v_and_b32 v231, 0xffff0000, v231
s_waitcnt vmcnt(26)
v_lshlrev_b32 v250, 16, v232
v_mfma_f32_32x32x16_bf16 v[176:191], v[88:91], a[12:15], v[176:191]
s_add_u32 m0, s43, 4096
s_add_u32 s99, s99, 18432
buffer_load_dwordx4 v72, s[4:7], s99 offen offset:0 lds
ds_read_b64_tr_b16 v[92:93], v6 offset:2048
ds_read_b64_tr_b16 v[94:95], v6 offset:2560
s_waitcnt lgkmcnt(0)
v_mfma_f32_32x32x16_bf16 v[192:207], v[92:95], a[8:11], v[192:207]
buffer_load_dwordx4 v73, s[4:7], s99 offen offset:1024 lds
s_waitcnt vmcnt(6)
s_barrier
ds_read_b128 a[32:35], v76 offset:8192
v_and_b32 v232, 0xffff0000, v232
v_mfma_f32_32x32x16_bf16 v[208:223], v[92:95], a[12:15], v[208:223]
buffer_load_dwordx4 v74, s[4:7], s99 offen offset:2048 lds
ds_read_b64_tr_b16 v[80:81], v3 offset:4096
ds_read_b64_tr_b16 v[82:83], v3 offset:4608
ds_read_b128 a[36:39], v76 offset:12288
v_add_f32 v235, v242, v243
s_waitcnt lgkmcnt(1)
v_mfma_f32_32x32x16_bf16 v[160:175], v[80:83], a[16:19], v[160:175]
buffer_load_dwordx4 v75, s[4:7], s99 offen offset:3072 lds
ds_read_b128 a[40:43], v77 offset:8192
v_add_f32 v236, v224, v225
v_add_f32 v235, v235, v244
v_add_f32 v236, v236, v226
v_mfma_f32_32x32x16_bf16 v[176:191], v[80:83], a[20:23], v[176:191]
ds_read_b64_tr_b16 v[84:85], v6 offset:4096
ds_read_b64_tr_b16 v[86:87], v6 offset:4608
ds_read_b128 a[44:47], v77 offset:12288
v_add_f32 v235, v235, v245
v_add_f32 v236, v236, v227
v_add_f32 v235, v235, v246
v_add_f32 v236, v236, v228
v_add_f32 v235, v235, v247
v_add_f32 v236, v236, v229
s_waitcnt lgkmcnt(1)
v_mfma_f32_32x32x16_bf16 v[192:207], v[84:87], a[16:19], v[192:207]
s_add_u32 m0, s3, 81920
s_mul_i32 s61, s53, 589824
s_add_u32 s61, s61, s42
buffer_load_dwordx4 v12, s[8:11], s61 offen lds
ds_read_b128 a[48:51], v78 offset:8192
v_mfma_f32_32x32x16_bf16 v[208:223], v[84:87], a[20:23], v[208:223]
buffer_load_dwordx4 v13, s[8:11], s61 offen offset:1024 lds
ds_read_b64_tr_b16 v[88:89], v3 offset:6144
ds_read_b64_tr_b16 v[90:91], v3 offset:6656
ds_read_b128 a[52:55], v78 offset:12288
v_add_f32 v235, v235, v248
s_waitcnt lgkmcnt(1)
v_mfma_f32_32x32x16_bf16 v[160:175], v[88:91], a[24:27], v[160:175]
s_add_u32 m0, s3, 90112
s_mul_i32 s61, s54, 589824
s_add_u32 s61, s61, s42
buffer_load_dwordx4 v12, s[8:11], s61 offen lds
ds_read_b128 a[56:59], v79 offset:8192
v_mfma_f32_32x32x16_bf16 v[176:191], v[88:91], a[28:31], v[176:191]
buffer_load_dwordx4 v13, s[8:11], s61 offen offset:1024 lds
ds_read_b64_tr_b16 v[92:93], v6 offset:6144
ds_read_b64_tr_b16 v[94:95], v6 offset:6656
ds_read_b128 a[60:63], v79 offset:12288
v_add_f32 v236, v236, v230
s_waitcnt lgkmcnt(1)
v_mfma_f32_32x32x16_bf16 v[192:207], v[92:95], a[24:27], v[192:207]
v_add_f32 v235, v235, v249
v_add_f32 v236, v236, v231
v_add_f32 v235, v235, v250
v_add_f32 v236, v236, v232
v_add_f32 v235, v235, v236
s_nop 1
v_add_f32_dpp v235, v235, v235 quad_perm:[1,0,3,2] row_mask:0xf bank_mask:0xf
s_nop 1
v_add_f32_dpp v235, v235, v235 quad_perm:[2,3,0,1] row_mask:0xf bank_mask:0xf
s_nop 1
v_add_f32_dpp v235, v235, v235 row_half_mirror row_mask:0xf bank_mask:0xf
v_mfma_f32_32x32x16_bf16 v[208:223], v[92:95], a[28:31], v[208:223]
ds_read_b64_tr_b16 v[80:81], v3 offset:8192
ds_read_b64_tr_b16 v[82:83], v3 offset:8704
v_add_f32_dpp v235, v235, v235 row_mirror row_mask:0xf bank_mask:0xf
v_mov_b32 v236, v235
s_nop 1
v_permlane16_swap_b32 v235, v236
v_add_f32 v235, v235, v236
v_mul_f32 v252, 0x3ae38e39, v235
v_sub_f32 v242, v242, v252
s_waitcnt lgkmcnt(0)
v_mfma_f32_32x32x16_bf16 v[160:175], v[80:83], a[32:35], v[160:175]
s_add_u32 m0, s43, 8192
s_lshl_b32 s99, s54, 7
s_add_u32 s99, s99, s40
buffer_load_dwordx4 v72, s[4:7], s99 offen offset:0 lds
v_sub_f32 v224, v224, v252
v_mfma_f32_32x32x16_bf16 v[176:191], v[80:83], a[36:39], v[176:191]
buffer_load_dwordx4 v73, s[4:7], s99 offen offset:1024 lds
ds_read_b64_tr_b16 v[84:85], v6 offset:8192
ds_read_b64_tr_b16 v[86:87], v6 offset:8704
v_sub_f32 v243, v243, v252
v_sub_f32 v225, v225, v252
L_stub0:
s_cbranch_execz L_stub4
s_waitcnt lgkmcnt(0)
v_mfma_f32_32x32x16_bf16 v[192:207], v[84:87], a[32:35], v[192:207]
v_sub_f32 v244, v244, v252
v_sub_f32 v226, v226, v252
v_sub_f32 v245, v245, v252
v_sub_f32 v227, v227, v252
v_sub_f32 v246, v246, v252
v_sub_f32 v228, v228, v252
v_sub_f32 v247, v247, v252
v_sub_f32 v229, v229, v252
v_mfma_f32_32x32x16_bf16 v[208:223], v[84:87], a[36:39], v[208:223]
buffer_load_dwordx4 v74, s[4:7], s99 offen offset:2048 lds
ds_read_b64_tr_b16 v[88:89], v3 offset:10240
ds_read_b64_tr_b16 v[90:91], v3 offset:10752
v_sub_f32 v248, v248, v252
v_sub_f32 v230, v230, v252
s_waitcnt lgkmcnt(0)
v_mfma_f32_32x32x16_bf16 v[160:175], v[88:91], a[40:43], v[160:175]
buffer_load_dwordx4 v75, s[4:7], s99 offen offset:3072 lds
v_sub_f32 v249, v249, v252
v_sub_f32 v231, v231, v252
v_sub_f32 v250, v250, v252
v_sub_f32 v232, v232, v252
v_mfma_f32_32x32x16_bf16 v[176:191], v[88:91], a[44:47], v[176:191]
ds_read_b64_tr_b16 v[92:93], v6 offset:10240
ds_read_b64_tr_b16 v[94:95], v6 offset:10752
v_mul_f32 v235, v242, v242
v_mul_f32 v236, v224, v224
v_fmac_f32 v235, v243, v243
v_fmac_f32 v236, v225, v225
v_fmac_f32 v235, v244, v244
v_fmac_f32 v236, v226, v226
s_waitcnt lgkmcnt(0)
v_mfma_f32_32x32x16_bf16 v[192:207], v[92:95], a[40:43], v[192:207]
s_add_u32 m0, s43, 12288
s_add_u32 s99, s99, 18432
buffer_load_dwordx4 v72, s[4:7], s99 offen offset:0 lds
s_waitcnt vmcnt(7)
s_barrier
ds_read_b128 a[64:67], v76 offset:0
v_mfma_f32_32x32x16_bf16 v[208:223], v[92:95], a[44:47], v[208:223]
buffer_load_dwordx4 v73, s[4:7], s99 offen offset:1024 lds
ds_read_b64_tr_b16 v[80:81], v3 offset:12288
ds_read_b64_tr_b16 v[82:83], v3 offset:12800
ds_read_b128 a[68:71], v76 offset:4096
v_fmac_f32 v235, v245, v245
v_fmac_f32 v236, v227, v227
s_waitcnt lgkmcnt(1)
v_mfma_f32_32x32x16_bf16 v[160:175], v[80:83], a[48:51], v[160:175]
ds_read_b128 a[72:75], v77 offset:0
v_fmac_f32 v235, v246, v246
v_fmac_f32 v236, v228, v228
v_fmac_f32 v235, v247, v247
v_fmac_f32 v236, v229, v229
v_fmac_f32 v235, v248, v248
v_fmac_f32 v236, v230, v230
v_fmac_f32 v235, v249, v249
v_mfma_f32_32x32x16_bf16 v[176:191], v[80:83], a[52:55], v[176:191]
buffer_load_dwordx4 v74, s[4:7], s99 offen offset:2048 lds
ds_read_b64_tr_b16 v[84:85], v6 offset:12288
ds_read_b64_tr_b16 v[86:87], v6 offset:12800
ds_read_b128 a[76:79], v77 offset:4096
v_fmac_f32 v236, v231, v231
s_waitcnt lgkmcnt(1)
v_mfma_f32_32x32x16_bf16 v[192:207], v[84:87], a[48:51], v[192:207]
buffer_load_dwordx4 v75, s[4:7], s99 offen offset:3072 lds
ds_read_b128 a[80:83], v78 offset:0
v_fmac_f32 v235, v250, v250
v_fmac_f32 v236, v232, v232
v_add_f32 v235, v235, v236
v_mfma_f32_32x32x16_bf16 v[208:223], v[84:87], a[52:55], v[208:223]
ds_read_b64_tr_b16 v[88:89], v3 offset:14336
ds_read_b64_tr_b16 v[90:91], v3 offset:14848
ds_read_b128 a[84:87], v78 offset:4096
v_add_f32_dpp v235, v235, v235 quad_perm:[1,0,3,2] row_mask:0xf bank_mask:0xf
s_nop 1
v_add_f32_dpp v235, v235, v235 quad_perm:[2,3,0,1] row_mask:0xf bank_mask:0xf
s_nop 1
v_add_f32_dpp v235, v235, v235 row_half_mirror row_mask:0xf bank_mask:0xf
s_nop 1
v_add_f32_dpp v235, v235, v235 row_mirror row_mask:0xf bank_mask:0xf
v_mov_b32 v236, v235
s_waitcnt lgkmcnt(1)
v_mfma_f32_32x32x16_bf16 v[160:175], v[88:91], a[56:59], v[160:175]
s_add_u32 m0, s3, 98304
s_mul_i32 s61, s55, 589824
s_add_u32 s61, s61, s42
buffer_load_dwordx4 v12, s[8:11], s61 offen lds
ds_read_b128 a[88:91], v79 offset:0
v_mfma_f32_32x32x16_bf16 v[176:191], v[88:91], a[60:63], v[176:191]
buffer_load_dwordx4 v13, s[8:11], s61 offen offset:1024 lds
ds_read_b64_tr_b16 v[92:93], v6 offset:14336
ds_read_b64_tr_b16 v[94:95], v6 offset:14848
ds_read_b128 a[92:95], v79 offset:4096
v_permlane16_swap_b32 v235, v236
s_waitcnt lgkmcnt(1)
v_mfma_f32_32x32x16_bf16 v[192:207], v[92:95], a[56:59], v[192:207]
v_add_f32 v235, v235, v236
v_mul_f32 v235, 0x3ae38e39, v235
v_add_f32 v236, 0x3727c5ac, v235
v_rsq_f32 v253, v236
s_nop 0
v_mul_f32 v235, v235, v253
v_mul_f32 v235, v235, v253
v_add_f32 v235, 0x3727c5ac, v235
v_mfma_f32_32x32x16_bf16 v[208:223], v[92:95], a[60:63], v[208:223]
ds_read_b64_tr_b16 v[80:81], v3 offset:16384
ds_read_b64_tr_b16 v[82:83], v3 offset:16896
v_rsq_f32 v254, v235
v_mov_b32 v255, s45
v_lshlrev_b32 v237, 4, v233
v_mov_b32 v238, 0x80000000
s_waitcnt lgkmcnt(0)
v_mfma_f32_32x32x16_bf16 v[160:175], v[80:83], a[64:67], v[160:175]
s_add_u32 m0, s43, 0
s_lshl_b32 s99, s55, 7
s_add_u32 s99, s99, s40
buffer_load_dwordx4 v72, s[4:7], s99 offen offset:0 lds
v_mfma_f32_32x32x16_bf16 v[176:191], v[80:83], a[68:71], v[176:191]
buffer_load_dwordx4 v73, s[4:7], s99 offen offset:1024 lds
ds_read_b64_tr_b16 v[84:85], v6 offset:16384
ds_read_b64_tr_b16 v[86:87], v6 offset:16896
s_waitcnt lgkmcnt(0)
v_mfma_f32_32x32x16_bf16 v[192:207], v[84:87], a[64:67], v[192:207]
v_cmp_eq_u32 vcc, 0, v234
s_mov_b32 s71, 65536
s_nop 0
v_cndmask_b32 v237, v238, v237, vcc
buffer_store_dwordx4 v[252:255], v237, s[16:19], s71 offen sc1
v_lshlrev_b32 v242, 16, v36
v_and_b32 v36, 0xffff0000, v36
v_lshlrev_b32 v243, 16, v37
v_and_b32 v37, 0xffff0000, v37
v_lshlrev_b32 v244, 16, v38
v_mfma_f32_32x32x16_bf16 v[208:223], v[84:87], a[68:71], v[208:223]
buffer_load_dwordx4 v74, s[4:7], s99 offen offset:2048 lds
ds_read_b64_tr_b16 v[88:89], v3 offset:18432
ds_read_b64_tr_b16 v[90:91], v3 offset:18944
v_and_b32 v38, 0xffff0000, v38
v_lshlrev_b32 v245, 16, v39
s_waitcnt lgkmcnt(0)
v_mfma_f32_32x32x16_bf16 v[160:175], v[88:91], a[72:75], v[160:175]
buffer_load_dwordx4 v75, s[4:7], s99 offen offset:3072 lds
v_and_b32 v39, 0xffff0000, v39
v_lshlrev_b32 v246, 16, v40
v_and_b32 v40, 0xffff0000, v40
v_lshlrev_b32 v247, 16, v41
v_mfma_f32_32x32x16_bf16 v[176:191], v[88:91], a[76:79], v[176:191]
ds_read_b64_tr_b16 v[92:93], v6 offset:18432
ds_read_b64_tr_b16 v[94:95], v6 offset:18944
v_and_b32 v41, 0xffff0000, v41
v_lshlrev_b32 v248, 16, v42
v_and_b32 v42, 0xffff0000, v42
v_lshlrev_b32 v249, 16, v43
v_and_b32 v43, 0xffff0000, v43
v_lshlrev_b32 v250, 16, v44
v_and_b32 v44, 0xffff0000, v44
s_waitcnt lgkmcnt(0)
v_mfma_f32_32x32x16_bf16 v[192:207], v[92:95], a[72:75], v[192:207]
s_add_u32 m0, s43, 4096
s_add_u32 s99, s99, 18432
buffer_load_dwordx4 v72, s[4:7], s99 offen offset:0 lds
s_waitcnt vmcnt(8)
s_barrier
ds_read_b128 a[96:99], v76 offset:8192
v_mfma_f32_32x32x16_bf16 v[208:223], v[92:95], a[76:79], v[208:223]
buffer_load_dwordx4 v73, s[4:7], s99 offen offset:1024 lds
ds_read_b64_tr_b16 v[80:81], v3 offset:20480
ds_read_b64_tr_b16 v[82:83], v3 offset:20992
ds_read_b128 a[100:103], v76 offset:12288
v_add_f32 v235, v242, v243
s_waitcnt lgkmcnt(1)
v_mfma_f32_32x32x16_bf16 v[160:175], v[80:83], a[80:83], v[160:175]
ds_read_b128 a[104:107], v77 offset:8192
v_add_f32 v236, v36, v37
v_add_f32 v235, v235, v244
v_add_f32 v236, v236, v38
v_add_f32 v235, v235, v245
v_add_f32 v236, v236, v39
v_add_f32 v235, v235, v246
v_add_f32 v236, v236, v40
v_mfma_f32_32x32x16_bf16 v[176:191], v[80:83], a[84:87], v[176:191]
buffer_load_dwordx4 v74, s[4:7], s99 offen offset:2048 lds
ds_read_b64_tr_b16 v[84:85], v6 offset:20480
ds_read_b64_tr_b16 v[86:87], v6 offset:20992
ds_read_b128 a[108:111], v77 offset:12288
v_add_f32 v235, v235, v247
s_waitcnt lgkmcnt(1)
v_mfma_f32_32x32x16_bf16 v[192:207], v[84:87], a[80:83], v[192:207]
buffer_load_dwordx4 v75, s[4:7], s99 offen offset:3072 lds
ds_read_b128 a[112:115], v78 offset:8192
v_add_f32 v236, v236, v41
v_add_f32 v235, v235, v248
v_add_f32 v236, v236, v42
v_mfma_f32_32x32x16_bf16 v[208:223], v[84:87], a[84:87], v[208:223]
ds_read_b64_tr_b16 v[88:89], v3 offset:22528
ds_read_b64_tr_b16 v[90:91], v3 offset:23040
ds_read_b128 a[116:119], v78 offset:12288
v_add_f32 v235, v235, v249
v_add_f32 v236, v236, v43
v_add_f32 v235, v235, v250
v_add_f32 v236, v236, v44
v_add_f32 v36, v235, v236
s_waitcnt lgkmcnt(1)
v_mfma_f32_32x32x16_bf16 v[160:175], v[88:91], a[88:91], v[160:175]
s_add_u32 m0, s3, 65536
s_mul_i32 s61, s56, 589824
s_add_u32 s61, s61, s42
buffer_load_dwordx4 v12, s[8:11], s61 offen lds
ds_read_b128 a[120:123], v79 offset:8192
v_add_f32_dpp v36, v36, v36 quad_perm:[1,0,3,2] row_mask:0xf bank_mask:0xf
v_mfma_f32_32x32x16_bf16 v[176:191], v[88:91], a[92:95], v[176:191]
buffer_load_dwordx4 v13, s[8:11], s61 offen offset:1024 lds
ds_read_b64_tr_b16 v[92:93], v6 offset:22528
ds_read_b64_tr_b16 v[94:95], v6 offset:23040
ds_read_b128 a[124:127], v79 offset:12288
v_add_f32_dpp v36, v36, v36 quad_perm:[2,3,0,1] row_mask:0xf bank_mask:0xf
s_waitcnt lgkmcnt(1)
v_mfma_f32_32x32x16_bf16 v[192:207], v[92:95], a[88:91], v[192:207]
v_add_f32_dpp v36, v36, v36 row_half_mirror row_mask:0xf bank_mask:0xf
s_nop 1
v_add_f32_dpp v36, v36, v36 row_mirror row_mask:0xf bank_mask:0xf
v_mov_b32 v236, v36
s_nop 1
v_permlane16_swap_b32 v36, v236
v_add_f32 v36, v36, v236
v_mov_b32 v37, s45
v_lshrrev_b32 v237, 1, v237
v_mfma_f32_32x32x16_bf16 v[208:223], v[92:95], a[92:95], v[208:223]
ds_read_b64_tr_b16 v[80:81], v3 offset:24576
ds_read_b64_tr_b16 v[82:83], v3 offset:25088
v_cmp_gt_u32 vcc, 1152, v233
s_mov_b32 s71, 139264
s_nop 0
v_cndmask_b32 v237, v238, v237, vcc
buffer_store_dwordx2 v[36:37], v237, s[16:19], s71 offen sc1
s_waitcnt lgkmcnt(0)
v_mfma_f32_32x32x16_bf16 v[160:175], v[80:83], a[96:99], v[160:175]
s_add_u32 m0, s43, 8192
s_lshl_b32 s99, s56, 7
s_add_u32 s99, s99, s40
buffer_load_dwordx4 v72, s[4:7], s99 offen offset:0 lds
v_mfma_f32_32x32x16_bf16 v[176:191], v[80:83], a[100:103], v[176:191]
buffer_load_dwordx4 v73, s[4:7], s99 offen offset:1024 lds
ds_read_b64_tr_b16 v[84:85], v6 offset:24576
ds_read_b64_tr_b16 v[86:87], v6 offset:25088
s_waitcnt lgkmcnt(0)
v_mfma_f32_32x32x16_bf16 v[192:207], v[84:87], a[96:99], v[192:207]
buffer_load_dwordx4 v74, s[4:7], s99 offen offset:2048 lds
v_mfma_f32_32x32x16_bf16 v[208:223], v[84:87], a[100:103], v[208:223]
buffer_load_dwordx4 v75, s[4:7], s99 offen offset:3072 lds
ds_read_b64_tr_b16 v[88:89], v3 offset:26624
ds_read_b64_tr_b16 v[90:91], v3 offset:27136
s_waitcnt lgkmcnt(0)
v_mfma_f32_32x32x16_bf16 v[160:175], v[88:91], a[104:107], v[160:175]
v_mfma_f32_32x32x16_bf16 v[176:191], v[88:91], a[108:111], v[176:191]
s_add_u32 m0, s43, 12288
s_add_u32 s99, s99, 18432
buffer_load_dwordx4 v72, s[4:7], s99 offen offset:0 lds
ds_read_b64_tr_b16 v[92:93], v6 offset:26624
ds_read_b64_tr_b16 v[94:95], v6 offset:27136
s_waitcnt lgkmcnt(0)
v_mfma_f32_32x32x16_bf16 v[192:207], v[92:95], a[104:107], v[192:207]
buffer_load_dwordx4 v73, s[4:7], s99 offen offset:1024 lds
s_waitcnt vmcnt(9)
s_barrier
ds_read_b128 a[128:131], v76 offset:0
v_mfma_f32_32x32x16_bf16 v[208:223], v[92:95], a[108:111], v[208:223]
buffer_load_dwordx4 v74, s[4:7], s99 offen offset:2048 lds
ds_read_b64_tr_b16 v[80:81], v3 offset:28672
ds_read_b64_tr_b16 v[82:83], v3 offset:29184
ds_read_b128 a[132:135], v76 offset:4096
s_waitcnt lgkmcnt(1)
v_mfma_f32_32x32x16_bf16 v[160:175], v[80:83], a[112:115], v[160:175]
buffer_load_dwordx4 v75, s[4:7], s99 offen offset:3072 lds
ds_read_b128 a[136:139], v77 offset:0
v_mfma_f32_32x32x16_bf16 v[176:191], v[80:83], a[116:119], v[176:191]
ds_read_b64_tr_b16 v[84:85], v6 offset:28672
ds_read_b64_tr_b16 v[86:87], v6 offset:29184
ds_read_b128 a[140:143], v77 offset:4096
s_waitcnt lgkmcnt(1)
v_mfma_f32_32x32x16_bf16 v[192:207], v[84:87], a[112:115], v[192:207]
s_add_u32 m0, s3, 106496
s_mul_i32 s61, s50, 589824
s_add_u32 s61, s61, s100
buffer_load_dwordx4 v12, s[8:11], s61 offen lds
ds_read_b128 a[144:147], v78 offset:0
v_mfma_f32_32x32x16_bf16 v[208:223], v[84:87], a[116:119], v[208:223]
buffer_load_dwordx4 v13, s[8:11], s61 offen offset:1024 lds
ds_read_b64_tr_b16 v[88:89], v3 offset:30720
ds_read_b64_tr_b16 v[90:91], v3 offset:31232
ds_read_b128 a[148:151], v78 offset:4096
s_waitcnt lgkmcnt(1)
v_mfma_f32_32x32x16_bf16 v[160:175], v[88:91], a[120:123], v[160:175]
s_add_u32 m0, s3, 73728
s_mul_i32 s61, s57, 589824
s_add_u32 s61, s61, s42
buffer_load_dwordx4 v12, s[8:11], s61 offen lds
ds_read_b128 a[152:155], v79 offset:0
v_mfma_f32_32x32x16_bf16 v[176:191], v[88:91], a[124:127], v[176:191]
buffer_load_dwordx4 v13, s[8:11], s61 offen offset:1024 lds
ds_read_b64_tr_b16 v[92:93], v6 offset:30720
ds_read_b64_tr_b16 v[94:95], v6 offset:31232
ds_read_b128 a[156:159], v79 offset:4096
s_waitcnt lgkmcnt(1)
v_mfma_f32_32x32x16_bf16 v[192:207], v[92:95], a[120:123], v[192:207]
v_mfma_f32_32x32x16_bf16 v[208:223], v[92:95], a[124:127], v[208:223]
ds_read_b64_tr_b16 v[80:81], v3 offset:32768
ds_read_b64_tr_b16 v[82:83], v3 offset:33280
s_waitcnt lgkmcnt(0)
v_mfma_f32_32x32x16_bf16 v[160:175], v[80:83], a[128:131], v[160:175]
s_add_u32 m0, s43, 0
s_lshl_b32 s99, s57, 7
s_add_u32 s99, s99, s40
buffer_load_dwordx4 v72, s[4:7], s99 offen offset:0 lds
v_mfma_f32_32x32x16_bf16 v[176:191], v[80:83], a[132:135], v[176:191]
buffer_load_dwordx4 v73, s[4:7], s99 offen offset:1024 lds
ds_read_b64_tr_b16 v[84:85], v6 offset:32768
ds_read_b64_tr_b16 v[86:87], v6 offset:33280
v_bfe_u32 v243, v0, 2, 1
s_waitcnt lgkmcnt(0)
v_mfma_f32_32x32x16_bf16 v[192:207], v[84:87], a[128:131], v[192:207]
buffer_load_dwordx4 v74, s[4:7], s99 offen offset:2048 lds
v_lshlrev_b32 v243, 5, v243
v_bfe_u32 v235, v0, 3, 2
v_lshl_add_u32 v243, v235, 2, v243
v_mfma_f32_32x32x16_bf16 v[208:223], v[84:87], a[132:135], v[208:223]
buffer_load_dwordx4 v75, s[4:7], s99 offen offset:3072 lds
ds_read_b64_tr_b16 v[88:89], v3 offset:34816
ds_read_b64_tr_b16 v[90:91], v3 offset:35328
v_and_b32 v235, 3, v0
v_add_u32 v243, v243, v235
s_waitcnt lgkmcnt(0)
v_mfma_f32_32x32x16_bf16 v[160:175], v[88:91], a[136:139], v[160:175]
s_lshl_b32 s71, s44, 6
v_add_u32 v243, s71, v243
s_lshl_b32 s71, s46, 12
s_add_u32 s71, s71, 65536
v_lshlrev_b32 v242, 4, v243
v_add_u32 v242, s71, v242
v_mfma_f32_32x32x16_bf16 v[176:191], v[88:91], a[140:143], v[176:191]
s_add_u32 m0, s43, 4096
s_add_u32 s99, s99, 18432
buffer_load_dwordx4 v72, s[4:7], s99 offen offset:0 lds
ds_read_b64_tr_b16 v[92:93], v6 offset:34816
ds_read_b64_tr_b16 v[94:95], v6 offset:35328
s_waitcnt lgkmcnt(0)
v_mfma_f32_32x32x16_bf16 v[192:207], v[92:95], a[136:139], v[192:207]
buffer_load_dwordx4 v73, s[4:7], s99 offen offset:1024 lds
s_waitcnt vmcnt(8)
s_barrier
ds_read_b128 a[160:163], v76 offset:8192
v_mfma_f32_32x32x16_bf16 v[208:223], v[92:95], a[140:143], v[208:223]
buffer_load_dwordx4 v74, s[4:7], s99 offen offset:2048 lds
ds_read_b64_tr_b16 v[80:81], v3 offset:36864
ds_read_b64_tr_b16 v[82:83], v3 offset:37376
ds_read_b128 a[164:167], v76 offset:12288
s_waitcnt lgkmcnt(1)
v_mfma_f32_32x32x16_bf16 v[160:175], v[80:83], a[144:147], v[160:175]
buffer_load_dwordx4 v75, s[4:7], s99 offen offset:3072 lds
ds_read_b128 a[168:171], v77 offset:8192
buffer_load_dwordx4 v[244:247], v242, s[16:19], 0 offen offset:0 sc1
v_mfma_f32_32x32x16_bf16 v[176:191], v[80:83], a[148:151], v[176:191]
ds_read_b64_tr_b16 v[84:85], v6 offset:36864
ds_read_b64_tr_b16 v[86:87], v6 offset:37376
ds_read_b128 a[172:175], v77 offset:12288
buffer_load_dwordx4 v[248:251], v242, s[16:19], 0 offen offset:256 sc1
s_waitcnt lgkmcnt(1)
v_mfma_f32_32x32x16_bf16 v[192:207], v[84:87], a[144:147], v[192:207]
s_add_u32 m0, s3, 114688
s_mul_i32 s61, s52, 589824
s_add_u32 s61, s61, s100
buffer_load_dwordx4 v12, s[8:11], s61 offen lds
ds_read_b128 a[176:179], v78 offset:8192
v_mfma_f32_32x32x16_bf16 v[208:223], v[84:87], a[148:151], v[208:223]
buffer_load_dwordx4 v13, s[8:11], s61 offen offset:1024 lds
ds_read_b64_tr_b16 v[88:89], v3 offset:38912
ds_read_b64_tr_b16 v[90:91], v3 offset:39424
ds_read_b128 a[180:183], v78 offset:12288
s_waitcnt lgkmcnt(1)
v_mfma_f32_32x32x16_bf16 v[160:175], v[88:91], a[152:155], v[160:175]
s_add_u32 m0, s3, 81920
s_mul_i32 s61, s58, 589824
s_add_u32 s61, s61, s42
buffer_load_dwordx4 v12, s[8:11], s61 offen lds
ds_read_b128 a[184:187], v79 offset:8192
v_mfma_f32_32x32x16_bf16 v[176:191], v[88:91], a[156:159], v[176:191]
buffer_load_dwordx4 v13, s[8:11], s61 offen offset:1024 lds
ds_read_b64_tr_b16 v[92:93], v6 offset:38912
ds_read_b64_tr_b16 v[94:95], v6 offset:39424
ds_read_b128 a[188:191], v79 offset:12288
s_waitcnt lgkmcnt(1)
v_mfma_f32_32x32x16_bf16 v[192:207], v[92:95], a[152:155], v[192:207]
s_mul_i32 s41, s49, 703744
s_add_u32 s72, s41, 1048576
s_mul_i32 s92, s44, 175616
s_add_u32 s41, s72, s92
s_mul_i32 s92, s48, 4864
v_mfma_f32_32x32x16_bf16 v[208:223], v[92:95], a[156:159], v[208:223]
ds_read_b64_tr_b16 v[80:81], v3 offset:0
ds_read_b64_tr_b16 v[82:83], v3 offset:512
s_add_u32 s41, s41, s92
s_lshl_b32 s73, s49, 9
s_add_u32 s73, s73, 4096
s_lshl_b32 s92, s44, 7
s_lshl_b32 s63, s46, 2
s_add_u32 s63, s63, s44
s_mul_i32 s63, s63, 18
v_min_u32 v45, 17, v0
v_add_u32 v45, s63, v45
v_lshlrev_b32 v46, 7, v45
s_mul_i32 s62, s101, 576
s_sub_u32 s62, s62, 3096576
buffer_load_dword v47, v46, s[12:15], s62 offen
s_waitcnt lgkmcnt(0)
v_mfma_f32_32x32x16_bf16 v[160:175], v[80:83], a[160:163], v[160:175]
ds_read_b64_tr_b16 v[84:85], v6 offset:0
ds_read_b64_tr_b16 v[86:87], v6 offset:512
s_add_u32 m0, s43, 8192
s_lshl_b32 s99, s58, 7
s_add_u32 s99, s99, s40
buffer_load_dwordx4 v72, s[4:7], s99 offen offset:0 lds
v_mfma_f32_32x32x16_bf16 v[176:191], v[80:83], a[164:167], v[176:191]
ds_read_b64_tr_b16 v[88:89], v3 offset:40960
ds_read_b64_tr_b16 v[90:91], v3 offset:41472
s_add_u32 s60, s73, s92
s_lshl_b32 s92, s48, 2
s_add_u32 s60, s60, s92
s_waitcnt lgkmcnt(2)
v_mfma_f32_32x32x16_bf16 v[192:207], v[84:87], a[160:163], v[192:207]
buffer_load_dwordx4 v73, s[4:7], s99 offen offset:1024 lds
ds_read_b64_tr_b16 v[92:93], v6 offset:40960
ds_read_b64_tr_b16 v[94:95], v6 offset:41472
v_mfma_f32_32x32x16_bf16 v[208:223], v[84:87], a[164:167], v[208:223]
ds_read_b64_tr_b16 v[80:81], v3 offset:2048
ds_read_b64_tr_b16 v[82:83], v3 offset:2560
s_waitcnt lgkmcnt(2)
s_cmp_ge_u32 s48, 3
s_cselect_b32 s92, 3, 0
s_cselect_b32 s93, 4, 0
v_mfma_f32_32x32x16_bf16 v[96:111], v[88:91], a[0:3], 0
ds_read_b64_tr_b16 v[84:85], v6 offset:2048
s_sub_u32 s88, s48, s92
s_add_u32 s93, s93, s44
s_mul_i32 s92, s93, 87808
s_add_u32 s72, s72, s92
v_mfma_f32_32x32x16_bf16 v[112:127], v[88:91], a[4:7], 0
buffer_load_dwordx4 v74, s[4:7], s99 offen offset:2048 lds
ds_read_b64_tr_b16 v[86:87], v6 offset:2560
s_lshr_b32 s93, s93, 1
v_mfma_f32_32x32x16_bf16 v[128:143], v[92:95], a[0:3], 0
ds_read_b64_tr_b16 v[88:89], v3 offset:43008
s_lshl_b32 s93, s93, 7
s_add_u32 s73, s73, s93
s_mul_i32 s92, s88, 384
s_lshl_b32 s93, s47, 1
v_mfma_f32_32x32x16_bf16 v[144:159], v[92:95], a[4:7], 0
buffer_load_dwordx4 v75, s[4:7], s99 offen offset:3072 lds
ds_read_b64_tr_b16 v[90:91], v3 offset:43520
s_waitcnt lgkmcnt(2)
v_mfma_f32_32x32x16_bf16 v[160:175], v[80:83], a[168:171], v[160:175]
ds_read_b64_tr_b16 v[92:93], v6 offset:43008
s_sub_u32 s93, s93, s51
s_add_u32 s93, s93, 34
s_mul_i32 s93, s93, 73728
s_add_u32 s97, s93, s92
v_mfma_f32_32x32x16_bf16 v[176:191], v[80:83], a[172:175], v[176:191]
ds_read_b64_tr_b16 v[94:95], v6 offset:43520
s_mul_i32 s93, s47, 442368
s_add_u32 s89, s93, s92
s_mul_i32 s77, s88, 221184
s_lshl_b32 s93, s47, 8
s_add_u32 s77, s77, s93
v_mfma_f32_32x32x16_bf16 v[192:207], v[84:87], a[168:171], v[192:207]
s_add_u32 m0, s43, 12288
s_add_u32 s99, s99, 18432
buffer_load_dwordx4 v72, s[4:7], s99 offen offset:0 lds
ds_read_b64_tr_b16 v[80:81], v3 offset:4096
v_mfma_f32_32x32x16_bf16 v[208:223], v[84:87], a[172:175], v[208:223]
ds_read_b64_tr_b16 v[82:83], v3 offset:4608
s_waitcnt lgkmcnt(2)
s_add_u32 s92, s77, 128
s_sub_u32 s93, s97, 147456
s_sub_u32 s75, s97, 73728
v_mfma_f32_32x32x16_bf16 v[96:111], v[88:91], a[8:11], v[96:111]
buffer_load_dwordx4 v73, s[4:7], s99 offen offset:1024 lds
ds_read_b64_tr_b16 v[84:85], v6 offset:4096
s_mov_b32 s76, 128
v_mfma_f32_32x32x16_bf16 v[112:127], v[88:91], a[12:15], v[112:127]
ds_read_b64_tr_b16 v[86:87], v6 offset:4608
s_cmp_lt_u32 s47, 4
s_cselect_b32 s74, s92, s93
s_cselect_b32 s75, s92, s75
s_cselect_b32 s76, 73728, s76
v_mfma_f32_32x32x16_bf16 v[128:143], v[92:95], a[8:11], v[128:143]
ds_read_b64_tr_b16 v[88:89], v3 offset:45056
s_mul_i32 s92, s46, 6
s_add_u32 s92, s92, s48
s_mul_i32 s95, s92, 271360
s_add_u32 s95, s95, 33554432
s_lshl_b32 s93, s47, 2
v_mfma_f32_32x32x16_bf16 v[144:159], v[92:95], a[12:15], v[144:159]
buffer_load_dwordx4 v74, s[4:7], s99 offen offset:2048 lds
ds_read_b64_tr_b16 v[90:91], v3 offset:45568
s_waitcnt lgkmcnt(2)
v_mfma_f32_32x32x16_bf16 v[160:175], v[80:83], a[176:179], v[160:175]
ds_read_b64_tr_b16 v[92:93], v6 offset:45056
s_add_u32 s93, s93, s44
s_mul_i32 s93, s93, 13568
s_add_u32 s82, s95, s93
s_mul_i32 s93, s47, 13568
v_mfma_f32_32x32x16_bf16 v[176:191], v[80:83], a[180:183], v[176:191]
ds_read_b64_tr_b16 v[94:95], v6 offset:45568
s_add_u32 s95, s95, s93
s_lshl_b32 s92, s92, 9
s_add_u32 s92, s92, 32768
s_lshl_b32 s93, s47, 7
v_mfma_f32_32x32x16_bf16 v[192:207], v[84:87], a[176:179], v[192:207]
buffer_load_dwordx4 v75, s[4:7], s99 offen offset:3072 lds
ds_read_b64_tr_b16 v[80:81], v3 offset:6144
s_add_u32 s96, s92, s93
v_mfma_f32_32x32x16_bf16 v[208:223], v[84:87], a[180:183], v[208:223]
ds_read_b64_tr_b16 v[82:83], v3 offset:6656
s_waitcnt lgkmcnt(2)
s_lshl_b32 s93, s44, 7
s_add_u32 s94, s92, s93
s_lshl_b32 s93, s47, 2
v_mfma_f32_32x32x16_bf16 v[96:111], v[88:91], a[16:19], v[96:111]
s_add_u32 m0, s3, 122880
s_mul_i32 s61, s53, 589824
s_add_u32 s61, s61, s100
buffer_load_dwordx4 v12, s[8:11], s61 offen lds
ds_read_b64_tr_b16 v[84:85], v6 offset:6144
v_mfma_f32_32x32x16_bf16 v[112:127], v[88:91], a[20:23], v[112:127]
ds_read_b64_tr_b16 v[86:87], v6 offset:6656
s_add_u32 s94, s94, s93
v_and_b32 v63, 16, v0
v_bfe_u32 v62, v0, 5, 1
v_lshl_add_u32 v63, v62, 2, v63
v_bfe_u32 v62, v0, 2, 2
v_mfma_f32_32x32x16_bf16 v[128:143], v[92:95], a[16:19], v[128:143]
ds_read_b64_tr_b16 v[88:89], v3 offset:47104
s_waitcnt vmcnt(12)
s_barrier
ds_read_b128 a[192:195], v76 offset:0
v_add_u32 v63, v63, v62
v_mfma_f32_32x32x16_bf16 v[144:159], v[92:95], a[20:23], v[144:159]
buffer_load_dwordx4 v13, s[8:11], s61 offen offset:1024 lds
ds_read_b64_tr_b16 v[90:91], v3 offset:47616
s_waitcnt lgkmcnt(3)
ds_read_b128 a[196:199], v76 offset:4096
v_mfma_f32_32x32x16_bf16 v[160:175], v[80:83], a[184:187], v[160:175]
ds_read_b64_tr_b16 v[92:93], v6 offset:47104
ds_read_b128 a[200:203], v77 offset:0
v_lshlrev_b32 v63, 7, v63
v_bfe_u32 v62, v0, 3, 2
v_lshl_add_u32 v63, v62, 5, v63
v_and_b32 v62, 3, v0
v_mfma_f32_32x32x16_bf16 v[176:191], v[80:83], a[188:191], v[176:191]
s_add_u32 m0, s3, 90112
s_mul_i32 s61, s59, 589824
s_add_u32 s61, s61, s42
buffer_load_dwordx4 v12, s[8:11], s61 offen lds
ds_read_b64_tr_b16 v[94:95], v6 offset:47616
ds_read_b128 a[204:207], v77 offset:4096
v_mfma_f32_32x32x16_bf16 v[192:207], v[84:87], a[184:187], v[192:207]
ds_read_b64_tr_b16 v[80:81], v3 offset:8192
ds_read_b128 a[208:211], v78 offset:0
v_lshl_add_u32 v52, v62, 3, v63
v_xor_b32 v55, 32, v52
v_xor_b32 v58, 64, v52
v_mfma_f32_32x32x16_bf16 v[208:223], v[84:87], a[188:191], v[208:223]
ds_read_b64_tr_b16 v[82:83], v3 offset:8704
s_waitcnt lgkmcnt(4)
ds_read_b128 a[212:215], v78 offset:4096
v_xor_b32 v61, 96, v52
v_add_u32 v53, 65536, v52
v_mfma_f32_32x32x16_bf16 v[96:111], v[88:91], a[24:27], v[96:111]
buffer_load_dwordx4 v13, s[8:11], s61 offen offset:1024 lds
ds_read_b64_tr_b16 v[84:85], v6 offset:8192
ds_read_b128 a[216:219], v79 offset:0
v_mfma_f32_32x32x16_bf16 v[112:127], v[88:91], a[28:31], v[112:127]
ds_read_b64_tr_b16 v[86:87], v6 offset:8704
ds_read_b128 a[220:223], v79 offset:4096
v_add_u32 v54, 131072, v52
v_add_u32 v56, 65536, v55
v_add_u32 v57, 131072, v55
v_add_u32 v59, 65536, v58
v_mfma_f32_32x32x16_bf16 v[128:143], v[92:95], a[24:27], v[128:143]
ds_read_b64_tr_b16 v[88:89], v3 offset:49152
v_add_u32 v60, 131072, v58
v_add_u32 v62, 65536, v61
v_add_u32 v63, 131072, v61
v_mfma_f32_32x32x16_bf16 v[144:159], v[92:95], a[28:31], v[144:159]
ds_read_b64_tr_b16 v[90:91], v3 offset:49664
s_waitcnt lgkmcnt(3)
s_lshl_b32 s92, s44, 4
v_lshrrev_b32 v15, 3, v0
v_add_u32 v15, s92, v15
v_mul_u32_u24 v15, 1152, v15
v_and_b32 v19, 7, v0
s_lshl_b32 s63, s46, 2
s_add_u32 s63, s63, s44
s_mul_i32 s63, s63, 18
v_min_u32 v45, 17, v0
v_add_u32 v45, s63, v45
v_mul_u32_u24 v46, 9216, v45
buffer_load_dword v47, v46, s[8:11], s101 offen
v_mfma_f32_32x32x16_bf16 v[160:175], v[80:83], a[192:195], v[160:175]
ds_read_b64_tr_b16 v[92:93], v6 offset:49152
s_waitcnt lgkmcnt(3)
s_add_u32 m0, s43, 0
s_lshl_b32 s99, s59, 7
s_add_u32 s99, s99, s40
buffer_load_dwordx4 v72, s[4:7], s99 offen offset:0 lds
v_mfma_f32_32x32x16_bf16 v[176:191], v[80:83], a[196:199], v[176:191]
ds_read_b64_tr_b16 v[94:95], v6 offset:49664
v_bfe_u32 v18, v0, 4, 1
v_lshlrev_b32 v18, 1, v18
v_xor_b32 v18, v18, v19
v_mfma_f32_32x32x16_bf16 v[192:207], v[84:87], a[192:195], v[192:207]
buffer_load_dwordx4 v73, s[4:7], s99 offen offset:1024 lds
ds_read_b64_tr_b16 v[80:81], v3 offset:10240
v_mfma_f32_32x32x16_bf16 v[208:223], v[84:87], a[196:199], v[208:223]
ds_read_b64_tr_b16 v[82:83], v3 offset:10752
L_stub1:
s_cbranch_execz L_stub5
s_waitcnt lgkmcnt(2)
s_and_b32 s93, s44, 1
s_lshl_b32 s93, s93, 2
v_xor_b32 v18, s93, v18
v_lshl_add_u32 v14, v18, 4, v15
v_add_u32 v15, 8192, v14
v_mfma_f32_32x32x16_bf16 v[96:111], v[88:91], a[32:35], v[96:111]
ds_read_b64_tr_b16 v[84:85], v6 offset:10240
v_mfma_f32_32x32x16_bf16 v[112:127], v[88:91], a[36:39], v[112:127]
buffer_load_dwordx4 v74, s[4:7], s99 offen offset:2048 lds
ds_read_b64_tr_b16 v[86:87], v6 offset:10752
v_mfma_f32_32x32x16_bf16 v[128:143], v[92:95], a[32:35], v[128:143]
ds_read_b64_tr_b16 v[88:89], v3 offset:51200
v_cmp_ne_u32 vcc, s45, v247
v_cmp_ne_u32 s[64:65], s45, v251
s_nop 0
s_or_b64 vcc, vcc, s[64:65]
s_cbranch_scc1 stM_slow
stM_ok:
v_mfma_f32_32x32x16_bf16 v[144:159], v[92:95], a[36:39], v[144:159]
buffer_load_dwordx4 v75, s[4:7], s99 offen offset:3072 lds
ds_read_b64_tr_b16 v[90:91], v3 offset:51712
s_waitcnt lgkmcnt(2)
v_mfma_f32_32x32x16_bf16 v[160:175], v[80:83], a[200:203], v[160:175]
ds_read_b64_tr_b16 v[92:93], v6 offset:51200
v_lshlrev_b32 v243, 2, v243
v_add_u32 v243, 155648, v243
v_mfma_f32_32x32x16_bf16 v[176:191], v[80:83], a[204:207], v[176:191]
ds_read_b64_tr_b16 v[94:95], v6 offset:51712
v_cmp_gt_u32 vcc, 32, v0
ds_write_b32 v243, v245 offset:0
ds_write_b32 v243, v244 offset:1024
v_mfma_f32_32x32x16_bf16 v[192:207], v[84:87], a[200:203], v[192:207]
s_add_u32 m0, s43, 4096
s_add_u32 s99, s99, 18432
buffer_load_dwordx4 v72, s[4:7], s99 offen offset:0 lds
ds_read_b64_tr_b16 v[80:81], v3 offset:12288
v_mfma_f32_32x32x16_bf16 v[208:223], v[84:87], a[204:207], v[208:223]
ds_read_b64_tr_b16 v[82:83], v3 offset:12800
s_waitcnt lgkmcnt(4)
v_mul_f32 v235, v245, v246
v_mfma_f32_32x32x16_bf16 v[96:111], v[88:91], a[40:43], v[96:111]
buffer_load_dwordx4 v73, s[4:7], s99 offen offset:1024 lds
ds_read_b64_tr_b16 v[84:85], v6 offset:12288
v_mfma_f32_32x32x16_bf16 v[112:127], v[88:91], a[44:47], v[112:127]
ds_read_b64_tr_b16 v[86:87], v6 offset:12800
v_rcp_f32 v24, v235
v_mfma_f32_32x32x16_bf16 v[128:143], v[92:95], a[40:43], v[128:143]
ds_read_b64_tr_b16 v[88:89], v3 offset:53248
v_mul_f32 v20, 0xc0135761, v235
v_mul_f32 v236, v235, v235
v_mfma_f32_32x32x16_bf16 v[144:159], v[92:95], a[44:47], v[144:159]
buffer_load_dwordx4 v74, s[4:7], s99 offen offset:2048 lds
ds_read_b64_tr_b16 v[90:91], v3 offset:53760
s_waitcnt lgkmcnt(2)
v_mfma_f32_32x32x16_bf16 v[160:175], v[80:83], a[208:211], v[160:175]
ds_read_b64_tr_b16 v[92:93], v6 offset:53248
v_mul_f32 v236, v236, v235
v_mul_f32 v22, 0xbdd2d3e8, v236
v_mfma_f32_32x32x16_bf16 v[176:191], v[80:83], a[212:215], v[176:191]
ds_read_b64_tr_b16 v[94:95], v6 offset:53760
v_cvt_pk_bf16_f32 v29, -v244, v24
v_lshlrev_b32 v235, 16, v29
v_mfma_f32_32x32x16_bf16 v[192:207], v[84:87], a[208:211], v[192:207]
buffer_load_dwordx4 v75, s[4:7], s99 offen offset:3072 lds
ds_read_b64_tr_b16 v[80:81], v3 offset:14336
v_mfma_f32_32x32x16_bf16 v[208:223], v[84:87], a[212:215], v[208:223]
ds_read_b64_tr_b16 v[82:83], v3 offset:14848
s_waitcnt lgkmcnt(2)
v_and_b32 v236, 0xffff0000, v29
v_sub_f32 v237, -v244, v235
v_mfma_f32_32x32x16_bf16 v[96:111], v[88:91], a[48:51], v[96:111]
s_add_u32 m0, s3, 131072
s_mul_i32 s61, s54, 589824
s_add_u32 s61, s61, s100
buffer_load_dwordx4 v12, s[8:11], s61 offen lds
ds_read_b64_tr_b16 v[84:85], v6 offset:14336
v_mfma_f32_32x32x16_bf16 v[112:127], v[88:91], a[52:55], v[112:127]
ds_read_b64_tr_b16 v[86:87], v6 offset:14848
v_sub_f32 v236, v24, v236
v_cvt_pk_bf16_f32 v28, v235, v237
v_mfma_f32_32x32x16_bf16 v[128:143], v[92:95], a[48:51], v[128:143]
ds_read_b64_tr_b16 v[88:89], v3 offset:55296
s_waitcnt vmcnt(12)
s_barrier
ds_read_b128 a[224:227], v76 offset:8192
v_mfma_f32_32x32x16_bf16 v[144:159], v[92:95], a[52:55], v[144:159]
buffer_load_dwordx4 v13, s[8:11], s61 offen offset:1024 lds
ds_read_b64_tr_b16 v[90:91], v3 offset:55808
s_waitcnt lgkmcnt(3)
ds_read_b128 a[228:231], v76 offset:12288
v_mfma_f32_32x32x16_bf16 v[160:175], v[80:83], a[216:219], v[160:175]
ds_read_b64_tr_b16 v[92:93], v6 offset:55296
ds_read_b128 a[232:235], v77 offset:8192
v_cvt_pk_bf16_f32 v30, v236, 0
v_mfma_f32_32x32x16_bf16 v[176:191], v[80:83], a[220:223], v[176:191]
s_add_u32 m0, s3, 139264
s_mul_i32 s61, s55, 589824
s_add_u32 s61, s61, s100
buffer_load_dwordx4 v12, s[8:11], s61 offen lds
ds_read_b64_tr_b16 v[94:95], v6 offset:55808
ds_read_b128 a[236:239], v77 offset:12288
v_mfma_f32_32x32x16_bf16 v[192:207], v[84:87], a[216:219], v[192:207]
ds_read_b64_tr_b16 v[80:81], v3 offset:16384
ds_read_b128 a[240:243], v78 offset:8192
v_cndmask_b32 v28, 0, v28, vcc
v_mfma_f32_32x32x16_bf16 v[208:223], v[84:87], a[220:223], v[208:223]
ds_read_b64_tr_b16 v[82:83], v3 offset:16896
s_waitcnt lgkmcnt(4)
ds_read_b128 a[244:247], v78 offset:12288
v_mfma_f32_32x32x16_bf16 v[96:111], v[88:91], a[56:59], v[96:111]
buffer_load_dwordx4 v13, s[8:11], s61 offen offset:1024 lds
ds_read_b64_tr_b16 v[84:85], v6 offset:16384
ds_read_b128 a[248:251], v79 offset:8192
v_mfma_f32_32x32x16_bf16 v[112:127], v[88:91], a[60:63], v[112:127]
ds_read_b64_tr_b16 v[86:87], v6 offset:16896
ds_read_b128 a[252:255], v79 offset:12288
v_cndmask_b32 v29, 0, v29, vcc
v_mfma_f32_32x32x16_bf16 v[128:143], v[92:95], a[56:59], v[128:143]
ds_read_b64_tr_b16 v[88:89], v3 offset:57344
v_cndmask_b32 v30, 0, v30, vcc
ds_write_b32 v243, v249 offset:64
ds_write_b32 v243, v248 offset:1088
s_lshl_b32 s63, s42, 2
s_add_u32 s63, s63, 98304
v_lshl_add_u32 v70, v0, 3, s63
buffer_load_dwordx2 v[68:69], v70, s[16:19], 0 offen sc1
v_mfma_f32_32x32x16_bf16 v[144:159], v[92:95], a[60:63], v[144:159]
ds_read_b64_tr_b16 v[90:91], v3 offset:57856
s_waitcnt lgkmcnt(5)
v_mul_f32 v235, v249, v250
s_lshl_b32 s63, s46, 2
s_add_u32 s63, s63, s44
s_mul_i32 s63, s63, 18
v_min_u32 v45, 17, v0
v_add_u32 v45, s63, v45
v_lshlrev_b32 v46, 7, v45
s_mul_i32 s62, s100, 576
buffer_load_dword v47, v46, s[12:15], s62 offen
v_mfma_f32_32x32x16_bf16 v[160:175], v[80:83], a[224:227], v[160:175]
s_add_u32 m0, s3, 147456
s_mul_i32 s61, s50, 589824
s_add_u32 s61, s61, s101
buffer_load_dwordx4 v12, s[8:11], s61 offen lds
ds_read_b64_tr_b16 v[92:93], v6 offset:57344
v_mfma_f32_32x32x16_bf16 v[176:191], v[80:83], a[228:231], v[176:191]
ds_read_b64_tr_b16 v[94:95], v6 offset:57856
v_rcp_f32 v25, v235
v_mfma_f32_32x32x16_bf16 v[192:207], v[84:87], a[224:227], v[192:207]
ds_read_b64_tr_b16 v[80:81], v3 offset:18432
v_mul_f32 v21, 0xc0135761, v235
v_mul_f32 v236, v235, v235
v_mfma_f32_32x32x16_bf16 v[208:223], v[84:87], a[228:231], v[208:223]
ds_read_b64_tr_b16 v[82:83], v3 offset:18944
s_waitcnt lgkmcnt(2)
v_mul_f32 v236, v236, v235
v_mfma_f32_32x32x16_bf16 v[96:111], v[88:91], a[64:67], v[96:111]
ds_read_b64_tr_b16 v[84:85], v6 offset:18432
v_mul_f32 v23, 0xbdd2d3e8, v236
v_cvt_pk_bf16_f32 v33, -v248, v25
v_mfma_f32_32x32x16_bf16 v[112:127], v[88:91], a[68:71], v[112:127]
ds_read_b64_tr_b16 v[86:87], v6 offset:18944
v_lshlrev_b32 v235, 16, v33
v_and_b32 v236, 0xffff0000, v33
v_sub_f32 v237, -v248, v235
v_mfma_f32_32x32x16_bf16 v[128:143], v[92:95], a[64:67], v[128:143]
ds_read_b64_tr_b16 v[88:89], v3 offset:59392
v_sub_f32 v236, v25, v236
v_cvt_pk_bf16_f32 v32, v235, v237
v_mfma_f32_32x32x16_bf16 v[144:159], v[92:95], a[68:71], v[144:159]
buffer_load_dwordx4 v13, s[8:11], s61 offen offset:1024 lds
ds_read_b64_tr_b16 v[90:91], v3 offset:59904
s_waitcnt lgkmcnt(2)
v_mfma_f32_32x32x16_bf16 v[160:175], v[80:83], a[232:235], v[160:175]
ds_read_b64_tr_b16 v[92:93], v6 offset:59392
v_cvt_pk_bf16_f32 v34, v236, 0
v_cndmask_b32 v32, 0, v32, vcc
v_mfma_f32_32x32x16_bf16 v[176:191], v[80:83], a[236:239], v[176:191]
ds_read_b64_tr_b16 v[94:95], v6 offset:59904
v_cndmask_b32 v33, 0, v33, vcc
v_cndmask_b32 v34, 0, v34, vcc
v_mfma_f32_32x32x16_bf16 v[192:207], v[84:87], a[232:235], v[192:207]
ds_read_b64_tr_b16 v[80:81], v3 offset:20480
s_cmp_ge_u32 s48, 3
s_cselect_b32 s92, 1, 0
v_mfma_f32_32x32x16_bf16 v[208:223], v[84:87], a[236:239], v[208:223]
ds_read_b64_tr_b16 v[82:83], v3 offset:20992
s_waitcnt lgkmcnt(2)
s_add_u32 s92, s92, s88
s_add_u32 s92, s92, s49
v_mfma_f32_32x32x16_bf16 v[96:111], v[88:91], a[72:75], v[96:111]
ds_read_b64_tr_b16 v[84:85], v6 offset:20480
s_mul_i32 s93, s92, 86
s_lshr_b32 s93, s93, 8
v_mfma_f32_32x32x16_bf16 v[112:127], v[88:91], a[76:79], v[112:127]
ds_read_b64_tr_b16 v[86:87], v6 offset:20992
s_mul_i32 s93, s93, 3
s_sub_u32 s92, s92, s93
v_mfma_f32_32x32x16_bf16 v[128:143], v[92:95], a[72:75], v[128:143]
ds_read_b64_tr_b16 v[88:89], v3 offset:61440
s_mul_i32 s93, s92, 4864
s_add_u32 s83, s72, s93
v_mfma_f32_32x32x16_bf16 v[144:159], v[92:95], a[76:79], v[144:159]
s_add_u32 m0, s3, 98304
s_mul_i32 s61, s52, 589824
s_add_u32 s61, s61, s101
buffer_load_dwordx4 v12, s[8:11], s61 offen lds
ds_read_b64_tr_b16 v[90:91], v3 offset:61952
s_waitcnt lgkmcnt(2)
v_mfma_f32_32x32x16_bf16 v[160:175], v[80:83], a[240:243], v[160:175]
ds_read_b64_tr_b16 v[92:93], v6 offset:61440
s_mul_i32 s93, s92, 73728
s_add_u32 s64, s89, s93
s_add_u32 s92, s92, 1
v_mfma_f32_32x32x16_bf16 v[176:191], v[80:83], a[244:247], v[176:191]
ds_read_b64_tr_b16 v[94:95], v6 offset:61952
s_cmp_eq_u32 s92, 3
s_cselect_b32 s92, 0, s92
v_mfma_f32_32x32x16_bf16 v[192:207], v[84:87], a[240:243], v[192:207]
ds_read_b64_tr_b16 v[80:81], v3 offset:22528
s_mul_i32 s93, s92, 4864
s_add_u32 s86, s72, s93
v_mfma_f32_32x32x16_bf16 v[208:223], v[84:87], a[244:247], v[208:223]
ds_read_b64_tr_b16 v[82:83], v3 offset:23040
s_waitcnt lgkmcnt(2)
s_mul_i32 s93, s92, 73728
v_mfma_f32_32x32x16_bf16 v[96:111], v[88:91], a[80:83], v[96:111]
ds_read_b64_tr_b16 v[84:85], v6 offset:22528
s_add_u32 s65, s89, s93
s_add_u32 s92, s92, 1
v_mfma_f32_32x32x16_bf16 v[112:127], v[88:91], a[84:87], v[112:127]
ds_read_b64_tr_b16 v[86:87], v6 offset:23040
s_cmp_eq_u32 s92, 3
s_cselect_b32 s92, 0, s92
s_mul_i32 s93, s92, 4864
v_mfma_f32_32x32x16_bf16 v[128:143], v[92:95], a[80:83], v[128:143]
ds_read_b64_tr_b16 v[88:89], v3 offset:63488
s_waitcnt vmcnt(7)
s_barrier
ds_read_b128 v[224:227], v76 offset:0
v_mfma_f32_32x32x16_bf16 v[144:159], v[92:95], a[84:87], v[144:159]
buffer_load_dwordx4 v13, s[8:11], s61 offen offset:1024 lds
ds_read_b64_tr_b16 v[90:91], v3 offset:64000
s_waitcnt lgkmcnt(3)
ds_read_b128 v[228:231], v76 offset:4096
v_mfma_f32_32x32x16_bf16 v[160:175], v[80:83], a[248:251], v[160:175]
ds_read_b64_tr_b16 v[92:93], v6 offset:63488
ds_read_b128 v[232:235], v77 offset:0
s_add_u32 s87, s72, s93
v_mfma_f32_32x32x16_bf16 v[176:191], v[80:83], a[252:255], v[176:191]
ds_read_b64_tr_b16 v[94:95], v6 offset:64000
ds_read_b128 v[236:239], v77 offset:4096
s_mul_i32 s93, s92, 73728
v_mfma_f32_32x32x16_bf16 v[192:207], v[84:87], a[248:251], v[192:207]
ds_read_b64_tr_b16 v[80:81], v3 offset:24576
ds_read_b128 v[240:243], v78 offset:0
s_add_u32 s40, s89, s93
v_and_b32 v31, 0xf0, v1
v_mfma_f32_32x32x16_bf16 v[208:223], v[84:87], a[252:255], v[208:223]
ds_read_b64_tr_b16 v[82:83], v3 offset:25088
s_waitcnt lgkmcnt(4)
ds_read_b128 v[244:247], v78 offset:4096
v_mfma_f32_32x32x16_bf16 v[96:111], v[88:91], a[88:91], v[96:111]
ds_read_b64_tr_b16 v[84:85], v6 offset:24576
ds_read_b128 v[248:251], v79 offset:0
v_and_b32 v51, 16, v0
v_mfma_f32_32x32x16_bf16 v[112:127], v[88:91], a[92:95], v[112:127]
ds_read_b64_tr_b16 v[86:87], v6 offset:25088
ds_read_b128 v[252:255], v79 offset:4096
v_lshl_add_u32 v31, v51, 6, v31
v_mfma_f32_32x32x16_bf16 v[128:143], v[92:95], a[88:91], v[128:143]
ds_read_b64_tr_b16 v[88:89], v4 offset:0
v_and_b32 v51, 32, v0
v_lshl_add_u32 v31, v51, 4, v31
s_mov_b32 s42, s45
v_mfma_f32_32x32x16_bf16 v[144:159], v[92:95], a[92:95], v[144:159]
ds_read_b64_tr_b16 v[90:91], v4 offset:512
s_waitcnt lgkmcnt(3)
s_mov_b32 s43, s45
v_mfma_f32_32x32x16_bf16 v[160:175], v[80:83], v[224:227], v[160:175]
s_add_u32 m0, s3, 106496
s_mul_i32 s61, s56, 589824
s_add_u32 s61, s61, s100
buffer_load_dwordx4 v12, s[8:11], s61 offen lds
ds_read_b64_tr_b16 v[92:93], v7 offset:0
v_mfma_f32_32x32x16_bf16 v[176:191], v[80:83], v[228:231], v[176:191]
ds_read_b64_tr_b16 v[94:95], v7 offset:512
v_mfma_f32_32x32x16_bf16 v[192:207], v[84:87], v[224:227], v[192:207]
ds_read_b64_tr_b16 v[80:81], v3 offset:26624
v_mfma_f32_32x32x16_bf16 v[208:223], v[84:87], v[228:231], v[208:223]
buffer_load_dwordx4 v13, s[8:11], s61 offen offset:1024 lds
ds_read_b64_tr_b16 v[82:83], v3 offset:27136
s_waitcnt lgkmcnt(2)
v_mfma_f32_32x32x16_bf16 v[96:111], v[88:91], a[96:99], v[96:111]
ds_read_b64_tr_b16 v[84:85], v6 offset:26624
v_mfma_f32_32x32x16_bf16 v[112:127], v[88:91], a[100:103], v[112:127]
ds_read_b64_tr_b16 v[86:87], v6 offset:27136
v_mfma_f32_32x32x16_bf16 v[128:143], v[92:95], a[96:99], v[128:143]
ds_read_b64_tr_b16 v[88:89], v4 offset:2048
v_mfma_f32_32x32x16_bf16 v[144:159], v[92:95], a[100:103], v[144:159]
s_add_u32 m0, s3, 65536
s_mul_i32 s61, s53, 589824
s_add_u32 s61, s61, s101
buffer_load_dwordx4 v12, s[8:11], s61 offen lds
ds_read_b64_tr_b16 v[90:91], v4 offset:2560
s_waitcnt lgkmcnt(2)
v_mfma_f32_32x32x16_bf16 v[160:175], v[80:83], v[232:235], v[160:175]
ds_read_b64_tr_b16 v[92:93], v7 offset:2048
v_mfma_f32_32x32x16_bf16 v[176:191], v[80:83], v[236:239], v[176:191]
ds_read_b64_tr_b16 v[94:95], v7 offset:2560
v_mfma_f32_32x32x16_bf16 v[192:207], v[84:87], v[232:235], v[192:207]
ds_read_b64_tr_b16 v[80:81], v3 offset:28672
v_mfma_f32_32x32x16_bf16 v[208:223], v[84:87], v[236:239], v[208:223]
buffer_load_dwordx4 v13, s[8:11], s61 offen offset:1024 lds
ds_read_b64_tr_b16 v[82:83], v3 offset:29184
s_waitcnt lgkmcnt(2)
v_mfma_f32_32x32x16_bf16 v[96:111], v[88:91], a[104:107], v[96:111]
ds_read_b64_tr_b16 v[84:85], v6 offset:28672
v_mfma_f32_32x32x16_bf16 v[112:127], v[88:91], a[108:111], v[112:127]
ds_read_b64_tr_b16 v[86:87], v6 offset:29184
v_mfma_f32_32x32x16_bf16 v[128:143], v[92:95], a[104:107], v[128:143]
ds_read_b64_tr_b16 v[88:89], v4 offset:4096
v_mfma_f32_32x32x16_bf16 v[144:159], v[92:95], a[108:111], v[144:159]
s_add_u32 m0, s3, 73728
s_mul_i32 s61, s54, 589824
s_add_u32 s61, s61, s101
buffer_load_dwordx4 v12, s[8:11], s61 offen lds
ds_read_b64_tr_b16 v[90:91], v4 offset:4608
s_waitcnt lgkmcnt(2)
v_mfma_f32_32x32x16_bf16 v[160:175], v[80:83], v[240:243], v[160:175]
ds_read_b64_tr_b16 v[92:93], v7 offset:4096
v_mfma_f32_32x32x16_bf16 v[176:191], v[80:83], v[244:247], v[176:191]
ds_read_b64_tr_b16 v[94:95], v7 offset:4608
v_mfma_f32_32x32x16_bf16 v[192:207], v[84:87], v[240:243], v[192:207]
ds_read_b64_tr_b16 v[80:81], v3 offset:30720
v_mfma_f32_32x32x16_bf16 v[208:223], v[84:87], v[244:247], v[208:223]
buffer_load_dwordx4 v13, s[8:11], s61 offen offset:1024 lds
ds_read_b64_tr_b16 v[82:83], v3 offset:31232
s_waitcnt lgkmcnt(2)
v_mfma_f32_32x32x16_bf16 v[96:111], v[88:91], a[112:115], v[96:111]
ds_read_b64_tr_b16 v[84:85], v6 offset:30720
s_waitcnt vmcnt(11)
v_cmp_ne_u32 vcc, s45, v69
s_nop 0
s_cmp_lg_u64 vcc, 0
s_cbranch_scc1 csM0_slow
csM0_ok:
v_mfma_f32_32x32x16_bf16 v[112:127], v[88:91], a[116:119], v[112:127]
ds_read_b64_tr_b16 v[86:87], v6 offset:31232
v_mov_b32 v73, v68
v_mov_b32 v77, v68
v_mfma_f32_32x32x16_bf16 v[128:143], v[92:95], a[112:115], v[128:143]
ds_read_b64_tr_b16 v[88:89], v4 offset:6144
s_barrier
v_permlane32_swap_b32 v68, v77
v_mfma_f32_32x32x16_bf16 v[144:159], v[92:95], a[116:119], v[144:159]
s_add_u32 m0, s3, 24576
s_mul_i32 s61, s55, 589824
s_add_u32 s61, s61, s101
buffer_load_dwordx4 v12, s[8:11], s61 offen lds
ds_read_b64_tr_b16 v[90:91], v4 offset:6656
s_waitcnt lgkmcnt(2)
v_mfma_f32_32x32x16_bf16 v[160:175], v[80:83], v[248:251], v[160:175]
ds_read_b64_tr_b16 v[92:93], v7 offset:6144
v_mov_b32 v74, v66
v_cvt_pk_bf16_f32 v72, v73, v73
v_mfma_f32_32x32x16_bf16 v[176:191], v[80:83], v[252:255], v[176:191]
ds_read_b64_tr_b16 v[94:95], v7 offset:6656
v_lshlrev_b32 v45, 16, v72
v_lshlrev_b32 v75, 16, v74
v_sub_f32 v45, v73, v45
v_mfma_f32_32x32x16_bf16 v[192:207], v[84:87], v[248:251], v[192:207]
ds_read_b64_tr_b16 v[80:81], v4 offset:8192
v_cvt_pk_bf16_f32 v73, v45, v75
v_mov_b32 v75, 0
v_mfma_f32_32x32x16_bf16 v[208:223], v[84:87], v[252:255], v[208:223]
buffer_load_dwordx4 v13, s[8:11], s61 offen offset:1024 lds
ds_read_b64_tr_b16 v[82:83], v4 offset:8704
s_waitcnt lgkmcnt(2)
v_mfma_f32_32x32x16_bf16 v[96:111], v[88:91], a[120:123], v[96:111]
ds_read_b64_tr_b16 v[84:85], v7 offset:8192
v_mov_b32 v78, v66
s_nop 1
v_permlane32_swap_b32 v66, v78
v_cvt_pk_bf16_f32 v76, v77, v77
v_mfma_f32_32x32x16_bf16 v[112:127], v[88:91], a[124:127], v[112:127]
ds_read_b64_tr_b16 v[86:87], v7 offset:8704
v_lshlrev_b32 v46, 16, v76
v_lshlrev_b32 v79, 16, v78
v_mfma_f32_32x32x16_bf16 v[128:143], v[92:95], a[120:123], v[128:143]
ds_read_b64_tr_b16 v[88:89], v4 offset:10240
v_sub_f32 v46, v77, v46
v_cvt_pk_bf16_f32 v77, v46, v79
v_mov_b32 v79, 0
v_mfma_f32_32x32x16_bf16 v[144:159], v[92:95], a[124:127], v[144:159]
ds_read_b64_tr_b16 v[90:91], v4 offset:10752
s_waitcnt lgkmcnt(2)
v_mfma_f32_32x32x16_bf16 v[160:175], v[72:75], v[28:31], v[160:175]
s_add_u32 m0, s3, 114688
s_mul_i32 s61, s57, 589824
s_add_u32 s61, s61, s100
buffer_load_dwordx4 v12, s[8:11], s61 offen lds
v_mfma_f32_32x32x16_bf16 v[176:191], v[72:75], v[32:35], v[176:191]
v_mfma_f32_32x32x16_bf16 v[192:207], v[76:79], v[28:31], v[192:207]
v_mfma_f32_32x32x16_bf16 v[208:223], v[76:79], v[32:35], v[208:223]
buffer_load_dwordx4 v13, s[8:11], s61 offen offset:1024 lds
v_mfma_f32_32x32x16_bf16 v[96:111], v[80:83], a[128:131], v[96:111]
ds_read_b64_tr_b16 v[92:93], v7 offset:10240
v_mfma_f32_32x32x16_bf16 v[112:127], v[80:83], a[132:135], v[112:127]
ds_read_b64_tr_b16 v[94:95], v7 offset:10752
v_mfma_f32_32x32x16_bf16 v[128:143], v[84:87], a[128:131], v[128:143]
s_add_u32 m0, s3, 40960
s_mul_i32 s61, s56, 589824
s_add_u32 s61, s61, s101
buffer_load_dwordx4 v12, s[8:11], s61 offen lds
ds_read_b64_tr_b16 v[80:81], v4 offset:12288
v_mfma_f32_32x32x16_bf16 v[144:159], v[84:87], a[132:135], v[144:159]
ds_read_b64_tr_b16 v[82:83], v4 offset:12800
s_waitcnt lgkmcnt(2)
v_mul_f32 v44, v160, v160
v_mul_f32 v45, v161, v161
v_mul_f32 v46, v162, v162
s_waitcnt vmcnt(15)
v_mul_f32 v47, v163, v163
v_fma_f32 v44, v44, v22, v20
v_fma_f32 v45, v45, v22, v20
v_fma_f32 v46, v46, v22, v20
v_fma_f32 v47, v47, v22, v20
v_mul_f32 v44, v44, v160
v_mfma_f32_32x32x16_bf16 v[96:111], v[88:91], a[136:139], v[96:111]
ds_read_b64_tr_b16 v[84:85], v7 offset:12288
v_mul_f32 v45, v45, v161
v_mul_f32 v46, v46, v162
v_mul_f32 v47, v47, v163
v_exp_f32 v44, v44
v_exp_f32 v45, v45
v_exp_f32 v46, v46
v_exp_f32 v47, v47
v_mfma_f32_32x32x16_bf16 v[112:127], v[88:91], a[140:143], v[112:127]
buffer_load_dwordx4 v13, s[8:11], s61 offen offset:1024 lds
ds_read_b64_tr_b16 v[86:87], v7 offset:12800
v_fma_f32 v44, v44, v24, v24
v_fma_f32 v45, v45, v24, v24
v_fma_f32 v46, v46, v24, v24
v_fma_f32 v47, v47, v24, v24
v_rcp_f32 v44, v44
v_mfma_f32_32x32x16_bf16 v[128:143], v[92:95], a[136:139], v[128:143]
ds_read_b64_tr_b16 v[88:89], v4 offset:14336
s_waitcnt vmcnt(10)
s_barrier
v_rcp_f32 v45, v45
v_rcp_f32 v46, v46
v_rcp_f32 v47, v47
v_mul_f32 v160, v160, v44
v_mul_f32 v161, v161, v45
v_mfma_f32_32x32x16_bf16 v[144:159], v[92:95], a[140:143], v[144:159]
ds_read_b64_tr_b16 v[90:91], v4 offset:14848
s_waitcnt lgkmcnt(2)
v_mul_f32 v162, v162, v46
v_mul_f32 v163, v163, v47
v_cvt_pk_bf16_f32 v160, v160, v161
v_cvt_pk_bf16_f32 v161, v162, v163
v_mul_f32 v44, v164, v164
v_mul_f32 v45, v165, v165
v_mul_f32 v46, v166, v166
v_mul_f32 v47, v167, v167
v_fma_f32 v44, v44, v22, v20
v_fma_f32 v45, v45, v22, v20
v_mfma_f32_32x32x16_bf16 v[96:111], v[80:83], a[144:147], v[96:111]
s_add_u32 m0, s3, 57344
s_mul_i32 s61, s57, 589824
s_add_u32 s61, s61, s101
buffer_load_dwordx4 v12, s[8:11], s61 offen lds
ds_read_b64_tr_b16 v[92:93], v7 offset:14336
v_fma_f32 v46, v46, v22, v20
v_fma_f32 v47, v47, v22, v20
v_mul_f32 v44, v44, v164
v_mfma_f32_32x32x16_bf16 v[112:127], v[80:83], a[148:151], v[112:127]
ds_read_b64_tr_b16 v[94:95], v7 offset:14848
v_mul_f32 v45, v45, v165
v_mul_f32 v46, v46, v166
v_mul_f32 v47, v47, v167
v_exp_f32 v44, v44
v_exp_f32 v45, v45
v_exp_f32 v46, v46
v_mfma_f32_32x32x16_bf16 v[128:143], v[84:87], a[144:147], v[128:143]
ds_read_b64_tr_b16 v[80:81], v3 offset:40960
v_exp_f32 v47, v47
v_fma_f32 v44, v44, v24, v24
v_fma_f32 v45, v45, v24, v24
v_fma_f32 v46, v46, v24, v24
v_fma_f32 v47, v47, v24, v24
v_rcp_f32 v44, v44
v_rcp_f32 v45, v45
v_mfma_f32_32x32x16_bf16 v[144:159], v[84:87], a[148:151], v[144:159]
buffer_load_dwordx4 v13, s[8:11], s61 offen offset:1024 lds
ds_read_b64_tr_b16 v[82:83], v3 offset:41472
s_waitcnt lgkmcnt(2)
v_rcp_f32 v46, v46
v_rcp_f32 v47, v47
v_mul_f32 v164, v164, v44
v_mul_f32 v165, v165, v45
v_mfma_f32_32x32x16_bf16 v[96:111], v[88:91], a[152:155], v[96:111]
ds_read_b64_tr_b16 v[84:85], v6 offset:40960
v_mul_f32 v166, v166, v46
v_mul_f32 v167, v167, v47
v_cvt_pk_bf16_f32 v162, v164, v165
v_cvt_pk_bf16_f32 v163, v166, v167
s_add_u32 s99, s41, 0
buffer_store_dwordx4 v[160:163], v31, s[16:19], s99 offen offset:0 sc1
v_mul_f32 v44, v168, v168
v_mul_f32 v45, v169, v169
v_mfma_f32_32x32x16_bf16 v[112:127], v[88:91], a[156:159], v[112:127]
ds_read_b64_tr_b16 v[86:87], v6 offset:41472
v_mul_f32 v46, v170, v170
v_mul_f32 v47, v171, v171
v_fma_f32 v44, v44, v22, v20
v_fma_f32 v45, v45, v22, v20
v_fma_f32 v46, v46, v22, v20
v_fma_f32 v47, v47, v22, v20
v_mul_f32 v44, v44, v168
v_mul_f32 v45, v45, v169
v_mul_f32 v46, v46, v170
v_mul_f32 v47, v47, v171
v_mfma_f32_32x32x16_bf16 v[128:143], v[92:95], a[152:155], v[128:143]
ds_read_b64_tr_b16 v[88:89], v3 offset:43008
v_exp_f32 v44, v44
v_exp_f32 v45, v45
v_exp_f32 v46, v46
v_exp_f32 v47, v47
v_fma_f32 v44, v44, v24, v24
v_fma_f32 v45, v45, v24, v24
v_mfma_f32_32x32x16_bf16 v[144:159], v[92:95], a[156:159], v[144:159]
ds_read_b64_tr_b16 v[90:91], v3 offset:43520
s_waitcnt lgkmcnt(2)
v_fma_f32 v46, v46, v24, v24
v_fma_f32 v47, v47, v24, v24
v_rcp_f32 v44, v44
v_rcp_f32 v45, v45
v_rcp_f32 v46, v46
v_rcp_f32 v47, v47
v_mfma_f32_32x32x16_bf16 v[96:111], v[80:83], a[160:163], v[96:111]
s_add_u32 m0, s3, 122880
s_mul_i32 s61, s58, 589824
s_add_u32 s61, s61, s100
buffer_load_dwordx4 v12, s[8:11], s61 offen lds
ds_read_b64_tr_b16 v[92:93], v6 offset:43008
v_mul_f32 v168, v168, v44
v_mul_f32 v169, v169, v45
v_mul_f32 v170, v170, v46
v_mfma_f32_32x32x16_bf16 v[112:127], v[80:83], a[164:167], v[112:127]
ds_read_b64_tr_b16 v[94:95], v6 offset:43520
v_mul_f32 v171, v171, v47
v_cvt_pk_bf16_f32 v168, v168, v169
v_cvt_pk_bf16_f32 v169, v170, v171
v_mul_f32 v44, v172, v172
v_mul_f32 v45, v173, v173
v_mul_f32 v46, v174, v174
v_mul_f32 v47, v175, v175
v_fma_f32 v44, v44, v22, v20
v_fma_f32 v45, v45, v22, v20
v_fma_f32 v46, v46, v22, v20
v_mfma_f32_32x32x16_bf16 v[128:143], v[84:87], a[160:163], v[128:143]
buffer_load_dwordx4 v13, s[8:11], s61 offen offset:1024 lds
ds_read_b64_tr_b16 v[80:81], v3 offset:45056
v_fma_f32 v47, v47, v22, v20
v_mul_f32 v44, v44, v172
v_mul_f32 v45, v45, v173
v_mul_f32 v46, v46, v174
v_mul_f32 v47, v47, v175
v_exp_f32 v44, v44
v_mfma_f32_32x32x16_bf16 v[144:159], v[84:87], a[164:167], v[144:159]
ds_read_b64_tr_b16 v[82:83], v3 offset:45568
s_waitcnt lgkmcnt(2)
v_exp_f32 v45, v45
v_exp_f32 v46, v46
v_exp_f32 v47, v47
v_fma_f32 v44, v44, v24, v24
v_fma_f32 v45, v45, v24, v24
v_fma_f32 v46, v46, v24, v24
v_mfma_f32_32x32x16_bf16 v[96:111], v[88:91], a[168:171], v[96:111]
ds_read_b64_tr_b16 v[84:85], v6 offset:45056
v_fma_f32 v47, v47, v24, v24
v_rcp_f32 v44, v44
v_rcp_f32 v45, v45
v_rcp_f32 v46, v46
v_rcp_f32 v47, v47
v_mul_f32 v172, v172, v44
v_mfma_f32_32x32x16_bf16 v[112:127], v[88:91], a[172:175], v[112:127]
s_add_u32 m0, s3, 81920
s_mul_i32 s61, s58, 589824
s_add_u32 s61, s61, s101
buffer_load_dwordx4 v12, s[8:11], s61 offen lds
ds_read_b64_tr_b16 v[86:87], v6 offset:45568
v_mul_f32 v173, v173, v45
v_mul_f32 v174, v174, v46
v_mul_f32 v175, v175, v47
v_cvt_pk_bf16_f32 v170, v172, v173
v_mfma_f32_32x32x16_bf16 v[128:143], v[92:95], a[168:171], v[128:143]
ds_read_b64_tr_b16 v[88:89], v3 offset:47104
s_waitcnt vmcnt(8)
s_barrier
v_cvt_pk_bf16_f32 v171, v174, v175
s_add_u32 s99, s41, 0
buffer_store_dwordx4 v[168:171], v31, s[16:19], s99 offen offset:256 sc1
v_mul_f32 v44, v176, v176
v_mul_f32 v45, v177, v177
v_mfma_f32_32x32x16_bf16 v[144:159], v[92:95], a[172:175], v[144:159]
buffer_load_dwordx4 v13, s[8:11], s61 offen offset:1024 lds
ds_read_b64_tr_b16 v[90:91], v3 offset:47616
s_waitcnt lgkmcnt(2)
v_mul_f32 v46, v178, v178
v_mul_f32 v47, v179, v179
v_fma_f32 v44, v44, v23, v21
v_fma_f32 v45, v45, v23, v21
v_fma_f32 v46, v46, v23, v21
v_mfma_f32_32x32x16_bf16 v[96:111], v[80:83], a[176:179], v[96:111]
ds_read_b64_tr_b16 v[92:93], v6 offset:47104
v_fma_f32 v47, v47, v23, v21
v_mul_f32 v44, v44, v176
v_mul_f32 v45, v45, v177
v_mul_f32 v46, v46, v178
v_mul_f32 v47, v47, v179
v_exp_f32 v44, v44
L_stub2:
s_cbranch_execz L_stub13
v_exp_f32 v45, v45
v_exp_f32 v46, v46
v_mfma_f32_32x32x16_bf16 v[112:127], v[80:83], a[180:183], v[112:127]
ds_read_b64_tr_b16 v[94:95], v6 offset:47616
v_exp_f32 v47, v47
v_fma_f32 v44, v44, v25, v25
v_fma_f32 v45, v45, v25, v25
v_fma_f32 v46, v46, v25, v25
v_fma_f32 v47, v47, v25, v25
v_rcp_f32 v44, v44
v_rcp_f32 v45, v45
v_mfma_f32_32x32x16_bf16 v[128:143], v[84:87], a[176:179], v[128:143]
s_add_u32 m0, s3, 32768
s_mul_i32 s61, s59, 589824
s_add_u32 s61, s61, s101
buffer_load_dwordx4 v12, s[8:11], s61 offen lds
ds_read_b64_tr_b16 v[80:81], v3 offset:49152
v_rcp_f32 v46, v46
v_mfma_f32_32x32x16_bf16 v[144:159], v[84:87], a[180:183], v[144:159]
ds_read_b64_tr_b16 v[82:83], v3 offset:49664
s_waitcnt lgkmcnt(2)
v_rcp_f32 v47, v47
v_mul_f32 v176, v176, v44
v_mul_f32 v177, v177, v45
v_mul_f32 v178, v178, v46
v_mul_f32 v179, v179, v47
v_cvt_pk_bf16_f32 v176, v176, v177
v_cvt_pk_bf16_f32 v177, v178, v179
v_mul_f32 v44, v180, v180
v_mul_f32 v45, v181, v181
v_mfma_f32_32x32x16_bf16 v[96:111], v[88:91], a[184:187], v[96:111]
buffer_load_dwordx4 v13, s[8:11], s61 offen offset:1024 lds
ds_read_b64_tr_b16 v[84:85], v6 offset:49152
v_mul_f32 v46, v182, v182
v_mul_f32 v47, v183, v183
v_fma_f32 v44, v44, v23, v21
v_fma_f32 v45, v45, v23, v21
v_fma_f32 v46, v46, v23, v21
v_fma_f32 v47, v47, v23, v21
v_mul_f32 v44, v44, v180
v_mfma_f32_32x32x16_bf16 v[112:127], v[88:91], a[188:191], v[112:127]
ds_read_b64_tr_b16 v[86:87], v6 offset:49664
v_mul_f32 v45, v45, v181
v_mul_f32 v46, v46, v182
v_mul_f32 v47, v47, v183
v_exp_f32 v44, v44
v_exp_f32 v45, v45
v_exp_f32 v46, v46
v_mfma_f32_32x32x16_bf16 v[128:143], v[92:95], a[184:187], v[128:143]
ds_read_b64_tr_b16 v[88:89], v3 offset:51200
s_lshl_b32 s63, s100, 2
s_add_u32 s63, s63, 98304
v_lshl_add_u32 v70, v0, 3, s63
buffer_load_dwordx2 v[68:69], v70, s[16:19], 0 offen sc1
v_exp_f32 v47, v47
v_fma_f32 v44, v44, v25, v25
v_fma_f32 v45, v45, v25, v25
v_mfma_f32_32x32x16_bf16 v[144:159], v[92:95], a[188:191], v[144:159]
ds_read_b64_tr_b16 v[90:91], v3 offset:51712
s_waitcnt lgkmcnt(2)
v_fma_f32 v46, v46, v25, v25
v_fma_f32 v47, v47, v25, v25
v_rcp_f32 v44, v44
v_rcp_f32 v45, v45
v_rcp_f32 v46, v46
v_rcp_f32 v47, v47
v_mfma_f32_32x32x16_bf16 v[96:111], v[80:83], a[192:195], v[96:111]
s_add_u32 m0, s3, 131072
s_mul_i32 s61, s59, 589824
s_add_u32 s61, s61, s100
buffer_load_dwordx4 v12, s[8:11], s61 offen lds
ds_read_b64_tr_b16 v[92:93], v6 offset:51200
v_mul_f32 v180, v180, v44
v_mul_f32 v181, v181, v45
v_mul_f32 v182, v182, v46
v_mfma_f32_32x32x16_bf16 v[112:127], v[80:83], a[196:199], v[112:127]
ds_read_b64_tr_b16 v[94:95], v6 offset:51712
v_mul_f32 v183, v183, v47
v_cvt_pk_bf16_f32 v178, v180, v181
v_cvt_pk_bf16_f32 v179, v182, v183
s_add_u32 s99, s41, 87808
buffer_store_dwordx4 v[176:179], v31, s[16:19], s99 offen offset:0 sc1
v_mul_f32 v44, v184, v184
v_mul_f32 v45, v185, v185
v_mfma_f32_32x32x16_bf16 v[128:143], v[84:87], a[192:195], v[128:143]
ds_read_b64_tr_b16 v[80:81], v3 offset:53248
v_mov_b32 v36, -1
v_mov_b32 v37, -1
v_mov_b32 v38, -1
v_mov_b32 v39, -1
v_mul_f32 v46, v186, v186
v_mul_f32 v47, v187, v187
v_fma_f32 v44, v44, v23, v21
v_fma_f32 v45, v45, v23, v21
v_fma_f32 v46, v46, v23, v21
v_fma_f32 v47, v47, v23, v21
v_mul_f32 v44, v44, v184
v_mfma_f32_32x32x16_bf16 v[144:159], v[84:87], a[196:199], v[144:159]
ds_read_b64_tr_b16 v[82:83], v3 offset:53760
s_waitcnt lgkmcnt(2)
v_mul_f32 v45, v45, v185
v_mul_f32 v46, v46, v186
v_mul_f32 v47, v47, v187
v_exp_f32 v44, v44
v_exp_f32 v45, v45
v_exp_f32 v46, v46
v_mfma_f32_32x32x16_bf16 v[96:111], v[88:91], a[200:203], v[96:111]
ds_read_b64_tr_b16 v[84:85], v6 offset:53248
v_exp_f32 v47, v47
v_fma_f32 v44, v44, v25, v25
v_fma_f32 v45, v45, v25, v25
v_fma_f32 v46, v46, v25, v25
v_fma_f32 v47, v47, v25, v25
v_rcp_f32 v44, v44
v_rcp_f32 v45, v45
v_mfma_f32_32x32x16_bf16 v[112:127], v[88:91], a[204:207], v[112:127]
ds_read_b64_tr_b16 v[86:87], v6 offset:53760
v_rcp_f32 v46, v46
v_rcp_f32 v47, v47
v_mul_f32 v184, v184, v44
v_mul_f32 v185, v185, v45
v_mul_f32 v186, v186, v46
v_mul_f32 v187, v187, v47
v_cvt_pk_bf16_f32 v184, v184, v185
v_cvt_pk_bf16_f32 v185, v186, v187
v_mul_f32 v44, v188, v188
v_mfma_f32_32x32x16_bf16 v[128:143], v[92:95], a[200:203], v[128:143]
ds_read_b64_tr_b16 v[88:89], v3 offset:55296
s_waitcnt vmcnt(8)
s_barrier
v_mul_f32 v45, v189, v189
v_mul_f32 v46, v190, v190
v_mul_f32 v47, v191, v191
v_fma_f32 v44, v44, v23, v21
v_fma_f32 v45, v45, v23, v21
v_fma_f32 v46, v46, v23, v21
v_fma_f32 v47, v47, v23, v21
v_mul_f32 v44, v44, v188
v_mfma_f32_32x32x16_bf16 v[144:159], v[92:95], a[204:207], v[144:159]
buffer_load_dwordx4 v13, s[8:11], s61 offen offset:1024 lds
ds_read_b64_tr_b16 v[90:91], v3 offset:55808
s_waitcnt lgkmcnt(2)
v_mul_f32 v45, v45, v189
v_mul_f32 v46, v46, v190
v_mul_f32 v47, v47, v191
v_exp_f32 v44, v44
v_mfma_f32_32x32x16_bf16 v[96:111], v[80:83], a[208:211], v[96:111]
ds_read_b64_tr_b16 v[92:93], v6 offset:55296
s_add_u32 s63, s82, 8192
buffer_store_dwordx4 v[36:39], v1, s[16:19], s63 offen offset:0 sc1
v_exp_f32 v45, v45
v_exp_f32 v46, v46
v_exp_f32 v47, v47
v_mfma_f32_32x32x16_bf16 v[112:127], v[80:83], a[212:215], v[112:127]
ds_read_b64_tr_b16 v[94:95], v6 offset:55808
v_fma_f32 v44, v44, v25, v25
v_fma_f32 v45, v45, v25, v25
v_fma_f32 v46, v46, v25, v25
v_fma_f32 v47, v47, v25, v25
v_rcp_f32 v44, v44
v_rcp_f32 v45, v45
v_rcp_f32 v46, v46
v_mfma_f32_32x32x16_bf16 v[128:143], v[84:87], a[208:211], v[128:143]
ds_read_b64_tr_b16 v[80:81], v3 offset:57344
v_rcp_f32 v47, v47
v_mul_f32 v188, v188, v44
v_mul_f32 v189, v189, v45
v_mul_f32 v190, v190, v46
v_mul_f32 v191, v191, v47
v_cvt_pk_bf16_f32 v186, v188, v189
v_cvt_pk_bf16_f32 v187, v190, v191
s_add_u32 s99, s41, 87808
buffer_store_dwordx4 v[184:187], v31, s[16:19], s99 offen offset:256 sc1
v_mfma_f32_32x32x16_bf16 v[144:159], v[84:87], a[212:215], v[144:159]
ds_read_b64_tr_b16 v[82:83], v3 offset:57856
s_waitcnt lgkmcnt(2)
v_mul_f32 v44, v192, v192
v_mul_f32 v45, v193, v193
v_mul_f32 v46, v194, v194
v_mul_f32 v47, v195, v195
v_fma_f32 v44, v44, v22, v20
v_fma_f32 v45, v45, v22, v20
v_mfma_f32_32x32x16_bf16 v[96:111], v[88:91], a[216:219], v[96:111]
ds_read_b64_tr_b16 v[84:85], v6 offset:57344
v_fma_f32 v46, v46, v22, v20
v_fma_f32 v47, v47, v22, v20
v_mul_f32 v44, v44, v192
v_mul_f32 v45, v45, v193
v_mul_f32 v46, v46, v194
v_mul_f32 v47, v47, v195
v_exp_f32 v44, v44
v_exp_f32 v45, v45
v_mfma_f32_32x32x16_bf16 v[112:127], v[88:91], a[220:223], v[112:127]
ds_read_b64_tr_b16 v[86:87], v6 offset:57856
v_exp_f32 v46, v46
v_exp_f32 v47, v47
v_fma_f32 v44, v44, v24, v24
v_fma_f32 v45, v45, v24, v24
v_fma_f32 v46, v46, v24, v24
v_fma_f32 v47, v47, v24, v24
v_rcp_f32 v44, v44
v_mfma_f32_32x32x16_bf16 v[128:143], v[92:95], a[216:219], v[128:143]
ds_read_b64_tr_b16 v[88:89], v3 offset:59392
s_add_u32 s63, s82, 8192
buffer_store_dwordx4 v[36:39], v1, s[16:19], s63 offen offset:1024 sc1
v_rcp_f32 v45, v45
v_rcp_f32 v46, v46
v_rcp_f32 v47, v47
v_mfma_f32_32x32x16_bf16 v[144:159], v[92:95], a[220:223], v[144:159]
ds_read_b64_tr_b16 v[90:91], v3 offset:59904
s_waitcnt lgkmcnt(2)
v_mul_f32 v192, v192, v44
v_mul_f32 v193, v193, v45
v_mul_f32 v194, v194, v46
v_mul_f32 v195, v195, v47
v_cvt_pk_bf16_f32 v192, v192, v193
v_cvt_pk_bf16_f32 v193, v194, v195
v_mul_f32 v44, v196, v196
v_mul_f32 v45, v197, v197
v_mul_f32 v46, v198, v198
v_mul_f32 v47, v199, v199
v_mfma_f32_32x32x16_bf16 v[96:111], v[80:83], a[224:227], v[96:111]
ds_read_b64_tr_b16 v[92:93], v6 offset:59392
s_cmp_lt_u32 s47, 4
s_cselect_b32 s36, s28, s12
s_cselect_b32 s37, s29, s13
s_cselect_b32 s38, s30, s14
s_cmp_lt_u32 s47, 4
s_cselect_b32 s24, s32, s12
s_cselect_b32 s25, s33, s13
s_cselect_b32 s26, s34, s14
s_add_u32 m0, s3, 49152
s_add_u32 s61, s64, 0
buffer_load_dwordx4 v14, s[12:15], s61 offen lds
v_mfma_f32_32x32x16_bf16 v[112:127], v[80:83], a[228:231], v[112:127]
ds_read_b64_tr_b16 v[94:95], v6 offset:59904
v_and_b32 v18, 0xffffff80, v14
v_fma_f32 v44, v44, v22, v20
v_fma_f32 v45, v45, v22, v20
v_fma_f32 v46, v46, v22, v20
v_fma_f32 v47, v47, v22, v20
v_mul_f32 v44, v44, v196
v_mfma_f32_32x32x16_bf16 v[128:143], v[84:87], a[224:227], v[128:143]
ds_read_b64_tr_b16 v[80:81], v3 offset:61440
v_bfe_u32 v19, v0, 4, 2
v_mul_f32 v45, v45, v197
v_mul_f32 v46, v46, v198
v_mul_f32 v47, v47, v199
v_exp_f32 v44, v44
v_exp_f32 v45, v45
v_exp_f32 v46, v46
v_mfma_f32_32x32x16_bf16 v[144:159], v[84:87], a[228:231], v[144:159]
ds_read_b64_tr_b16 v[82:83], v3 offset:61952
s_waitcnt lgkmcnt(2)
v_and_b32 v16, 7, v0
v_exp_f32 v47, v47
v_fma_f32 v44, v44, v24, v24
v_fma_f32 v45, v45, v24, v24
v_fma_f32 v46, v46, v24, v24
v_fma_f32 v47, v47, v24, v24
v_rcp_f32 v44, v44
v_mfma_f32_32x32x16_bf16 v[96:111], v[88:91], a[232:235], v[96:111]
ds_read_b64_tr_b16 v[84:85], v6 offset:61440
s_add_u32 s63, s82, 8192
buffer_store_dwordx4 v[36:39], v1, s[16:19], s63 offen offset:2048 sc1
v_xor_b32 v19, v19, v16
buffer_load_dwordx4 v15, s[12:15], s61 offen offset:1024 lds
v_mfma_f32_32x32x16_bf16 v[112:127], v[88:91], a[236:239], v[112:127]
ds_read_b64_tr_b16 v[86:87], v6 offset:61952
v_lshlrev_b32 v19, 4, v19
v_add_u32 v16, v18, v19
v_rcp_f32 v45, v45
v_rcp_f32 v46, v46
v_rcp_f32 v47, v47
v_mul_f32 v196, v196, v44
v_mul_f32 v197, v197, v45
v_mul_f32 v198, v198, v46
v_mfma_f32_32x32x16_bf16 v[128:143], v[92:95], a[232:235], v[128:143]
ds_read_b64_tr_b16 v[88:89], v3 offset:63488
s_waitcnt vmcnt(6)
s_barrier
v_xor_b32 v17, 64, v16
v_mul_f32 v199, v199, v47
v_cvt_pk_bf16_f32 v194, v196, v197
v_cvt_pk_bf16_f32 v195, v198, v199
s_add_u32 s99, s41, 0
buffer_store_dwordx4 v[192:195], v31, s[16:19], s99 offen offset:2048 sc1
v_mfma_f32_32x32x16_bf16 v[144:159], v[92:95], a[236:239], v[144:159]
ds_read_b64_tr_b16 v[90:91], v3 offset:64000
s_waitcnt lgkmcnt(2)
v_add_u32 v17, 8192, v17
v_mul_f32 v44, v200, v200
v_mul_f32 v45, v201, v201
v_mul_f32 v46, v202, v202
v_mul_f32 v47, v203, v203
v_fma_f32 v44, v44, v22, v20
v_fma_f32 v45, v45, v22, v20
v_fma_f32 v46, v46, v22, v20
v_fma_f32 v47, v47, v22, v20
v_mfma_f32_32x32x16_bf16 v[96:111], v[80:83], a[240:243], v[96:111]
ds_read_b64_tr_b16 v[92:93], v6 offset:63488
s_cmp_lt_u32 s47, 4
s_cselect_b64 s[92:93], -1, 0
v_cndmask_b32 v18, v14, v16, s[92:93]
v_cndmask_b32 v19, v15, v17, s[92:93]
s_add_u32 m0, s3, 90112
s_add_u32 s61, s64, 128
buffer_load_dwordx4 v14, s[12:15], s61 offen lds
v_mfma_f32_32x32x16_bf16 v[112:127], v[80:83], a[244:247], v[112:127]
ds_read_b64_tr_b16 v[94:95], v6 offset:64000
v_mov_b32 v13, s45
v_mul_f32 v44, v44, v200
v_mul_f32 v45, v45, v201
v_mul_f32 v46, v46, v202
v_mul_f32 v47, v47, v203
v_exp_f32 v44, v44
v_exp_f32 v45, v45
v_exp_f32 v46, v46
v_mfma_f32_32x32x16_bf16 v[128:143], v[84:87], a[240:243], v[128:143]
ds_read_b64_tr_b16 v[80:81], v4 offset:0
s_add_u32 s63, s82, 8192
buffer_store_dwordx4 v[36:39], v1, s[16:19], s63 offen offset:3072 sc1
v_exp_f32 v47, v47
v_fma_f32 v44, v44, v24, v24
v_fma_f32 v45, v45, v24, v24
v_fma_f32 v46, v46, v24, v24
v_mfma_f32_32x32x16_bf16 v[144:159], v[84:87], a[244:247], v[144:159]
ds_read_b64_tr_b16 v[82:83], v4 offset:512
s_waitcnt lgkmcnt(2)
v_fma_f32 v47, v47, v24, v24
v_rcp_f32 v44, v44
v_rcp_f32 v45, v45
v_rcp_f32 v46, v46
v_rcp_f32 v47, v47
v_mfma_f32_32x32x16_bf16 v[96:111], v[88:91], a[248:251], v[96:111]
buffer_load_dwordx4 v15, s[12:15], s61 offen offset:1024 lds
ds_read_b64_tr_b16 v[84:85], v7 offset:0
v_mul_f32 v200, v200, v44
v_mul_f32 v201, v201, v45
v_mul_f32 v202, v202, v46
v_mul_f32 v203, v203, v47
v_cvt_pk_bf16_f32 v200, v200, v201
v_cvt_pk_bf16_f32 v201, v202, v203
v_mul_f32 v44, v204, v204
v_mfma_f32_32x32x16_bf16 v[112:127], v[88:91], a[252:255], v[112:127]
ds_read_b64_tr_b16 v[86:87], v7 offset:512
v_mul_f32 v45, v205, v205
v_mul_f32 v46, v206, v206
v_mul_f32 v47, v207, v207
v_fma_f32 v44, v44, v22, v20
v_fma_f32 v45, v45, v22, v20
v_fma_f32 v46, v46, v22, v20
v_fma_f32 v47, v47, v22, v20
v_mul_f32 v44, v44, v204
v_mul_f32 v45, v45, v205
v_mul_f32 v46, v46, v206
v_mfma_f32_32x32x16_bf16 v[128:143], v[92:95], a[248:251], v[128:143]
ds_read_b64_tr_b16 v[88:89], v4 offset:2048
v_mul_f32 v47, v47, v207
v_exp_f32 v44, v44
v_exp_f32 v45, v45
v_exp_f32 v46, v46
v_exp_f32 v47, v47
v_fma_f32 v44, v44, v24, v24
v_mfma_f32_32x32x16_bf16 v[144:159], v[92:95], a[252:255], v[144:159]
ds_read_b64_tr_b16 v[90:91], v4 offset:2560
s_waitcnt lgkmcnt(2)
v_fma_f32 v45, v45, v24, v24
v_fma_f32 v46, v46, v24, v24
v_fma_f32 v47, v47, v24, v24
v_rcp_f32 v44, v44
v_rcp_f32 v45, v45
v_rcp_f32 v46, v46
v_mfma_f32_32x32x16_bf16 v[96:111], v[80:83], v[224:227], v[96:111]
s_add_u32 m0, s3, 139264
s_add_u32 s61, s65, 0
buffer_load_dwordx4 v14, s[12:15], s61 offen lds
ds_read_b64_tr_b16 v[92:93], v7 offset:2048
v_rcp_f32 v47, v47
v_mul_f32 v204, v204, v44
v_mul_f32 v205, v205, v45
v_mul_f32 v206, v206, v46
v_mfma_f32_32x32x16_bf16 v[112:127], v[80:83], v[228:231], v[112:127]
ds_read_b64_tr_b16 v[94:95], v7 offset:2560
v_mul_f32 v207, v207, v47
v_cvt_pk_bf16_f32 v202, v204, v205
v_cvt_pk_bf16_f32 v203, v206, v207
s_add_u32 s99, s41, 0
buffer_store_dwordx4 v[200:203], v31, s[16:19], s99 offen offset:2304 sc1
v_mul_f32 v44, v208, v208
v_mul_f32 v45, v209, v209
v_mfma_f32_32x32x16_bf16 v[128:143], v[84:87], v[224:227], v[128:143]
ds_read_b64_tr_b16 v[80:81], v4 offset:4096
v_mul_f32 v46, v210, v210
v_mul_f32 v47, v211, v211
v_fma_f32 v44, v44, v23, v21
v_fma_f32 v45, v45, v23, v21
v_fma_f32 v46, v46, v23, v21
v_fma_f32 v47, v47, v23, v21
v_mul_f32 v44, v44, v208
v_mul_f32 v45, v45, v209
v_mul_f32 v46, v46, v210
v_mul_f32 v47, v47, v211
v_mfma_f32_32x32x16_bf16 v[144:159], v[84:87], v[228:231], v[144:159]
ds_read_b64_tr_b16 v[82:83], v4 offset:4608
s_waitcnt lgkmcnt(2)
v_exp_f32 v44, v44
v_exp_f32 v45, v45
v_exp_f32 v46, v46
v_exp_f32 v47, v47
v_fma_f32 v44, v44, v25, v25
v_fma_f32 v45, v45, v25, v25
v_mfma_f32_32x32x16_bf16 v[96:111], v[88:91], v[232:235], v[96:111]
buffer_load_dwordx4 v15, s[12:15], s61 offen offset:1024 lds
ds_read_b64_tr_b16 v[84:85], v7 offset:4096
v_fma_f32 v46, v46, v25, v25
v_fma_f32 v47, v47, v25, v25
v_rcp_f32 v44, v44
v_rcp_f32 v45, v45
v_mfma_f32_32x32x16_bf16 v[112:127], v[88:91], v[236:239], v[112:127]
ds_read_b64_tr_b16 v[86:87], v7 offset:4608
v_cmp_ne_u32 vcc, s45, v69
s_nop 0
s_cmp_lg_u64 vcc, 0
s_cbranch_scc1 csM1_slow
csM1_ok:
v_mov_b32 v73, v68
v_mov_b32 v77, v68
v_rcp_f32 v46, v46
v_rcp_f32 v47, v47
v_mul_f32 v208, v208, v44
v_mfma_f32_32x32x16_bf16 v[128:143], v[92:95], v[232:235], v[128:143]
ds_read_b64_tr_b16 v[88:89], v4 offset:6144
v_permlane32_swap_b32 v68, v77
v_mov_b32 v74, v64
v_mul_f32 v209, v209, v45
v_mul_f32 v210, v210, v46
v_mul_f32 v211, v211, v47
v_cvt_pk_bf16_f32 v208, v208, v209
v_cvt_pk_bf16_f32 v209, v210, v211
v_mul_f32 v44, v212, v212
v_mul_f32 v45, v213, v213
v_mul_f32 v46, v214, v214
v_mul_f32 v47, v215, v215
v_mfma_f32_32x32x16_bf16 v[144:159], v[92:95], v[236:239], v[144:159]
ds_read_b64_tr_b16 v[90:91], v4 offset:6656
s_waitcnt lgkmcnt(2)
v_cvt_pk_bf16_f32 v72, v73, v73
v_fma_f32 v44, v44, v23, v21
v_fma_f32 v45, v45, v23, v21
v_fma_f32 v46, v46, v23, v21
v_fma_f32 v47, v47, v23, v21
v_mul_f32 v44, v44, v212
v_mul_f32 v45, v45, v213
v_mul_f32 v46, v46, v214
v_mul_f32 v47, v47, v215
v_mfma_f32_32x32x16_bf16 v[96:111], v[80:83], v[240:243], v[96:111]
ds_read_b64_tr_b16 v[92:93], v7 offset:6144
s_barrier
s_add_u32 m0, s3, 106496
s_add_u32 s61, s65, 128
buffer_load_dwordx4 v14, s[12:15], s61 offen lds
v_exp_f32 v44, v44
v_mfma_f32_32x32x16_bf16 v[112:127], v[80:83], v[244:247], v[112:127]
ds_read_b64_tr_b16 v[94:95], v7 offset:6656
v_lshlrev_b32 v40, 16, v72
v_lshlrev_b32 v75, 16, v74
v_sub_f32 v40, v73, v40
v_exp_f32 v45, v45
v_exp_f32 v46, v46
v_exp_f32 v47, v47
v_fma_f32 v44, v44, v25, v25
v_fma_f32 v45, v45, v25, v25
v_mfma_f32_32x32x16_bf16 v[128:143], v[84:87], v[240:243], v[128:143]
ds_read_b64_tr_b16 v[80:81], v4 offset:16384
v_cvt_pk_bf16_f32 v73, v40, v75
v_mov_b32 v75, 0
v_fma_f32 v46, v46, v25, v25
v_fma_f32 v47, v47, v25, v25
v_rcp_f32 v44, v44
v_rcp_f32 v45, v45
v_rcp_f32 v46, v46
v_mfma_f32_32x32x16_bf16 v[144:159], v[84:87], v[244:247], v[144:159]
ds_read_b64_tr_b16 v[82:83], v4 offset:16896
s_waitcnt lgkmcnt(2)
v_mov_b32 v78, v64
v_rcp_f32 v47, v47
v_mul_f32 v212, v212, v44
v_mul_f32 v213, v213, v45
v_mul_f32 v214, v214, v46
v_mul_f32 v215, v215, v47
v_cvt_pk_bf16_f32 v210, v212, v213
v_cvt_pk_bf16_f32 v211, v214, v215
v_mfma_f32_32x32x16_bf16 v[96:111], v[88:91], v[248:251], v[96:111]
ds_read_b64_tr_b16 v[84:85], v4 offset:18432
v_permlane32_swap_b32 v64, v78
v_cvt_pk_bf16_f32 v76, v77, v77
buffer_load_dwordx4 v15, s[12:15], s61 offen offset:1024 lds
s_add_u32 s99, s41, 87808
buffer_store_dwordx4 v[208:211], v31, s[16:19], s99 offen offset:2048 sc1
v_mfma_f32_32x32x16_bf16 v[112:127], v[88:91], v[252:255], v[112:127]
ds_read_b64_tr_b16 v[86:87], v4 offset:18944
v_lshlrev_b32 v41, 16, v76
v_lshlrev_b32 v79, 16, v78
v_sub_f32 v41, v77, v41
v_mul_f32 v44, v216, v216
v_mul_f32 v45, v217, v217
v_mul_f32 v46, v218, v218
v_mul_f32 v47, v219, v219
v_fma_f32 v44, v44, v23, v21
v_fma_f32 v45, v45, v23, v21
v_fma_f32 v46, v46, v23, v21
v_mfma_f32_32x32x16_bf16 v[128:143], v[92:95], v[248:251], v[128:143]
ds_read_b64_tr_b16 v[88:89], v4 offset:20480
v_cvt_pk_bf16_f32 v77, v41, v79
v_mov_b32 v79, 0
v_fma_f32 v47, v47, v23, v21
v_mul_f32 v44, v44, v216
v_mul_f32 v45, v45, v217
v_mul_f32 v46, v46, v218
v_mul_f32 v47, v47, v219
v_exp_f32 v44, v44
v_mfma_f32_32x32x16_bf16 v[144:159], v[92:95], v[252:255], v[144:159]
ds_read_b64_tr_b16 v[90:91], v4 offset:20992
s_waitcnt lgkmcnt(2)
v_exp_f32 v45, v45
v_exp_f32 v46, v46
v_exp_f32 v47, v47
v_fma_f32 v44, v44, v25, v25
v_fma_f32 v45, v45, v25, v25
v_fma_f32 v46, v46, v25, v25
v_fma_f32 v47, v47, v25, v25
v_mfma_f32_32x32x16_bf16 v[96:111], v[72:75], v[28:31], v[96:111]
s_add_u32 m0, s3, 114688
s_add_u32 s61, s40, 0
buffer_load_dwordx4 v14, s[12:15], s61 offen lds
v_rcp_f32 v44, v44
v_rcp_f32 v45, v45
v_rcp_f32 v46, v46
v_mfma_f32_32x32x16_bf16 v[112:127], v[72:75], v[32:35], v[112:127]
v_rcp_f32 v47, v47
v_mul_f32 v216, v216, v44
v_mul_f32 v217, v217, v45
v_mul_f32 v218, v218, v46
v_mul_f32 v219, v219, v47
v_cvt_pk_bf16_f32 v216, v216, v217
v_cvt_pk_bf16_f32 v217, v218, v219
v_mul_f32 v44, v220, v220
v_mul_f32 v45, v221, v221
v_mul_f32 v46, v222, v222
v_mfma_f32_32x32x16_bf16 v[128:143], v[76:79], v[28:31], v[128:143]
v_mul_f32 v47, v223, v223
v_fma_f32 v44, v44, v23, v21
v_fma_f32 v45, v45, v23, v21
v_fma_f32 v46, v46, v23, v21
v_fma_f32 v47, v47, v23, v21
v_mul_f32 v44, v44, v220
v_mul_f32 v45, v45, v221
v_mul_f32 v46, v46, v222
v_mul_f32 v47, v47, v223
v_exp_f32 v44, v44
v_mfma_f32_32x32x16_bf16 v[144:159], v[76:79], v[32:35], v[144:159]
v_exp_f32 v45, v45
v_exp_f32 v46, v46
v_exp_f32 v47, v47
v_fma_f32 v44, v44, v25, v25
v_fma_f32 v45, v45, v25, v25
v_fma_f32 v46, v46, v25, v25
v_fma_f32 v47, v47, v25, v25
v_rcp_f32 v44, v44
v_mfma_f32_32x32x16_bf16 v[160:175], v[80:83], a[0:3], 0
buffer_load_dwordx4 v15, s[12:15], s61 offen offset:1024 lds
ds_read_b64_tr_b16 v[92:93], v4 offset:22528
v_rcp_f32 v45, v45
v_rcp_f32 v46, v46
v_rcp_f32 v47, v47
v_mfma_f32_32x32x16_bf16 v[176:191], v[80:83], a[4:7], 0
ds_read_b64_tr_b16 v[94:95], v4 offset:23040
v_mul_f32 v220, v220, v44
v_mul_f32 v221, v221, v45
v_mul_f32 v222, v222, v46
v_mul_f32 v223, v223, v47
v_cvt_pk_bf16_f32 v218, v220, v221
v_cvt_pk_bf16_f32 v219, v222, v223
s_add_u32 s99, s41, 87808
buffer_store_dwordx4 v[216:219], v31, s[16:19], s99 offen offset:2304 sc1
v_mfma_f32_32x32x16_bf16 v[160:175], v[84:87], a[8:11], v[160:175]
ds_read_b64_tr_b16 v[80:81], v3 offset:32768
v_mfma_f32_32x32x16_bf16 v[176:191], v[84:87], a[12:15], v[176:191]
ds_read_b64_tr_b16 v[82:83], v3 offset:33280
s_waitcnt lgkmcnt(2)
v_mul_f32 v44, v96, v96
v_mul_f32 v45, v97, v97
v_mul_f32 v46, v98, v98
v_mul_f32 v47, v99, v99
v_fma_f32 v44, v44, v22, v20
v_fma_f32 v45, v45, v22, v20
v_fma_f32 v46, v46, v22, v20
v_mfma_f32_32x32x16_bf16 v[160:175], v[88:91], a[16:19], v[160:175]
s_add_u32 m0, s3, 122880
s_add_u32 s61, s40, 128
buffer_load_dwordx4 v14, s[12:15], s61 offen lds
ds_read_b64_tr_b16 v[84:85], v3 offset:34816
v_fma_f32 v47, v47, v22, v20
v_mul_f32 v44, v44, v96
v_mfma_f32_32x32x16_bf16 v[176:191], v[88:91], a[20:23], v[176:191]
ds_read_b64_tr_b16 v[86:87], v3 offset:35328
v_mul_f32 v45, v45, v97
v_mul_f32 v46, v46, v98
v_mul_f32 v47, v47, v99
v_exp_f32 v44, v44
v_exp_f32 v45, v45
v_mfma_f32_32x32x16_bf16 v[160:175], v[92:95], a[24:27], v[160:175]
ds_read_b64_tr_b16 v[88:89], v3 offset:36864
v_exp_f32 v46, v46
v_exp_f32 v47, v47
v_fma_f32 v44, v44, v24, v24
v_fma_f32 v45, v45, v24, v24
v_fma_f32 v46, v46, v24, v24
v_fma_f32 v47, v47, v24, v24
v_mfma_f32_32x32x16_bf16 v[176:191], v[92:95], a[28:31], v[176:191]
ds_read_b64_tr_b16 v[90:91], v3 offset:37376
s_waitcnt lgkmcnt(2)
v_rcp_f32 v44, v44
v_rcp_f32 v45, v45
v_rcp_f32 v46, v46
v_rcp_f32 v47, v47
v_mfma_f32_32x32x16_bf16 v[160:175], v[80:83], a[32:35], v[160:175]
buffer_load_dwordx4 v15, s[12:15], s61 offen offset:1024 lds
ds_read_b64_tr_b16 v[92:93], v3 offset:38912
v_mul_f32 v96, v96, v44
v_mul_f32 v97, v97, v45
v_mul_f32 v98, v98, v46
v_mul_f32 v99, v99, v47
v_mfma_f32_32x32x16_bf16 v[176:191], v[80:83], a[36:39], v[176:191]
ds_read_b64_tr_b16 v[94:95], v3 offset:39424
v_cvt_pk_bf16_f32 v96, v96, v97
v_cvt_pk_bf16_f32 v97, v98, v99
v_mul_f32 v44, v100, v100
v_mul_f32 v45, v101, v101
v_mul_f32 v46, v102, v102
v_mul_f32 v47, v103, v103
v_fma_f32 v44, v44, v22, v20
v_fma_f32 v45, v45, v22, v20
v_mfma_f32_32x32x16_bf16 v[160:175], v[84:87], a[40:43], v[160:175]
ds_read_b64_tr_b16 v[80:81], v3 offset:0
v_fma_f32 v46, v46, v22, v20
v_fma_f32 v47, v47, v22, v20
v_mul_f32 v44, v44, v100
v_mul_f32 v45, v45, v101
v_mul_f32 v46, v46, v102
v_mul_f32 v47, v47, v103
v_exp_f32 v44, v44
v_mfma_f32_32x32x16_bf16 v[176:191], v[84:87], a[44:47], v[176:191]
ds_read_b64_tr_b16 v[82:83], v3 offset:512
s_waitcnt lgkmcnt(2)
v_exp_f32 v45, v45
v_exp_f32 v46, v46
v_exp_f32 v47, v47
v_fma_f32 v44, v44, v24, v24
v_mfma_f32_32x32x16_bf16 v[160:175], v[88:91], a[48:51], v[160:175]
ds_read_b64_tr_b16 v[84:85], v3 offset:2048
v_fma_f32 v45, v45, v24, v24
v_fma_f32 v46, v46, v24, v24
v_fma_f32 v47, v47, v24, v24
v_rcp_f32 v44, v44
v_rcp_f32 v45, v45
v_rcp_f32 v46, v46
v_mfma_f32_32x32x16_bf16 v[176:191], v[88:91], a[52:55], v[176:191]
ds_read_b64_tr_b16 v[86:87], v3 offset:2560
v_rcp_f32 v47, v47
v_mul_f32 v100, v100, v44
v_mul_f32 v101, v101, v45
v_mul_f32 v102, v102, v46
v_mul_f32 v103, v103, v47
v_cvt_pk_bf16_f32 v98, v100, v101
v_cvt_pk_bf16_f32 v99, v102, v103
v_mfma_f32_32x32x16_bf16 v[160:175], v[92:95], a[56:59], v[160:175]
ds_read_b64_tr_b16 v[88:89], v3 offset:4096
s_add_u32 s99, s41, 29184
buffer_store_dwordx4 v[96:99], v31, s[16:19], s99 offen offset:0 sc1
v_mul_f32 v44, v104, v104
v_mul_f32 v45, v105, v105
L_stub3:
s_cbranch_execz L_stub12
v_mul_f32 v46, v106, v106
v_mfma_f32_32x32x16_bf16 v[176:191], v[92:95], a[60:63], v[176:191]
ds_read_b64_tr_b16 v[90:91], v3 offset:4608
s_waitcnt lgkmcnt(2)
v_mul_f32 v47, v107, v107
v_fma_f32 v44, v44, v22, v20
v_fma_f32 v45, v45, v22, v20
v_fma_f32 v46, v46, v22, v20
v_fma_f32 v47, v47, v22, v20
v_mul_f32 v44, v44, v104
v_mul_f32 v45, v45, v105
v_mfma_f32_32x32x16_bf16 v[160:175], v[80:83], a[64:67], v[160:175]
ds_read_b64_tr_b16 v[92:93], v3 offset:6144
v_mul_f32 v46, v46, v106
v_mul_f32 v47, v47, v107
v_exp_f32 v44, v44
v_exp_f32 v45, v45
v_exp_f32 v46, v46
v_mfma_f32_32x32x16_bf16 v[176:191], v[80:83], a[68:71], v[176:191]
ds_read_b64_tr_b16 v[94:95], v3 offset:6656
v_exp_f32 v47, v47
v_fma_f32 v44, v44, v24, v24
v_fma_f32 v45, v45, v24, v24
v_fma_f32 v46, v46, v24, v24
v_fma_f32 v47, v47, v24, v24
v_rcp_f32 v44, v44
v_mfma_f32_32x32x16_bf16 v[160:175], v[84:87], a[72:75], v[160:175]
ds_read_b64_tr_b16 v[80:81], v3 offset:8192
v_rcp_f32 v45, v45
v_rcp_f32 v46, v46
v_rcp_f32 v47, v47
v_mul_f32 v104, v104, v44
v_mul_f32 v105, v105, v45
v_mfma_f32_32x32x16_bf16 v[176:191], v[84:87], a[76:79], v[176:191]
ds_read_b64_tr_b16 v[82:83], v3 offset:8704
s_waitcnt lgkmcnt(2)
v_mul_f32 v106, v106, v46
v_mul_f32 v107, v107, v47
v_cvt_pk_bf16_f32 v104, v104, v105
v_cvt_pk_bf16_f32 v105, v106, v107
v_mul_f32 v44, v108, v108
v_mul_f32 v45, v109, v109
v_mul_f32 v46, v110, v110
v_mfma_f32_32x32x16_bf16 v[160:175], v[88:91], a[80:83], v[160:175]
ds_read_b64_tr_b16 v[84:85], v3 offset:10240
s_lshl_b32 s63, s101, 2
s_add_u32 s63, s63, 98304
v_lshl_add_u32 v70, v0, 3, s63
buffer_load_dwordx2 v[68:69], v70, s[16:19], 0 offen sc1
v_mul_f32 v47, v111, v111
v_mfma_f32_32x32x16_bf16 v[176:191], v[88:91], a[84:87], v[176:191]
ds_read_b64_tr_b16 v[86:87], v3 offset:10752
v_fma_f32 v44, v44, v22, v20
v_fma_f32 v45, v45, v22, v20
v_fma_f32 v46, v46, v22, v20
v_fma_f32 v47, v47, v22, v20
v_mul_f32 v44, v44, v108
v_mul_f32 v45, v45, v109
v_mul_f32 v46, v46, v110
v_mul_f32 v47, v47, v111
v_mfma_f32_32x32x16_bf16 v[160:175], v[92:95], a[88:91], v[160:175]
ds_read_b64_tr_b16 v[88:89], v3 offset:12288
v_exp_f32 v44, v44
v_exp_f32 v45, v45
v_exp_f32 v46, v46
v_exp_f32 v47, v47
v_mfma_f32_32x32x16_bf16 v[176:191], v[92:95], a[92:95], v[176:191]
ds_read_b64_tr_b16 v[90:91], v3 offset:12800
s_waitcnt lgkmcnt(2)
v_fma_f32 v44, v44, v24, v24
v_fma_f32 v45, v45, v24, v24
v_fma_f32 v46, v46, v24, v24
v_fma_f32 v47, v47, v24, v24
v_rcp_f32 v44, v44
v_mfma_f32_32x32x16_bf16 v[160:175], v[80:83], a[96:99], v[160:175]
ds_read_b64_tr_b16 v[92:93], v3 offset:14336
v_rcp_f32 v45, v45
v_rcp_f32 v46, v46
v_rcp_f32 v47, v47
v_mul_f32 v108, v108, v44
v_mul_f32 v109, v109, v45
v_mul_f32 v110, v110, v46
v_mfma_f32_32x32x16_bf16 v[176:191], v[80:83], a[100:103], v[176:191]
ds_read_b64_tr_b16 v[94:95], v3 offset:14848
v_mul_f32 v111, v111, v47
v_cvt_pk_bf16_f32 v106, v108, v109
v_cvt_pk_bf16_f32 v107, v110, v111
s_add_u32 s99, s41, 29184
buffer_store_dwordx4 v[104:107], v31, s[16:19], s99 offen offset:256 sc1
v_mfma_f32_32x32x16_bf16 v[160:175], v[84:87], a[104:107], v[160:175]
ds_read_b64_tr_b16 v[80:81], v2 offset:24576
v_mul_f32 v44, v112, v112
v_mul_f32 v45, v113, v113
v_mul_f32 v46, v114, v114
v_mul_f32 v47, v115, v115
v_fma_f32 v44, v44, v23, v21
v_fma_f32 v45, v45, v23, v21
v_fma_f32 v46, v46, v23, v21
v_fma_f32 v47, v47, v23, v21
v_mfma_f32_32x32x16_bf16 v[176:191], v[84:87], a[108:111], v[176:191]
ds_read_b64_tr_b16 v[82:83], v2 offset:25088
s_waitcnt lgkmcnt(2)
v_mul_f32 v44, v44, v112
v_mul_f32 v45, v45, v113
v_mul_f32 v46, v46, v114
v_mul_f32 v47, v47, v115
v_exp_f32 v44, v44
v_mfma_f32_32x32x16_bf16 v[160:175], v[88:91], a[112:115], v[160:175]
ds_read_b64_tr_b16 v[84:85], v2 offset:26624
v_exp_f32 v45, v45
v_exp_f32 v46, v46
v_exp_f32 v47, v47
v_fma_f32 v44, v44, v25, v25
v_fma_f32 v45, v45, v25, v25
v_fma_f32 v46, v46, v25, v25
v_mfma_f32_32x32x16_bf16 v[176:191], v[88:91], a[116:119], v[176:191]
ds_read_b64_tr_b16 v[86:87], v2 offset:27136
v_fma_f32 v47, v47, v25, v25
v_rcp_f32 v44, v44
v_rcp_f32 v45, v45
v_rcp_f32 v46, v46
v_mfma_f32_32x32x16_bf16 v[160:175], v[92:95], a[120:123], v[160:175]
ds_read_b64_tr_b16 v[88:89], v2 offset:28672
v_rcp_f32 v47, v47
v_mul_f32 v112, v112, v44
v_mul_f32 v113, v113, v45
v_mul_f32 v114, v114, v46
v_mul_f32 v115, v115, v47
v_cvt_pk_bf16_f32 v112, v112, v113
v_cvt_pk_bf16_f32 v113, v114, v115
v_mul_f32 v44, v116, v116
v_mfma_f32_32x32x16_bf16 v[176:191], v[92:95], a[124:127], v[176:191]
ds_read_b64_tr_b16 v[90:91], v2 offset:29184
s_waitcnt lgkmcnt(2)
v_mul_f32 v45, v117, v117
v_mul_f32 v46, v118, v118
v_mul_f32 v47, v119, v119
v_fma_f32 v44, v44, v23, v21
v_fma_f32 v45, v45, v23, v21
v_fma_f32 v46, v46, v23, v21
v_fma_f32 v47, v47, v23, v21
v_mfma_f32_32x32x16_bf16 v[160:175], v[80:83], a[128:131], v[160:175]
ds_read_b64_tr_b16 v[92:93], v2 offset:30720
v_mul_f32 v44, v44, v116
v_mul_f32 v45, v45, v117
v_mul_f32 v46, v46, v118
v_mul_f32 v47, v47, v119
v_exp_f32 v44, v44
v_exp_f32 v45, v45
v_mfma_f32_32x32x16_bf16 v[176:191], v[80:83], a[132:135], v[176:191]
ds_read_b64_tr_b16 v[94:95], v2 offset:31232
v_exp_f32 v46, v46
v_exp_f32 v47, v47
v_fma_f32 v44, v44, v25, v25
v_fma_f32 v45, v45, v25, v25
v_fma_f32 v46, v46, v25, v25
v_fma_f32 v47, v47, v25, v25
v_mfma_f32_32x32x16_bf16 v[160:175], v[84:87], a[136:139], v[160:175]
ds_read_b64_tr_b16 v[80:81], v2 offset:40960
v_rcp_f32 v44, v44
v_rcp_f32 v45, v45
v_rcp_f32 v46, v46
v_rcp_f32 v47, v47
v_mfma_f32_32x32x16_bf16 v[176:191], v[84:87], a[140:143], v[176:191]
ds_read_b64_tr_b16 v[82:83], v2 offset:41472
s_waitcnt lgkmcnt(2)
v_mul_f32 v116, v116, v44
v_mul_f32 v117, v117, v45
v_mul_f32 v118, v118, v46
v_mul_f32 v119, v119, v47
v_cvt_pk_bf16_f32 v114, v116, v117
v_cvt_pk_bf16_f32 v115, v118, v119
s_add_u32 s99, s41, 116992
buffer_store_dwordx4 v[112:115], v31, s[16:19], s99 offen offset:0 sc1
v_mfma_f32_32x32x16_bf16 v[160:175], v[88:91], a[144:147], v[160:175]
ds_read_b64_tr_b16 v[84:85], v2 offset:43008
v_mul_f32 v44, v120, v120
v_mul_f32 v45, v121, v121
v_mul_f32 v46, v122, v122
v_mul_f32 v47, v123, v123
v_fma_f32 v44, v44, v23, v21
v_mfma_f32_32x32x16_bf16 v[176:191], v[88:91], a[148:151], v[176:191]
ds_read_b64_tr_b16 v[86:87], v2 offset:43520
s_waitcnt vmcnt(6)
buffer_store_dword v13, v26, s[16:19], s60 offen offset:0 sc1
v_fma_f32 v45, v45, v23, v21
v_fma_f32 v46, v46, v23, v21
v_fma_f32 v47, v47, v23, v21
v_mfma_f32_32x32x16_bf16 v[160:175], v[92:95], a[152:155], v[160:175]
ds_read_b64_tr_b16 v[88:89], v2 offset:45056
v_mul_f32 v44, v44, v120
v_mul_f32 v45, v45, v121
v_mul_f32 v46, v46, v122
v_mul_f32 v47, v47, v123
v_exp_f32 v44, v44
v_exp_f32 v45, v45
v_mfma_f32_32x32x16_bf16 v[176:191], v[92:95], a[156:159], v[176:191]
ds_read_b64_tr_b16 v[90:91], v2 offset:45568
s_waitcnt lgkmcnt(2)
v_exp_f32 v46, v46
v_exp_f32 v47, v47
v_fma_f32 v44, v44, v25, v25
v_fma_f32 v45, v45, v25, v25
v_fma_f32 v46, v46, v25, v25
v_mfma_f32_32x32x16_bf16 v[160:175], v[80:83], a[160:163], v[160:175]
ds_read_b64_tr_b16 v[92:93], v2 offset:47104
v_fma_f32 v47, v47, v25, v25
v_rcp_f32 v44, v44
v_rcp_f32 v45, v45
v_rcp_f32 v46, v46
v_mfma_f32_32x32x16_bf16 v[176:191], v[80:83], a[164:167], v[176:191]
ds_read_b64_tr_b16 v[94:95], v2 offset:47616
v_rcp_f32 v47, v47
v_mul_f32 v120, v120, v44
v_mul_f32 v121, v121, v45
v_mul_f32 v122, v122, v46
v_mul_f32 v123, v123, v47
v_cvt_pk_bf16_f32 v120, v120, v121
v_cvt_pk_bf16_f32 v121, v122, v123
v_mul_f32 v44, v124, v124
v_mfma_f32_32x32x16_bf16 v[160:175], v[84:87], a[168:171], v[160:175]
ds_read_b64_tr_b16 v[80:81], v2 offset:57344
v_mul_f32 v45, v125, v125
v_mul_f32 v46, v126, v126
v_mul_f32 v47, v127, v127
v_fma_f32 v44, v44, v23, v21
v_fma_f32 v45, v45, v23, v21
v_fma_f32 v46, v46, v23, v21
v_fma_f32 v47, v47, v23, v21
v_mul_f32 v44, v44, v124
v_mfma_f32_32x32x16_bf16 v[176:191], v[84:87], a[172:175], v[176:191]
ds_read_b64_tr_b16 v[82:83], v2 offset:57856
s_waitcnt lgkmcnt(2)
v_mul_f32 v45, v45, v125
v_mul_f32 v46, v46, v126
v_mul_f32 v47, v47, v127
v_exp_f32 v44, v44
v_exp_f32 v45, v45
v_mfma_f32_32x32x16_bf16 v[160:175], v[88:91], a[176:179], v[160:175]
ds_read_b64_tr_b16 v[84:85], v2 offset:59392
v_exp_f32 v46, v46
v_exp_f32 v47, v47
v_fma_f32 v44, v44, v25, v25
v_fma_f32 v45, v45, v25, v25
v_fma_f32 v46, v46, v25, v25
v_fma_f32 v47, v47, v25, v25
v_mfma_f32_32x32x16_bf16 v[176:191], v[88:91], a[180:183], v[176:191]
ds_read_b64_tr_b16 v[86:87], v2 offset:59904
v_rcp_f32 v44, v44
v_rcp_f32 v45, v45
v_rcp_f32 v46, v46
v_rcp_f32 v47, v47
v_mfma_f32_32x32x16_bf16 v[160:175], v[92:95], a[184:187], v[160:175]
ds_read_b64_tr_b16 v[88:89], v2 offset:61440
v_mul_f32 v124, v124, v44
v_mul_f32 v125, v125, v45
v_mul_f32 v126, v126, v46
v_mul_f32 v127, v127, v47
v_cvt_pk_bf16_f32 v122, v124, v125
v_cvt_pk_bf16_f32 v123, v126, v127
s_add_u32 s99, s41, 116992
buffer_store_dwordx4 v[120:123], v31, s[16:19], s99 offen offset:256 sc1
v_mfma_f32_32x32x16_bf16 v[176:191], v[92:95], a[188:191], v[176:191]
ds_read_b64_tr_b16 v[90:91], v2 offset:61952
s_waitcnt lgkmcnt(2)
v_mul_f32 v44, v128, v128
v_mul_f32 v45, v129, v129
v_mul_f32 v46, v130, v130
v_mul_f32 v47, v131, v131
v_fma_f32 v44, v44, v22, v20
v_mfma_f32_32x32x16_bf16 v[160:175], v[80:83], a[192:195], v[160:175]
ds_read_b64_tr_b16 v[92:93], v2 offset:63488
v_fma_f32 v45, v45, v22, v20
v_fma_f32 v46, v46, v22, v20
v_fma_f32 v47, v47, v22, v20
v_mul_f32 v44, v44, v128
v_mul_f32 v45, v45, v129
v_mul_f32 v46, v46, v130
v_mul_f32 v47, v47, v131
v_mfma_f32_32x32x16_bf16 v[176:191], v[80:83], a[196:199], v[176:191]
ds_read_b64_tr_b16 v[94:95], v2 offset:64000
v_exp_f32 v44, v44
v_exp_f32 v45, v45
v_exp_f32 v46, v46
v_exp_f32 v47, v47
v_fma_f32 v44, v44, v24, v24
v_mfma_f32_32x32x16_bf16 v[160:175], v[84:87], a[200:203], v[160:175]
ds_read_b64_tr_b16 v[80:81], v3 offset:16384
v_fma_f32 v45, v45, v24, v24
v_fma_f32 v46, v46, v24, v24
v_fma_f32 v47, v47, v24, v24
v_rcp_f32 v44, v44
v_rcp_f32 v45, v45
v_mfma_f32_32x32x16_bf16 v[176:191], v[84:87], a[204:207], v[176:191]
ds_read_b64_tr_b16 v[82:83], v3 offset:16896
s_waitcnt lgkmcnt(2)
v_rcp_f32 v46, v46
v_rcp_f32 v47, v47
v_mul_f32 v128, v128, v44
v_mul_f32 v129, v129, v45
v_mul_f32 v130, v130, v46
v_mul_f32 v131, v131, v47
v_mfma_f32_32x32x16_bf16 v[160:175], v[88:91], a[208:211], v[160:175]
ds_read_b64_tr_b16 v[84:85], v3 offset:18432
s_barrier
v_cvt_pk_bf16_f32 v128, v128, v129
v_cvt_pk_bf16_f32 v129, v130, v131
v_mul_f32 v44, v132, v132
v_mul_f32 v45, v133, v133
v_mul_f32 v46, v134, v134
v_mul_f32 v47, v135, v135
v_mfma_f32_32x32x16_bf16 v[176:191], v[88:91], a[212:215], v[176:191]
s_add_u32 m0, s3, 131072
s_add_u32 s61, s64, 221184
buffer_load_dwordx4 v14, s[12:15], s61 offen lds
ds_read_b64_tr_b16 v[86:87], v3 offset:18944
v_fma_f32 v44, v44, v22, v20
v_fma_f32 v45, v45, v22, v20
v_mfma_f32_32x32x16_bf16 v[160:175], v[92:95], a[216:219], v[160:175]
ds_read_b64_tr_b16 v[88:89], v3 offset:20480
v_fma_f32 v46, v46, v22, v20
v_fma_f32 v47, v47, v22, v20
v_mul_f32 v44, v44, v132
v_mul_f32 v45, v45, v133
v_mul_f32 v46, v46, v134
v_mul_f32 v47, v47, v135
v_exp_f32 v44, v44
v_mfma_f32_32x32x16_bf16 v[176:191], v[92:95], a[220:223], v[176:191]
ds_read_b64_tr_b16 v[90:91], v3 offset:20992
s_waitcnt lgkmcnt(2)
v_exp_f32 v45, v45
v_exp_f32 v46, v46
v_exp_f32 v47, v47
v_fma_f32 v44, v44, v24, v24
v_mfma_f32_32x32x16_bf16 v[160:175], v[80:83], a[224:227], v[160:175]
ds_read_b64_tr_b16 v[92:93], v3 offset:22528
v_fma_f32 v45, v45, v24, v24
v_fma_f32 v46, v46, v24, v24
v_fma_f32 v47, v47, v24, v24
v_rcp_f32 v44, v44
v_rcp_f32 v45, v45
v_mfma_f32_32x32x16_bf16 v[176:191], v[80:83], a[228:231], v[176:191]
buffer_load_dwordx4 v15, s[12:15], s61 offen offset:1024 lds
ds_read_b64_tr_b16 v[94:95], v3 offset:23040
v_rcp_f32 v46, v46
v_rcp_f32 v47, v47
v_mul_f32 v132, v132, v44
v_mfma_f32_32x32x16_bf16 v[160:175], v[84:87], a[232:235], v[160:175]
ds_read_b64_tr_b16 v[80:81], v2 offset:32768
v_mul_f32 v133, v133, v45
v_mul_f32 v134, v134, v46
v_mul_f32 v135, v135, v47
v_cvt_pk_bf16_f32 v130, v132, v133
v_cvt_pk_bf16_f32 v131, v134, v135
s_add_u32 s99, s41, 29184
buffer_store_dwordx4 v[128:131], v31, s[16:19], s99 offen offset:2048 sc1
v_mfma_f32_32x32x16_bf16 v[176:191], v[84:87], a[236:239], v[176:191]
ds_read_b64_tr_b16 v[82:83], v2 offset:33280
s_waitcnt lgkmcnt(2)
v_mul_f32 v44, v136, v136
v_mul_f32 v45, v137, v137
v_mul_f32 v46, v138, v138
v_mul_f32 v47, v139, v139
v_fma_f32 v44, v44, v22, v20
v_mfma_f32_32x32x16_bf16 v[160:175], v[88:91], a[240:243], v[160:175]
ds_read_b64_tr_b16 v[84:85], v2 offset:34816
v_fma_f32 v45, v45, v22, v20
v_fma_f32 v46, v46, v22, v20
v_fma_f32 v47, v47, v22, v20
v_mul_f32 v44, v44, v136
v_mul_f32 v45, v45, v137
v_mul_f32 v46, v46, v138
v_mul_f32 v47, v47, v139
v_mfma_f32_32x32x16_bf16 v[176:191], v[88:91], a[244:247], v[176:191]
ds_read_b64_tr_b16 v[86:87], v2 offset:35328
s_waitcnt vmcnt(7)
v_cmp_ne_u32 vcc, s45, v69
s_nop 0
s_cmp_lg_u64 vcc, 0
s_cbranch_scc1 csM2_slow
csM2_ok:
v_mov_b32 v49, v68
v_exp_f32 v44, v44
v_exp_f32 v45, v45
v_mfma_f32_32x32x16_bf16 v[160:175], v[92:95], a[248:251], v[160:175]
ds_read_b64_tr_b16 v[88:89], v2 offset:36864
v_mov_b32 v37, v68
s_nop 1
v_permlane32_swap_b32 v68, v37
v_exp_f32 v46, v46
v_exp_f32 v47, v47
v_fma_f32 v44, v44, v24, v24
v_fma_f32 v45, v45, v24, v24
v_fma_f32 v46, v46, v24, v24
v_mfma_f32_32x32x16_bf16 v[176:191], v[92:95], a[252:255], v[176:191]
ds_read_b64_tr_b16 v[90:91], v2 offset:37376
s_waitcnt lgkmcnt(2)
v_mov_b32 v50, v35
v_fma_f32 v47, v47, v24, v24
v_rcp_f32 v44, v44
v_rcp_f32 v45, v45
v_mfma_f32_32x32x16_bf16 v[160:175], v[80:83], v[224:227], v[160:175]
ds_read_b64_tr_b16 v[92:93], v2 offset:38912
v_cvt_pk_bf16_f32 v48, v49, v49
v_lshlrev_b32 v8, 16, v48
v_rcp_f32 v46, v46
v_rcp_f32 v47, v47
v_mul_f32 v136, v136, v44
v_mul_f32 v137, v137, v45
v_mul_f32 v138, v138, v46
v_mfma_f32_32x32x16_bf16 v[176:191], v[80:83], v[228:231], v[176:191]
ds_read_b64_tr_b16 v[94:95], v2 offset:39424
v_lshlrev_b32 v51, 16, v50
v_sub_f32 v8, v49, v8
v_cvt_pk_bf16_f32 v49, v8, v51
v_mul_f32 v139, v139, v47
v_cvt_pk_bf16_f32 v136, v136, v137
v_cvt_pk_bf16_f32 v137, v138, v139
v_mul_f32 v44, v140, v140
v_mul_f32 v45, v141, v141
v_mfma_f32_32x32x16_bf16 v[160:175], v[84:87], v[232:235], v[160:175]
ds_read_b64_tr_b16 v[80:81], v7 offset:16384
v_mov_b32 v51, 0
v_mov_b32 v38, v35
v_mul_f32 v46, v142, v142
v_mul_f32 v47, v143, v143
v_fma_f32 v44, v44, v22, v20
v_fma_f32 v45, v45, v22, v20
v_fma_f32 v46, v46, v22, v20
v_fma_f32 v47, v47, v22, v20
v_mfma_f32_32x32x16_bf16 v[176:191], v[84:87], v[236:239], v[176:191]
ds_read_b64_tr_b16 v[82:83], v7 offset:16896
s_waitcnt lgkmcnt(2)
v_permlane32_swap_b32 v35, v38
v_mul_f32 v44, v44, v140
v_mul_f32 v45, v45, v141
v_mul_f32 v46, v46, v142
v_mul_f32 v47, v47, v143
v_exp_f32 v44, v44
v_mfma_f32_32x32x16_bf16 v[160:175], v[88:91], v[240:243], v[160:175]
ds_read_b64_tr_b16 v[84:85], v7 offset:18432
v_cvt_pk_bf16_f32 v36, v37, v37
v_lshlrev_b32 v9, 16, v36
v_exp_f32 v45, v45
v_exp_f32 v46, v46
v_exp_f32 v47, v47
v_mfma_f32_32x32x16_bf16 v[176:191], v[88:91], v[244:247], v[176:191]
ds_read_b64_tr_b16 v[86:87], v7 offset:18944
v_lshlrev_b32 v39, 16, v38
v_sub_f32 v9, v37, v9
v_fma_f32 v44, v44, v24, v24
v_fma_f32 v45, v45, v24, v24
v_fma_f32 v46, v46, v24, v24
v_fma_f32 v47, v47, v24, v24
v_rcp_f32 v44, v44
v_mfma_f32_32x32x16_bf16 v[160:175], v[92:95], v[248:251], v[160:175]
ds_read_b64_tr_b16 v[88:89], v7 offset:20480
v_cvt_pk_bf16_f32 v37, v9, v39
v_mov_b32 v39, 0
v_rcp_f32 v45, v45
v_rcp_f32 v46, v46
v_rcp_f32 v47, v47
v_mul_f32 v140, v140, v44
v_mfma_f32_32x32x16_bf16 v[176:191], v[92:95], v[252:255], v[176:191]
ds_read_b64_tr_b16 v[90:91], v7 offset:20992
s_waitcnt lgkmcnt(2)
v_mul_f32 v141, v141, v45
v_mul_f32 v142, v142, v46
v_mul_f32 v143, v143, v47
v_cvt_pk_bf16_f32 v138, v140, v141
v_cvt_pk_bf16_f32 v139, v142, v143
s_add_u32 s99, s41, 29184
buffer_store_dwordx4 v[136:139], v31, s[16:19], s99 offen offset:2304 sc1
v_mfma_f32_32x32x16_bf16 v[160:175], v[48:51], v[28:31], v[160:175]
v_mul_f32 v44, v144, v144
v_mul_f32 v45, v145, v145
v_mul_f32 v46, v146, v146
v_mul_f32 v47, v147, v147
v_fma_f32 v44, v44, v23, v21
v_fma_f32 v45, v45, v23, v21
v_mfma_f32_32x32x16_bf16 v[176:191], v[48:51], v[32:35], v[176:191]
v_fma_f32 v46, v46, v23, v21
v_fma_f32 v47, v47, v23, v21
v_mul_f32 v44, v44, v144
v_mul_f32 v45, v45, v145
v_mul_f32 v46, v46, v146
v_mul_f32 v47, v47, v147
v_exp_f32 v44, v44
v_mfma_f32_32x32x16_bf16 v[192:207], v[36:39], v[28:31], 0
v_exp_f32 v45, v45
v_exp_f32 v46, v46
v_exp_f32 v47, v47
v_fma_f32 v44, v44, v25, v25
v_fma_f32 v45, v45, v25, v25
v_fma_f32 v46, v46, v25, v25
v_fma_f32 v47, v47, v25, v25
v_mfma_f32_32x32x16_bf16 v[208:223], v[36:39], v[32:35], 0
v_rcp_f32 v44, v44
v_rcp_f32 v45, v45
v_rcp_f32 v46, v46
v_rcp_f32 v47, v47
v_mul_f32 v144, v144, v44
v_mfma_f32_32x32x16_bf16 v[192:207], v[80:83], a[0:3], v[192:207]
ds_read_b64_tr_b16 v[92:93], v7 offset:22528
v_mul_f32 v145, v145, v45
v_mul_f32 v146, v146, v46
v_mul_f32 v147, v147, v47
v_cvt_pk_bf16_f32 v144, v144, v145
v_cvt_pk_bf16_f32 v145, v146, v147
v_mul_f32 v44, v148, v148
v_mul_f32 v45, v149, v149
v_mul_f32 v46, v150, v150
v_mfma_f32_32x32x16_bf16 v[208:223], v[80:83], a[4:7], v[208:223]
ds_read_b64_tr_b16 v[94:95], v7 offset:23040
v_mul_f32 v47, v151, v151
v_fma_f32 v44, v44, v23, v21
v_fma_f32 v45, v45, v23, v21
v_fma_f32 v46, v46, v23, v21
v_fma_f32 v47, v47, v23, v21
v_mul_f32 v44, v44, v148
v_mul_f32 v45, v45, v149
v_mul_f32 v46, v46, v150
v_mfma_f32_32x32x16_bf16 v[192:207], v[84:87], a[8:11], v[192:207]
ds_read_b64_tr_b16 v[80:81], v6 offset:32768
v_and_b32 v8, 15, v0
v_lshlrev_b32 v8, 7, v8
v_bfe_u32 v9, v0, 1, 3
v_lshrrev_b32 v10, 4, v0
v_xor_b32 v9, v9, v10
v_lshl_add_u32 v8, v9, 4, v8
v_xor_b32 v9, 64, v8
v_mul_f32 v47, v47, v151
v_mfma_f32_32x32x16_bf16 v[208:223], v[84:87], a[12:15], v[208:223]
ds_read_b64_tr_b16 v[82:83], v6 offset:33280
s_waitcnt lgkmcnt(2)
v_exp_f32 v44, v44
v_exp_f32 v45, v45
v_exp_f32 v46, v46
v_mfma_f32_32x32x16_bf16 v[192:207], v[88:91], a[16:19], v[192:207]
ds_read_b64_tr_b16 v[84:85], v6 offset:34816
v_exp_f32 v47, v47
v_fma_f32 v44, v44, v25, v25
v_fma_f32 v45, v45, v25, v25
v_fma_f32 v46, v46, v25, v25
v_fma_f32 v47, v47, v25, v25
v_rcp_f32 v44, v44
v_mfma_f32_32x32x16_bf16 v[208:223], v[88:91], a[20:23], v[208:223]
ds_read_b64_tr_b16 v[86:87], v6 offset:35328
v_rcp_f32 v45, v45
v_rcp_f32 v46, v46
v_rcp_f32 v47, v47
v_mul_f32 v148, v148, v44
v_mul_f32 v149, v149, v45
v_mul_f32 v150, v150, v46
v_mfma_f32_32x32x16_bf16 v[192:207], v[92:95], a[24:27], v[192:207]
ds_read_b64_tr_b16 v[88:89], v6 offset:36864
v_mul_f32 v151, v151, v47
v_cvt_pk_bf16_f32 v146, v148, v149
v_cvt_pk_bf16_f32 v147, v150, v151
s_add_u32 s99, s41, 116992
buffer_store_dwordx4 v[144:147], v31, s[16:19], s99 offen offset:2048 sc1
v_mfma_f32_32x32x16_bf16 v[208:223], v[92:95], a[28:31], v[208:223]
ds_read_b64_tr_b16 v[90:91], v6 offset:37376
s_waitcnt lgkmcnt(2)
v_mul_f32 v44, v152, v152
v_mul_f32 v45, v153, v153
v_mul_f32 v46, v154, v154
v_mul_f32 v47, v155, v155
v_fma_f32 v44, v44, v23, v21
v_fma_f32 v45, v45, v23, v21
v_fma_f32 v46, v46, v23, v21
v_mfma_f32_32x32x16_bf16 v[192:207], v[80:83], a[32:35], v[192:207]
ds_read_b64_tr_b16 v[92:93], v6 offset:38912
v_fma_f32 v47, v47, v23, v21
v_mul_f32 v44, v44, v152
v_mul_f32 v45, v45, v153
v_mul_f32 v46, v46, v154
v_mul_f32 v47, v47, v155
v_exp_f32 v44, v44
v_mfma_f32_32x32x16_bf16 v[208:223], v[80:83], a[36:39], v[208:223]
ds_read_b64_tr_b16 v[94:95], v6 offset:39424
v_exp_f32 v45, v45
v_exp_f32 v46, v46
v_exp_f32 v47, v47
v_fma_f32 v44, v44, v25, v25
v_fma_f32 v45, v45, v25, v25
v_fma_f32 v46, v46, v25, v25
v_mfma_f32_32x32x16_bf16 v[192:207], v[84:87], a[40:43], v[192:207]
ds_read_b64_tr_b16 v[80:81], v6 offset:0
s_add_u32 s63, s73, 0
s_load_dwordx8 s[52:59], s[16:17], s63 glc
v_fma_f32 v47, v47, v25, v25
v_rcp_f32 v44, v44
v_rcp_f32 v45, v45
v_mfma_f32_32x32x16_bf16 v[208:223], v[84:87], a[44:47], v[208:223]
ds_read_b64_tr_b16 v[82:83], v6 offset:512
s_waitcnt lgkmcnt(2)
v_rcp_f32 v46, v46
v_rcp_f32 v47, v47
v_mul_f32 v152, v152, v44
v_mul_f32 v153, v153, v45
v_mul_f32 v154, v154, v46
v_mul_f32 v155, v155, v47
v_mfma_f32_32x32x16_bf16 v[192:207], v[88:91], a[48:51], v[192:207]
ds_read_b64_tr_b16 v[84:85], v6 offset:2048
v_cvt_pk_bf16_f32 v152, v152, v153
v_cvt_pk_bf16_f32 v153, v154, v155
v_mul_f32 v44, v156, v156
v_mul_f32 v45, v157, v157
v_mul_f32 v46, v158, v158
v_mul_f32 v47, v159, v159
v_fma_f32 v44, v44, v23, v21
v_fma_f32 v45, v45, v23, v21
v_mfma_f32_32x32x16_bf16 v[208:223], v[88:91], a[52:55], v[208:223]
ds_read_b64_tr_b16 v[86:87], v6 offset:2560
v_fma_f32 v46, v46, v23, v21
v_fma_f32 v47, v47, v23, v21
v_mul_f32 v44, v44, v156
v_mul_f32 v45, v45, v157
v_mul_f32 v46, v46, v158
v_mul_f32 v47, v47, v159
v_exp_f32 v44, v44
v_mfma_f32_32x32x16_bf16 v[192:207], v[92:95], a[56:59], v[192:207]
ds_read_b64_tr_b16 v[88:89], v6 offset:4096
v_exp_f32 v45, v45
v_exp_f32 v46, v46
v_exp_f32 v47, v47
v_fma_f32 v44, v44, v25, v25
v_fma_f32 v45, v45, v25, v25
v_mfma_f32_32x32x16_bf16 v[208:223], v[92:95], a[60:63], v[208:223]
ds_read_b64_tr_b16 v[90:91], v6 offset:4608
s_waitcnt lgkmcnt(2)
v_fma_f32 v46, v46, v25, v25
v_fma_f32 v47, v47, v25, v25
v_rcp_f32 v44, v44
v_rcp_f32 v45, v45
v_mfma_f32_32x32x16_bf16 v[192:207], v[80:83], a[64:67], v[192:207]
ds_read_b64_tr_b16 v[92:93], v6 offset:6144
v_rcp_f32 v46, v46
v_rcp_f32 v47, v47
v_mul_f32 v156, v156, v44
v_mul_f32 v157, v157, v45
v_mul_f32 v158, v158, v46
v_mul_f32 v159, v159, v47
v_cvt_pk_bf16_f32 v154, v156, v157
v_mfma_f32_32x32x16_bf16 v[208:223], v[80:83], a[68:71], v[208:223]
ds_read_b64_tr_b16 v[94:95], v6 offset:6656
v_cvt_pk_bf16_f32 v155, v158, v159
s_add_u32 s99, s41, 116992
buffer_store_dwordx4 v[152:155], v31, s[16:19], s99 offen offset:2304 sc1
v_mul_f32 v44, v160, v160
v_mul_f32 v45, v161, v161
v_mfma_f32_32x32x16_bf16 v[192:207], v[84:87], a[72:75], v[192:207]
ds_read_b64_tr_b16 v[80:81], v6 offset:8192
v_mul_f32 v46, v162, v162
v_mul_f32 v47, v163, v163
v_fma_f32 v44, v44, v22, v20
v_fma_f32 v45, v45, v22, v20
v_fma_f32 v46, v46, v22, v20
v_fma_f32 v47, v47, v22, v20
v_mul_f32 v44, v44, v160
v_mul_f32 v45, v45, v161
v_mfma_f32_32x32x16_bf16 v[208:223], v[84:87], a[76:79], v[208:223]
ds_read_b64_tr_b16 v[82:83], v6 offset:8704
s_waitcnt lgkmcnt(2)
v_mul_f32 v46, v46, v162
v_mul_f32 v47, v47, v163
v_exp_f32 v44, v44
v_exp_f32 v45, v45
v_mfma_f32_32x32x16_bf16 v[192:207], v[88:91], a[80:83], v[192:207]
ds_read_b64_tr_b16 v[84:85], v6 offset:10240
v_exp_f32 v46, v46
v_exp_f32 v47, v47
v_fma_f32 v44, v44, v24, v24
v_fma_f32 v45, v45, v24, v24
v_fma_f32 v46, v46, v24, v24
v_fma_f32 v47, v47, v24, v24
v_mfma_f32_32x32x16_bf16 v[208:223], v[88:91], a[84:87], v[208:223]
ds_read_b64_tr_b16 v[86:87], v6 offset:10752
v_rcp_f32 v44, v44
v_rcp_f32 v45, v45
v_rcp_f32 v46, v46
v_rcp_f32 v47, v47
v_mul_f32 v160, v160, v44
v_mfma_f32_32x32x16_bf16 v[192:207], v[92:95], a[88:91], v[192:207]
L_stub4:
s_cbranch_execz L_stub15
ds_read_b64_tr_b16 v[88:89], v6 offset:12288
v_mul_f32 v161, v161, v45
v_mul_f32 v162, v162, v46
v_mul_f32 v163, v163, v47
v_cvt_pk_bf16_f32 v160, v160, v161
v_cvt_pk_bf16_f32 v161, v162, v163
v_mul_f32 v44, v164, v164
v_mul_f32 v45, v165, v165
v_mul_f32 v46, v166, v166
v_mfma_f32_32x32x16_bf16 v[208:223], v[92:95], a[92:95], v[208:223]
ds_read_b64_tr_b16 v[90:91], v6 offset:12800
s_waitcnt lgkmcnt(2)
v_mul_f32 v47, v167, v167
v_fma_f32 v44, v44, v22, v20
v_fma_f32 v45, v45, v22, v20
v_fma_f32 v46, v46, v22, v20
v_fma_f32 v47, v47, v22, v20
v_mul_f32 v44, v44, v164
v_mul_f32 v45, v45, v165
v_mfma_f32_32x32x16_bf16 v[192:207], v[80:83], a[96:99], v[192:207]
ds_read_b64_tr_b16 v[92:93], v6 offset:14336
v_mul_f32 v46, v46, v166
v_mul_f32 v47, v47, v167
v_exp_f32 v44, v44
v_exp_f32 v45, v45
v_exp_f32 v46, v46
v_mfma_f32_32x32x16_bf16 v[208:223], v[80:83], a[100:103], v[208:223]
ds_read_b64_tr_b16 v[94:95], v6 offset:14848
v_exp_f32 v47, v47
v_fma_f32 v44, v44, v24, v24
v_fma_f32 v45, v45, v24, v24
v_fma_f32 v46, v46, v24, v24
v_fma_f32 v47, v47, v24, v24
v_rcp_f32 v44, v44
v_mfma_f32_32x32x16_bf16 v[192:207], v[84:87], a[104:107], v[192:207]
ds_read_b64_tr_b16 v[80:81], v5 offset:24576
v_rcp_f32 v45, v45
v_rcp_f32 v46, v46
v_rcp_f32 v47, v47
v_mul_f32 v164, v164, v44
v_mul_f32 v165, v165, v45
v_mul_f32 v166, v166, v46
v_mfma_f32_32x32x16_bf16 v[208:223], v[84:87], a[108:111], v[208:223]
ds_read_b64_tr_b16 v[82:83], v5 offset:25088
s_waitcnt lgkmcnt(2)
v_mul_f32 v167, v167, v47
v_cvt_pk_bf16_f32 v162, v164, v165
v_cvt_pk_bf16_f32 v163, v166, v167
s_add_u32 s99, s41, 58368
buffer_store_dwordx4 v[160:163], v31, s[16:19], s99 offen offset:0 sc1
v_mfma_f32_32x32x16_bf16 v[192:207], v[88:91], a[112:115], v[192:207]
ds_read_b64_tr_b16 v[84:85], v5 offset:26624
s_waitcnt lgkmcnt(0)
s_xor_b64 s[52:53], s[52:53], s[42:43]
s_xor_b64 s[54:55], s[54:55], s[42:43]
s_or_b64 s[52:53], s[52:53], s[54:55]
s_xor_b64 s[56:57], s[56:57], s[42:43]
s_or_b64 s[52:53], s[52:53], s[56:57]
s_cbranch_scc1 fh1_slow
fh1_ok:
v_mul_f32 v44, v168, v168
v_mfma_f32_32x32x16_bf16 v[208:223], v[88:91], a[116:119], v[208:223]
s_add_u32 s0, s83, 0
buffer_load_dwordx4 a[0:3], v1, s[16:19], s0 offen offset:0 sc1
ds_read_b64_tr_b16 v[86:87], v5 offset:27136
v_mul_f32 v45, v169, v169
v_mul_f32 v46, v170, v170
v_mul_f32 v47, v171, v171
v_mfma_f32_32x32x16_bf16 v[192:207], v[92:95], a[120:123], v[192:207]
ds_read_b64_tr_b16 v[88:89], v5 offset:28672
s_barrier
v_fma_f32 v44, v44, v22, v20
v_fma_f32 v45, v45, v22, v20
v_fma_f32 v46, v46, v22, v20
v_fma_f32 v47, v47, v22, v20
v_mul_f32 v44, v44, v168
v_mul_f32 v45, v45, v169
v_mul_f32 v46, v46, v170
v_mfma_f32_32x32x16_bf16 v[208:223], v[92:95], a[124:127], v[208:223]
buffer_load_dwordx4 a[4:7], v1, s[16:19], s0 offen offset:1024 sc1
ds_read_b64_tr_b16 v[90:91], v5 offset:29184
s_waitcnt lgkmcnt(2)
v_mul_f32 v47, v47, v171
v_exp_f32 v44, v44
v_mfma_f32_32x32x16_bf16 v[192:207], v[80:83], a[128:131], v[192:207]
ds_read_b64_tr_b16 v[92:93], v5 offset:30720
v_exp_f32 v45, v45
v_exp_f32 v46, v46
v_exp_f32 v47, v47
v_fma_f32 v44, v44, v24, v24
v_fma_f32 v45, v45, v24, v24
v_mfma_f32_32x32x16_bf16 v[208:223], v[80:83], a[132:135], v[208:223]
buffer_load_dwordx4 a[8:11], v1, s[16:19], s0 offen offset:2048 sc1
ds_read_b64_tr_b16 v[94:95], v5 offset:31232
v_fma_f32 v46, v46, v24, v24
v_fma_f32 v47, v47, v24, v24
v_rcp_f32 v44, v44
v_mfma_f32_32x32x16_bf16 v[192:207], v[84:87], a[136:139], v[192:207]
ds_read_b64_tr_b16 v[80:81], v5 offset:40960
v_rcp_f32 v45, v45
v_rcp_f32 v46, v46
v_rcp_f32 v47, v47
v_mul_f32 v168, v168, v44
v_mul_f32 v169, v169, v45
v_mfma_f32_32x32x16_bf16 v[208:223], v[84:87], a[140:143], v[208:223]
buffer_load_dwordx4 a[12:15], v1, s[16:19], s0 offen offset:3072 sc1
ds_read_b64_tr_b16 v[82:83], v5 offset:41472
s_waitcnt lgkmcnt(2)
v_mul_f32 v170, v170, v46
v_mul_f32 v171, v171, v47
v_cvt_pk_bf16_f32 v168, v168, v169
v_mfma_f32_32x32x16_bf16 v[192:207], v[88:91], a[144:147], v[192:207]
ds_read_b64_tr_b16 v[84:85], v5 offset:43008
v_cvt_pk_bf16_f32 v169, v170, v171
v_mul_f32 v44, v172, v172
v_mul_f32 v45, v173, v173
v_mul_f32 v46, v174, v174
v_mul_f32 v47, v175, v175
v_fma_f32 v44, v44, v22, v20
v_fma_f32 v45, v45, v22, v20
v_fma_f32 v46, v46, v22, v20
v_mfma_f32_32x32x16_bf16 v[208:223], v[88:91], a[148:151], v[208:223]
s_add_u32 s0, s86, 0
buffer_load_dwordx4 a[16:19], v1, s[16:19], s0 offen offset:0 sc1
ds_read_b64_tr_b16 v[86:87], v5 offset:43520
v_fma_f32 v47, v47, v22, v20
v_mul_f32 v44, v44, v172
v_mul_f32 v45, v45, v173
v_mfma_f32_32x32x16_bf16 v[192:207], v[92:95], a[152:155], v[192:207]
ds_read_b64_tr_b16 v[88:89], v5 offset:45056
v_mul_f32 v46, v46, v174
v_mul_f32 v47, v47, v175
v_exp_f32 v44, v44
v_exp_f32 v45, v45
v_exp_f32 v46, v46
v_mfma_f32_32x32x16_bf16 v[208:223], v[92:95], a[156:159], v[208:223]
buffer_load_dwordx4 a[20:23], v1, s[16:19], s0 offen offset:1024 sc1
ds_read_b64_tr_b16 v[90:91], v5 offset:45568
s_waitcnt lgkmcnt(2)
v_exp_f32 v47, v47
v_fma_f32 v44, v44, v24, v24
v_fma_f32 v45, v45, v24, v24
v_mfma_f32_32x32x16_bf16 v[192:207], v[80:83], a[160:163], v[192:207]
ds_read_b64_tr_b16 v[92:93], v5 offset:47104
v_fma_f32 v46, v46, v24, v24
v_fma_f32 v47, v47, v24, v24
v_rcp_f32 v44, v44
v_rcp_f32 v45, v45
v_rcp_f32 v46, v46
v_mfma_f32_32x32x16_bf16 v[208:223], v[80:83], a[164:167], v[208:223]
buffer_load_dwordx4 a[24:27], v1, s[16:19], s0 offen offset:2048 sc1
ds_read_b64_tr_b16 v[94:95], v5 offset:47616
v_rcp_f32 v47, v47
v_mul_f32 v172, v172, v44
v_mul_f32 v173, v173, v45
v_mfma_f32_32x32x16_bf16 v[192:207], v[84:87], a[168:171], v[192:207]
ds_read_b64_tr_b16 v[80:81], v5 offset:57344
v_mul_f32 v174, v174, v46
v_mul_f32 v175, v175, v47
v_cvt_pk_bf16_f32 v170, v172, v173
v_cvt_pk_bf16_f32 v171, v174, v175
s_add_u32 s99, s41, 58368
buffer_store_dwordx4 v[168:171], v31, s[16:19], s99 offen offset:256 sc1
v_mfma_f32_32x32x16_bf16 v[208:223], v[84:87], a[172:175], v[208:223]
buffer_load_dwordx4 a[28:31], v1, s[16:19], s0 offen offset:3072 sc1
ds_read_b64_tr_b16 v[82:83], v5 offset:57856
s_waitcnt lgkmcnt(2)
v_mul_f32 v44, v176, v176
v_mul_f32 v45, v177, v177
v_mfma_f32_32x32x16_bf16 v[192:207], v[88:91], a[176:179], v[192:207]
ds_read_b64_tr_b16 v[84:85], v5 offset:59392
v_mul_f32 v46, v178, v178
v_mul_f32 v47, v179, v179
v_fma_f32 v44, v44, v23, v21
v_fma_f32 v45, v45, v23, v21
v_fma_f32 v46, v46, v23, v21
v_fma_f32 v47, v47, v23, v21
v_mul_f32 v44, v44, v176
v_mul_f32 v45, v45, v177
v_mfma_f32_32x32x16_bf16 v[208:223], v[88:91], a[180:183], v[208:223]
s_add_u32 m0, s3, 147456
s_add_u32 s61, s64, 221312
buffer_load_dwordx4 v14, s[12:15], s61 offen lds
ds_read_b64_tr_b16 v[86:87], v5 offset:59904
v_mul_f32 v46, v46, v178
v_mul_f32 v47, v47, v179
v_mfma_f32_32x32x16_bf16 v[192:207], v[92:95], a[184:187], v[192:207]
ds_read_b64_tr_b16 v[88:89], v5 offset:61440
v_exp_f32 v44, v44
v_exp_f32 v45, v45
v_exp_f32 v46, v46
v_exp_f32 v47, v47
v_mfma_f32_32x32x16_bf16 v[208:223], v[92:95], a[188:191], v[208:223]
buffer_load_dwordx4 v15, s[12:15], s61 offen offset:1024 lds
ds_read_b64_tr_b16 v[90:91], v5 offset:61952
s_waitcnt lgkmcnt(2)
v_fma_f32 v44, v44, v25, v25
v_fma_f32 v45, v45, v25, v25
v_fma_f32 v46, v46, v25, v25
v_mfma_f32_32x32x16_bf16 v[192:207], v[80:83], a[192:195], v[192:207]
ds_read_b64_tr_b16 v[92:93], v5 offset:63488
v_fma_f32 v47, v47, v25, v25
v_rcp_f32 v44, v44
v_rcp_f32 v45, v45
v_rcp_f32 v46, v46
v_mfma_f32_32x32x16_bf16 v[208:223], v[80:83], a[196:199], v[208:223]
s_add_u32 s0, s87, 0
buffer_load_dwordx4 a[32:35], v1, s[16:19], s0 offen offset:0 sc1
ds_read_b64_tr_b16 v[94:95], v5 offset:64000
v_rcp_f32 v47, v47
v_mul_f32 v176, v176, v44
v_mul_f32 v177, v177, v45
v_mfma_f32_32x32x16_bf16 v[192:207], v[84:87], a[200:203], v[192:207]
ds_read_b64_tr_b16 v[80:81], v6 offset:16384
v_mul_f32 v178, v178, v46
v_mul_f32 v179, v179, v47
v_cvt_pk_bf16_f32 v176, v176, v177
v_cvt_pk_bf16_f32 v177, v178, v179
v_mul_f32 v44, v180, v180
v_mul_f32 v45, v181, v181
v_mul_f32 v46, v182, v182
v_mul_f32 v47, v183, v183
v_mfma_f32_32x32x16_bf16 v[208:223], v[84:87], a[204:207], v[208:223]
buffer_load_dwordx4 a[36:39], v1, s[16:19], s0 offen offset:1024 sc1
ds_read_b64_tr_b16 v[82:83], v6 offset:16896
s_waitcnt lgkmcnt(2)
v_fma_f32 v44, v44, v23, v21
v_fma_f32 v45, v45, v23, v21
v_fma_f32 v46, v46, v23, v21
v_mfma_f32_32x32x16_bf16 v[192:207], v[88:91], a[208:211], v[192:207]
ds_read_b64_tr_b16 v[84:85], v6 offset:18432
v_fma_f32 v47, v47, v23, v21
v_mul_f32 v44, v44, v180
v_mul_f32 v45, v45, v181
v_mul_f32 v46, v46, v182
v_mul_f32 v47, v47, v183
v_exp_f32 v44, v44
v_mfma_f32_32x32x16_bf16 v[208:223], v[88:91], a[212:215], v[208:223]
buffer_load_dwordx4 a[40:43], v1, s[16:19], s0 offen offset:2048 sc1
ds_read_b64_tr_b16 v[86:87], v6 offset:18944
v_exp_f32 v45, v45
v_exp_f32 v46, v46
s_waitcnt vmcnt(15)
buffer_store_dword v13, v26, s[16:19], s60 offen offset:32 sc1
v_mfma_f32_32x32x16_bf16 v[192:207], v[92:95], a[216:219], v[192:207]
ds_read_b64_tr_b16 v[88:89], v6 offset:20480
v_exp_f32 v47, v47
v_fma_f32 v44, v44, v25, v25
v_fma_f32 v45, v45, v25, v25
v_fma_f32 v46, v46, v25, v25
v_fma_f32 v47, v47, v25, v25
v_rcp_f32 v44, v44
v_mfma_f32_32x32x16_bf16 v[208:223], v[92:95], a[220:223], v[208:223]
buffer_load_dwordx4 a[44:47], v1, s[16:19], s0 offen offset:3072 sc1
ds_read_b64_tr_b16 v[90:91], v6 offset:20992
s_waitcnt lgkmcnt(2)
v_rcp_f32 v45, v45
v_rcp_f32 v46, v46
v_mfma_f32_32x32x16_bf16 v[192:207], v[80:83], a[224:227], v[192:207]
ds_read_b64_tr_b16 v[92:93], v6 offset:22528
v_rcp_f32 v47, v47
v_mul_f32 v180, v180, v44
v_mul_f32 v181, v181, v45
v_mul_f32 v182, v182, v46
v_mul_f32 v183, v183, v47
v_cvt_pk_bf16_f32 v178, v180, v181
v_cvt_pk_bf16_f32 v179, v182, v183
v_mfma_f32_32x32x16_bf16 v[208:223], v[80:83], a[228:231], v[208:223]
s_add_u32 s0, s83, 14592
buffer_load_dwordx4 a[48:51], v1, s[16:19], s0 offen offset:0 sc1
ds_read_b64_tr_b16 v[94:95], v6 offset:23040
s_add_u32 s99, s41, 146176
buffer_store_dwordx4 v[176:179], v31, s[16:19], s99 offen offset:0 sc1
v_mfma_f32_32x32x16_bf16 v[192:207], v[84:87], a[232:235], v[192:207]
ds_read_b64_tr_b16 v[80:81], v5 offset:32768
v_mul_f32 v44, v184, v184
v_mul_f32 v45, v185, v185
v_mul_f32 v46, v186, v186
v_mul_f32 v47, v187, v187
v_fma_f32 v44, v44, v23, v21
v_fma_f32 v45, v45, v23, v21
v_mfma_f32_32x32x16_bf16 v[208:223], v[84:87], a[236:239], v[208:223]
buffer_load_dwordx4 a[52:55], v1, s[16:19], s0 offen offset:1024 sc1
ds_read_b64_tr_b16 v[82:83], v5 offset:33280
s_waitcnt lgkmcnt(2)
v_fma_f32 v46, v46, v23, v21
v_fma_f32 v47, v47, v23, v21
v_mul_f32 v44, v44, v184
v_mfma_f32_32x32x16_bf16 v[192:207], v[88:91], a[240:243], v[192:207]
ds_read_b64_tr_b16 v[84:85], v5 offset:34816
v_mul_f32 v45, v45, v185
v_mul_f32 v46, v46, v186
v_mul_f32 v47, v47, v187
v_exp_f32 v44, v44
v_exp_f32 v45, v45
v_exp_f32 v46, v46
v_mfma_f32_32x32x16_bf16 v[208:223], v[88:91], a[244:247], v[208:223]
buffer_load_dwordx4 a[56:59], v1, s[16:19], s0 offen offset:2048 sc1
ds_read_b64_tr_b16 v[86:87], v5 offset:35328
v_exp_f32 v47, v47
v_fma_f32 v44, v44, v25, v25
v_fma_f32 v45, v45, v25, v25
v_mfma_f32_32x32x16_bf16 v[192:207], v[92:95], a[248:251], v[192:207]
ds_read_b64_tr_b16 v[88:89], v5 offset:36864
v_fma_f32 v46, v46, v25, v25
v_fma_f32 v47, v47, v25, v25
v_rcp_f32 v44, v44
v_rcp_f32 v45, v45
v_rcp_f32 v46, v46
v_mfma_f32_32x32x16_bf16 v[208:223], v[92:95], a[252:255], v[208:223]
buffer_load_dwordx4 a[60:63], v1, s[16:19], s0 offen offset:3072 sc1
ds_read_b64_tr_b16 v[90:91], v5 offset:37376
s_waitcnt lgkmcnt(2)
v_rcp_f32 v47, v47
v_mul_f32 v184, v184, v44
v_mfma_f32_32x32x16_bf16 v[192:207], v[80:83], v[224:227], v[192:207]
ds_read_b64_tr_b16 v[92:93], v5 offset:38912
v_mul_f32 v185, v185, v45
v_mul_f32 v186, v186, v46
v_mul_f32 v187, v187, v47
v_cvt_pk_bf16_f32 v184, v184, v185
v_cvt_pk_bf16_f32 v185, v186, v187
v_mul_f32 v44, v188, v188
v_mul_f32 v45, v189, v189
v_mul_f32 v46, v190, v190
v_mfma_f32_32x32x16_bf16 v[208:223], v[80:83], v[228:231], v[208:223]
s_add_u32 m0, s3, 98304
s_add_u32 s61, s65, 221184
buffer_load_dwordx4 v14, s[12:15], s61 offen lds
ds_read_b64_tr_b16 v[94:95], v5 offset:39424
v_mul_f32 v47, v191, v191
v_fma_f32 v44, v44, v23, v21
v_mfma_f32_32x32x16_bf16 v[192:207], v[84:87], v[232:235], v[192:207]
v_fma_f32 v45, v45, v23, v21
v_fma_f32 v46, v46, v23, v21
v_fma_f32 v47, v47, v23, v21
v_mul_f32 v44, v44, v188
v_mul_f32 v45, v45, v189
v_mul_f32 v46, v46, v190
v_mul_f32 v47, v47, v191
v_exp_f32 v44, v44
v_mfma_f32_32x32x16_bf16 v[208:223], v[84:87], v[236:239], v[208:223]
buffer_load_dwordx4 v15, s[12:15], s61 offen offset:1024 lds
s_waitcnt lgkmcnt(0)
v_exp_f32 v45, v45
v_exp_f32 v46, v46
v_mfma_f32_32x32x16_bf16 v[192:207], v[88:91], v[240:243], v[192:207]
v_exp_f32 v47, v47
v_fma_f32 v44, v44, v25, v25
v_fma_f32 v45, v45, v25, v25
v_fma_f32 v46, v46, v25, v25
v_fma_f32 v47, v47, v25, v25
v_rcp_f32 v44, v44
v_mfma_f32_32x32x16_bf16 v[208:223], v[88:91], v[244:247], v[208:223]
s_add_u32 m0, s3, 65536
s_add_u32 s61, s65, 221312
buffer_load_dwordx4 v14, s[12:15], s61 offen lds
v_rcp_f32 v45, v45
v_rcp_f32 v46, v46
v_mfma_f32_32x32x16_bf16 v[192:207], v[92:95], v[248:251], v[192:207]
s_barrier
v_rcp_f32 v47, v47
v_mul_f32 v188, v188, v44
v_mul_f32 v189, v189, v45
v_mul_f32 v190, v190, v46
v_mul_f32 v191, v191, v47
v_cvt_pk_bf16_f32 v186, v188, v189
v_mfma_f32_32x32x16_bf16 v[208:223], v[92:95], v[252:255], v[208:223]
buffer_load_dwordx4 v15, s[12:15], s61 offen offset:1024 lds
v_cvt_pk_bf16_f32 v187, v190, v191
s_add_u32 s99, s41, 146176
buffer_store_dwordx4 v[184:187], v31, s[16:19], s99 offen offset:256 sc1
s_nop 7
v_pk_mul_f32 v[44:45], v[192:193], v[192:193]
v_pk_mul_f32 v[46:47], v[194:195], v[194:195]
v_pk_mul_f32 v[48:49], v[196:197], v[196:197]
v_pk_mul_f32 v[50:51], v[198:199], v[198:199]
v_pk_fma_f32 v[44:45], v[44:45], v[22:23], v[20:21] op_sel:[0,0,0] op_sel_hi:[1,0,0]
v_pk_fma_f32 v[46:47], v[46:47], v[22:23], v[20:21] op_sel:[0,0,0] op_sel_hi:[1,0,0]
v_pk_fma_f32 v[48:49], v[48:49], v[22:23], v[20:21] op_sel:[0,0,0] op_sel_hi:[1,0,0]
v_pk_fma_f32 v[50:51], v[50:51], v[22:23], v[20:21] op_sel:[0,0,0] op_sel_hi:[1,0,0]
v_pk_mul_f32 v[44:45], v[44:45], v[192:193]
v_pk_mul_f32 v[46:47], v[46:47], v[194:195]
v_pk_mul_f32 v[48:49], v[48:49], v[196:197]
v_pk_mul_f32 v[50:51], v[50:51], v[198:199]
v_exp_f32 v44, v44
v_exp_f32 v45, v45
v_exp_f32 v46, v46
v_exp_f32 v47, v47
v_exp_f32 v48, v48
v_exp_f32 v49, v49
v_exp_f32 v50, v50
v_exp_f32 v51, v51
v_pk_fma_f32 v[44:45], v[44:45], v[24:25], v[24:25] op_sel:[0,0,0] op_sel_hi:[1,0,0]
v_pk_fma_f32 v[46:47], v[46:47], v[24:25], v[24:25] op_sel:[0,0,0] op_sel_hi:[1,0,0]
v_pk_fma_f32 v[48:49], v[48:49], v[24:25], v[24:25] op_sel:[0,0,0] op_sel_hi:[1,0,0]
v_pk_fma_f32 v[50:51], v[50:51], v[24:25], v[24:25] op_sel:[0,0,0] op_sel_hi:[1,0,0]
v_rcp_f32 v44, v44
v_rcp_f32 v45, v45
v_rcp_f32 v46, v46
v_rcp_f32 v47, v47
v_rcp_f32 v48, v48
v_rcp_f32 v49, v49
v_rcp_f32 v50, v50
v_rcp_f32 v51, v51
v_pk_mul_f32 v[44:45], v[44:45], v[192:193]
v_pk_mul_f32 v[46:47], v[46:47], v[194:195]
v_pk_mul_f32 v[48:49], v[48:49], v[196:197]
v_pk_mul_f32 v[50:51], v[50:51], v[198:199]
v_cvt_pk_bf16_f32 v192, v44, v45
v_cvt_pk_bf16_f32 v193, v46, v47
v_cvt_pk_bf16_f32 v194, v48, v49
v_cvt_pk_bf16_f32 v195, v50, v51
s_add_u32 m0, s3, 73728
s_add_u32 s61, s40, 221184
buffer_load_dwordx4 v14, s[12:15], s61 offen lds
s_add_u32 s99, s41, 58368
buffer_store_dwordx4 v[192:195], v31, s[16:19], s99 offen offset:2048 sc1
v_pk_mul_f32 v[44:45], v[200:201], v[200:201]
v_pk_mul_f32 v[46:47], v[202:203], v[202:203]
v_pk_mul_f32 v[48:49], v[204:205], v[204:205]
v_pk_mul_f32 v[50:51], v[206:207], v[206:207]
v_pk_fma_f32 v[44:45], v[44:45], v[22:23], v[20:21] op_sel:[0,0,0] op_sel_hi:[1,0,0]
v_pk_fma_f32 v[46:47], v[46:47], v[22:23], v[20:21] op_sel:[0,0,0] op_sel_hi:[1,0,0]
v_pk_fma_f32 v[48:49], v[48:49], v[22:23], v[20:21] op_sel:[0,0,0] op_sel_hi:[1,0,0]
v_pk_fma_f32 v[50:51], v[50:51], v[22:23], v[20:21] op_sel:[0,0,0] op_sel_hi:[1,0,0]
v_pk_mul_f32 v[44:45], v[44:45], v[200:201]
v_pk_mul_f32 v[46:47], v[46:47], v[202:203]
v_pk_mul_f32 v[48:49], v[48:49], v[204:205]
v_pk_mul_f32 v[50:51], v[50:51], v[206:207]
v_exp_f32 v44, v44
v_exp_f32 v45, v45
v_exp_f32 v46, v46
v_exp_f32 v47, v47
v_exp_f32 v48, v48
v_exp_f32 v49, v49
v_exp_f32 v50, v50
v_exp_f32 v51, v51
v_pk_fma_f32 v[44:45], v[44:45], v[24:25], v[24:25] op_sel:[0,0,0] op_sel_hi:[1,0,0]
v_pk_fma_f32 v[46:47], v[46:47], v[24:25], v[24:25] op_sel:[0,0,0] op_sel_hi:[1,0,0]
v_pk_fma_f32 v[48:49], v[48:49], v[24:25], v[24:25] op_sel:[0,0,0] op_sel_hi:[1,0,0]
v_pk_fma_f32 v[50:51], v[50:51], v[24:25], v[24:25] op_sel:[0,0,0] op_sel_hi:[1,0,0]
v_rcp_f32 v44, v44
v_rcp_f32 v45, v45
v_rcp_f32 v46, v46
v_rcp_f32 v47, v47
v_rcp_f32 v48, v48
v_rcp_f32 v49, v49
v_rcp_f32 v50, v50
v_rcp_f32 v51, v51
v_pk_mul_f32 v[44:45], v[44:45], v[200:201]
v_pk_mul_f32 v[46:47], v[46:47], v[202:203]
v_pk_mul_f32 v[48:49], v[48:49], v[204:205]
v_pk_mul_f32 v[50:51], v[50:51], v[206:207]
v_cvt_pk_bf16_f32 v200, v44, v45
v_cvt_pk_bf16_f32 v201, v46, v47
v_cvt_pk_bf16_f32 v202, v48, v49
v_cvt_pk_bf16_f32 v203, v50, v51
s_add_u32 s99, s41, 58368
buffer_store_dwordx4 v[200:203], v31, s[16:19], s99 offen offset:2304 sc1
v_pk_mul_f32 v[44:45], v[208:209], v[208:209]
v_pk_mul_f32 v[46:47], v[210:211], v[210:211]
buffer_load_dwordx4 v15, s[12:15], s61 offen offset:1024 lds
v_pk_mul_f32 v[48:49], v[212:213], v[212:213]
v_pk_mul_f32 v[50:51], v[214:215], v[214:215]
v_pk_fma_f32 v[44:45], v[44:45], v[22:23], v[20:21] op_sel:[0,1,1] op_sel_hi:[1,1,1]
v_pk_fma_f32 v[46:47], v[46:47], v[22:23], v[20:21] op_sel:[0,1,1] op_sel_hi:[1,1,1]
v_pk_fma_f32 v[48:49], v[48:49], v[22:23], v[20:21] op_sel:[0,1,1] op_sel_hi:[1,1,1]
v_pk_fma_f32 v[50:51], v[50:51], v[22:23], v[20:21] op_sel:[0,1,1] op_sel_hi:[1,1,1]
v_pk_mul_f32 v[44:45], v[44:45], v[208:209]
v_pk_mul_f32 v[46:47], v[46:47], v[210:211]
v_pk_mul_f32 v[48:49], v[48:49], v[212:213]
v_pk_mul_f32 v[50:51], v[50:51], v[214:215]
v_exp_f32 v44, v44
v_exp_f32 v45, v45
v_exp_f32 v46, v46
v_exp_f32 v47, v47
v_exp_f32 v48, v48
v_exp_f32 v49, v49
v_exp_f32 v50, v50
v_exp_f32 v51, v51
v_pk_fma_f32 v[44:45], v[44:45], v[24:25], v[24:25] op_sel:[0,1,1] op_sel_hi:[1,1,1]
v_pk_fma_f32 v[46:47], v[46:47], v[24:25], v[24:25] op_sel:[0,1,1] op_sel_hi:[1,1,1]
v_pk_fma_f32 v[48:49], v[48:49], v[24:25], v[24:25] op_sel:[0,1,1] op_sel_hi:[1,1,1]
v_pk_fma_f32 v[50:51], v[50:51], v[24:25], v[24:25] op_sel:[0,1,1] op_sel_hi:[1,1,1]
v_rcp_f32 v44, v44
v_rcp_f32 v45, v45
v_rcp_f32 v46, v46
v_rcp_f32 v47, v47
v_rcp_f32 v48, v48
v_rcp_f32 v49, v49
v_rcp_f32 v50, v50
v_rcp_f32 v51, v51
v_pk_mul_f32 v[44:45], v[44:45], v[208:209]
v_pk_mul_f32 v[46:47], v[46:47], v[210:211]
v_pk_mul_f32 v[48:49], v[48:49], v[212:213]
v_pk_mul_f32 v[50:51], v[50:51], v[214:215]
v_cvt_pk_bf16_f32 v208, v44, v45
v_cvt_pk_bf16_f32 v209, v46, v47
v_cvt_pk_bf16_f32 v210, v48, v49
v_cvt_pk_bf16_f32 v211, v50, v51
s_add_u32 s99, s41, 146176
buffer_store_dwordx4 v[208:211], v31, s[16:19], s99 offen offset:2048 sc1
v_pk_mul_f32 v[44:45], v[216:217], v[216:217]
v_pk_mul_f32 v[46:47], v[218:219], v[218:219]
v_pk_mul_f32 v[48:49], v[220:221], v[220:221]
v_pk_mul_f32 v[50:51], v[222:223], v[222:223]
v_pk_fma_f32 v[44:45], v[44:45], v[22:23], v[20:21] op_sel:[0,1,1] op_sel_hi:[1,1,1]
v_pk_fma_f32 v[46:47], v[46:47], v[22:23], v[20:21] op_sel:[0,1,1] op_sel_hi:[1,1,1]
v_pk_fma_f32 v[48:49], v[48:49], v[22:23], v[20:21] op_sel:[0,1,1] op_sel_hi:[1,1,1]
v_pk_fma_f32 v[50:51], v[50:51], v[22:23], v[20:21] op_sel:[0,1,1] op_sel_hi:[1,1,1]
s_add_u32 m0, s3, 24576
s_add_u32 s61, s40, 221312
buffer_load_dwordx4 v14, s[12:15], s61 offen lds
v_pk_mul_f32 v[44:45], v[44:45], v[216:217]
v_pk_mul_f32 v[46:47], v[46:47], v[218:219]
v_pk_mul_f32 v[48:49], v[48:49], v[220:221]
v_pk_mul_f32 v[50:51], v[50:51], v[222:223]
v_exp_f32 v44, v44
v_exp_f32 v45, v45
v_exp_f32 v46, v46
v_exp_f32 v47, v47
v_exp_f32 v48, v48
v_exp_f32 v49, v49
v_exp_f32 v50, v50
v_exp_f32 v51, v51
v_pk_fma_f32 v[44:45], v[44:45], v[24:25], v[24:25] op_sel:[0,1,1] op_sel_hi:[1,1,1]
v_pk_fma_f32 v[46:47], v[46:47], v[24:25], v[24:25] op_sel:[0,1,1] op_sel_hi:[1,1,1]
v_pk_fma_f32 v[48:49], v[48:49], v[24:25], v[24:25] op_sel:[0,1,1] op_sel_hi:[1,1,1]
v_pk_fma_f32 v[50:51], v[50:51], v[24:25], v[24:25] op_sel:[0,1,1] op_sel_hi:[1,1,1]
v_rcp_f32 v44, v44
v_rcp_f32 v45, v45
v_rcp_f32 v46, v46
v_rcp_f32 v47, v47
v_rcp_f32 v48, v48
v_rcp_f32 v49, v49
v_rcp_f32 v50, v50
v_rcp_f32 v51, v51
v_pk_mul_f32 v[44:45], v[44:45], v[216:217]
v_pk_mul_f32 v[46:47], v[46:47], v[218:219]
v_pk_mul_f32 v[48:49], v[48:49], v[220:221]
v_pk_mul_f32 v[50:51], v[50:51], v[222:223]
v_cvt_pk_bf16_f32 v216, v44, v45
v_cvt_pk_bf16_f32 v217, v46, v47
v_cvt_pk_bf16_f32 v218, v48, v49
v_cvt_pk_bf16_f32 v219, v50, v51
s_add_u32 s99, s41, 146176
buffer_store_dwordx4 v[216:219], v31, s[16:19], s99 offen offset:2304 sc1
ds_read_b64_tr_b16 v[64:65], v52 offset:49152
ds_read_b64_tr_b16 v[66:67], v52 offset:50176
ds_read_b64_tr_b16 v[68:69], v55 offset:49152
ds_read_b64_tr_b16 v[70:71], v55 offset:50176
ds_read_b64_tr_b16 v[72:73], v58 offset:49152
ds_read_b64_tr_b16 v[74:75], v58 offset:50176
ds_read_b64_tr_b16 v[76:77], v61 offset:49152
ds_read_b64_tr_b16 v[78:79], v61 offset:50176
buffer_load_dwordx4 v15, s[12:15], s61 offen offset:1024 lds
ds_read_b64_tr_b16 v[80:81], v52 offset:53248
ds_read_b64_tr_b16 v[82:83], v52 offset:54272
ds_read_b64_tr_b16 v[84:85], v55 offset:53248
ds_read_b64_tr_b16 v[86:87], v55 offset:54272
s_waitcnt vmcnt(32) lgkmcnt(10)
v_mfma_f32_16x16x32_bf16 v[112:115], v[64:67], a[4:7], 0
s_add_u32 s0, s86, 14592
v_mfma_f32_16x16x32_bf16 v[96:99], v[64:67], a[0:3], 0
buffer_load_dwordx4 a[64:67], v1, s[16:19], s0 offen offset:0 sc1
s_waitcnt lgkmcnt(8)
v_mfma_f32_16x16x32_bf16 v[100:103], v[68:71], a[0:3], 0
ds_read_b64_tr_b16 v[88:89], v58 offset:53248
ds_read_b64_tr_b16 v[90:91], v58 offset:54272
v_mfma_f32_16x16x32_bf16 v[116:119], v[68:71], a[4:7], 0
ds_read_b64_tr_b16 v[92:93], v61 offset:53248
ds_read_b64_tr_b16 v[94:95], v61 offset:54272
s_waitcnt lgkmcnt(10)
v_mfma_f32_16x16x32_bf16 v[120:123], v[72:75], a[4:7], 0
buffer_load_dwordx4 a[68:71], v1, s[16:19], s0 offen offset:1024 sc1
v_mfma_f32_16x16x32_bf16 v[104:107], v[72:75], a[0:3], 0
ds_read_b64_tr_b16 v[64:65], v53 offset:24576
ds_read_b64_tr_b16 v[66:67], v53 offset:25600
s_waitcnt lgkmcnt(10)
v_mfma_f32_16x16x32_bf16 v[108:111], v[76:79], a[0:3], 0
s_waitcnt lgkmcnt(6)
ds_read_b64_tr_b16 v[68:69], v56 offset:24576
v_mfma_f32_16x16x32_bf16 v[124:127], v[76:79], a[4:7], 0
ds_read_b64_tr_b16 v[70:71], v56 offset:25600
s_waitcnt vmcnt(32)
v_mfma_f32_16x16x32_bf16 v[112:115], v[80:83], a[12:15], v[112:115]
buffer_load_dwordx4 a[72:75], v1, s[16:19], s0 offen offset:2048 sc1
v_mfma_f32_16x16x32_bf16 v[96:99], v[80:83], a[8:11], v[96:99]
ds_read_b64_tr_b16 v[72:73], v59 offset:24576
ds_read_b64_tr_b16 v[74:75], v59 offset:25600
v_mfma_f32_16x16x32_bf16 v[100:103], v[84:87], a[8:11], v[100:103]
ds_read_b64_tr_b16 v[76:77], v62 offset:24576
ds_read_b64_tr_b16 v[78:79], v62 offset:25600
v_mfma_f32_16x16x32_bf16 v[116:119], v[84:87], a[12:15], v[116:119]
s_waitcnt lgkmcnt(6)
v_mfma_f32_16x16x32_bf16 v[120:123], v[88:91], a[12:15], v[120:123]
buffer_load_dwordx4 a[76:79], v1, s[16:19], s0 offen offset:3072 sc1
v_mfma_f32_16x16x32_bf16 v[104:107], v[88:91], a[8:11], v[104:107]
ds_read_b64_tr_b16 v[80:81], v53 offset:28672
ds_read_b64_tr_b16 v[82:83], v53 offset:29696
v_mfma_f32_16x16x32_bf16 v[108:111], v[92:95], a[8:11], v[108:111]
ds_read_b64_tr_b16 v[84:85], v56 offset:28672
ds_read_b64_tr_b16 v[86:87], v56 offset:29696
v_mfma_f32_16x16x32_bf16 v[124:127], v[92:95], a[12:15], v[124:127]
v_mfma_f32_16x16x32_bf16 v[144:147], v[64:67], a[4:7], 0
s_add_u32 s0, s87, 14592
v_mfma_f32_16x16x32_bf16 v[128:131], v[64:67], a[0:3], 0
buffer_load_dwordx4 a[80:83], v1, s[16:19], s0 offen offset:0 sc1
s_waitcnt lgkmcnt(8)
v_mfma_f32_16x16x32_bf16 v[132:135], v[68:71], a[0:3], 0
ds_read_b64_tr_b16 v[88:89], v59 offset:28672
ds_read_b64_tr_b16 v[90:91], v59 offset:29696
v_mfma_f32_16x16x32_bf16 v[148:151], v[68:71], a[4:7], 0
s_waitcnt lgkmcnt(6)
ds_read_b64_tr_b16 v[92:93], v62 offset:28672
v_mfma_f32_16x16x32_bf16 v[152:155], v[72:75], a[4:7], 0
ds_read_b64_tr_b16 v[94:95], v62 offset:29696
v_mfma_f32_16x16x32_bf16 v[136:139], v[72:75], a[0:3], 0
buffer_load_dwordx4 a[84:87], v1, s[16:19], s0 offen offset:1024 sc1
v_mfma_f32_16x16x32_bf16 v[140:143], v[76:79], a[0:3], 0
ds_read_b64_tr_b16 v[64:65], v54 offset:8192
ds_read_b64_tr_b16 v[66:67], v54 offset:9216
v_mfma_f32_16x16x32_bf16 v[156:159], v[76:79], a[4:7], 0
ds_read_b64_tr_b16 v[68:69], v57 offset:8192
ds_read_b64_tr_b16 v[70:71], v57 offset:9216
s_waitcnt lgkmcnt(10)
v_mfma_f32_16x16x32_bf16 v[144:147], v[80:83], a[12:15], v[144:147]
s_waitcnt lgkmcnt(6)
ds_read_b64_tr_b16 v[72:73], v60 offset:8192
ds_read_b64_tr_b16 v[74:75], v60 offset:9216
v_mfma_f32_16x16x32_bf16 v[128:131], v[80:83], a[8:11], v[128:131]
s_add_u32 s63, s73, 32
s_load_dwordx8 s[52:59], s[16:17], s63 glc
v_mfma_f32_16x16x32_bf16 v[132:135], v[84:87], a[8:11], v[132:135]
L_stub5:
s_cbranch_execz L_stub14
buffer_load_dwordx4 a[88:91], v1, s[16:19], s0 offen offset:2048 sc1
v_mfma_f32_16x16x32_bf16 v[148:151], v[84:87], a[12:15], v[148:151]
ds_read_b64_tr_b16 v[76:77], v63 offset:8192
ds_read_b64_tr_b16 v[78:79], v63 offset:9216
v_mfma_f32_16x16x32_bf16 v[152:155], v[88:91], a[12:15], v[152:155]
buffer_load_dwordx4 a[92:95], v1, s[16:19], s0 offen offset:3072 sc1
v_mfma_f32_16x16x32_bf16 v[136:139], v[88:91], a[8:11], v[136:139]
ds_read_b64_tr_b16 v[80:81], v54 offset:12288
ds_read_b64_tr_b16 v[82:83], v54 offset:13312
s_waitcnt lgkmcnt(10)
v_mfma_f32_16x16x32_bf16 v[140:143], v[92:95], a[8:11], v[140:143]
s_waitcnt lgkmcnt(6)
ds_read_b64_tr_b16 v[84:85], v57 offset:12288
v_mfma_f32_16x16x32_bf16 v[156:159], v[92:95], a[12:15], v[156:159]
ds_read_b64_tr_b16 v[86:87], v57 offset:13312
s_waitcnt vmcnt(36)
v_mfma_f32_16x16x32_bf16 v[112:115], v[64:67], a[20:23], v[112:115]
s_add_u32 m0, s3, 40960
s_add_u32 s61, s97, 0
v_mfma_f32_16x16x32_bf16 v[96:99], v[64:67], a[16:19], v[96:99]
buffer_load_dwordx4 v14, s[12:15], s61 offen lds
v_mfma_f32_16x16x32_bf16 v[100:103], v[68:71], a[16:19], v[100:103]
ds_read_b64_tr_b16 v[88:89], v60 offset:12288
ds_read_b64_tr_b16 v[90:91], v60 offset:13312
v_mfma_f32_16x16x32_bf16 v[116:119], v[68:71], a[20:23], v[116:119]
ds_read_b64_tr_b16 v[92:93], v63 offset:12288
ds_read_b64_tr_b16 v[94:95], v63 offset:13312
s_waitcnt lgkmcnt(10)
v_mfma_f32_16x16x32_bf16 v[120:123], v[72:75], a[20:23], v[120:123]
s_waitcnt lgkmcnt(6)
v_mfma_f32_16x16x32_bf16 v[104:107], v[72:75], a[16:19], v[104:107]
buffer_load_dwordx4 v15, s[12:15], s61 offen offset:1024 lds
v_mfma_f32_16x16x32_bf16 v[108:111], v[76:79], a[16:19], v[108:111]
ds_read_b64_tr_b16 v[64:65], v53 offset:40960
ds_read_b64_tr_b16 v[66:67], v53 offset:41984
v_mfma_f32_16x16x32_bf16 v[124:127], v[76:79], a[20:23], v[124:127]
ds_read_b64_tr_b16 v[68:69], v56 offset:40960
ds_read_b64_tr_b16 v[70:71], v56 offset:41984
s_waitcnt vmcnt(35)
v_mfma_f32_16x16x32_bf16 v[112:115], v[80:83], a[28:31], v[112:115]
s_add_u32 m0, s3, 57344
s_add_u32 s61, s97, 128
v_mfma_f32_16x16x32_bf16 v[96:99], v[80:83], a[24:27], v[96:99]
buffer_load_dwordx4 v14, s[12:15], s61 offen lds
s_waitcnt lgkmcnt(8)
v_mfma_f32_16x16x32_bf16 v[100:103], v[84:87], a[24:27], v[100:103]
ds_read_b64_tr_b16 v[72:73], v59 offset:40960
ds_read_b64_tr_b16 v[74:75], v59 offset:41984
v_mfma_f32_16x16x32_bf16 v[116:119], v[84:87], a[28:31], v[116:119]
s_waitcnt lgkmcnt(6)
ds_read_b64_tr_b16 v[76:77], v62 offset:40960
v_mfma_f32_16x16x32_bf16 v[120:123], v[88:91], a[28:31], v[120:123]
ds_read_b64_tr_b16 v[78:79], v62 offset:41984
ds_read_b64_tr_b16 v[80:81], v53 offset:45056
ds_read_b64_tr_b16 v[82:83], v53 offset:46080
v_mfma_f32_16x16x32_bf16 v[104:107], v[88:91], a[24:27], v[104:107]
s_waitcnt vmcnt(34)
s_barrier
v_mfma_f32_16x16x32_bf16 v[108:111], v[92:95], a[24:27], v[108:111]
buffer_load_dwordx4 v15, s[12:15], s61 offen offset:1024 lds
v_mfma_f32_16x16x32_bf16 v[124:127], v[92:95], a[28:31], v[124:127]
ds_read_b64_tr_b16 v[84:85], v56 offset:45056
ds_read_b64_tr_b16 v[86:87], v56 offset:46080
s_waitcnt lgkmcnt(10)
v_mfma_f32_16x16x32_bf16 v[144:147], v[64:67], a[20:23], v[144:147]
s_waitcnt lgkmcnt(6)
s_add_u32 m0, s3, 81920
s_add_u32 s61, s97, 73728
v_mfma_f32_16x16x32_bf16 v[128:131], v[64:67], a[16:19], v[128:131]
buffer_load_dwordx4 v14, s[12:15], s61 offen lds
v_mfma_f32_16x16x32_bf16 v[132:135], v[68:71], a[16:19], v[132:135]
ds_read_b64_tr_b16 v[88:89], v59 offset:45056
ds_read_b64_tr_b16 v[90:91], v59 offset:46080
v_mfma_f32_16x16x32_bf16 v[148:151], v[68:71], a[20:23], v[148:151]
ds_read_b64_tr_b16 v[92:93], v62 offset:45056
ds_read_b64_tr_b16 v[94:95], v62 offset:46080
v_mfma_f32_16x16x32_bf16 v[152:155], v[72:75], a[20:23], v[152:155]
buffer_load_dwordx4 v15, s[12:15], s61 offen offset:1024 lds
v_mfma_f32_16x16x32_bf16 v[136:139], v[72:75], a[16:19], v[136:139]
ds_read_b64_tr_b16 v[64:65], v53 offset:49152
ds_read_b64_tr_b16 v[66:67], v53 offset:50176
s_waitcnt lgkmcnt(10)
v_mfma_f32_16x16x32_bf16 v[140:143], v[76:79], a[16:19], v[140:143]
s_waitcnt lgkmcnt(6)
ds_read_b64_tr_b16 v[68:69], v56 offset:49152
v_mfma_f32_16x16x32_bf16 v[156:159], v[76:79], a[20:23], v[156:159]
ds_read_b64_tr_b16 v[70:71], v56 offset:50176
v_mfma_f32_16x16x32_bf16 v[144:147], v[80:83], a[28:31], v[144:147]
s_add_u32 m0, s3, 32768
s_add_u32 s61, s97, 73856
v_mfma_f32_16x16x32_bf16 v[128:131], v[80:83], a[24:27], v[128:131]
buffer_load_dwordx4 v14, s[12:15], s61 offen lds
v_mfma_f32_16x16x32_bf16 v[132:135], v[84:87], a[24:27], v[132:135]
ds_read_b64_tr_b16 v[72:73], v59 offset:49152
ds_read_b64_tr_b16 v[74:75], v59 offset:50176
v_mfma_f32_16x16x32_bf16 v[148:151], v[84:87], a[28:31], v[148:151]
ds_read_b64_tr_b16 v[76:77], v62 offset:49152
ds_read_b64_tr_b16 v[78:79], v62 offset:50176
s_waitcnt lgkmcnt(10)
v_mfma_f32_16x16x32_bf16 v[152:155], v[88:91], a[28:31], v[152:155]
s_waitcnt lgkmcnt(6)
ds_read_b64_tr_b16 v[80:81], v53 offset:53248
ds_read_b64_tr_b16 v[82:83], v53 offset:54272
v_mfma_f32_16x16x32_bf16 v[136:139], v[88:91], a[24:27], v[136:139]
s_waitcnt lgkmcnt(0)
s_cmp_lg_u64 s[56:57], s[42:43]
s_cbranch_scc1 fh2_slow
fh2_ok:
v_mfma_f32_16x16x32_bf16 v[140:143], v[92:95], a[24:27], v[140:143]
buffer_load_dwordx4 v15, s[12:15], s61 offen offset:1024 lds
v_mfma_f32_16x16x32_bf16 v[156:159], v[92:95], a[28:31], v[156:159]
ds_read_b64_tr_b16 v[84:85], v56 offset:53248
ds_read_b64_tr_b16 v[86:87], v56 offset:54272
s_waitcnt vmcnt(37)
v_mfma_f32_16x16x32_bf16 v[112:115], v[64:67], a[36:39], v[112:115]
s_add_u32 s0, s72, 48640
v_mfma_f32_16x16x32_bf16 v[96:99], v[64:67], a[32:35], v[96:99]
buffer_load_dwordx4 a[96:99], v1, s[16:19], s0 offen offset:0 sc1
v_mfma_f32_16x16x32_bf16 v[100:103], v[68:71], a[32:35], v[100:103]
ds_read_b64_tr_b16 v[88:89], v59 offset:53248
ds_read_b64_tr_b16 v[90:91], v59 offset:54272
v_mfma_f32_16x16x32_bf16 v[116:119], v[68:71], a[36:39], v[116:119]
ds_read_b64_tr_b16 v[92:93], v62 offset:53248
v_mfma_f32_16x16x32_bf16 v[120:123], v[72:75], a[36:39], v[120:123]
ds_read_b64_tr_b16 v[94:95], v62 offset:54272
v_mfma_f32_16x16x32_bf16 v[104:107], v[72:75], a[32:35], v[104:107]
buffer_load_dwordx4 a[100:103], v1, s[16:19], s0 offen offset:1024 sc1
v_mfma_f32_16x16x32_bf16 v[108:111], v[76:79], a[32:35], v[108:111]
ds_read_b64_tr_b16 v[64:65], v53 offset:57344
ds_read_b64_tr_b16 v[66:67], v53 offset:58368
v_mfma_f32_16x16x32_bf16 v[124:127], v[76:79], a[36:39], v[124:127]
ds_read_b64_tr_b16 v[68:69], v56 offset:57344
ds_read_b64_tr_b16 v[70:71], v56 offset:58368
s_waitcnt vmcnt(36)
v_mfma_f32_16x16x32_bf16 v[112:115], v[80:83], a[44:47], v[112:115]
s_waitcnt lgkmcnt(6)
buffer_load_dwordx4 a[104:107], v1, s[16:19], s0 offen offset:2048 sc1
ds_read_b64_tr_b16 v[72:73], v59 offset:57344
v_mfma_f32_16x16x32_bf16 v[96:99], v[80:83], a[40:43], v[96:99]
ds_read_b64_tr_b16 v[74:75], v59 offset:58368
v_mfma_f32_16x16x32_bf16 v[100:103], v[84:87], a[40:43], v[100:103]
s_waitcnt vmcnt(20)
buffer_store_dword v13, v26, s[16:19], s60 offen offset:64 sc1
v_mfma_f32_16x16x32_bf16 v[116:119], v[84:87], a[44:47], v[116:119]
ds_read_b64_tr_b16 v[76:77], v62 offset:57344
ds_read_b64_tr_b16 v[78:79], v62 offset:58368
v_mfma_f32_16x16x32_bf16 v[120:123], v[88:91], a[44:47], v[120:123]
buffer_load_dwordx4 a[108:111], v1, s[16:19], s0 offen offset:3072 sc1
v_mfma_f32_16x16x32_bf16 v[104:107], v[88:91], a[40:43], v[104:107]
ds_read_b64_tr_b16 v[80:81], v53 offset:61440
ds_read_b64_tr_b16 v[82:83], v53 offset:62464
s_waitcnt lgkmcnt(10)
v_mfma_f32_16x16x32_bf16 v[108:111], v[92:95], a[40:43], v[108:111]
s_waitcnt lgkmcnt(6)
ds_read_b64_tr_b16 v[84:85], v56 offset:61440
v_mfma_f32_16x16x32_bf16 v[124:127], v[92:95], a[44:47], v[124:127]
ds_read_b64_tr_b16 v[86:87], v56 offset:62464
v_mfma_f32_16x16x32_bf16 v[144:147], v[64:67], a[36:39], v[144:147]
s_add_u32 s0, s72, 53504
v_mfma_f32_16x16x32_bf16 v[128:131], v[64:67], a[32:35], v[128:131]
buffer_load_dwordx4 a[112:115], v1, s[16:19], s0 offen offset:0 sc1
v_mfma_f32_16x16x32_bf16 v[132:135], v[68:71], a[32:35], v[132:135]
ds_read_b64_tr_b16 v[88:89], v59 offset:61440
ds_read_b64_tr_b16 v[90:91], v59 offset:62464
v_mfma_f32_16x16x32_bf16 v[148:151], v[68:71], a[36:39], v[148:151]
ds_read_b64_tr_b16 v[92:93], v62 offset:61440
ds_read_b64_tr_b16 v[94:95], v62 offset:62464
s_waitcnt lgkmcnt(10)
v_mfma_f32_16x16x32_bf16 v[152:155], v[72:75], a[36:39], v[152:155]
s_waitcnt lgkmcnt(6)
v_mfma_f32_16x16x32_bf16 v[136:139], v[72:75], a[32:35], v[136:139]
buffer_load_dwordx4 a[116:119], v1, s[16:19], s0 offen offset:1024 sc1
v_mfma_f32_16x16x32_bf16 v[140:143], v[76:79], a[32:35], v[140:143]
ds_read_b64_tr_b16 v[64:65], v54 offset:0
ds_read_b64_tr_b16 v[66:67], v54 offset:1024
v_mfma_f32_16x16x32_bf16 v[156:159], v[76:79], a[36:39], v[156:159]
ds_read_b64_tr_b16 v[68:69], v57 offset:0
ds_read_b64_tr_b16 v[70:71], v57 offset:1024
v_mfma_f32_16x16x32_bf16 v[144:147], v[80:83], a[44:47], v[144:147]
buffer_load_dwordx4 a[120:123], v1, s[16:19], s0 offen offset:2048 sc1
v_mfma_f32_16x16x32_bf16 v[128:131], v[80:83], a[40:43], v[128:131]
ds_read_b64_tr_b16 v[72:73], v60 offset:0
ds_read_b64_tr_b16 v[74:75], v60 offset:1024
s_waitcnt lgkmcnt(10)
v_mfma_f32_16x16x32_bf16 v[132:135], v[84:87], a[40:43], v[132:135]
s_waitcnt lgkmcnt(6)
ds_read_b64_tr_b16 v[76:77], v63 offset:0
v_mfma_f32_16x16x32_bf16 v[148:151], v[84:87], a[44:47], v[148:151]
ds_read_b64_tr_b16 v[78:79], v63 offset:1024
v_mfma_f32_16x16x32_bf16 v[152:155], v[88:91], a[44:47], v[152:155]
buffer_load_dwordx4 a[124:127], v1, s[16:19], s0 offen offset:3072 sc1
v_mfma_f32_16x16x32_bf16 v[136:139], v[88:91], a[40:43], v[136:139]
ds_read_b64_tr_b16 v[80:81], v54 offset:4096
ds_read_b64_tr_b16 v[82:83], v54 offset:5120
v_mfma_f32_16x16x32_bf16 v[140:143], v[92:95], a[40:43], v[140:143]
ds_read_b64_tr_b16 v[84:85], v57 offset:4096
ds_read_b64_tr_b16 v[86:87], v57 offset:5120
v_mfma_f32_16x16x32_bf16 v[156:159], v[92:95], a[44:47], v[156:159]
s_waitcnt lgkmcnt(6)
s_branch L_common
L_backS:
s_mov_b64 exec, -1
s_add_u32 m0, s43, 8192
s_lshl_b32 s99, s52, 7
s_add_u32 s99, s99, s40
buffer_load_dwordx4 v72, s[4:7], s99 offen offset:0 lds
buffer_load_dwordx4 v73, s[4:7], s99 offen offset:1024 lds
buffer_load_dwordx4 v74, s[4:7], s99 offen offset:2048 lds
buffer_load_dwordx4 v75, s[4:7], s99 offen offset:3072 lds
s_add_u32 m0, s43, 12288
s_add_u32 s99, s99, 18432
buffer_load_dwordx4 v72, s[4:7], s99 offen offset:0 lds
buffer_load_dwordx4 v73, s[4:7], s99 offen offset:1024 lds
buffer_load_dwordx4 v74, s[4:7], s99 offen offset:2048 lds
buffer_load_dwordx4 v75, s[4:7], s99 offen offset:3072 lds
s_add_u32 m0, s3, 73728
s_mul_i32 s61, s52, 589824
s_add_u32 s61, s61, s42
buffer_load_dwordx4 v12, s[8:11], s61 offen lds
buffer_load_dwordx4 v13, s[8:11], s61 offen offset:1024 lds
s_waitcnt vmcnt(33)
s_barrier
ds_read_b128 a[0:3], v76 offset:0
ds_read_b128 a[4:7], v76 offset:4096
ds_read_b128 a[8:11], v77 offset:0
ds_read_b128 a[12:15], v77 offset:4096
ds_read_b128 a[16:19], v78 offset:0
ds_read_b128 a[20:23], v78 offset:4096
ds_read_b128 a[24:27], v79 offset:0
ds_read_b128 a[28:31], v79 offset:4096
ds_read_b64_tr_b16 v[80:81], v3 offset:0
ds_read_b64_tr_b16 v[82:83], v3 offset:512
s_waitcnt lgkmcnt(0)
v_mfma_f32_32x32x16_bf16 v[160:175], v[80:83], a[0:3], 0
s_add_u32 m0, s43, 0
s_lshl_b32 s99, s53, 7
s_add_u32 s99, s99, s40
buffer_load_dwordx4 v72, s[4:7], s99 offen offset:0 lds
s_waitcnt vmcnt(33)
v_lshlrev_b32 v242, 16, v224
v_and_b32 v224, 0xffff0000, v224
v_mfma_f32_32x32x16_bf16 v[176:191], v[80:83], a[4:7], 0
buffer_load_dwordx4 v73, s[4:7], s99 offen offset:1024 lds
ds_read_b64_tr_b16 v[84:85], v6 offset:0
ds_read_b64_tr_b16 v[86:87], v6 offset:512
s_waitcnt vmcnt(33)
v_lshlrev_b32 v243, 16, v225
v_and_b32 v225, 0xffff0000, v225
s_waitcnt vmcnt(32)
v_lshlrev_b32 v244, 16, v226
v_and_b32 v226, 0xffff0000, v226
s_waitcnt lgkmcnt(0)
v_mfma_f32_32x32x16_bf16 v[192:207], v[84:87], a[0:3], 0
buffer_load_dwordx4 v74, s[4:7], s99 offen offset:2048 lds
s_waitcnt vmcnt(32)
v_lshlrev_b32 v245, 16, v227
v_and_b32 v227, 0xffff0000, v227
s_waitcnt vmcnt(31)
v_lshlrev_b32 v246, 16, v228
v_and_b32 v228, 0xffff0000, v228
s_waitcnt vmcnt(30)
v_lshlrev_b32 v247, 16, v229
v_and_b32 v229, 0xffff0000, v229
v_mfma_f32_32x32x16_bf16 v[208:223], v[84:87], a[4:7], 0
buffer_load_dwordx4 v75, s[4:7], s99 offen offset:3072 lds
ds_read_b64_tr_b16 v[88:89], v3 offset:2048
ds_read_b64_tr_b16 v[90:91], v3 offset:2560
s_waitcnt vmcnt(30)
v_lshlrev_b32 v248, 16, v230
v_and_b32 v230, 0xffff0000, v230
s_waitcnt vmcnt(29)
v_lshlrev_b32 v249, 16, v231
v_and_b32 v231, 0xffff0000, v231
s_waitcnt lgkmcnt(0)
v_mfma_f32_32x32x16_bf16 v[160:175], v[88:91], a[8:11], v[160:175]
s_waitcnt vmcnt(28)
v_lshlrev_b32 v250, 16, v232
v_and_b32 v232, 0xffff0000, v232
v_add_f32 v235, v242, v243
v_add_f32 v236, v224, v225
v_add_f32 v235, v235, v244
v_add_f32 v236, v236, v226
v_add_f32 v235, v235, v245
v_add_f32 v236, v236, v227
v_add_f32 v235, v235, v246
v_add_f32 v236, v236, v228
v_mfma_f32_32x32x16_bf16 v[176:191], v[88:91], a[12:15], v[176:191]
s_add_u32 m0, s43, 4096
s_add_u32 s99, s99, 18432
buffer_load_dwordx4 v72, s[4:7], s99 offen offset:0 lds
ds_read_b64_tr_b16 v[92:93], v6 offset:2048
ds_read_b64_tr_b16 v[94:95], v6 offset:2560
v_add_f32 v235, v235, v247
v_add_f32 v236, v236, v229
s_waitcnt lgkmcnt(0)
v_mfma_f32_32x32x16_bf16 v[192:207], v[92:95], a[8:11], v[192:207]
buffer_load_dwordx4 v73, s[4:7], s99 offen offset:1024 lds
s_waitcnt vmcnt(6)
s_barrier
ds_read_b128 a[32:35], v76 offset:8192
v_add_f32 v235, v235, v248
v_add_f32 v236, v236, v230
v_add_f32 v235, v235, v249
v_mfma_f32_32x32x16_bf16 v[208:223], v[92:95], a[12:15], v[208:223]
buffer_load_dwordx4 v74, s[4:7], s99 offen offset:2048 lds
ds_read_b64_tr_b16 v[80:81], v3 offset:4096
ds_read_b64_tr_b16 v[82:83], v3 offset:4608
ds_read_b128 a[36:39], v76 offset:12288
v_add_f32 v236, v236, v231
v_add_f32 v235, v235, v250
v_add_f32 v236, v236, v232
s_waitcnt lgkmcnt(1)
v_mfma_f32_32x32x16_bf16 v[160:175], v[80:83], a[16:19], v[160:175]
buffer_load_dwordx4 v75, s[4:7], s99 offen offset:3072 lds
ds_read_b128 a[40:43], v77 offset:8192
v_add_f32 v235, v235, v236
s_nop 1
v_add_f32_dpp v235, v235, v235 quad_perm:[1,0,3,2] row_mask:0xf bank_mask:0xf
s_nop 1
v_add_f32_dpp v235, v235, v235 quad_perm:[2,3,0,1] row_mask:0xf bank_mask:0xf
s_nop 1
v_add_f32_dpp v235, v235, v235 row_half_mirror row_mask:0xf bank_mask:0xf
s_nop 1
v_add_f32_dpp v235, v235, v235 row_mirror row_mask:0xf bank_mask:0xf
v_mfma_f32_32x32x16_bf16 v[176:191], v[80:83], a[20:23], v[176:191]
ds_read_b64_tr_b16 v[84:85], v6 offset:4096
ds_read_b64_tr_b16 v[86:87], v6 offset:4608
ds_read_b128 a[44:47], v77 offset:12288
v_mov_b32 v236, v235
s_nop 1
v_permlane16_swap_b32 v235, v236
v_add_f32 v235, v235, v236
v_mul_f32 v252, 0x3ae38e39, v235
v_sub_f32 v242, v242, v252
v_sub_f32 v224, v224, v252
v_sub_f32 v243, v243, v252
s_waitcnt lgkmcnt(1)
v_mfma_f32_32x32x16_bf16 v[192:207], v[84:87], a[16:19], v[192:207]
s_add_u32 m0, s3, 81920
s_mul_i32 s61, s53, 589824
s_add_u32 s61, s61, s42
buffer_load_dwordx4 v12, s[8:11], s61 offen lds
ds_read_b128 a[48:51], v78 offset:8192
v_sub_f32 v225, v225, v252
v_sub_f32 v244, v244, v252
v_mfma_f32_32x32x16_bf16 v[208:223], v[84:87], a[20:23], v[208:223]
buffer_load_dwordx4 v13, s[8:11], s61 offen offset:1024 lds
ds_read_b64_tr_b16 v[88:89], v3 offset:6144
ds_read_b64_tr_b16 v[90:91], v3 offset:6656
ds_read_b128 a[52:55], v78 offset:12288
v_sub_f32 v226, v226, v252
v_sub_f32 v245, v245, v252
v_sub_f32 v227, v227, v252
s_waitcnt lgkmcnt(1)
v_mfma_f32_32x32x16_bf16 v[160:175], v[88:91], a[24:27], v[160:175]
s_add_u32 m0, s3, 90112
s_mul_i32 s61, s54, 589824
s_add_u32 s61, s61, s42
buffer_load_dwordx4 v12, s[8:11], s61 offen lds
ds_read_b128 a[56:59], v79 offset:8192
v_sub_f32 v246, v246, v252
v_sub_f32 v228, v228, v252
v_mfma_f32_32x32x16_bf16 v[176:191], v[88:91], a[28:31], v[176:191]
buffer_load_dwordx4 v13, s[8:11], s61 offen offset:1024 lds
ds_read_b64_tr_b16 v[92:93], v6 offset:6144
ds_read_b64_tr_b16 v[94:95], v6 offset:6656
ds_read_b128 a[60:63], v79 offset:12288
v_sub_f32 v247, v247, v252
v_sub_f32 v229, v229, v252
v_sub_f32 v248, v248, v252
s_waitcnt lgkmcnt(1)
v_mfma_f32_32x32x16_bf16 v[192:207], v[92:95], a[24:27], v[192:207]
v_sub_f32 v230, v230, v252
v_sub_f32 v249, v249, v252
v_sub_f32 v231, v231, v252
v_sub_f32 v250, v250, v252
v_sub_f32 v232, v232, v252
v_mul_f32 v235, v242, v242
v_mul_f32 v236, v224, v224
v_fmac_f32 v235, v243, v243
v_fmac_f32 v236, v225, v225
v_fmac_f32 v235, v244, v244
v_mfma_f32_32x32x16_bf16 v[208:223], v[92:95], a[28:31], v[208:223]
ds_read_b64_tr_b16 v[80:81], v3 offset:8192
ds_read_b64_tr_b16 v[82:83], v3 offset:8704
v_fmac_f32 v236, v226, v226
v_fmac_f32 v235, v245, v245
v_fmac_f32 v236, v227, v227
v_fmac_f32 v235, v246, v246
v_fmac_f32 v236, v228, v228
v_fmac_f32 v235, v247, v247
v_fmac_f32 v236, v229, v229
v_fmac_f32 v235, v248, v248
s_waitcnt lgkmcnt(0)
v_mfma_f32_32x32x16_bf16 v[160:175], v[80:83], a[32:35], v[160:175]
s_add_u32 m0, s43, 8192
s_lshl_b32 s99, s54, 7
s_add_u32 s99, s99, s40
buffer_load_dwordx4 v72, s[4:7], s99 offen offset:0 lds
v_fmac_f32 v236, v230, v230
v_fmac_f32 v235, v249, v249
v_mfma_f32_32x32x16_bf16 v[176:191], v[80:83], a[36:39], v[176:191]
buffer_load_dwordx4 v73, s[4:7], s99 offen offset:1024 lds
ds_read_b64_tr_b16 v[84:85], v6 offset:8192
ds_read_b64_tr_b16 v[86:87], v6 offset:8704
v_fmac_f32 v236, v231, v231
v_fmac_f32 v235, v250, v250
v_fmac_f32 v236, v232, v232
v_add_f32 v235, v235, v236
s_waitcnt lgkmcnt(0)
v_mfma_f32_32x32x16_bf16 v[192:207], v[84:87], a[32:35], v[192:207]
v_add_f32_dpp v235, v235, v235 quad_perm:[1,0,3,2] row_mask:0xf bank_mask:0xf
s_nop 1
v_add_f32_dpp v235, v235, v235 quad_perm:[2,3,0,1] row_mask:0xf bank_mask:0xf
s_nop 1
v_add_f32_dpp v235, v235, v235 row_half_mirror row_mask:0xf bank_mask:0xf
s_nop 1
v_add_f32_dpp v235, v235, v235 row_mirror row_mask:0xf bank_mask:0xf
v_mov_b32 v236, v235
s_nop 1
v_permlane16_swap_b32 v235, v236
v_add_f32 v235, v235, v236
v_mul_f32 v235, 0x3ae38e39, v235
v_add_f32 v236, 0x3727c5ac, v235
v_mfma_f32_32x32x16_bf16 v[208:223], v[84:87], a[36:39], v[208:223]
buffer_load_dwordx4 v74, s[4:7], s99 offen offset:2048 lds
ds_read_b64_tr_b16 v[88:89], v3 offset:10240
ds_read_b64_tr_b16 v[90:91], v3 offset:10752
v_rsq_f32 v253, v236
s_nop 0
v_mul_f32 v235, v235, v253
v_mul_f32 v235, v235, v253
v_add_f32 v235, 0x3727c5ac, v235
s_waitcnt lgkmcnt(0)
v_mfma_f32_32x32x16_bf16 v[160:175], v[88:91], a[40:43], v[160:175]
buffer_load_dwordx4 v75, s[4:7], s99 offen offset:3072 lds
v_rsq_f32 v254, v235
v_mov_b32 v255, s45
v_lshlrev_b32 v237, 4, v233
v_mov_b32 v238, 0x80000000
v_mfma_f32_32x32x16_bf16 v[176:191], v[88:91], a[44:47], v[176:191]
ds_read_b64_tr_b16 v[92:93], v6 offset:10240
ds_read_b64_tr_b16 v[94:95], v6 offset:10752
v_cmp_eq_u32 vcc, 0, v234
s_mov_b32 s71, 65536
s_nop 0
v_cndmask_b32 v237, v238, v237, vcc
buffer_store_dwordx4 v[252:255], v237, s[16:19], s71 offen sc1
v_lshlrev_b32 v242, 16, v36
v_and_b32 v36, 0xffff0000, v36
s_waitcnt lgkmcnt(0)
v_mfma_f32_32x32x16_bf16 v[192:207], v[92:95], a[40:43], v[192:207]
s_add_u32 m0, s43, 12288
s_add_u32 s99, s99, 18432
buffer_load_dwordx4 v72, s[4:7], s99 offen offset:0 lds
s_waitcnt vmcnt(8)
s_barrier
ds_read_b128 a[64:67], v76 offset:0
v_lshlrev_b32 v243, 16, v37
v_mfma_f32_32x32x16_bf16 v[208:223], v[92:95], a[44:47], v[208:223]
buffer_load_dwordx4 v73, s[4:7], s99 offen offset:1024 lds
ds_read_b64_tr_b16 v[80:81], v3 offset:12288
ds_read_b64_tr_b16 v[82:83], v3 offset:12800
ds_read_b128 a[68:71], v76 offset:4096
v_and_b32 v37, 0xffff0000, v37
v_lshlrev_b32 v244, 16, v38
v_and_b32 v38, 0xffff0000, v38
s_waitcnt lgkmcnt(1)
v_mfma_f32_32x32x16_bf16 v[160:175], v[80:83], a[48:51], v[160:175]
ds_read_b128 a[72:75], v77 offset:0
v_lshlrev_b32 v245, 16, v39
v_and_b32 v39, 0xffff0000, v39
v_lshlrev_b32 v246, 16, v40
v_and_b32 v40, 0xffff0000, v40
v_lshlrev_b32 v247, 16, v41
v_and_b32 v41, 0xffff0000, v41
v_lshlrev_b32 v248, 16, v42
v_and_b32 v42, 0xffff0000, v42
v_lshlrev_b32 v249, 16, v43
v_mfma_f32_32x32x16_bf16 v[176:191], v[80:83], a[52:55], v[176:191]
buffer_load_dwordx4 v74, s[4:7], s99 offen offset:2048 lds
ds_read_b64_tr_b16 v[84:85], v6 offset:12288
ds_read_b64_tr_b16 v[86:87], v6 offset:12800
ds_read_b128 a[76:79], v77 offset:4096
v_and_b32 v43, 0xffff0000, v43
v_lshlrev_b32 v250, 16, v44
v_and_b32 v44, 0xffff0000, v44
s_waitcnt lgkmcnt(1)
v_mfma_f32_32x32x16_bf16 v[192:207], v[84:87], a[48:51], v[192:207]
buffer_load_dwordx4 v75, s[4:7], s99 offen offset:3072 lds
ds_read_b128 a[80:83], v78 offset:0
v_add_f32 v235, v242, v243
v_add_f32 v236, v36, v37
v_add_f32 v235, v235, v244
v_add_f32 v236, v236, v38
v_add_f32 v235, v235, v245
v_mfma_f32_32x32x16_bf16 v[208:223], v[84:87], a[52:55], v[208:223]
ds_read_b64_tr_b16 v[88:89], v3 offset:14336
ds_read_b64_tr_b16 v[90:91], v3 offset:14848
ds_read_b128 a[84:87], v78 offset:4096
v_add_f32 v236, v236, v39
v_add_f32 v235, v235, v246
v_add_f32 v236, v236, v40
v_add_f32 v235, v235, v247
v_add_f32 v236, v236, v41
v_add_f32 v235, v235, v248
v_add_f32 v236, v236, v42
s_waitcnt lgkmcnt(1)
v_mfma_f32_32x32x16_bf16 v[160:175], v[88:91], a[56:59], v[160:175]
s_add_u32 m0, s3, 98304
s_mul_i32 s61, s55, 589824
s_add_u32 s61, s61, s42
buffer_load_dwordx4 v12, s[8:11], s61 offen lds
ds_read_b128 a[88:91], v79 offset:0
v_add_f32 v235, v235, v249
v_add_f32 v236, v236, v43
v_mfma_f32_32x32x16_bf16 v[176:191], v[88:91], a[60:63], v[176:191]
buffer_load_dwordx4 v13, s[8:11], s61 offen offset:1024 lds
ds_read_b64_tr_b16 v[92:93], v6 offset:14336
ds_read_b64_tr_b16 v[94:95], v6 offset:14848
ds_read_b128 a[92:95], v79 offset:4096
v_add_f32 v235, v235, v250
v_add_f32 v236, v236, v44
v_add_f32 v36, v235, v236
s_waitcnt lgkmcnt(1)
v_mfma_f32_32x32x16_bf16 v[192:207], v[92:95], a[56:59], v[192:207]
v_add_f32_dpp v36, v36, v36 quad_perm:[1,0,3,2] row_mask:0xf bank_mask:0xf
s_nop 1
v_add_f32_dpp v36, v36, v36 quad_perm:[2,3,0,1] row_mask:0xf bank_mask:0xf
s_nop 1
v_add_f32_dpp v36, v36, v36 row_half_mirror row_mask:0xf bank_mask:0xf
s_nop 1
v_add_f32_dpp v36, v36, v36 row_mirror row_mask:0xf bank_mask:0xf
v_mov_b32 v236, v36
s_nop 1
v_permlane16_swap_b32 v36, v236
v_add_f32 v36, v36, v236
v_mov_b32 v37, s45
v_lshrrev_b32 v237, 1, v237
v_mfma_f32_32x32x16_bf16 v[208:223], v[92:95], a[60:63], v[208:223]
ds_read_b64_tr_b16 v[80:81], v3 offset:16384
ds_read_b64_tr_b16 v[82:83], v3 offset:16896
v_cmp_gt_u32 vcc, 1152, v233
s_mov_b32 s71, 139264
s_nop 0
v_cndmask_b32 v237, v238, v237, vcc
buffer_store_dwordx2 v[36:37], v237, s[16:19], s71 offen sc1
v_lshlrev_b32 v239, 16, v239
v_lshlrev_b32 v240, 16, v240
s_waitcnt lgkmcnt(0)
v_mfma_f32_32x32x16_bf16 v[160:175], v[80:83], a[64:67], v[160:175]
s_add_u32 m0, s43, 0
s_lshl_b32 s99, s55, 7
s_add_u32 s99, s99, s40
buffer_load_dwordx4 v72, s[4:7], s99 offen offset:0 lds
v_lshlrev_b32 v241, 16, v241
v_mul_f32 v241, 0x3fb8aa3b, v241
v_mfma_f32_32x32x16_bf16 v[176:191], v[80:83], a[68:71], v[176:191]
buffer_load_dwordx4 v73, s[4:7], s99 offen offset:1024 lds
ds_read_b64_tr_b16 v[84:85], v6 offset:16384
ds_read_b64_tr_b16 v[86:87], v6 offset:16896
v_exp_f32 v241, v241
s_nop 0
v_cvt_pk_bf16_f32 v241, v241, v241
v_lshlrev_b32 v241, 16, v241
s_waitcnt lgkmcnt(0)
v_mfma_f32_32x32x16_bf16 v[192:207], v[84:87], a[64:67], v[192:207]
v_mul_f32 v225, v241, v239
v_mul_f32 v226, v241, v240
v_mul_f32 v225, 0x3fb8aa3b, v225
v_mul_f32 v226, 0x3e22f983, v226
v_lshrrev_b32 v227, 5, v0
s_lshl_b32 s71, s44, 1
v_add_u32 v227, s71, v227
v_lshlrev_b32 v227, 5, v227
v_cvt_f32_u32 v227, v227
v_and_b32 v230, 32, v0
v_mfma_f32_32x32x16_bf16 v[208:223], v[84:87], a[68:71], v[208:223]
buffer_load_dwordx4 v74, s[4:7], s99 offen offset:2048 lds
ds_read_b64_tr_b16 v[88:89], v3 offset:18432
ds_read_b64_tr_b16 v[90:91], v3 offset:18944
v_lshlrev_b32 v230, 3, v230
v_cvt_f32_u32 v230, v230
v_mul_f32 v228, 0x3f800000, v225
v_mul_f32 v229, 0x3f800000, v226
s_waitcnt lgkmcnt(0)
v_mfma_f32_32x32x16_bf16 v[160:175], v[88:91], a[72:75], v[160:175]
buffer_load_dwordx4 v75, s[4:7], s99 offen offset:3072 lds
v_exp_f32 v228, v228
v_fract_f32 v229, v229
v_cos_f32 v52, v229
v_mfma_f32_32x32x16_bf16 v[176:191], v[88:91], a[76:79], v[176:191]
ds_read_b64_tr_b16 v[92:93], v6 offset:18432
ds_read_b64_tr_b16 v[94:95], v6 offset:18944
v_sin_f32 v53, v229
v_mul_f32 v52, v52, v228
v_mul_f32 v53, v53, v228
v_mul_f32 v228, 0x42000000, v225
v_mul_f32 v229, 0x42000000, v226
v_exp_f32 v228, v228
v_fract_f32 v229, v229
s_waitcnt lgkmcnt(0)
v_mfma_f32_32x32x16_bf16 v[192:207], v[92:95], a[72:75], v[192:207]
s_add_u32 m0, s43, 4096
s_add_u32 s99, s99, 18432
buffer_load_dwordx4 v72, s[4:7], s99 offen offset:0 lds
s_waitcnt vmcnt(8)
s_barrier
ds_read_b128 a[96:99], v76 offset:8192
v_mfma_f32_32x32x16_bf16 v[208:223], v[92:95], a[76:79], v[208:223]
buffer_load_dwordx4 v73, s[4:7], s99 offen offset:1024 lds
ds_read_b64_tr_b16 v[80:81], v3 offset:20480
ds_read_b64_tr_b16 v[82:83], v3 offset:20992
ds_read_b128 a[100:103], v76 offset:12288
v_cos_f32 v56, v229
v_sin_f32 v57, v229
s_waitcnt lgkmcnt(1)
v_mfma_f32_32x32x16_bf16 v[160:175], v[80:83], a[80:83], v[160:175]
ds_read_b128 a[104:107], v77 offset:8192
v_mul_f32 v56, v56, v228
v_mul_f32 v57, v57, v228
v_mul_f32 v228, v227, v225
v_mul_f32 v229, v227, v226
v_exp_f32 v228, v228
v_fract_f32 v229, v229
v_cos_f32 v58, v229
v_mfma_f32_32x32x16_bf16 v[176:191], v[80:83], a[84:87], v[176:191]
buffer_load_dwordx4 v74, s[4:7], s99 offen offset:2048 lds
ds_read_b64_tr_b16 v[84:85], v6 offset:20480
ds_read_b64_tr_b16 v[86:87], v6 offset:20992
ds_read_b128 a[108:111], v77 offset:12288
v_sin_f32 v59, v229
v_mul_f32 v58, v58, v228
s_waitcnt lgkmcnt(1)
v_mfma_f32_32x32x16_bf16 v[192:207], v[84:87], a[80:83], v[192:207]
buffer_load_dwordx4 v75, s[4:7], s99 offen offset:3072 lds
ds_read_b128 a[112:115], v78 offset:8192
v_mul_f32 v59, v59, v228
L_stub6:
s_cbranch_execz L_stub10
v_mul_f32 v228, v230, v225
v_mul_f32 v229, v230, v226
v_exp_f32 v228, v228
v_mfma_f32_32x32x16_bf16 v[208:223], v[84:87], a[84:87], v[208:223]
ds_read_b64_tr_b16 v[88:89], v3 offset:22528
ds_read_b64_tr_b16 v[90:91], v3 offset:23040
ds_read_b128 a[116:119], v78 offset:12288
v_fract_f32 v229, v229
v_cos_f32 v60, v229
v_sin_f32 v61, v229
v_mul_f32 v60, v60, v228
v_mul_f32 v61, v61, v228
s_waitcnt lgkmcnt(1)
v_mfma_f32_32x32x16_bf16 v[160:175], v[88:91], a[88:91], v[160:175]
s_add_u32 m0, s3, 65536
s_mul_i32 s61, s56, 589824
s_add_u32 s61, s61, s42
buffer_load_dwordx4 v12, s[8:11], s61 offen lds
ds_read_b128 a[120:123], v79 offset:8192
v_mul_f32 v228, 0x44000000, v225
v_mul_f32 v229, 0x44000000, v226
v_mfma_f32_32x32x16_bf16 v[176:191], v[88:91], a[92:95], v[176:191]
buffer_load_dwordx4 v13, s[8:11], s61 offen offset:1024 lds
ds_read_b64_tr_b16 v[92:93], v6 offset:22528
ds_read_b64_tr_b16 v[94:95], v6 offset:23040
ds_read_b128 a[124:127], v79 offset:12288
v_exp_f32 v228, v228
v_fract_f32 v229, v229
s_waitcnt lgkmcnt(1)
v_mfma_f32_32x32x16_bf16 v[192:207], v[92:95], a[88:91], v[192:207]
v_cos_f32 v62, v229
v_sin_f32 v63, v229
v_mul_f32 v62, v62, v228
v_mul_f32 v63, v63, v228
v_add_f32 v228, -1.0, v52
v_mul_f32 v229, v239, v239
v_fmac_f32 v229, v240, v240
v_mfma_f32_32x32x16_bf16 v[208:223], v[92:95], a[92:95], v[208:223]
ds_read_b64_tr_b16 v[80:81], v3 offset:24576
ds_read_b64_tr_b16 v[82:83], v3 offset:25088
v_rcp_f32 v229, v229
v_mul_f32 v54, v228, v239
v_fmac_f32 v54, v53, v240
v_mul_f32 v55, v53, v239
v_fma_f32 v55, -v228, v240, v55
v_add_f32 v229, v229, v229
v_mul_f32 v54, v54, v229
v_mul_f32 v55, v55, v229
s_waitcnt lgkmcnt(0)
v_mfma_f32_32x32x16_bf16 v[160:175], v[80:83], a[96:99], v[160:175]
s_add_u32 m0, s43, 8192
s_lshl_b32 s99, s56, 7
s_add_u32 s99, s99, s40
buffer_load_dwordx4 v72, s[4:7], s99 offen offset:0 lds
v_mfma_f32_32x32x16_bf16 v[176:191], v[80:83], a[100:103], v[176:191]
buffer_load_dwordx4 v73, s[4:7], s99 offen offset:1024 lds
ds_read_b64_tr_b16 v[84:85], v6 offset:24576
ds_read_b64_tr_b16 v[86:87], v6 offset:25088
s_waitcnt lgkmcnt(0)
v_mfma_f32_32x32x16_bf16 v[192:207], v[84:87], a[96:99], v[192:207]
buffer_load_dwordx4 v74, s[4:7], s99 offen offset:2048 lds
v_mfma_f32_32x32x16_bf16 v[208:223], v[84:87], a[100:103], v[208:223]
buffer_load_dwordx4 v75, s[4:7], s99 offen offset:3072 lds
ds_read_b64_tr_b16 v[88:89], v3 offset:26624
ds_read_b64_tr_b16 v[90:91], v3 offset:27136
s_waitcnt lgkmcnt(0)
v_mfma_f32_32x32x16_bf16 v[160:175], v[88:91], a[104:107], v[160:175]
v_mfma_f32_32x32x16_bf16 v[176:191], v[88:91], a[108:111], v[176:191]
s_add_u32 m0, s43, 12288
s_add_u32 s99, s99, 18432
buffer_load_dwordx4 v72, s[4:7], s99 offen offset:0 lds
ds_read_b64_tr_b16 v[92:93], v6 offset:26624
ds_read_b64_tr_b16 v[94:95], v6 offset:27136
s_waitcnt lgkmcnt(0)
v_mfma_f32_32x32x16_bf16 v[192:207], v[92:95], a[104:107], v[192:207]
buffer_load_dwordx4 v73, s[4:7], s99 offen offset:1024 lds
s_waitcnt vmcnt(8)
s_barrier
ds_read_b128 a[128:131], v76 offset:0
v_mfma_f32_32x32x16_bf16 v[208:223], v[92:95], a[108:111], v[208:223]
buffer_load_dwordx4 v74, s[4:7], s99 offen offset:2048 lds
ds_read_b64_tr_b16 v[80:81], v3 offset:28672
ds_read_b64_tr_b16 v[82:83], v3 offset:29184
ds_read_b128 a[132:135], v76 offset:4096
s_waitcnt lgkmcnt(1)
v_mfma_f32_32x32x16_bf16 v[160:175], v[80:83], a[112:115], v[160:175]
buffer_load_dwordx4 v75, s[4:7], s99 offen offset:3072 lds
ds_read_b128 a[136:139], v77 offset:0
v_mfma_f32_32x32x16_bf16 v[176:191], v[80:83], a[116:119], v[176:191]
ds_read_b64_tr_b16 v[84:85], v6 offset:28672
ds_read_b64_tr_b16 v[86:87], v6 offset:29184
ds_read_b128 a[140:143], v77 offset:4096
s_waitcnt lgkmcnt(1)
v_mfma_f32_32x32x16_bf16 v[192:207], v[84:87], a[112:115], v[192:207]
s_add_u32 m0, s3, 106496
s_lshl_b32 s61, s50, 7
buffer_load_dwordx4 v16, s[24:27], s61 offen lds
ds_read_b128 a[144:147], v78 offset:0
v_mfma_f32_32x32x16_bf16 v[208:223], v[84:87], a[116:119], v[208:223]
buffer_load_dwordx4 v17, s[24:27], s61 offen offset:1024 lds
ds_read_b64_tr_b16 v[88:89], v3 offset:30720
ds_read_b64_tr_b16 v[90:91], v3 offset:31232
ds_read_b128 a[148:151], v78 offset:4096
s_waitcnt lgkmcnt(1)
v_mfma_f32_32x32x16_bf16 v[160:175], v[88:91], a[120:123], v[160:175]
s_add_u32 m0, s3, 73728
s_mul_i32 s61, s57, 589824
s_add_u32 s61, s61, s42
buffer_load_dwordx4 v12, s[8:11], s61 offen lds
ds_read_b128 a[152:155], v79 offset:0
v_mfma_f32_32x32x16_bf16 v[176:191], v[88:91], a[124:127], v[176:191]
buffer_load_dwordx4 v13, s[8:11], s61 offen offset:1024 lds
ds_read_b64_tr_b16 v[92:93], v6 offset:30720
ds_read_b64_tr_b16 v[94:95], v6 offset:31232
ds_read_b128 a[156:159], v79 offset:4096
s_waitcnt lgkmcnt(1)
v_mfma_f32_32x32x16_bf16 v[192:207], v[92:95], a[120:123], v[192:207]
v_mfma_f32_32x32x16_bf16 v[208:223], v[92:95], a[124:127], v[208:223]
ds_read_b64_tr_b16 v[80:81], v3 offset:32768
ds_read_b64_tr_b16 v[82:83], v3 offset:33280
s_waitcnt lgkmcnt(0)
v_mfma_f32_32x32x16_bf16 v[160:175], v[80:83], a[128:131], v[160:175]
s_add_u32 m0, s43, 0
s_lshl_b32 s99, s57, 7
s_add_u32 s99, s99, s40
buffer_load_dwordx4 v72, s[4:7], s99 offen offset:0 lds
v_mfma_f32_32x32x16_bf16 v[176:191], v[80:83], a[132:135], v[176:191]
buffer_load_dwordx4 v73, s[4:7], s99 offen offset:1024 lds
ds_read_b64_tr_b16 v[84:85], v6 offset:32768
ds_read_b64_tr_b16 v[86:87], v6 offset:33280
v_bfe_u32 v243, v0, 2, 1
s_waitcnt lgkmcnt(0)
v_mfma_f32_32x32x16_bf16 v[192:207], v[84:87], a[128:131], v[192:207]
buffer_load_dwordx4 v74, s[4:7], s99 offen offset:2048 lds
v_lshlrev_b32 v243, 5, v243
v_bfe_u32 v235, v0, 3, 2
v_lshl_add_u32 v243, v235, 2, v243
v_mfma_f32_32x32x16_bf16 v[208:223], v[84:87], a[132:135], v[208:223]
buffer_load_dwordx4 v75, s[4:7], s99 offen offset:3072 lds
ds_read_b64_tr_b16 v[88:89], v3 offset:34816
ds_read_b64_tr_b16 v[90:91], v3 offset:35328
v_and_b32 v235, 3, v0
v_add_u32 v243, v243, v235
s_waitcnt lgkmcnt(0)
v_mfma_f32_32x32x16_bf16 v[160:175], v[88:91], a[136:139], v[160:175]
s_lshl_b32 s71, s44, 6
v_add_u32 v243, s71, v243
s_lshl_b32 s71, s46, 12
s_add_u32 s71, s71, 65536
v_lshlrev_b32 v242, 4, v243
v_add_u32 v242, s71, v242
v_mfma_f32_32x32x16_bf16 v[176:191], v[88:91], a[140:143], v[176:191]
s_add_u32 m0, s43, 4096
s_add_u32 s99, s99, 18432
buffer_load_dwordx4 v72, s[4:7], s99 offen offset:0 lds
ds_read_b64_tr_b16 v[92:93], v6 offset:34816
ds_read_b64_tr_b16 v[94:95], v6 offset:35328
s_waitcnt lgkmcnt(0)
v_mfma_f32_32x32x16_bf16 v[192:207], v[92:95], a[136:139], v[192:207]
buffer_load_dwordx4 v73, s[4:7], s99 offen offset:1024 lds
s_waitcnt vmcnt(8)
s_barrier
ds_read_b128 a[160:163], v76 offset:8192
v_mfma_f32_32x32x16_bf16 v[208:223], v[92:95], a[140:143], v[208:223]
buffer_load_dwordx4 v74, s[4:7], s99 offen offset:2048 lds
ds_read_b64_tr_b16 v[80:81], v3 offset:36864
ds_read_b64_tr_b16 v[82:83], v3 offset:37376
ds_read_b128 a[164:167], v76 offset:12288
s_waitcnt lgkmcnt(1)
v_mfma_f32_32x32x16_bf16 v[160:175], v[80:83], a[144:147], v[160:175]
buffer_load_dwordx4 v75, s[4:7], s99 offen offset:3072 lds
ds_read_b128 a[168:171], v77 offset:8192
v_mfma_f32_32x32x16_bf16 v[176:191], v[80:83], a[148:151], v[176:191]
ds_read_b64_tr_b16 v[84:85], v6 offset:36864
ds_read_b64_tr_b16 v[86:87], v6 offset:37376
ds_read_b128 a[172:175], v77 offset:12288
buffer_load_dwordx4 v[244:247], v242, s[16:19], 0 offen offset:0 sc1
buffer_load_dwordx4 v[248:251], v242, s[16:19], 0 offen offset:256 sc1
s_waitcnt lgkmcnt(1)
v_mfma_f32_32x32x16_bf16 v[192:207], v[84:87], a[144:147], v[192:207]
s_add_u32 m0, s3, 114688
s_lshl_b32 s61, s52, 7
buffer_load_dwordx4 v16, s[24:27], s61 offen lds
ds_read_b128 a[176:179], v78 offset:8192
v_mfma_f32_32x32x16_bf16 v[208:223], v[84:87], a[148:151], v[208:223]
buffer_load_dwordx4 v17, s[24:27], s61 offen offset:1024 lds
ds_read_b64_tr_b16 v[88:89], v3 offset:38912
ds_read_b64_tr_b16 v[90:91], v3 offset:39424
ds_read_b128 a[180:183], v78 offset:12288
s_waitcnt lgkmcnt(1)
v_mfma_f32_32x32x16_bf16 v[160:175], v[88:91], a[152:155], v[160:175]
s_add_u32 m0, s3, 81920
s_mul_i32 s61, s58, 589824
s_add_u32 s61, s61, s42
buffer_load_dwordx4 v12, s[8:11], s61 offen lds
ds_read_b128 a[184:187], v79 offset:8192
v_mfma_f32_32x32x16_bf16 v[176:191], v[88:91], a[156:159], v[176:191]
buffer_load_dwordx4 v13, s[8:11], s61 offen offset:1024 lds
ds_read_b64_tr_b16 v[92:93], v6 offset:38912
ds_read_b64_tr_b16 v[94:95], v6 offset:39424
ds_read_b128 a[188:191], v79 offset:12288
s_waitcnt lgkmcnt(1)
v_mfma_f32_32x32x16_bf16 v[192:207], v[92:95], a[152:155], v[192:207]
s_mul_i32 s41, s49, 703744
s_add_u32 s72, s41, 1048576
s_mul_i32 s92, s44, 175616
s_add_u32 s41, s72, s92
v_mfma_f32_32x32x16_bf16 v[208:223], v[92:95], a[156:159], v[208:223]
ds_read_b64_tr_b16 v[80:81], v3 offset:0
ds_read_b64_tr_b16 v[82:83], v3 offset:512
s_mul_i32 s92, s48, 4864
s_add_u32 s41, s41, s92
s_lshl_b32 s73, s49, 9
s_lshl_b32 s63, s46, 2
s_add_u32 s63, s63, s44
s_mul_i32 s63, s63, 18
v_min_u32 v45, 17, v0
v_add_u32 v45, s63, v45
v_lshlrev_b32 v46, 7, v45
s_mul_i32 s62, s101, 576
s_sub_u32 s62, s62, 3096576
buffer_load_dword v47, v46, s[12:15], s62 offen
s_waitcnt lgkmcnt(0)
v_mfma_f32_32x32x16_bf16 v[160:175], v[80:83], a[160:163], v[160:175]
ds_read_b64_tr_b16 v[84:85], v6 offset:0
s_add_u32 m0, s43, 8192
s_lshl_b32 s99, s58, 7
s_add_u32 s99, s99, s40
buffer_load_dwordx4 v72, s[4:7], s99 offen offset:0 lds
v_mfma_f32_32x32x16_bf16 v[176:191], v[80:83], a[164:167], v[176:191]
ds_read_b64_tr_b16 v[86:87], v6 offset:512
ds_read_b128 v[88:91], v8 offset:0
s_add_u32 s73, s73, 4096
s_lshl_b32 s92, s44, 7
s_waitcnt lgkmcnt(1)
v_mfma_f32_32x32x16_bf16 v[192:207], v[84:87], a[160:163], v[192:207]
buffer_load_dwordx4 v73, s[4:7], s99 offen offset:1024 lds
ds_read_b128 v[92:95], v8 offset:4096
v_mfma_f32_32x32x16_bf16 v[208:223], v[84:87], a[164:167], v[208:223]
ds_read_b64_tr_b16 v[80:81], v3 offset:2048
ds_read_b64_tr_b16 v[82:83], v3 offset:2560
s_waitcnt lgkmcnt(2)
s_add_u32 s60, s73, s92
v_mfma_f32_32x32x16_bf16 v[96:111], a[0:3], v[88:91], 0
ds_read_b64_tr_b16 v[84:85], v6 offset:2048
s_lshl_b32 s92, s48, 2
s_add_u32 s60, s60, s92
v_mfma_f32_32x32x16_bf16 v[112:127], a[4:7], v[88:91], 0
buffer_load_dwordx4 v74, s[4:7], s99 offen offset:2048 lds
ds_read_b64_tr_b16 v[86:87], v6 offset:2560
v_mfma_f32_32x32x16_bf16 v[128:143], a[0:3], v[92:95], 0
s_cmp_ge_u32 s48, 3
s_cselect_b32 s92, 3, 0
s_cselect_b32 s93, 4, 0
s_sub_u32 s88, s48, s92
s_add_u32 s93, s93, s44
s_mul_i32 s92, s93, 87808
v_mfma_f32_32x32x16_bf16 v[144:159], a[4:7], v[92:95], 0
buffer_load_dwordx4 v75, s[4:7], s99 offen offset:3072 lds
ds_read_b128 v[88:91], v9 offset:0
s_waitcnt lgkmcnt(1)
v_mfma_f32_32x32x16_bf16 v[160:175], v[80:83], a[168:171], v[160:175]
s_add_u32 s72, s72, s92
s_lshr_b32 s93, s93, 1
s_lshl_b32 s93, s93, 7
s_add_u32 s73, s73, s93
v_mfma_f32_32x32x16_bf16 v[176:191], v[80:83], a[172:175], v[176:191]
ds_read_b128 v[92:95], v9 offset:4096
s_mul_i32 s92, s88, 384
s_lshl_b32 s93, s47, 1
s_sub_u32 s93, s93, s51
s_add_u32 s93, s93, 34
v_mfma_f32_32x32x16_bf16 v[192:207], v[84:87], a[168:171], v[192:207]
s_add_u32 m0, s43, 12288
s_add_u32 s99, s99, 18432
buffer_load_dwordx4 v72, s[4:7], s99 offen offset:0 lds
ds_read_b64_tr_b16 v[80:81], v3 offset:4096
v_mfma_f32_32x32x16_bf16 v[208:223], v[84:87], a[172:175], v[208:223]
ds_read_b64_tr_b16 v[82:83], v3 offset:4608
s_waitcnt lgkmcnt(2)
s_mul_i32 s93, s93, 73728
s_add_u32 s97, s93, s92
v_mfma_f32_32x32x16_bf16 v[96:111], a[8:11], v[88:91], v[96:111]
buffer_load_dwordx4 v73, s[4:7], s99 offen offset:1024 lds
ds_read_b64_tr_b16 v[84:85], v6 offset:4096
v_mfma_f32_32x32x16_bf16 v[112:127], a[12:15], v[88:91], v[112:127]
ds_read_b64_tr_b16 v[86:87], v6 offset:4608
s_mul_i32 s93, s47, 442368
s_add_u32 s89, s93, s92
s_mul_i32 s77, s88, 221184
v_mfma_f32_32x32x16_bf16 v[128:143], a[8:11], v[92:95], v[128:143]
s_lshl_b32 s93, s47, 8
s_add_u32 s77, s77, s93
s_add_u32 s92, s77, 128
s_sub_u32 s93, s97, 147456
s_sub_u32 s75, s97, 73728
v_mfma_f32_32x32x16_bf16 v[144:159], a[12:15], v[92:95], v[144:159]
buffer_load_dwordx4 v74, s[4:7], s99 offen offset:2048 lds
ds_read_b128 v[88:91], v10 offset:0
s_waitcnt lgkmcnt(1)
v_mfma_f32_32x32x16_bf16 v[160:175], v[80:83], a[176:179], v[160:175]
s_mov_b32 s76, 128
v_mfma_f32_32x32x16_bf16 v[176:191], v[80:83], a[180:183], v[176:191]
ds_read_b128 v[92:95], v10 offset:4096
s_cmp_lt_u32 s47, 4
s_cselect_b32 s74, s92, s93
s_cselect_b32 s75, s92, s75
s_cselect_b32 s76, 73728, s76
s_mul_i32 s92, s46, 6
s_add_u32 s92, s92, s48
v_mfma_f32_32x32x16_bf16 v[192:207], v[84:87], a[176:179], v[192:207]
buffer_load_dwordx4 v75, s[4:7], s99 offen offset:3072 lds
ds_read_b64_tr_b16 v[80:81], v3 offset:6144
v_mfma_f32_32x32x16_bf16 v[208:223], v[84:87], a[180:183], v[208:223]
ds_read_b64_tr_b16 v[82:83], v3 offset:6656
s_waitcnt lgkmcnt(2)
s_mul_i32 s95, s92, 271360
s_add_u32 s95, s95, 33554432
s_lshl_b32 s93, s47, 2
v_mfma_f32_32x32x16_bf16 v[96:111], a[16:19], v[88:91], v[96:111]
s_add_u32 m0, s3, 122880
s_lshl_b32 s61, s53, 7
buffer_load_dwordx4 v16, s[24:27], s61 offen lds
ds_read_b64_tr_b16 v[84:85], v6 offset:6144
v_mfma_f32_32x32x16_bf16 v[112:127], a[20:23], v[88:91], v[112:127]
ds_read_b64_tr_b16 v[86:87], v6 offset:6656
s_add_u32 s93, s93, s44
s_mul_i32 s93, s93, 13568
s_add_u32 s82, s95, s93
v_mfma_f32_32x32x16_bf16 v[128:143], a[16:19], v[92:95], v[128:143]
s_waitcnt vmcnt(12)
s_barrier
ds_read_b128 a[192:195], v76 offset:0
s_mul_i32 s93, s47, 13568
v_mfma_f32_32x32x16_bf16 v[144:159], a[20:23], v[92:95], v[144:159]
buffer_load_dwordx4 v17, s[24:27], s61 offen offset:1024 lds
ds_read_b128 v[88:91], v11 offset:0
s_waitcnt lgkmcnt(2)
ds_read_b128 a[196:199], v76 offset:4096
v_mfma_f32_32x32x16_bf16 v[160:175], v[80:83], a[184:187], v[160:175]
ds_read_b128 a[200:203], v77 offset:0
s_add_u32 s95, s95, s93
s_lshl_b32 s92, s92, 9
s_add_u32 s92, s92, 32768
s_lshl_b32 s93, s47, 7
v_mfma_f32_32x32x16_bf16 v[176:191], v[80:83], a[188:191], v[176:191]
s_add_u32 m0, s3, 90112
s_mul_i32 s61, s59, 589824
s_add_u32 s61, s61, s42
buffer_load_dwordx4 v12, s[8:11], s61 offen lds
ds_read_b128 v[92:95], v11 offset:4096
ds_read_b128 a[204:207], v77 offset:4096
v_mfma_f32_32x32x16_bf16 v[192:207], v[84:87], a[184:187], v[192:207]
ds_read_b64_tr_b16 v[80:81], v3 offset:8192
ds_read_b128 a[208:211], v78 offset:0
s_add_u32 s96, s92, s93
s_lshl_b32 s93, s44, 7
v_mfma_f32_32x32x16_bf16 v[208:223], v[84:87], a[188:191], v[208:223]
ds_read_b64_tr_b16 v[82:83], v3 offset:8704
s_waitcnt lgkmcnt(4)
ds_read_b128 a[212:215], v78 offset:4096
s_add_u32 s94, s92, s93
v_mfma_f32_32x32x16_bf16 v[96:111], a[24:27], v[88:91], v[96:111]
buffer_load_dwordx4 v13, s[8:11], s61 offen offset:1024 lds
ds_read_b64_tr_b16 v[84:85], v6 offset:8192
ds_read_b128 a[216:219], v79 offset:0
v_mfma_f32_32x32x16_bf16 v[112:127], a[28:31], v[88:91], v[112:127]
ds_read_b64_tr_b16 v[86:87], v6 offset:8704
ds_read_b128 a[220:223], v79 offset:4096
s_lshl_b32 s93, s47, 2
s_add_u32 s94, s94, s93
v_mfma_f32_32x32x16_bf16 v[128:143], a[24:27], v[92:95], v[128:143]
s_lshl_b32 s92, s44, 4
v_lshrrev_b32 v15, 3, v0
v_add_u32 v15, s92, v15
v_mul_u32_u24 v15, 1152, v15
v_and_b32 v19, 7, v0
v_mfma_f32_32x32x16_bf16 v[144:159], a[28:31], v[92:95], v[144:159]
ds_read_b128 v[88:91], v8 offset:8192
s_waitcnt lgkmcnt(2)
v_bfe_u32 v18, v0, 4, 1
v_lshlrev_b32 v18, 1, v18
s_lshl_b32 s63, s46, 2
s_add_u32 s63, s63, s44
s_mul_i32 s63, s63, 18
v_min_u32 v45, 17, v0
v_add_u32 v45, s63, v45
v_mul_u32_u24 v46, 9216, v45
buffer_load_dword v47, v46, s[8:11], s101 offen
v_mfma_f32_32x32x16_bf16 v[160:175], v[80:83], a[192:195], v[160:175]
s_waitcnt lgkmcnt(1)
s_add_u32 m0, s43, 0
s_lshl_b32 s99, s59, 7
s_add_u32 s99, s99, s40
buffer_load_dwordx4 v72, s[4:7], s99 offen offset:0 lds
v_mfma_f32_32x32x16_bf16 v[176:191], v[80:83], a[196:199], v[176:191]
ds_read_b128 v[92:95], v8 offset:12288
v_xor_b32 v18, v18, v19
s_and_b32 s93, s44, 1
s_lshl_b32 s93, s93, 2
v_xor_b32 v18, s93, v18
v_mfma_f32_32x32x16_bf16 v[192:207], v[84:87], a[192:195], v[192:207]
buffer_load_dwordx4 v73, s[4:7], s99 offen offset:1024 lds
ds_read_b64_tr_b16 v[80:81], v3 offset:10240
v_mfma_f32_32x32x16_bf16 v[208:223], v[84:87], a[196:199], v[208:223]
ds_read_b64_tr_b16 v[82:83], v3 offset:10752
s_waitcnt lgkmcnt(2)
v_lshl_add_u32 v14, v18, 4, v15
v_add_u32 v15, 8192, v14
v_mfma_f32_32x32x16_bf16 v[96:111], a[32:35], v[88:91], v[96:111]
ds_read_b64_tr_b16 v[84:85], v6 offset:10240
v_mfma_f32_32x32x16_bf16 v[112:127], a[36:39], v[88:91], v[112:127]
buffer_load_dwordx4 v74, s[4:7], s99 offen offset:2048 lds
ds_read_b64_tr_b16 v[86:87], v6 offset:10752
v_mfma_f32_32x32x16_bf16 v[128:143], a[32:35], v[92:95], v[128:143]
v_cmp_ne_u32 vcc, s45, v247
v_cmp_ne_u32 s[64:65], s45, v251
s_nop 0
s_or_b64 vcc, vcc, s[64:65]
s_cbranch_scc1 stSS_slow
stSS_ok:
v_lshlrev_b32 v243, 2, v243
v_mfma_f32_32x32x16_bf16 v[144:159], a[36:39], v[92:95], v[144:159]
buffer_load_dwordx4 v75, s[4:7], s99 offen offset:3072 lds
ds_read_b128 v[88:91], v9 offset:8192
s_waitcnt lgkmcnt(1)
v_mfma_f32_32x32x16_bf16 v[160:175], v[80:83], a[200:203], v[160:175]
v_add_u32 v243, 155648, v243
v_cmp_gt_u32 vcc, 32, v0
ds_write_b32 v243, v245 offset:0
v_mfma_f32_32x32x16_bf16 v[176:191], v[80:83], a[204:207], v[176:191]
ds_read_b128 v[92:95], v9 offset:12288
ds_write_b32 v243, v244 offset:1024
v_mfma_f32_32x32x16_bf16 v[192:207], v[84:87], a[200:203], v[192:207]
s_add_u32 m0, s43, 4096
s_add_u32 s99, s99, 18432
buffer_load_dwordx4 v72, s[4:7], s99 offen offset:0 lds
ds_read_b64_tr_b16 v[80:81], v3 offset:12288
v_mfma_f32_32x32x16_bf16 v[208:223], v[84:87], a[204:207], v[208:223]
ds_read_b64_tr_b16 v[82:83], v3 offset:12800
s_waitcnt lgkmcnt(3)
v_mul_f32 v235, v245, v246
v_mfma_f32_32x32x16_bf16 v[96:111], a[40:43], v[88:91], v[96:111]
buffer_load_dwordx4 v73, s[4:7], s99 offen offset:1024 lds
ds_read_b64_tr_b16 v[84:85], v6 offset:12288
v_mfma_f32_32x32x16_bf16 v[112:127], a[44:47], v[88:91], v[112:127]
ds_read_b64_tr_b16 v[86:87], v6 offset:12800
v_rcp_f32 v24, v235
v_mfma_f32_32x32x16_bf16 v[128:143], a[40:43], v[92:95], v[128:143]
v_mul_f32 v20, 0xc0135761, v235
v_mul_f32 v236, v235, v235
v_mul_f32 v236, v236, v235
v_mfma_f32_32x32x16_bf16 v[144:159], a[44:47], v[92:95], v[144:159]
buffer_load_dwordx4 v74, s[4:7], s99 offen offset:2048 lds
ds_read_b128 v[88:91], v10 offset:8192
s_waitcnt lgkmcnt(1)
v_mfma_f32_32x32x16_bf16 v[160:175], v[80:83], a[208:211], v[160:175]
v_mul_f32 v22, 0xbdd2d3e8, v236
v_cvt_pk_bf16_f32 v29, -v244, v24
v_lshlrev_b32 v235, 16, v29
v_mfma_f32_32x32x16_bf16 v[176:191], v[80:83], a[212:215], v[176:191]
ds_read_b128 v[92:95], v10 offset:12288
v_and_b32 v236, 0xffff0000, v29
v_sub_f32 v237, -v244, v235
v_mfma_f32_32x32x16_bf16 v[192:207], v[84:87], a[208:211], v[192:207]
buffer_load_dwordx4 v75, s[4:7], s99 offen offset:3072 lds
ds_read_b64_tr_b16 v[80:81], v3 offset:14336
v_mfma_f32_32x32x16_bf16 v[208:223], v[84:87], a[212:215], v[208:223]
ds_read_b64_tr_b16 v[82:83], v3 offset:14848
s_waitcnt lgkmcnt(2)
v_mfma_f32_32x32x16_bf16 v[96:111], a[48:51], v[88:91], v[96:111]
s_add_u32 m0, s3, 131072
s_lshl_b32 s61, s54, 7
buffer_load_dwordx4 v16, s[24:27], s61 offen lds
ds_read_b64_tr_b16 v[84:85], v6 offset:14336
v_mfma_f32_32x32x16_bf16 v[112:127], a[52:55], v[88:91], v[112:127]
ds_read_b64_tr_b16 v[86:87], v6 offset:14848
v_sub_f32 v236, v24, v236
v_cvt_pk_bf16_f32 v28, v235, v237
v_mfma_f32_32x32x16_bf16 v[128:143], a[48:51], v[92:95], v[128:143]
s_waitcnt vmcnt(12)
s_barrier
ds_read_b128 a[224:227], v76 offset:8192
v_mfma_f32_32x32x16_bf16 v[144:159], a[52:55], v[92:95], v[144:159]
buffer_load_dwordx4 v17, s[24:27], s61 offen offset:1024 lds
ds_read_b128 v[88:91], v11 offset:8192
s_waitcnt lgkmcnt(2)
ds_read_b128 a[228:231], v76 offset:12288
v_mfma_f32_32x32x16_bf16 v[160:175], v[80:83], a[216:219], v[160:175]
ds_read_b128 a[232:235], v77 offset:8192
v_cvt_pk_bf16_f32 v30, v236, 0
v_cndmask_b32 v28, 0, v28, vcc
v_mfma_f32_32x32x16_bf16 v[176:191], v[80:83], a[220:223], v[176:191]
s_add_u32 m0, s3, 139264
s_lshl_b32 s61, s55, 7
buffer_load_dwordx4 v16, s[24:27], s61 offen lds
ds_read_b128 v[92:95], v11 offset:12288
ds_read_b128 a[236:239], v77 offset:12288
v_mfma_f32_32x32x16_bf16 v[192:207], v[84:87], a[216:219], v[192:207]
ds_read_b64_tr_b16 v[80:81], v3 offset:16384
ds_read_b128 a[240:243], v78 offset:8192
v_cndmask_b32 v29, 0, v29, vcc
v_mfma_f32_32x32x16_bf16 v[208:223], v[84:87], a[220:223], v[208:223]
ds_read_b64_tr_b16 v[82:83], v3 offset:16896
s_waitcnt lgkmcnt(4)
ds_read_b128 a[244:247], v78 offset:12288
v_mfma_f32_32x32x16_bf16 v[96:111], a[56:59], v[88:91], v[96:111]
buffer_load_dwordx4 v17, s[24:27], s61 offen offset:1024 lds
ds_read_b64_tr_b16 v[84:85], v6 offset:16384
ds_read_b128 a[248:251], v79 offset:8192
v_mfma_f32_32x32x16_bf16 v[112:127], a[60:63], v[88:91], v[112:127]
ds_read_b64_tr_b16 v[86:87], v6 offset:16896
ds_read_b128 a[252:255], v79 offset:12288
v_cndmask_b32 v30, 0, v30, vcc
v_mfma_f32_32x32x16_bf16 v[128:143], a[56:59], v[92:95], v[128:143]
ds_write_b32 v243, v249 offset:64
ds_write_b32 v243, v248 offset:1088
v_mul_f32 v235, v249, v250
s_lshl_b32 s63, s42, 2
s_add_u32 s63, s63, 98304
v_lshl_add_u32 v70, v0, 3, s63
buffer_load_dwordx2 v[68:69], v70, s[16:19], 0 offen sc1
v_mfma_f32_32x32x16_bf16 v[144:159], a[60:63], v[92:95], v[144:159]
ds_read_b128 v[88:91], v8 offset:16384
s_waitcnt lgkmcnt(4)
s_lshl_b32 s63, s46, 2
s_add_u32 s63, s63, s44
s_mul_i32 s63, s63, 18
v_min_u32 v45, 17, v0
v_add_u32 v45, s63, v45
s_and_b32 s62, s48, 1
s_mul_i32 s62, s62, 9
s_add_u32 s62, s62, s63
v_min_u32 v46, 8, v0
v_add_u32 v46, s62, v46
v_mul_u32_u24 v46, 1152, v46
s_lshr_b32 s62, s98, 1
s_lshl_b32 s62, s62, 7
buffer_load_dword v47, v46, s[28:31], s62 offen
buffer_load_dword v47, v46, s[32:35], s62 offen
v_mfma_f32_32x32x16_bf16 v[160:175], v[80:83], a[224:227], v[160:175]
s_add_u32 m0, s3, 147456
s_mul_i32 s61, s50, 589824
s_add_u32 s61, s61, s101
buffer_load_dwordx4 v12, s[8:11], s61 offen lds
v_mfma_f32_32x32x16_bf16 v[176:191], v[80:83], a[228:231], v[176:191]
ds_read_b128 v[92:95], v8 offset:20480
v_rcp_f32 v25, v235
v_mfma_f32_32x32x16_bf16 v[192:207], v[84:87], a[224:227], v[192:207]
ds_read_b64_tr_b16 v[80:81], v3 offset:18432
v_mul_f32 v21, 0xc0135761, v235
v_mul_f32 v236, v235, v235
v_mfma_f32_32x32x16_bf16 v[208:223], v[84:87], a[228:231], v[208:223]
ds_read_b64_tr_b16 v[82:83], v3 offset:18944
s_waitcnt lgkmcnt(2)
v_mul_f32 v236, v236, v235
v_mfma_f32_32x32x16_bf16 v[96:111], a[64:67], v[88:91], v[96:111]
ds_read_b64_tr_b16 v[84:85], v6 offset:18432
v_mul_f32 v23, 0xbdd2d3e8, v236
v_cvt_pk_bf16_f32 v33, -v248, v25
v_mfma_f32_32x32x16_bf16 v[112:127], a[68:71], v[88:91], v[112:127]
ds_read_b64_tr_b16 v[86:87], v6 offset:18944
v_lshlrev_b32 v235, 16, v33
v_and_b32 v236, 0xffff0000, v33
v_mfma_f32_32x32x16_bf16 v[128:143], a[64:67], v[92:95], v[128:143]
v_sub_f32 v237, -v248, v235
v_sub_f32 v236, v25, v236
v_mfma_f32_32x32x16_bf16 v[144:159], a[68:71], v[92:95], v[144:159]
buffer_load_dwordx4 v13, s[8:11], s61 offen offset:1024 lds
ds_read_b128 v[88:91], v9 offset:16384
s_waitcnt lgkmcnt(1)
v_mfma_f32_32x32x16_bf16 v[160:175], v[80:83], a[232:235], v[160:175]
v_cvt_pk_bf16_f32 v32, v235, v237
v_cvt_pk_bf16_f32 v34, v236, 0
v_cndmask_b32 v32, 0, v32, vcc
v_mfma_f32_32x32x16_bf16 v[176:191], v[80:83], a[236:239], v[176:191]
ds_read_b128 v[92:95], v9 offset:20480
v_cndmask_b32 v33, 0, v33, vcc
v_cndmask_b32 v34, 0, v34, vcc
v_mfma_f32_32x32x16_bf16 v[192:207], v[84:87], a[232:235], v[192:207]
ds_read_b64_tr_b16 v[80:81], v3 offset:20480
s_cmp_ge_u32 s48, 3
s_cselect_b32 s92, 1, 0
v_mfma_f32_32x32x16_bf16 v[208:223], v[84:87], a[236:239], v[208:223]
ds_read_b64_tr_b16 v[82:83], v3 offset:20992
s_waitcnt lgkmcnt(2)
s_add_u32 s92, s92, s88
v_mfma_f32_32x32x16_bf16 v[96:111], a[72:75], v[88:91], v[96:111]
ds_read_b64_tr_b16 v[84:85], v6 offset:20480
s_add_u32 s92, s92, s49
s_mul_i32 s93, s92, 86
v_mfma_f32_32x32x16_bf16 v[112:127], a[76:79], v[88:91], v[112:127]
ds_read_b64_tr_b16 v[86:87], v6 offset:20992
s_lshr_b32 s93, s93, 8
s_mul_i32 s93, s93, 3
v_mfma_f32_32x32x16_bf16 v[128:143], a[72:75], v[92:95], v[128:143]
s_sub_u32 s92, s92, s93
s_mul_i32 s93, s92, 4864
s_add_u32 s83, s72, s93
v_mfma_f32_32x32x16_bf16 v[144:159], a[76:79], v[92:95], v[144:159]
s_add_u32 m0, s3, 98304
s_mul_i32 s61, s52, 589824
s_add_u32 s61, s61, s101
buffer_load_dwordx4 v12, s[8:11], s61 offen lds
ds_read_b128 v[88:91], v10 offset:16384
s_waitcnt lgkmcnt(1)
v_mfma_f32_32x32x16_bf16 v[160:175], v[80:83], a[240:243], v[160:175]
s_mul_i32 s93, s92, 73728
s_add_u32 s64, s89, s93
s_add_u32 s92, s92, 1
v_mfma_f32_32x32x16_bf16 v[176:191], v[80:83], a[244:247], v[176:191]
ds_read_b128 v[92:95], v10 offset:20480
s_cmp_eq_u32 s92, 3
s_cselect_b32 s92, 0, s92
v_mfma_f32_32x32x16_bf16 v[192:207], v[84:87], a[240:243], v[192:207]
ds_read_b64_tr_b16 v[80:81], v3 offset:22528
s_mul_i32 s93, s92, 4864
s_add_u32 s86, s72, s93
L_stub7:
s_cbranch_execz L_stub11
v_mfma_f32_32x32x16_bf16 v[208:223], v[84:87], a[244:247], v[208:223]
ds_read_b64_tr_b16 v[82:83], v3 offset:23040
s_waitcnt lgkmcnt(2)
s_mul_i32 s93, s92, 73728
v_mfma_f32_32x32x16_bf16 v[96:111], a[80:83], v[88:91], v[96:111]
ds_read_b64_tr_b16 v[84:85], v6 offset:22528
s_add_u32 s65, s89, s93
s_add_u32 s92, s92, 1
v_mfma_f32_32x32x16_bf16 v[112:127], a[84:87], v[88:91], v[112:127]
ds_read_b64_tr_b16 v[86:87], v6 offset:23040
s_cmp_eq_u32 s92, 3
s_cselect_b32 s92, 0, s92
s_mul_i32 s93, s92, 4864
v_mfma_f32_32x32x16_bf16 v[128:143], a[80:83], v[92:95], v[128:143]
s_waitcnt vmcnt(8)
s_barrier
ds_read_b128 v[224:227], v76 offset:0
v_mfma_f32_32x32x16_bf16 v[144:159], a[84:87], v[92:95], v[144:159]
buffer_load_dwordx4 v13, s[8:11], s61 offen offset:1024 lds
ds_read_b128 v[88:91], v11 offset:16384
s_waitcnt lgkmcnt(2)
ds_read_b128 v[228:231], v76 offset:4096
v_mfma_f32_32x32x16_bf16 v[160:175], v[80:83], a[248:251], v[160:175]
ds_read_b128 v[232:235], v77 offset:0
s_add_u32 s87, s72, s93
s_mul_i32 s93, s92, 73728
v_mfma_f32_32x32x16_bf16 v[176:191], v[80:83], a[252:255], v[176:191]
ds_read_b128 v[92:95], v11 offset:20480
ds_read_b128 v[236:239], v77 offset:4096
s_add_u32 s40, s89, s93
v_mfma_f32_32x32x16_bf16 v[192:207], v[84:87], a[248:251], v[192:207]
ds_read_b64_tr_b16 v[80:81], v3 offset:24576
ds_read_b128 v[240:243], v78 offset:0
v_and_b32 v31, 0xf0, v1
v_mfma_f32_32x32x16_bf16 v[208:223], v[84:87], a[252:255], v[208:223]
ds_read_b64_tr_b16 v[82:83], v3 offset:25088
s_waitcnt lgkmcnt(4)
ds_read_b128 v[244:247], v78 offset:4096
v_mfma_f32_32x32x16_bf16 v[96:111], a[88:91], v[88:91], v[96:111]
ds_read_b64_tr_b16 v[84:85], v6 offset:24576
ds_read_b128 v[248:251], v79 offset:0
v_and_b32 v51, 16, v0
v_mfma_f32_32x32x16_bf16 v[112:127], a[92:95], v[88:91], v[112:127]
ds_read_b64_tr_b16 v[86:87], v6 offset:25088
ds_read_b128 v[252:255], v79 offset:4096
v_lshl_add_u32 v31, v51, 6, v31
v_mfma_f32_32x32x16_bf16 v[128:143], a[88:91], v[92:95], v[128:143]
v_and_b32 v51, 32, v0
v_lshl_add_u32 v31, v51, 4, v31
s_mov_b32 s42, s45
v_mfma_f32_32x32x16_bf16 v[144:159], a[92:95], v[92:95], v[144:159]
ds_read_b128 v[88:91], v8 offset:24576
s_waitcnt lgkmcnt(2)
s_mov_b32 s43, s45
v_mfma_f32_32x32x16_bf16 v[160:175], v[80:83], v[224:227], v[160:175]
s_add_u32 m0, s3, 106496
s_lshl_b32 s61, s56, 7
buffer_load_dwordx4 v16, s[24:27], s61 offen lds
v_mfma_f32_32x32x16_bf16 v[176:191], v[80:83], v[228:231], v[176:191]
ds_read_b128 v[92:95], v8 offset:28672
v_mfma_f32_32x32x16_bf16 v[192:207], v[84:87], v[224:227], v[192:207]
ds_read_b64_tr_b16 v[80:81], v3 offset:26624
v_mfma_f32_32x32x16_bf16 v[208:223], v[84:87], v[228:231], v[208:223]
buffer_load_dwordx4 v17, s[24:27], s61 offen offset:1024 lds
ds_read_b64_tr_b16 v[82:83], v3 offset:27136
s_waitcnt lgkmcnt(2)
v_mfma_f32_32x32x16_bf16 v[96:111], a[96:99], v[88:91], v[96:111]
ds_read_b64_tr_b16 v[84:85], v6 offset:26624
v_mfma_f32_32x32x16_bf16 v[112:127], a[100:103], v[88:91], v[112:127]
ds_read_b64_tr_b16 v[86:87], v6 offset:27136
v_mfma_f32_32x32x16_bf16 v[128:143], a[96:99], v[92:95], v[128:143]
v_mfma_f32_32x32x16_bf16 v[144:159], a[100:103], v[92:95], v[144:159]
s_add_u32 m0, s3, 65536
s_mul_i32 s61, s53, 589824
s_add_u32 s61, s61, s101
buffer_load_dwordx4 v12, s[8:11], s61 offen lds
ds_read_b128 v[88:91], v9 offset:24576
s_waitcnt lgkmcnt(1)
v_mfma_f32_32x32x16_bf16 v[160:175], v[80:83], v[232:235], v[160:175]
v_mfma_f32_32x32x16_bf16 v[176:191], v[80:83], v[236:239], v[176:191]
ds_read_b128 v[92:95], v9 offset:28672
v_mfma_f32_32x32x16_bf16 v[192:207], v[84:87], v[232:235], v[192:207]
ds_read_b64_tr_b16 v[80:81], v3 offset:28672
v_mfma_f32_32x32x16_bf16 v[208:223], v[84:87], v[236:239], v[208:223]
buffer_load_dwordx4 v13, s[8:11], s61 offen offset:1024 lds
ds_read_b64_tr_b16 v[82:83], v3 offset:29184
s_waitcnt lgkmcnt(2)
v_mfma_f32_32x32x16_bf16 v[96:111], a[104:107], v[88:91], v[96:111]
ds_read_b64_tr_b16 v[84:85], v6 offset:28672
v_mfma_f32_32x32x16_bf16 v[112:127], a[108:111], v[88:91], v[112:127]
ds_read_b64_tr_b16 v[86:87], v6 offset:29184
v_mfma_f32_32x32x16_bf16 v[128:143], a[104:107], v[92:95], v[128:143]
v_mfma_f32_32x32x16_bf16 v[144:159], a[108:111], v[92:95], v[144:159]
s_add_u32 m0, s3, 73728
s_mul_i32 s61, s54, 589824
s_add_u32 s61, s61, s101
buffer_load_dwordx4 v12, s[8:11], s61 offen lds
ds_read_b128 v[88:91], v10 offset:24576
s_waitcnt lgkmcnt(1)
v_mfma_f32_32x32x16_bf16 v[160:175], v[80:83], v[240:243], v[160:175]
v_mfma_f32_32x32x16_bf16 v[176:191], v[80:83], v[244:247], v[176:191]
ds_read_b128 v[92:95], v10 offset:28672
v_mfma_f32_32x32x16_bf16 v[192:207], v[84:87], v[240:243], v[192:207]
ds_read_b64_tr_b16 v[80:81], v3 offset:30720
v_mfma_f32_32x32x16_bf16 v[208:223], v[84:87], v[244:247], v[208:223]
buffer_load_dwordx4 v13, s[8:11], s61 offen offset:1024 lds
ds_read_b64_tr_b16 v[82:83], v3 offset:31232
s_waitcnt lgkmcnt(2)
v_mfma_f32_32x32x16_bf16 v[96:111], a[112:115], v[88:91], v[96:111]
ds_read_b64_tr_b16 v[84:85], v6 offset:30720
v_mfma_f32_32x32x16_bf16 v[112:127], a[116:119], v[88:91], v[112:127]
ds_read_b64_tr_b16 v[86:87], v6 offset:31232
s_waitcnt vmcnt(12)
v_cmp_ne_u32 vcc, s45, v69
s_nop 0
s_cmp_lg_u64 vcc, 0
s_cbranch_scc1 csS0S_slow
csS0S_ok:
v_mov_b32 v73, v68
v_mfma_f32_32x32x16_bf16 v[128:143], a[112:115], v[92:95], v[128:143]
s_barrier
v_mov_b32 v77, v68
v_mfma_f32_32x32x16_bf16 v[144:159], a[116:119], v[92:95], v[144:159]
s_add_u32 m0, s3, 24576
s_mul_i32 s61, s55, 589824
s_add_u32 s61, s61, s101
buffer_load_dwordx4 v12, s[8:11], s61 offen lds
ds_read_b128 v[88:91], v11 offset:24576
s_waitcnt lgkmcnt(1)
v_mfma_f32_32x32x16_bf16 v[160:175], v[80:83], v[248:251], v[160:175]
v_permlane32_swap_b32 v68, v77
v_mov_b32 v74, v66
v_cvt_pk_bf16_f32 v72, v73, v73
v_mfma_f32_32x32x16_bf16 v[176:191], v[80:83], v[252:255], v[176:191]
ds_read_b128 v[92:95], v11 offset:28672
v_lshlrev_b32 v45, 16, v72
v_lshlrev_b32 v75, 16, v74
v_mfma_f32_32x32x16_bf16 v[192:207], v[84:87], v[248:251], v[192:207]
v_sub_f32 v45, v73, v45
v_cvt_pk_bf16_f32 v73, v45, v75
v_mov_b32 v75, 0
v_mfma_f32_32x32x16_bf16 v[208:223], v[84:87], v[252:255], v[208:223]
buffer_load_dwordx4 v13, s[8:11], s61 offen offset:1024 lds
ds_read_b128 v[80:83], v8 offset:32768
s_waitcnt lgkmcnt(1)
v_mfma_f32_32x32x16_bf16 v[96:111], a[120:123], v[88:91], v[96:111]
v_mov_b32 v78, v66
s_nop 1
v_permlane32_swap_b32 v66, v78
v_cvt_pk_bf16_f32 v76, v77, v77
v_mfma_f32_32x32x16_bf16 v[112:127], a[124:127], v[88:91], v[112:127]
ds_read_b128 v[84:87], v8 offset:36864
v_lshlrev_b32 v46, 16, v76
v_lshlrev_b32 v79, 16, v78
v_mfma_f32_32x32x16_bf16 v[128:143], a[120:123], v[92:95], v[128:143]
v_sub_f32 v46, v77, v46
v_cvt_pk_bf16_f32 v77, v46, v79
v_mov_b32 v79, 0
v_mfma_f32_32x32x16_bf16 v[144:159], a[124:127], v[92:95], v[144:159]
ds_read_b128 v[88:91], v9 offset:32768
s_waitcnt lgkmcnt(1)
v_mfma_f32_32x32x16_bf16 v[160:175], v[72:75], v[28:31], v[160:175]
s_add_u32 m0, s3, 114688
s_lshl_b32 s61, s57, 7
buffer_load_dwordx4 v16, s[24:27], s61 offen lds
v_mfma_f32_32x32x16_bf16 v[176:191], v[72:75], v[32:35], v[176:191]
v_mfma_f32_32x32x16_bf16 v[192:207], v[76:79], v[28:31], v[192:207]
v_mfma_f32_32x32x16_bf16 v[208:223], v[76:79], v[32:35], v[208:223]
buffer_load_dwordx4 v17, s[24:27], s61 offen offset:1024 lds
v_mfma_f32_32x32x16_bf16 v[96:111], a[128:131], v[80:83], v[96:111]
v_mfma_f32_32x32x16_bf16 v[112:127], a[132:135], v[80:83], v[112:127]
ds_read_b128 v[92:95], v9 offset:36864
v_mfma_f32_32x32x16_bf16 v[128:143], a[128:131], v[84:87], v[128:143]
s_add_u32 m0, s3, 40960
s_mul_i32 s61, s56, 589824
s_add_u32 s61, s61, s101
buffer_load_dwordx4 v12, s[8:11], s61 offen lds
v_mfma_f32_32x32x16_bf16 v[144:159], a[132:135], v[84:87], v[144:159]
ds_read_b128 v[80:83], v10 offset:32768
s_waitcnt lgkmcnt(1)
v_mul_f32 v44, v160, v160
v_mul_f32 v45, v161, v161
v_mul_f32 v46, v162, v162
s_waitcnt vmcnt(15)
v_mul_f32 v47, v163, v163
v_fma_f32 v44, v44, v22, v20
v_fma_f32 v45, v45, v22, v20
v_fma_f32 v46, v46, v22, v20
v_fma_f32 v47, v47, v22, v20
v_mul_f32 v44, v44, v160
v_mfma_f32_32x32x16_bf16 v[96:111], a[136:139], v[88:91], v[96:111]
v_mul_f32 v45, v45, v161
v_mul_f32 v46, v46, v162
v_mul_f32 v47, v47, v163
v_exp_f32 v44, v44
v_exp_f32 v45, v45
v_exp_f32 v46, v46
v_exp_f32 v47, v47
v_mfma_f32_32x32x16_bf16 v[112:127], a[140:143], v[88:91], v[112:127]
buffer_load_dwordx4 v13, s[8:11], s61 offen offset:1024 lds
ds_read_b128 v[84:87], v10 offset:36864
v_fma_f32 v44, v44, v24, v24
v_fma_f32 v45, v45, v24, v24
v_fma_f32 v46, v46, v24, v24
v_fma_f32 v47, v47, v24, v24
v_rcp_f32 v44, v44
v_mfma_f32_32x32x16_bf16 v[128:143], a[136:139], v[92:95], v[128:143]
s_waitcnt vmcnt(10)
s_barrier
v_rcp_f32 v45, v45
v_rcp_f32 v46, v46
v_rcp_f32 v47, v47
v_mul_f32 v160, v160, v44
v_mul_f32 v161, v161, v45
v_mul_f32 v162, v162, v46
v_mfma_f32_32x32x16_bf16 v[144:159], a[140:143], v[92:95], v[144:159]
ds_read_b128 v[88:91], v11 offset:32768
s_waitcnt lgkmcnt(1)
v_mul_f32 v163, v163, v47
v_cvt_pk_bf16_f32 v160, v160, v161
v_cvt_pk_bf16_f32 v161, v162, v163
v_mul_f32 v44, v164, v164
v_mul_f32 v45, v165, v165
v_mul_f32 v46, v166, v166
v_mul_f32 v47, v167, v167
v_fma_f32 v44, v44, v22, v20
v_mfma_f32_32x32x16_bf16 v[96:111], a[144:147], v[80:83], v[96:111]
s_add_u32 m0, s3, 57344
s_mul_i32 s61, s57, 589824
s_add_u32 s61, s61, s101
buffer_load_dwordx4 v12, s[8:11], s61 offen lds
v_fma_f32 v45, v45, v22, v20
v_fma_f32 v46, v46, v22, v20
v_fma_f32 v47, v47, v22, v20
v_mul_f32 v44, v44, v164
v_mfma_f32_32x32x16_bf16 v[112:127], a[148:151], v[80:83], v[112:127]
ds_read_b128 v[92:95], v11 offset:36864
v_mul_f32 v45, v45, v165
v_mul_f32 v46, v46, v166
v_mul_f32 v47, v47, v167
v_exp_f32 v44, v44
v_exp_f32 v45, v45
v_exp_f32 v46, v46
v_mfma_f32_32x32x16_bf16 v[128:143], a[144:147], v[84:87], v[128:143]
v_exp_f32 v47, v47
v_fma_f32 v44, v44, v24, v24
v_fma_f32 v45, v45, v24, v24
v_fma_f32 v46, v46, v24, v24
v_fma_f32 v47, v47, v24, v24
v_rcp_f32 v44, v44
v_rcp_f32 v45, v45
v_rcp_f32 v46, v46
v_mfma_f32_32x32x16_bf16 v[144:159], a[148:151], v[84:87], v[144:159]
buffer_load_dwordx4 v13, s[8:11], s61 offen offset:1024 lds
ds_read_b128 v[80:83], v8 offset:0
s_waitcnt lgkmcnt(1)
v_rcp_f32 v47, v47
v_mul_f32 v164, v164, v44
v_mul_f32 v165, v165, v45
v_mul_f32 v166, v166, v46
v_mfma_f32_32x32x16_bf16 v[96:111], a[152:155], v[88:91], v[96:111]
v_mul_f32 v167, v167, v47
v_cvt_pk_bf16_f32 v162, v164, v165
v_cvt_pk_bf16_f32 v163, v166, v167
s_add_u32 s99, s41, 0
buffer_store_dwordx4 v[160:163], v31, s[16:19], s99 offen offset:0 sc1
v_mul_f32 v44, v168, v168
v_mul_f32 v45, v169, v169
v_mul_f32 v46, v170, v170
v_mfma_f32_32x32x16_bf16 v[112:127], a[156:159], v[88:91], v[112:127]
ds_read_b128 v[84:87], v8 offset:4096
v_mul_f32 v47, v171, v171
v_fma_f32 v44, v44, v22, v20
v_fma_f32 v45, v45, v22, v20
v_fma_f32 v46, v46, v22, v20
v_fma_f32 v47, v47, v22, v20
v_mul_f32 v44, v44, v168
v_mul_f32 v45, v45, v169
v_mul_f32 v46, v46, v170
v_mul_f32 v47, v47, v171
v_mfma_f32_32x32x16_bf16 v[128:143], a[152:155], v[92:95], v[128:143]
v_exp_f32 v44, v44
v_exp_f32 v45, v45
v_exp_f32 v46, v46
v_exp_f32 v47, v47
v_fma_f32 v44, v44, v24, v24
v_fma_f32 v45, v45, v24, v24
v_fma_f32 v46, v46, v24, v24
v_mfma_f32_32x32x16_bf16 v[144:159], a[156:159], v[92:95], v[144:159]
ds_read_b128 v[88:91], v9 offset:0
s_waitcnt lgkmcnt(1)
v_fma_f32 v47, v47, v24, v24
v_rcp_f32 v44, v44
v_rcp_f32 v45, v45
v_rcp_f32 v46, v46
v_rcp_f32 v47, v47
v_mfma_f32_32x32x16_bf16 v[96:111], a[160:163], v[80:83], v[96:111]
s_add_u32 m0, s3, 122880
s_lshl_b32 s61, s58, 7
buffer_load_dwordx4 v16, s[24:27], s61 offen lds
v_mul_f32 v168, v168, v44
v_mul_f32 v169, v169, v45
v_mul_f32 v170, v170, v46
v_mul_f32 v171, v171, v47
v_cvt_pk_bf16_f32 v168, v168, v169
v_mfma_f32_32x32x16_bf16 v[112:127], a[164:167], v[80:83], v[112:127]
ds_read_b128 v[92:95], v9 offset:4096
v_cvt_pk_bf16_f32 v169, v170, v171
v_mul_f32 v44, v172, v172
v_mul_f32 v45, v173, v173
v_mul_f32 v46, v174, v174
v_mul_f32 v47, v175, v175
v_fma_f32 v44, v44, v22, v20
v_fma_f32 v45, v45, v22, v20
v_fma_f32 v46, v46, v22, v20
v_fma_f32 v47, v47, v22, v20
v_mul_f32 v44, v44, v172
v_mfma_f32_32x32x16_bf16 v[128:143], a[160:163], v[84:87], v[128:143]
buffer_load_dwordx4 v17, s[24:27], s61 offen offset:1024 lds
v_mul_f32 v45, v45, v173
v_mul_f32 v46, v46, v174
v_mul_f32 v47, v47, v175
v_exp_f32 v44, v44
v_exp_f32 v45, v45
v_mfma_f32_32x32x16_bf16 v[144:159], a[164:167], v[84:87], v[144:159]
ds_read_b128 v[80:83], v10 offset:0
s_waitcnt lgkmcnt(1)
v_exp_f32 v46, v46
v_exp_f32 v47, v47
v_fma_f32 v44, v44, v24, v24
v_fma_f32 v45, v45, v24, v24
v_fma_f32 v46, v46, v24, v24
v_fma_f32 v47, v47, v24, v24
v_mfma_f32_32x32x16_bf16 v[96:111], a[168:171], v[88:91], v[96:111]
v_rcp_f32 v44, v44
v_rcp_f32 v45, v45
v_rcp_f32 v46, v46
v_rcp_f32 v47, v47
v_mul_f32 v172, v172, v44
v_mul_f32 v173, v173, v45
v_mul_f32 v174, v174, v46
v_mul_f32 v175, v175, v47
v_mfma_f32_32x32x16_bf16 v[112:127], a[172:175], v[88:91], v[112:127]
s_add_u32 m0, s3, 81920
s_mul_i32 s61, s58, 589824
s_add_u32 s61, s61, s101
buffer_load_dwordx4 v12, s[8:11], s61 offen lds
ds_read_b128 v[84:87], v10 offset:4096
v_cvt_pk_bf16_f32 v170, v172, v173
v_cvt_pk_bf16_f32 v171, v174, v175
v_mfma_f32_32x32x16_bf16 v[128:143], a[168:171], v[92:95], v[128:143]
s_waitcnt vmcnt(8)
s_barrier
s_add_u32 s99, s41, 0
buffer_store_dwordx4 v[168:171], v31, s[16:19], s99 offen offset:256 sc1
v_mul_f32 v44, v176, v176
v_mul_f32 v45, v177, v177
v_mul_f32 v46, v178, v178
v_mul_f32 v47, v179, v179
v_mfma_f32_32x32x16_bf16 v[144:159], a[172:175], v[92:95], v[144:159]
buffer_load_dwordx4 v13, s[8:11], s61 offen offset:1024 lds
ds_read_b128 v[88:91], v11 offset:0
s_waitcnt lgkmcnt(1)
v_fma_f32 v44, v44, v23, v21
v_fma_f32 v45, v45, v23, v21
v_fma_f32 v46, v46, v23, v21
v_fma_f32 v47, v47, v23, v21
v_mul_f32 v44, v44, v176
v_mfma_f32_32x32x16_bf16 v[96:111], a[176:179], v[80:83], v[96:111]
v_mul_f32 v45, v45, v177
v_mul_f32 v46, v46, v178
v_mul_f32 v47, v47, v179
v_exp_f32 v44, v44
v_exp_f32 v45, v45
v_exp_f32 v46, v46
v_exp_f32 v47, v47
v_mfma_f32_32x32x16_bf16 v[112:127], a[180:183], v[80:83], v[112:127]
ds_read_b128 v[92:95], v11 offset:4096
v_fma_f32 v44, v44, v25, v25
v_fma_f32 v45, v45, v25, v25
v_fma_f32 v46, v46, v25, v25
v_fma_f32 v47, v47, v25, v25
v_rcp_f32 v44, v44
v_rcp_f32 v45, v45
v_rcp_f32 v46, v46
v_mfma_f32_32x32x16_bf16 v[128:143], a[176:179], v[84:87], v[128:143]
s_add_u32 m0, s3, 32768
s_mul_i32 s61, s59, 589824
s_add_u32 s61, s61, s101
buffer_load_dwordx4 v12, s[8:11], s61 offen lds
v_rcp_f32 v47, v47
v_mul_f32 v176, v176, v44
v_mul_f32 v177, v177, v45
v_mfma_f32_32x32x16_bf16 v[144:159], a[180:183], v[84:87], v[144:159]
ds_read_b128 v[80:83], v8 offset:8192
s_waitcnt lgkmcnt(1)
v_mul_f32 v178, v178, v46
v_mul_f32 v179, v179, v47
v_cvt_pk_bf16_f32 v176, v176, v177
v_cvt_pk_bf16_f32 v177, v178, v179
v_mul_f32 v44, v180, v180
v_mul_f32 v45, v181, v181
v_mul_f32 v46, v182, v182
v_mul_f32 v47, v183, v183
v_fma_f32 v44, v44, v23, v21
v_mfma_f32_32x32x16_bf16 v[96:111], a[184:187], v[88:91], v[96:111]
buffer_load_dwordx4 v13, s[8:11], s61 offen offset:1024 lds
v_fma_f32 v45, v45, v23, v21
v_fma_f32 v46, v46, v23, v21
v_fma_f32 v47, v47, v23, v21
v_mul_f32 v44, v44, v180
v_mul_f32 v45, v45, v181
v_mul_f32 v46, v46, v182
v_mul_f32 v47, v47, v183
v_mfma_f32_32x32x16_bf16 v[112:127], a[188:191], v[88:91], v[112:127]
ds_read_b128 v[84:87], v8 offset:12288
v_exp_f32 v44, v44
v_exp_f32 v45, v45
v_exp_f32 v46, v46
v_exp_f32 v47, v47
v_fma_f32 v44, v44, v25, v25
v_fma_f32 v45, v45, v25, v25
v_mfma_f32_32x32x16_bf16 v[128:143], a[184:187], v[92:95], v[128:143]
v_and_b32 v70, 31, v0
v_lshrrev_b32 v71, 5, v0
v_mul_u32_u24 v71, 576, v71
v_add_u32 v70, v70, v71
s_lshl_b32 s63, s98, 8
s_add_u32 s63, s63, 139264
v_lshl_add_u32 v70, v70, 3, s63
buffer_load_dwordx2 v[68:69], v70, s[16:19], 0 offen sc1
v_mfma_f32_32x32x16_bf16 v[144:159], a[188:191], v[92:95], v[144:159]
ds_read_b128 v[88:91], v9 offset:8192
s_waitcnt lgkmcnt(1)
v_fma_f32 v46, v46, v25, v25
v_fma_f32 v47, v47, v25, v25
v_rcp_f32 v44, v44
v_rcp_f32 v45, v45
v_rcp_f32 v46, v46
v_mfma_f32_32x32x16_bf16 v[96:111], a[192:195], v[80:83], v[96:111]
s_add_u32 m0, s3, 131072
s_lshl_b32 s61, s59, 7
buffer_load_dwordx4 v16, s[24:27], s61 offen lds
v_rcp_f32 v47, v47
v_mul_f32 v180, v180, v44
v_mul_f32 v181, v181, v45
v_mul_f32 v182, v182, v46
v_mfma_f32_32x32x16_bf16 v[112:127], a[196:199], v[80:83], v[112:127]
ds_read_b128 v[92:95], v9 offset:12288
v_mul_f32 v183, v183, v47
v_cvt_pk_bf16_f32 v178, v180, v181
v_cvt_pk_bf16_f32 v179, v182, v183
s_add_u32 s99, s41, 87808
buffer_store_dwordx4 v[176:179], v31, s[16:19], s99 offen offset:0 sc1
v_mul_f32 v44, v184, v184
v_mul_f32 v45, v185, v185
v_mfma_f32_32x32x16_bf16 v[128:143], a[192:195], v[84:87], v[128:143]
v_mov_b32 v36, -1
v_mov_b32 v37, -1
v_mov_b32 v38, -1
v_mov_b32 v39, -1
v_mul_f32 v46, v186, v186
v_mul_f32 v47, v187, v187
v_fma_f32 v44, v44, v23, v21
v_fma_f32 v45, v45, v23, v21
v_fma_f32 v46, v46, v23, v21
v_fma_f32 v47, v47, v23, v21
v_mul_f32 v44, v44, v184
v_mfma_f32_32x32x16_bf16 v[144:159], a[196:199], v[84:87], v[144:159]
ds_read_b128 v[80:83], v10 offset:8192
s_waitcnt lgkmcnt(1)
v_mul_f32 v45, v45, v185
v_mul_f32 v46, v46, v186
v_mul_f32 v47, v47, v187
v_exp_f32 v44, v44
v_exp_f32 v45, v45
v_exp_f32 v46, v46
v_mfma_f32_32x32x16_bf16 v[96:111], a[200:203], v[88:91], v[96:111]
v_exp_f32 v47, v47
v_fma_f32 v44, v44, v25, v25
v_fma_f32 v45, v45, v25, v25
v_fma_f32 v46, v46, v25, v25
v_fma_f32 v47, v47, v25, v25
v_rcp_f32 v44, v44
v_rcp_f32 v45, v45
v_mfma_f32_32x32x16_bf16 v[112:127], a[204:207], v[88:91], v[112:127]
ds_read_b128 v[84:87], v10 offset:12288
v_rcp_f32 v46, v46
v_rcp_f32 v47, v47
v_mul_f32 v184, v184, v44
v_mul_f32 v185, v185, v45
v_mul_f32 v186, v186, v46
v_mul_f32 v187, v187, v47
v_cvt_pk_bf16_f32 v184, v184, v185
v_cvt_pk_bf16_f32 v185, v186, v187
v_mul_f32 v44, v188, v188
v_mfma_f32_32x32x16_bf16 v[128:143], a[200:203], v[92:95], v[128:143]
s_waitcnt vmcnt(8)
s_barrier
v_mul_f32 v45, v189, v189
v_mul_f32 v46, v190, v190
v_mul_f32 v47, v191, v191
v_fma_f32 v44, v44, v23, v21
v_fma_f32 v45, v45, v23, v21
v_fma_f32 v46, v46, v23, v21
v_fma_f32 v47, v47, v23, v21
v_mul_f32 v44, v44, v188
v_mfma_f32_32x32x16_bf16 v[144:159], a[204:207], v[92:95], v[144:159]
buffer_load_dwordx4 v17, s[24:27], s61 offen offset:1024 lds
ds_read_b128 v[88:91], v11 offset:8192
s_waitcnt lgkmcnt(1)
v_mul_f32 v45, v45, v189
v_mul_f32 v46, v46, v190
v_mul_f32 v47, v47, v191
v_exp_f32 v44, v44
v_mfma_f32_32x32x16_bf16 v[96:111], a[208:211], v[80:83], v[96:111]
s_add_u32 s63, s82, 8192
buffer_store_dwordx4 v[36:39], v1, s[16:19], s63 offen offset:0 sc1
v_exp_f32 v45, v45
v_exp_f32 v46, v46
v_exp_f32 v47, v47
v_mfma_f32_32x32x16_bf16 v[112:127], a[212:215], v[80:83], v[112:127]
ds_read_b128 v[92:95], v11 offset:12288
v_fma_f32 v44, v44, v25, v25
v_fma_f32 v45, v45, v25, v25
v_fma_f32 v46, v46, v25, v25
v_fma_f32 v47, v47, v25, v25
v_rcp_f32 v44, v44
v_rcp_f32 v45, v45
v_rcp_f32 v46, v46
v_mfma_f32_32x32x16_bf16 v[128:143], a[208:211], v[84:87], v[128:143]
v_rcp_f32 v47, v47
v_mul_f32 v188, v188, v44
v_mul_f32 v189, v189, v45
v_mul_f32 v190, v190, v46
v_mul_f32 v191, v191, v47
v_cvt_pk_bf16_f32 v186, v188, v189
v_cvt_pk_bf16_f32 v187, v190, v191
s_add_u32 s99, s41, 87808
buffer_store_dwordx4 v[184:187], v31, s[16:19], s99 offen offset:256 sc1
v_mfma_f32_32x32x16_bf16 v[144:159], a[212:215], v[84:87], v[144:159]
ds_read_b128 v[80:83], v8 offset:16384
s_waitcnt lgkmcnt(1)
v_mul_f32 v44, v192, v192
v_mul_f32 v45, v193, v193
v_mul_f32 v46, v194, v194
v_mul_f32 v47, v195, v195
v_fma_f32 v44, v44, v22, v20
v_fma_f32 v45, v45, v22, v20
v_fma_f32 v46, v46, v22, v20
v_mfma_f32_32x32x16_bf16 v[96:111], a[216:219], v[88:91], v[96:111]
v_fma_f32 v47, v47, v22, v20
v_mul_f32 v44, v44, v192
v_mul_f32 v45, v45, v193
v_mul_f32 v46, v46, v194
v_mul_f32 v47, v47, v195
v_exp_f32 v44, v44
v_exp_f32 v45, v45
v_exp_f32 v46, v46
v_mfma_f32_32x32x16_bf16 v[112:127], a[220:223], v[88:91], v[112:127]
ds_read_b128 v[84:87], v8 offset:20480
v_exp_f32 v47, v47
v_fma_f32 v44, v44, v24, v24
v_fma_f32 v45, v45, v24, v24
v_fma_f32 v46, v46, v24, v24
v_fma_f32 v47, v47, v24, v24
v_rcp_f32 v44, v44
v_rcp_f32 v45, v45
v_mfma_f32_32x32x16_bf16 v[128:143], a[216:219], v[92:95], v[128:143]
s_add_u32 s63, s82, 8192
buffer_store_dwordx4 v[36:39], v1, s[16:19], s63 offen offset:1024 sc1
v_rcp_f32 v46, v46
v_rcp_f32 v47, v47
v_mul_f32 v192, v192, v44
v_mfma_f32_32x32x16_bf16 v[144:159], a[220:223], v[92:95], v[144:159]
ds_read_b128 v[88:91], v9 offset:16384
s_waitcnt lgkmcnt(1)
v_mul_f32 v193, v193, v45
v_mul_f32 v194, v194, v46
v_mul_f32 v195, v195, v47
v_cvt_pk_bf16_f32 v192, v192, v193
v_cvt_pk_bf16_f32 v193, v194, v195
v_mul_f32 v44, v196, v196
v_mul_f32 v45, v197, v197
v_mul_f32 v46, v198, v198
v_mul_f32 v47, v199, v199
v_mfma_f32_32x32x16_bf16 v[96:111], a[224:227], v[80:83], v[96:111]
s_cmp_lt_u32 s47, 4
s_cselect_b32 s36, s28, s12
s_cselect_b32 s37, s29, s13
s_cselect_b32 s38, s30, s14
s_cmp_lt_u32 s47, 4
s_cselect_b32 s24, s32, s12
s_cselect_b32 s25, s33, s13
s_cselect_b32 s26, s34, s14
s_add_u32 m0, s3, 49152
s_add_u32 s61, s64, 0
buffer_load_dwordx4 v14, s[12:15], s61 offen lds
v_mfma_f32_32x32x16_bf16 v[112:127], a[228:231], v[80:83], v[112:127]
ds_read_b128 v[92:95], v9 offset:20480
v_and_b32 v18, 0xffffff80, v14
v_fma_f32 v44, v44, v22, v20
v_fma_f32 v45, v45, v22, v20
v_fma_f32 v46, v46, v22, v20
v_fma_f32 v47, v47, v22, v20
v_mul_f32 v44, v44, v196
v_mul_f32 v45, v45, v197
v_mfma_f32_32x32x16_bf16 v[128:143], a[224:227], v[84:87], v[128:143]
v_bfe_u32 v19, v0, 4, 2
v_mul_f32 v46, v46, v198
v_mul_f32 v47, v47, v199
v_exp_f32 v44, v44
v_exp_f32 v45, v45
v_exp_f32 v46, v46
v_exp_f32 v47, v47
v_mfma_f32_32x32x16_bf16 v[144:159], a[228:231], v[84:87], v[144:159]
ds_read_b128 v[80:83], v10 offset:16384
s_waitcnt lgkmcnt(1)
v_and_b32 v16, 7, v0
v_fma_f32 v44, v44, v24, v24
v_fma_f32 v45, v45, v24, v24
v_fma_f32 v46, v46, v24, v24
v_fma_f32 v47, v47, v24, v24
v_rcp_f32 v44, v44
v_rcp_f32 v45, v45
v_mfma_f32_32x32x16_bf16 v[96:111], a[232:235], v[88:91], v[96:111]
s_add_u32 s63, s82, 8192
buffer_store_dwordx4 v[36:39], v1, s[16:19], s63 offen offset:2048 sc1
v_xor_b32 v19, v19, v16
buffer_load_dwordx4 v15, s[12:15], s61 offen offset:1024 lds
v_mfma_f32_32x32x16_bf16 v[112:127], a[236:239], v[88:91], v[112:127]
ds_read_b128 v[84:87], v10 offset:20480
v_lshlrev_b32 v19, 4, v19
v_add_u32 v16, v18, v19
v_rcp_f32 v46, v46
v_rcp_f32 v47, v47
v_mul_f32 v196, v196, v44
v_mul_f32 v197, v197, v45
v_mul_f32 v198, v198, v46
v_mul_f32 v199, v199, v47
v_cvt_pk_bf16_f32 v194, v196, v197
v_mfma_f32_32x32x16_bf16 v[128:143], a[232:235], v[92:95], v[128:143]
s_waitcnt vmcnt(6)
s_barrier
v_xor_b32 v17, 64, v16
v_cvt_pk_bf16_f32 v195, v198, v199
s_add_u32 s99, s41, 0
buffer_store_dwordx4 v[192:195], v31, s[16:19], s99 offen offset:2048 sc1
v_mul_f32 v44, v200, v200
v_mfma_f32_32x32x16_bf16 v[144:159], a[236:239], v[92:95], v[144:159]
ds_read_b128 v[88:91], v11 offset:16384
s_waitcnt lgkmcnt(1)
v_add_u32 v17, 8192, v17
v_mul_f32 v45, v201, v201
v_mul_f32 v46, v202, v202
v_mul_f32 v47, v203, v203
v_fma_f32 v44, v44, v22, v20
v_fma_f32 v45, v45, v22, v20
v_fma_f32 v46, v46, v22, v20
v_fma_f32 v47, v47, v22, v20
v_mul_f32 v44, v44, v200
v_mfma_f32_32x32x16_bf16 v[96:111], a[240:243], v[80:83], v[96:111]
s_cmp_lt_u32 s47, 4
s_cselect_b64 s[92:93], -1, 0
v_cndmask_b32 v18, v14, v16, s[92:93]
v_cndmask_b32 v19, v15, v17, s[92:93]
s_add_u32 m0, s3, 90112
s_add_u32 s61, s64, 128
L_stub8:
s_cbranch_execz L_stub13
buffer_load_dwordx4 v14, s[12:15], s61 offen lds
v_mul_f32 v45, v45, v201
v_mfma_f32_32x32x16_bf16 v[112:127], a[244:247], v[80:83], v[112:127]
ds_read_b128 v[92:95], v11 offset:20480
v_mov_b32 v13, s45
v_mul_f32 v46, v46, v202
v_mul_f32 v47, v47, v203
v_exp_f32 v44, v44
v_exp_f32 v45, v45
v_exp_f32 v46, v46
v_mfma_f32_32x32x16_bf16 v[128:143], a[240:243], v[84:87], v[128:143]
s_add_u32 s63, s82, 8192
buffer_store_dwordx4 v[36:39], v1, s[16:19], s63 offen offset:3072 sc1
v_exp_f32 v47, v47
v_fma_f32 v44, v44, v24, v24
v_fma_f32 v45, v45, v24, v24
v_fma_f32 v46, v46, v24, v24
v_fma_f32 v47, v47, v24, v24
v_mfma_f32_32x32x16_bf16 v[144:159], a[244:247], v[84:87], v[144:159]
ds_read_b128 v[80:83], v8 offset:24576
s_waitcnt lgkmcnt(1)
v_rcp_f32 v44, v44
v_rcp_f32 v45, v45
v_rcp_f32 v46, v46
v_rcp_f32 v47, v47
v_mul_f32 v200, v200, v44
v_mul_f32 v201, v201, v45
v_mfma_f32_32x32x16_bf16 v[96:111], a[248:251], v[88:91], v[96:111]
buffer_load_dwordx4 v15, s[12:15], s61 offen offset:1024 lds
v_mul_f32 v202, v202, v46
v_mul_f32 v203, v203, v47
v_cvt_pk_bf16_f32 v200, v200, v201
v_cvt_pk_bf16_f32 v201, v202, v203
v_mul_f32 v44, v204, v204
v_mul_f32 v45, v205, v205
v_mul_f32 v46, v206, v206
v_mfma_f32_32x32x16_bf16 v[112:127], a[252:255], v[88:91], v[112:127]
ds_read_b128 v[84:87], v8 offset:28672
v_mul_f32 v47, v207, v207
v_fma_f32 v44, v44, v22, v20
v_fma_f32 v45, v45, v22, v20
v_fma_f32 v46, v46, v22, v20
v_fma_f32 v47, v47, v22, v20
v_mul_f32 v44, v44, v204
v_mul_f32 v45, v45, v205
v_mul_f32 v46, v46, v206
v_mul_f32 v47, v47, v207
v_mfma_f32_32x32x16_bf16 v[128:143], a[248:251], v[92:95], v[128:143]
v_exp_f32 v44, v44
v_exp_f32 v45, v45
v_exp_f32 v46, v46
v_exp_f32 v47, v47
v_fma_f32 v44, v44, v24, v24
v_fma_f32 v45, v45, v24, v24
v_fma_f32 v46, v46, v24, v24
v_mfma_f32_32x32x16_bf16 v[144:159], a[252:255], v[92:95], v[144:159]
ds_read_b128 v[88:91], v9 offset:24576
s_waitcnt lgkmcnt(1)
v_fma_f32 v47, v47, v24, v24
v_rcp_f32 v44, v44
v_rcp_f32 v45, v45
v_rcp_f32 v46, v46
v_rcp_f32 v47, v47
v_mfma_f32_32x32x16_bf16 v[96:111], v[224:227], v[80:83], v[96:111]
s_add_u32 m0, s3, 139264
s_add_u32 s61, s65, 0
buffer_load_dwordx4 v14, s[12:15], s61 offen lds
v_mul_f32 v204, v204, v44
v_mul_f32 v205, v205, v45
v_mul_f32 v206, v206, v46
v_mul_f32 v207, v207, v47
v_cvt_pk_bf16_f32 v202, v204, v205
v_mfma_f32_32x32x16_bf16 v[112:127], v[228:231], v[80:83], v[112:127]
ds_read_b128 v[92:95], v9 offset:28672
v_cvt_pk_bf16_f32 v203, v206, v207
s_add_u32 s99, s41, 0
buffer_store_dwordx4 v[200:203], v31, s[16:19], s99 offen offset:2304 sc1
v_mul_f32 v44, v208, v208
v_mul_f32 v45, v209, v209
v_mul_f32 v46, v210, v210
v_mul_f32 v47, v211, v211
v_mfma_f32_32x32x16_bf16 v[128:143], v[224:227], v[84:87], v[128:143]
v_fma_f32 v44, v44, v23, v21
v_fma_f32 v45, v45, v23, v21
v_fma_f32 v46, v46, v23, v21
v_fma_f32 v47, v47, v23, v21
v_mul_f32 v44, v44, v208
v_mul_f32 v45, v45, v209
v_mul_f32 v46, v46, v210
v_mul_f32 v47, v47, v211
v_exp_f32 v44, v44
v_mfma_f32_32x32x16_bf16 v[144:159], v[228:231], v[84:87], v[144:159]
ds_read_b128 v[80:83], v10 offset:24576
s_waitcnt lgkmcnt(1)
v_exp_f32 v45, v45
v_exp_f32 v46, v46
v_exp_f32 v47, v47
v_fma_f32 v44, v44, v25, v25
v_fma_f32 v45, v45, v25, v25
v_fma_f32 v46, v46, v25, v25
v_fma_f32 v47, v47, v25, v25
v_mfma_f32_32x32x16_bf16 v[96:111], v[232:235], v[88:91], v[96:111]
v_cmp_ne_u32 vcc, s45, v69
s_nop 0
s_cmp_lg_u64 vcc, 0
s_cbranch_scc1 csS1S_slow
csS1S_ok:
buffer_load_dwordx4 v15, s[12:15], s61 offen offset:1024 lds
v_rcp_f32 v44, v44
v_rcp_f32 v45, v45
v_mfma_f32_32x32x16_bf16 v[112:127], v[236:239], v[88:91], v[112:127]
ds_read_b128 v[84:87], v10 offset:28672
v_mov_b32 v73, v68
v_mov_b32 v77, v68
v_rcp_f32 v46, v46
v_rcp_f32 v47, v47
v_mul_f32 v208, v208, v44
v_mul_f32 v209, v209, v45
v_mul_f32 v210, v210, v46
v_mul_f32 v211, v211, v47
v_mfma_f32_32x32x16_bf16 v[128:143], v[232:235], v[92:95], v[128:143]
v_permlane32_swap_b32 v68, v77
v_mov_b32 v74, 0
v_cvt_pk_bf16_f32 v72, v73, v73
v_cvt_pk_bf16_f32 v208, v208, v209
v_cvt_pk_bf16_f32 v209, v210, v211
v_mul_f32 v44, v212, v212
v_mul_f32 v45, v213, v213
v_mul_f32 v46, v214, v214
v_mul_f32 v47, v215, v215
v_fma_f32 v44, v44, v23, v21
v_mfma_f32_32x32x16_bf16 v[144:159], v[236:239], v[92:95], v[144:159]
ds_read_b128 v[88:91], v11 offset:24576
s_waitcnt lgkmcnt(1)
v_lshlrev_b32 v40, 16, v72
v_fma_f32 v45, v45, v23, v21
v_fma_f32 v46, v46, v23, v21
v_fma_f32 v47, v47, v23, v21
v_mul_f32 v44, v44, v212
v_mul_f32 v45, v45, v213
v_mul_f32 v46, v46, v214
v_mul_f32 v47, v47, v215
v_mfma_f32_32x32x16_bf16 v[96:111], v[240:243], v[80:83], v[96:111]
s_barrier
v_lshlrev_b32 v75, 16, v74
s_add_u32 m0, s3, 106496
s_add_u32 s61, s65, 128
buffer_load_dwordx4 v14, s[12:15], s61 offen lds
v_exp_f32 v44, v44
v_mfma_f32_32x32x16_bf16 v[112:127], v[244:247], v[80:83], v[112:127]
ds_read_b128 v[92:95], v11 offset:28672
v_sub_f32 v40, v73, v40
v_exp_f32 v45, v45
v_exp_f32 v46, v46
v_exp_f32 v47, v47
v_fma_f32 v44, v44, v25, v25
v_fma_f32 v45, v45, v25, v25
v_fma_f32 v46, v46, v25, v25
v_fma_f32 v47, v47, v25, v25
v_mfma_f32_32x32x16_bf16 v[128:143], v[240:243], v[84:87], v[128:143]
ds_read_b64_tr_b16 v[80:81], v4 offset:16384
v_cvt_pk_bf16_f32 v73, v40, v75
v_mov_b32 v75, 0
v_rcp_f32 v44, v44
v_rcp_f32 v45, v45
v_rcp_f32 v46, v46
v_rcp_f32 v47, v47
v_mfma_f32_32x32x16_bf16 v[144:159], v[244:247], v[84:87], v[144:159]
ds_read_b64_tr_b16 v[82:83], v4 offset:16896
s_waitcnt lgkmcnt(2)
v_mov_b32 v78, 0
v_mul_f32 v212, v212, v44
v_mul_f32 v213, v213, v45
v_mul_f32 v214, v214, v46
v_mul_f32 v215, v215, v47
v_cvt_pk_bf16_f32 v210, v212, v213
v_cvt_pk_bf16_f32 v211, v214, v215
s_add_u32 s99, s41, 87808
buffer_store_dwordx4 v[208:211], v31, s[16:19], s99 offen offset:2048 sc1
v_mfma_f32_32x32x16_bf16 v[96:111], v[248:251], v[88:91], v[96:111]
ds_read_b64_tr_b16 v[84:85], v4 offset:18432
v_cvt_pk_bf16_f32 v76, v77, v77
v_lshlrev_b32 v41, 16, v76
buffer_load_dwordx4 v15, s[12:15], s61 offen offset:1024 lds
v_mfma_f32_32x32x16_bf16 v[112:127], v[252:255], v[88:91], v[112:127]
ds_read_b64_tr_b16 v[86:87], v4 offset:18944
v_lshlrev_b32 v79, 16, v78
v_sub_f32 v41, v77, v41
v_mul_f32 v44, v216, v216
v_mul_f32 v45, v217, v217
v_mul_f32 v46, v218, v218
v_mul_f32 v47, v219, v219
v_fma_f32 v44, v44, v23, v21
v_fma_f32 v45, v45, v23, v21
v_fma_f32 v46, v46, v23, v21
v_fma_f32 v47, v47, v23, v21
v_mfma_f32_32x32x16_bf16 v[128:143], v[248:251], v[92:95], v[128:143]
ds_read_b64_tr_b16 v[88:89], v4 offset:20480
v_cvt_pk_bf16_f32 v77, v41, v79
v_mov_b32 v79, 0
v_mul_f32 v44, v44, v216
v_mul_f32 v45, v45, v217
v_mul_f32 v46, v46, v218
v_mul_f32 v47, v47, v219
v_exp_f32 v44, v44
v_exp_f32 v45, v45
v_mfma_f32_32x32x16_bf16 v[144:159], v[252:255], v[92:95], v[144:159]
ds_read_b64_tr_b16 v[90:91], v4 offset:20992
s_waitcnt lgkmcnt(2)
v_exp_f32 v46, v46
v_exp_f32 v47, v47
v_fma_f32 v44, v44, v25, v25
v_fma_f32 v45, v45, v25, v25
v_fma_f32 v46, v46, v25, v25
v_fma_f32 v47, v47, v25, v25
v_mfma_f32_32x32x16_bf16 v[96:111], v[28:31], v[72:75], v[96:111]
s_add_u32 m0, s3, 114688
s_add_u32 s61, s40, 0
buffer_load_dwordx4 v14, s[12:15], s61 offen lds
v_rcp_f32 v44, v44
v_rcp_f32 v45, v45
v_rcp_f32 v46, v46
v_mfma_f32_32x32x16_bf16 v[112:127], v[32:35], v[72:75], v[112:127]
v_rcp_f32 v47, v47
v_mul_f32 v216, v216, v44
v_mul_f32 v217, v217, v45
v_mul_f32 v218, v218, v46
v_mul_f32 v219, v219, v47
v_cvt_pk_bf16_f32 v216, v216, v217
v_cvt_pk_bf16_f32 v217, v218, v219
v_mul_f32 v44, v220, v220
v_mul_f32 v45, v221, v221
v_mul_f32 v46, v222, v222
v_mfma_f32_32x32x16_bf16 v[128:143], v[28:31], v[76:79], v[128:143]
v_mul_f32 v47, v223, v223
v_fma_f32 v44, v44, v23, v21
v_fma_f32 v45, v45, v23, v21
v_fma_f32 v46, v46, v23, v21
v_fma_f32 v47, v47, v23, v21
v_mul_f32 v44, v44, v220
v_mul_f32 v45, v45, v221
v_mul_f32 v46, v46, v222
v_mul_f32 v47, v47, v223
v_exp_f32 v44, v44
v_mfma_f32_32x32x16_bf16 v[144:159], v[32:35], v[76:79], v[144:159]
v_exp_f32 v45, v45
v_exp_f32 v46, v46
v_exp_f32 v47, v47
v_fma_f32 v44, v44, v25, v25
v_fma_f32 v45, v45, v25, v25
v_fma_f32 v46, v46, v25, v25
v_fma_f32 v47, v47, v25, v25
v_mfma_f32_32x32x16_bf16 v[160:175], v[80:83], a[0:3], 0
buffer_load_dwordx4 v15, s[12:15], s61 offen offset:1024 lds
ds_read_b64_tr_b16 v[92:93], v4 offset:22528
v_rcp_f32 v44, v44
v_rcp_f32 v45, v45
v_rcp_f32 v46, v46
v_mfma_f32_32x32x16_bf16 v[176:191], v[80:83], a[4:7], 0
ds_read_b64_tr_b16 v[94:95], v4 offset:23040
v_rcp_f32 v47, v47
v_mul_f32 v220, v220, v44
v_mul_f32 v221, v221, v45
v_mul_f32 v222, v222, v46
v_mul_f32 v223, v223, v47
v_cvt_pk_bf16_f32 v218, v220, v221
v_cvt_pk_bf16_f32 v219, v222, v223
s_add_u32 s99, s41, 87808
buffer_store_dwordx4 v[216:219], v31, s[16:19], s99 offen offset:2304 sc1
v_mfma_f32_32x32x16_bf16 v[160:175], v[84:87], a[8:11], v[160:175]
ds_read_b64_tr_b16 v[80:81], v3 offset:32768
v_mfma_f32_32x32x16_bf16 v[176:191], v[84:87], a[12:15], v[176:191]
ds_read_b64_tr_b16 v[82:83], v3 offset:33280
s_waitcnt lgkmcnt(2)
v_and_b32 v66, 32, v0
s_lshl_b32 s71, s44, 6
v_add_u32 v66, s71, v66
v_lshlrev_b32 v66, 2, v66
v_add_u32 v66, 155648, v66
ds_read_b128 v[72:75], v66 offset:0
ds_read_b128 v[76:79], v66 offset:16
v_mfma_f32_32x32x16_bf16 v[160:175], v[88:91], a[16:19], v[160:175]
s_add_u32 m0, s3, 122880
s_add_u32 s61, s40, 128
buffer_load_dwordx4 v14, s[12:15], s61 offen lds
ds_read_b64_tr_b16 v[84:85], v3 offset:34816
v_mul_f32 v44, v54, v96
v_mfma_f32_32x32x16_bf16 v[176:191], v[88:91], a[20:23], v[176:191]
ds_read_b64_tr_b16 v[86:87], v3 offset:35328
v_mul_f32 v45, v54, v128
v_fma_f32 v44, -v55, v128, v44
v_fmac_f32 v45, v55, v96
s_waitcnt lgkmcnt(3)
v_mul_f32 v96, v72, v44
v_mul_f32 v128, v72, v45
v_mul_f32 v44, v54, v97
v_mul_f32 v45, v54, v129
v_fma_f32 v44, -v55, v129, v44
v_mfma_f32_32x32x16_bf16 v[160:175], v[92:95], a[24:27], v[160:175]
ds_read_b64_tr_b16 v[88:89], v3 offset:36864
v_fmac_f32 v45, v55, v97
v_mov_b32 v40, v96
v_mov_b32 v41, v128
v_mul_f32 v97, v73, v44
v_mul_f32 v129, v73, v45
v_mul_f32 v44, v54, v98
v_mul_f32 v45, v54, v130
v_fma_f32 v46, -v53, v41, v97
v_mfma_f32_32x32x16_bf16 v[176:191], v[92:95], a[28:31], v[176:191]
ds_read_b64_tr_b16 v[90:91], v3 offset:37376
s_waitcnt lgkmcnt(2)
v_fma_f32 v47, v53, v40, v129
v_fma_f32 v44, -v55, v130, v44
v_fmac_f32 v45, v55, v98
v_fma_f32 v40, v52, v40, v46
v_fma_f32 v41, v52, v41, v47
v_mul_f32 v98, v74, v44
v_mfma_f32_32x32x16_bf16 v[160:175], v[80:83], a[32:35], v[160:175]
buffer_load_dwordx4 v15, s[12:15], s61 offen offset:1024 lds
ds_read_b64_tr_b16 v[92:93], v3 offset:38912
v_mul_f32 v130, v74, v45
v_mul_f32 v44, v54, v99
v_mul_f32 v45, v54, v131
v_fma_f32 v46, -v53, v41, v98
v_mfma_f32_32x32x16_bf16 v[176:191], v[80:83], a[36:39], v[176:191]
ds_read_b64_tr_b16 v[94:95], v3 offset:39424
v_fma_f32 v47, v53, v40, v130
v_fma_f32 v44, -v55, v131, v44
v_fmac_f32 v45, v55, v99
v_fma_f32 v40, v52, v40, v46
v_fma_f32 v41, v52, v41, v47
v_mul_f32 v99, v75, v44
v_mul_f32 v131, v75, v45
ds_read_b128 v[72:75], v66 offset:32
v_mfma_f32_32x32x16_bf16 v[160:175], v[84:87], a[40:43], v[160:175]
ds_read_b64_tr_b16 v[80:81], v3 offset:0
v_mul_f32 v44, v54, v100
v_mul_f32 v45, v54, v132
v_fma_f32 v46, -v53, v41, v99
v_fma_f32 v47, v53, v40, v131
v_fma_f32 v44, -v55, v132, v44
v_fmac_f32 v45, v55, v100
v_fma_f32 v40, v52, v40, v46
v_fma_f32 v41, v52, v41, v47
v_mfma_f32_32x32x16_bf16 v[176:191], v[84:87], a[44:47], v[176:191]
ds_read_b64_tr_b16 v[82:83], v3 offset:512
s_waitcnt lgkmcnt(3)
v_mul_f32 v100, v76, v44
v_mul_f32 v132, v76, v45
v_mul_f32 v44, v54, v101
v_mul_f32 v45, v54, v133
v_fma_f32 v46, -v53, v41, v100
v_fma_f32 v47, v53, v40, v132
v_mfma_f32_32x32x16_bf16 v[160:175], v[88:91], a[48:51], v[160:175]
ds_read_b64_tr_b16 v[84:85], v3 offset:2048
v_fma_f32 v44, -v55, v133, v44
v_fmac_f32 v45, v55, v101
v_fma_f32 v40, v52, v40, v46
v_fma_f32 v41, v52, v41, v47
v_mul_f32 v101, v77, v44
v_mul_f32 v133, v77, v45
v_mul_f32 v44, v54, v102
v_mul_f32 v45, v54, v134
v_mfma_f32_32x32x16_bf16 v[176:191], v[88:91], a[52:55], v[176:191]
ds_read_b64_tr_b16 v[86:87], v3 offset:2560
v_fma_f32 v46, -v53, v41, v101
v_fma_f32 v47, v53, v40, v133
v_fma_f32 v44, -v55, v134, v44
v_fmac_f32 v45, v55, v102
v_fma_f32 v40, v52, v40, v46
v_fma_f32 v41, v52, v41, v47
v_mul_f32 v102, v78, v44
v_mul_f32 v134, v78, v45
v_mfma_f32_32x32x16_bf16 v[160:175], v[92:95], a[56:59], v[160:175]
ds_read_b64_tr_b16 v[88:89], v3 offset:4096
v_mul_f32 v44, v54, v103
v_mul_f32 v45, v54, v135
v_fma_f32 v46, -v53, v41, v102
v_fma_f32 v47, v53, v40, v134
v_fma_f32 v44, -v55, v135, v44
v_fmac_f32 v45, v55, v103
v_fma_f32 v40, v52, v40, v46
v_mfma_f32_32x32x16_bf16 v[176:191], v[92:95], a[60:63], v[176:191]
ds_read_b64_tr_b16 v[90:91], v3 offset:4608
s_waitcnt lgkmcnt(2)
v_fma_f32 v41, v52, v41, v47
v_mul_f32 v103, v79, v44
v_mul_f32 v135, v79, v45
ds_read_b128 v[76:79], v66 offset:48
v_mul_f32 v44, v54, v104
v_mul_f32 v45, v54, v136
v_fma_f32 v46, -v53, v41, v103
v_mfma_f32_32x32x16_bf16 v[160:175], v[80:83], a[64:67], v[160:175]
ds_read_b64_tr_b16 v[92:93], v3 offset:6144
v_fma_f32 v47, v53, v40, v135
v_fma_f32 v44, -v55, v136, v44
v_fmac_f32 v45, v55, v104
v_fma_f32 v40, v52, v40, v46
v_fma_f32 v41, v52, v41, v47
v_mul_f32 v104, v72, v44
v_mul_f32 v136, v72, v45
v_mul_f32 v44, v54, v105
v_mfma_f32_32x32x16_bf16 v[176:191], v[80:83], a[68:71], v[176:191]
ds_read_b64_tr_b16 v[94:95], v3 offset:6656
v_mul_f32 v45, v54, v137
v_fma_f32 v46, -v53, v41, v104
v_fma_f32 v47, v53, v40, v136
v_fma_f32 v44, -v55, v137, v44
v_fmac_f32 v45, v55, v105
v_fma_f32 v40, v52, v40, v46
v_fma_f32 v41, v52, v41, v47
v_mfma_f32_32x32x16_bf16 v[160:175], v[84:87], a[72:75], v[160:175]
ds_read_b64_tr_b16 v[80:81], v3 offset:8192
v_mul_f32 v105, v73, v44
v_mul_f32 v137, v73, v45
v_mul_f32 v44, v54, v106
v_mul_f32 v45, v54, v138
v_fma_f32 v46, -v53, v41, v105
v_fma_f32 v47, v53, v40, v137
v_fma_f32 v44, -v55, v138, v44
v_fmac_f32 v45, v55, v106
v_mfma_f32_32x32x16_bf16 v[176:191], v[84:87], a[76:79], v[176:191]
ds_read_b64_tr_b16 v[82:83], v3 offset:8704
s_waitcnt lgkmcnt(2)
v_fma_f32 v40, v52, v40, v46
v_fma_f32 v41, v52, v41, v47
v_mul_f32 v106, v74, v44
v_mul_f32 v138, v74, v45
v_mul_f32 v44, v54, v107
v_mul_f32 v45, v54, v139
v_fma_f32 v46, -v53, v41, v106
v_mfma_f32_32x32x16_bf16 v[160:175], v[88:91], a[80:83], v[160:175]
ds_read_b64_tr_b16 v[84:85], v3 offset:10240
s_lshl_b32 s63, s101, 2
s_add_u32 s63, s63, 98304
v_lshl_add_u32 v70, v0, 3, s63
buffer_load_dwordx2 v[68:69], v70, s[16:19], 0 offen sc1
v_fma_f32 v47, v53, v40, v138
v_mfma_f32_32x32x16_bf16 v[176:191], v[88:91], a[84:87], v[176:191]
ds_read_b64_tr_b16 v[86:87], v3 offset:10752
v_fma_f32 v44, -v55, v139, v44
v_fmac_f32 v45, v55, v107
v_fma_f32 v40, v52, v40, v46
v_fma_f32 v41, v52, v41, v47
v_mul_f32 v107, v75, v44
v_mul_f32 v139, v75, v45
ds_read_b128 v[72:75], v66 offset:64
v_mfma_f32_32x32x16_bf16 v[160:175], v[92:95], a[88:91], v[160:175]
ds_read_b64_tr_b16 v[88:89], v3 offset:12288
v_mul_f32 v44, v54, v108
v_mul_f32 v45, v54, v140
v_fma_f32 v46, -v53, v41, v107
v_fma_f32 v47, v53, v40, v139
v_fma_f32 v44, -v55, v140, v44
v_fmac_f32 v45, v55, v108
v_fma_f32 v40, v52, v40, v46
v_fma_f32 v41, v52, v41, v47
v_mfma_f32_32x32x16_bf16 v[176:191], v[92:95], a[92:95], v[176:191]
ds_read_b64_tr_b16 v[90:91], v3 offset:12800
s_waitcnt lgkmcnt(3)
v_mul_f32 v108, v76, v44
v_mul_f32 v140, v76, v45
v_mul_f32 v44, v54, v109
v_mul_f32 v45, v54, v141
v_fma_f32 v46, -v53, v41, v108
v_fma_f32 v47, v53, v40, v140
v_fma_f32 v44, -v55, v141, v44
v_mfma_f32_32x32x16_bf16 v[160:175], v[80:83], a[96:99], v[160:175]
ds_read_b64_tr_b16 v[92:93], v3 offset:14336
v_fmac_f32 v45, v55, v109
v_fma_f32 v40, v52, v40, v46
v_fma_f32 v41, v52, v41, v47
v_mul_f32 v109, v77, v44
v_mul_f32 v141, v77, v45
v_mul_f32 v44, v54, v110
v_mul_f32 v45, v54, v142
v_mfma_f32_32x32x16_bf16 v[176:191], v[80:83], a[100:103], v[176:191]
ds_read_b64_tr_b16 v[94:95], v3 offset:14848
v_fma_f32 v46, -v53, v41, v109
v_fma_f32 v47, v53, v40, v141
v_fma_f32 v44, -v55, v142, v44
v_fmac_f32 v45, v55, v110
v_fma_f32 v40, v52, v40, v46
v_fma_f32 v41, v52, v41, v47
v_mul_f32 v110, v78, v44
v_mul_f32 v142, v78, v45
v_mfma_f32_32x32x16_bf16 v[160:175], v[84:87], a[104:107], v[160:175]
ds_read_b64_tr_b16 v[80:81], v2 offset:24576
v_mul_f32 v44, v54, v111
v_mul_f32 v45, v54, v143
v_fma_f32 v46, -v53, v41, v110
v_fma_f32 v47, v53, v40, v142
v_fma_f32 v44, -v55, v143, v44
v_fmac_f32 v45, v55, v111
v_fma_f32 v40, v52, v40, v46
v_fma_f32 v41, v52, v41, v47
v_mfma_f32_32x32x16_bf16 v[176:191], v[84:87], a[108:111], v[176:191]
ds_read_b64_tr_b16 v[82:83], v2 offset:25088
s_waitcnt lgkmcnt(2)
v_mul_f32 v111, v79, v44
v_mul_f32 v143, v79, v45
ds_read_b128 v[76:79], v66 offset:80
v_mul_f32 v44, v54, v112
v_mul_f32 v45, v54, v144
v_fma_f32 v46, -v53, v41, v111
v_mfma_f32_32x32x16_bf16 v[160:175], v[88:91], a[112:115], v[160:175]
ds_read_b64_tr_b16 v[84:85], v2 offset:26624
v_fma_f32 v47, v53, v40, v143
v_fma_f32 v44, -v55, v144, v44
v_fmac_f32 v45, v55, v112
v_fma_f32 v40, v52, v40, v46
v_fma_f32 v41, v52, v41, v47
v_mul_f32 v112, v72, v44
v_mul_f32 v144, v72, v45
v_mul_f32 v44, v54, v113
v_mfma_f32_32x32x16_bf16 v[176:191], v[88:91], a[116:119], v[176:191]
ds_read_b64_tr_b16 v[86:87], v2 offset:27136
v_mul_f32 v45, v54, v145
v_fma_f32 v46, -v53, v41, v112
v_fma_f32 v47, v53, v40, v144
v_fma_f32 v44, -v55, v145, v44
v_fmac_f32 v45, v55, v113
v_fma_f32 v40, v52, v40, v46
v_fma_f32 v41, v52, v41, v47
v_mul_f32 v113, v73, v44
v_mfma_f32_32x32x16_bf16 v[160:175], v[92:95], a[120:123], v[160:175]
ds_read_b64_tr_b16 v[88:89], v2 offset:28672
v_mul_f32 v145, v73, v45
v_mul_f32 v44, v54, v114
v_mul_f32 v45, v54, v146
v_fma_f32 v46, -v53, v41, v113
v_fma_f32 v47, v53, v40, v145
v_fma_f32 v44, -v55, v146, v44
v_fmac_f32 v45, v55, v114
v_fma_f32 v40, v52, v40, v46
v_mfma_f32_32x32x16_bf16 v[176:191], v[92:95], a[124:127], v[176:191]
ds_read_b64_tr_b16 v[90:91], v2 offset:29184
s_waitcnt lgkmcnt(2)
v_fma_f32 v41, v52, v41, v47
v_mul_f32 v114, v74, v44
v_mul_f32 v146, v74, v45
v_mul_f32 v44, v54, v115
v_mul_f32 v45, v54, v147
v_fma_f32 v46, -v53, v41, v114
v_mfma_f32_32x32x16_bf16 v[160:175], v[80:83], a[128:131], v[160:175]
ds_read_b64_tr_b16 v[92:93], v2 offset:30720
v_fma_f32 v47, v53, v40, v146
v_fma_f32 v44, -v55, v147, v44
v_fmac_f32 v45, v55, v115
v_fma_f32 v40, v52, v40, v46
v_fma_f32 v41, v52, v41, v47
v_mul_f32 v115, v75, v44
v_mul_f32 v147, v75, v45
ds_read_b128 v[72:75], v66 offset:96
v_mfma_f32_32x32x16_bf16 v[176:191], v[80:83], a[132:135], v[176:191]
ds_read_b64_tr_b16 v[94:95], v2 offset:31232
v_mul_f32 v44, v54, v116
v_mul_f32 v45, v54, v148
v_fma_f32 v46, -v53, v41, v115
v_fma_f32 v47, v53, v40, v147
v_fma_f32 v44, -v55, v148, v44
v_fmac_f32 v45, v55, v116
v_fma_f32 v40, v52, v40, v46
v_fma_f32 v41, v52, v41, v47
v_mfma_f32_32x32x16_bf16 v[160:175], v[84:87], a[136:139], v[160:175]
ds_read_b64_tr_b16 v[80:81], v2 offset:40960
v_mul_f32 v116, v76, v44
v_mul_f32 v148, v76, v45
v_mul_f32 v44, v54, v117
v_mul_f32 v45, v54, v149
v_fma_f32 v46, -v53, v41, v116
v_fma_f32 v47, v53, v40, v148
v_fma_f32 v44, -v55, v149, v44
v_mfma_f32_32x32x16_bf16 v[176:191], v[84:87], a[140:143], v[176:191]
ds_read_b64_tr_b16 v[82:83], v2 offset:41472
s_waitcnt lgkmcnt(2)
v_fmac_f32 v45, v55, v117
v_fma_f32 v40, v52, v40, v46
v_fma_f32 v41, v52, v41, v47
v_mul_f32 v117, v77, v44
v_mul_f32 v149, v77, v45
v_mul_f32 v44, v54, v118
v_mul_f32 v45, v54, v150
v_mfma_f32_32x32x16_bf16 v[160:175], v[88:91], a[144:147], v[160:175]
ds_read_b64_tr_b16 v[84:85], v2 offset:43008
v_fma_f32 v46, -v53, v41, v117
v_fma_f32 v47, v53, v40, v149
v_fma_f32 v44, -v55, v150, v44
v_fmac_f32 v45, v55, v118
v_fma_f32 v40, v52, v40, v46
v_fma_f32 v41, v52, v41, v47
v_mul_f32 v118, v78, v44
v_mul_f32 v150, v78, v45
v_mfma_f32_32x32x16_bf16 v[176:191], v[88:91], a[148:151], v[176:191]
ds_read_b64_tr_b16 v[86:87], v2 offset:43520
s_waitcnt vmcnt(3)
buffer_store_dword v13, v26, s[16:19], s60 offen offset:0 sc1
v_mul_f32 v44, v54, v119
v_mul_f32 v45, v54, v151
v_mfma_f32_32x32x16_bf16 v[160:175], v[92:95], a[152:155], v[160:175]
ds_read_b64_tr_b16 v[88:89], v2 offset:45056
v_fma_f32 v46, -v53, v41, v118
v_fma_f32 v47, v53, v40, v150
v_fma_f32 v44, -v55, v151, v44
v_fmac_f32 v45, v55, v119
v_fma_f32 v40, v52, v40, v46
v_fma_f32 v41, v52, v41, v47
v_mul_f32 v119, v79, v44
v_mul_f32 v151, v79, v45
v_mfma_f32_32x32x16_bf16 v[176:191], v[92:95], a[156:159], v[176:191]
ds_read_b64_tr_b16 v[90:91], v2 offset:45568
s_waitcnt lgkmcnt(2)
ds_read_b128 v[76:79], v66 offset:112
v_mul_f32 v44, v54, v120
v_mul_f32 v45, v54, v152
v_fma_f32 v46, -v53, v41, v119
v_fma_f32 v47, v53, v40, v151
v_fma_f32 v44, -v55, v152, v44
v_fmac_f32 v45, v55, v120
v_mfma_f32_32x32x16_bf16 v[160:175], v[80:83], a[160:163], v[160:175]
ds_read_b64_tr_b16 v[92:93], v2 offset:47104
v_fma_f32 v40, v52, v40, v46
v_fma_f32 v41, v52, v41, v47
v_mul_f32 v120, v72, v44
v_mul_f32 v152, v72, v45
v_mul_f32 v44, v54, v121
v_mul_f32 v45, v54, v153
v_fma_f32 v46, -v53, v41, v120
v_fma_f32 v47, v53, v40, v152
v_mfma_f32_32x32x16_bf16 v[176:191], v[80:83], a[164:167], v[176:191]
ds_read_b64_tr_b16 v[94:95], v2 offset:47616
v_fma_f32 v44, -v55, v153, v44
v_fmac_f32 v45, v55, v121
v_fma_f32 v40, v52, v40, v46
v_fma_f32 v41, v52, v41, v47
v_mul_f32 v121, v73, v44
v_mul_f32 v153, v73, v45
v_mul_f32 v44, v54, v122
v_mfma_f32_32x32x16_bf16 v[160:175], v[84:87], a[168:171], v[160:175]
ds_read_b64_tr_b16 v[80:81], v2 offset:57344
v_mul_f32 v45, v54, v154
v_fma_f32 v46, -v53, v41, v121
v_fma_f32 v47, v53, v40, v153
v_fma_f32 v44, -v55, v154, v44
v_fmac_f32 v45, v55, v122
v_fma_f32 v40, v52, v40, v46
v_fma_f32 v41, v52, v41, v47
v_mul_f32 v122, v74, v44
v_mfma_f32_32x32x16_bf16 v[176:191], v[84:87], a[172:175], v[176:191]
ds_read_b64_tr_b16 v[82:83], v2 offset:57856
s_waitcnt lgkmcnt(2)
v_mul_f32 v154, v74, v45
v_mul_f32 v44, v54, v123
v_mul_f32 v45, v54, v155
v_fma_f32 v46, -v53, v41, v122
v_fma_f32 v47, v53, v40, v154
v_fma_f32 v44, -v55, v155, v44
v_fmac_f32 v45, v55, v123
v_mfma_f32_32x32x16_bf16 v[160:175], v[88:91], a[176:179], v[160:175]
ds_read_b64_tr_b16 v[84:85], v2 offset:59392
v_fma_f32 v40, v52, v40, v46
v_fma_f32 v41, v52, v41, v47
v_mul_f32 v123, v75, v44
v_mul_f32 v155, v75, v45
L_stub9:
s_cbranch_execz L_stub12
v_mul_f32 v44, v54, v124
v_mul_f32 v45, v54, v156
v_fma_f32 v46, -v53, v41, v123
v_mfma_f32_32x32x16_bf16 v[176:191], v[88:91], a[180:183], v[176:191]
ds_read_b64_tr_b16 v[86:87], v2 offset:59904
v_fma_f32 v47, v53, v40, v155
v_fma_f32 v44, -v55, v156, v44
v_fmac_f32 v45, v55, v124
v_fma_f32 v40, v52, v40, v46
v_fma_f32 v41, v52, v41, v47
v_mul_f32 v124, v76, v44
v_mul_f32 v156, v76, v45
v_mul_f32 v44, v54, v125
v_mfma_f32_32x32x16_bf16 v[160:175], v[92:95], a[184:187], v[160:175]
ds_read_b64_tr_b16 v[88:89], v2 offset:61440
v_mul_f32 v45, v54, v157
v_fma_f32 v46, -v53, v41, v124
v_fma_f32 v47, v53, v40, v156
v_fma_f32 v44, -v55, v157, v44
v_fmac_f32 v45, v55, v125
v_fma_f32 v40, v52, v40, v46
v_fma_f32 v41, v52, v41, v47
v_mul_f32 v125, v77, v44
v_mfma_f32_32x32x16_bf16 v[176:191], v[92:95], a[188:191], v[176:191]
ds_read_b64_tr_b16 v[90:91], v2 offset:61952
s_waitcnt lgkmcnt(2)
v_mul_f32 v157, v77, v45
v_mul_f32 v44, v54, v126
v_mul_f32 v45, v54, v158
v_fma_f32 v46, -v53, v41, v125
v_fma_f32 v47, v53, v40, v157
v_fma_f32 v44, -v55, v158, v44
v_mfma_f32_32x32x16_bf16 v[160:175], v[80:83], a[192:195], v[160:175]
ds_read_b64_tr_b16 v[92:93], v2 offset:63488
v_fmac_f32 v45, v55, v126
v_fma_f32 v40, v52, v40, v46
v_fma_f32 v41, v52, v41, v47
v_mul_f32 v126, v78, v44
v_mul_f32 v158, v78, v45
v_mul_f32 v44, v54, v127
v_mul_f32 v45, v54, v159
v_fma_f32 v46, -v53, v41, v126
v_mfma_f32_32x32x16_bf16 v[176:191], v[80:83], a[196:199], v[176:191]
ds_read_b64_tr_b16 v[94:95], v2 offset:64000
v_fma_f32 v47, v53, v40, v158
v_fma_f32 v44, -v55, v159, v44
v_fmac_f32 v45, v55, v127
v_fma_f32 v40, v52, v40, v46
v_fma_f32 v41, v52, v41, v47
v_mul_f32 v127, v79, v44
v_mul_f32 v159, v79, v45
v_fma_f32 v46, -v53, v41, v127
v_mfma_f32_32x32x16_bf16 v[160:175], v[84:87], a[200:203], v[160:175]
ds_read_b64_tr_b16 v[80:81], v3 offset:16384
v_fma_f32 v47, v53, v40, v159
v_fma_f32 v40, v52, v40, v46
v_fma_f32 v41, v52, v41, v47
v_lshlrev_b32 v66, 3, v0
s_lshl_b32 s71, s44, 9
v_add_u32 v66, s71, v66
v_add_u32 v66, 157696, v66
ds_write_b64 v66, v[40:41]
v_mfma_f32_32x32x16_bf16 v[176:191], v[84:87], a[204:207], v[176:191]
ds_read_b64_tr_b16 v[82:83], v3 offset:16896
s_waitcnt lgkmcnt(3)
v_mfma_f32_32x32x16_bf16 v[160:175], v[88:91], a[208:211], v[160:175]
ds_read_b64_tr_b16 v[84:85], v3 offset:18432
s_waitcnt lgkmcnt(2)
s_barrier
v_mfma_f32_32x32x16_bf16 v[176:191], v[88:91], a[212:215], v[176:191]
s_add_u32 m0, s3, 131072
s_add_u32 s61, s64, 221184
buffer_load_dwordx4 v14, s[12:15], s61 offen lds
ds_read_b64_tr_b16 v[86:87], v3 offset:18944
v_mfma_f32_32x32x16_bf16 v[160:175], v[92:95], a[216:219], v[160:175]
ds_read_b64_tr_b16 v[88:89], v3 offset:20480
v_and_b32 v66, 31, v0
v_lshlrev_b32 v66, 3, v66
v_add_u32 v66, 157696, v66
ds_read_b64 v[72:73], v66 offset:0
ds_read_b64 v[74:75], v66 offset:256
ds_read_b64 v[76:77], v66 offset:512
v_mfma_f32_32x32x16_bf16 v[176:191], v[92:95], a[220:223], v[176:191]
ds_read_b64_tr_b16 v[90:91], v3 offset:20992
s_waitcnt lgkmcnt(5)
ds_read_b64 v[78:79], v66 offset:768
v_lshrrev_b32 v44, 5, v0
s_lshl_b32 s71, s44, 1
v_add_u32 v44, s71, v44
v_mov_b32 v64, 0
v_mfma_f32_32x32x16_bf16 v[160:175], v[80:83], a[224:227], v[160:175]
ds_read_b64_tr_b16 v[92:93], v3 offset:22528
v_mov_b32 v65, 0
v_mov_b32 v42, s45
v_mov_b32 v43, s45
v_and_b32 v47, 0x1f0, v1
v_mfma_f32_32x32x16_bf16 v[176:191], v[80:83], a[228:231], v[176:191]
buffer_load_dwordx4 v15, s[12:15], s61 offen offset:1024 lds
ds_read_b64_tr_b16 v[94:95], v3 offset:23040
s_lshl_b32 s71, s44, 29
v_or_b32 v47, s71, v47
s_waitcnt lgkmcnt(6)
v_mov_b32 v40, v72
v_mfma_f32_32x32x16_bf16 v[160:175], v[84:87], a[232:235], v[160:175]
ds_read_b64_tr_b16 v[80:81], v2 offset:32768
v_mov_b32 v41, v73
ds_read_b64 v[72:73], v66 offset:1024
v_cmp_eq_u32 s[68:69], 1, v44
s_waitcnt lgkmcnt(7)
v_fma_f32 v45, -v57, v41, v74
v_fma_f32 v46, v57, v40, v75
v_cndmask_b32 v64, v64, v40, s[68:69]
v_mfma_f32_32x32x16_bf16 v[176:191], v[84:87], a[236:239], v[176:191]
ds_read_b64_tr_b16 v[82:83], v2 offset:33280
s_waitcnt lgkmcnt(3)
v_cndmask_b32 v65, v65, v41, s[68:69]
v_fma_f32 v40, v56, v40, v45
v_fma_f32 v41, v56, v41, v46
ds_read_b64 v[74:75], v66 offset:1280
v_mfma_f32_32x32x16_bf16 v[160:175], v[88:91], a[240:243], v[160:175]
ds_read_b64_tr_b16 v[84:85], v2 offset:34816
v_cmp_eq_u32 s[68:69], 2, v44
v_fma_f32 v45, -v57, v41, v76
v_fma_f32 v46, v57, v40, v77
v_cndmask_b32 v64, v64, v40, s[68:69]
v_cndmask_b32 v65, v65, v41, s[68:69]
v_fma_f32 v40, v56, v40, v45
v_mfma_f32_32x32x16_bf16 v[176:191], v[88:91], a[244:247], v[176:191]
ds_read_b64_tr_b16 v[86:87], v2 offset:35328
s_waitcnt vmcnt(3)
v_cmp_ne_u32 vcc, s45, v69
s_nop 0
s_cmp_lg_u64 vcc, 0
s_cbranch_scc1 csS2S_slow
csS2S_ok:
v_mov_b32 v49, v68
v_fma_f32 v41, v56, v41, v46
ds_read_b64 v[76:77], v66 offset:1536
v_mfma_f32_32x32x16_bf16 v[160:175], v[92:95], a[248:251], v[160:175]
ds_read_b64_tr_b16 v[88:89], v2 offset:36864
v_mov_b32 v37, v68
s_nop 1
v_permlane32_swap_b32 v68, v37
v_cmp_eq_u32 s[68:69], 3, v44
v_fma_f32 v45, -v57, v41, v78
v_fma_f32 v46, v57, v40, v79
v_cndmask_b32 v64, v64, v40, s[68:69]
v_mfma_f32_32x32x16_bf16 v[176:191], v[92:95], a[252:255], v[176:191]
ds_read_b64_tr_b16 v[90:91], v2 offset:37376
s_waitcnt lgkmcnt(3)
v_mov_b32 v50, v35
v_cndmask_b32 v65, v65, v41, s[68:69]
v_fma_f32 v40, v56, v40, v45
v_fma_f32 v41, v56, v41, v46
v_mfma_f32_32x32x16_bf16 v[160:175], v[80:83], v[224:227], v[160:175]
ds_read_b64_tr_b16 v[92:93], v2 offset:38912
v_cvt_pk_bf16_f32 v48, v49, v49
v_lshlrev_b32 v8, 16, v48
ds_read_b64 v[78:79], v66 offset:1792
v_cmp_eq_u32 s[68:69], 4, v44
v_fma_f32 v45, -v57, v41, v72
v_fma_f32 v46, v57, v40, v73
v_mfma_f32_32x32x16_bf16 v[176:191], v[80:83], v[228:231], v[176:191]
ds_read_b64_tr_b16 v[94:95], v2 offset:39424
v_lshlrev_b32 v51, 16, v50
v_sub_f32 v8, v49, v8
v_cvt_pk_bf16_f32 v49, v8, v51
v_cndmask_b32 v64, v64, v40, s[68:69]
v_cndmask_b32 v65, v65, v41, s[68:69]
v_fma_f32 v40, v56, v40, v45
v_mfma_f32_32x32x16_bf16 v[160:175], v[84:87], v[232:235], v[160:175]
ds_read_b64_tr_b16 v[80:81], v7 offset:16384
v_mov_b32 v51, 0
v_mov_b32 v38, v35
v_fma_f32 v41, v56, v41, v46
v_cmp_eq_u32 s[68:69], 5, v44
v_fma_f32 v45, -v57, v41, v74
v_fma_f32 v46, v57, v40, v75
v_mfma_f32_32x32x16_bf16 v[176:191], v[84:87], v[236:239], v[176:191]
ds_read_b64_tr_b16 v[82:83], v7 offset:16896
s_waitcnt lgkmcnt(2)
v_permlane32_swap_b32 v35, v38
v_cndmask_b32 v64, v64, v40, s[68:69]
v_cndmask_b32 v65, v65, v41, s[68:69]
v_fma_f32 v40, v56, v40, v45
v_mfma_f32_32x32x16_bf16 v[160:175], v[88:91], v[240:243], v[160:175]
ds_read_b64_tr_b16 v[84:85], v7 offset:18432
v_cvt_pk_bf16_f32 v36, v37, v37
v_lshlrev_b32 v9, 16, v36
v_fma_f32 v41, v56, v41, v46
v_cmp_eq_u32 s[68:69], 6, v44
v_fma_f32 v45, -v57, v41, v76
v_fma_f32 v46, v57, v40, v77
v_mfma_f32_32x32x16_bf16 v[176:191], v[88:91], v[244:247], v[176:191]
ds_read_b64_tr_b16 v[86:87], v7 offset:18944
v_lshlrev_b32 v39, 16, v38
v_sub_f32 v9, v37, v9
v_cndmask_b32 v64, v64, v40, s[68:69]
v_cndmask_b32 v65, v65, v41, s[68:69]
v_fma_f32 v40, v56, v40, v45
v_fma_f32 v41, v56, v41, v46
v_mfma_f32_32x32x16_bf16 v[160:175], v[92:95], v[248:251], v[160:175]
ds_read_b64_tr_b16 v[88:89], v7 offset:20480
v_cvt_pk_bf16_f32 v37, v9, v39
v_mov_b32 v39, 0
v_cmp_eq_u32 s[68:69], 7, v44
v_fma_f32 v45, -v57, v41, v78
v_fma_f32 v46, v57, v40, v79
v_cndmask_b32 v64, v64, v40, s[68:69]
v_mfma_f32_32x32x16_bf16 v[176:191], v[92:95], v[252:255], v[176:191]
ds_read_b64_tr_b16 v[90:91], v7 offset:20992
s_waitcnt lgkmcnt(2)
v_cndmask_b32 v65, v65, v41, s[68:69]
v_fma_f32 v40, v56, v40, v45
v_fma_f32 v41, v56, v41, v46
s_lshl_b32 s71, s98, 3
s_add_u32 s71, s71, s46
s_lshl_b32 s71, s71, 9
s_add_u32 s71, s71, 163840
buffer_store_dwordx4 v[40:43], v47, s[16:19], s71 offen sc1
v_mfma_f32_32x32x16_bf16 v[160:175], v[48:51], v[28:31], v[160:175]
v_mfma_f32_32x32x16_bf16 v[176:191], v[48:51], v[32:35], v[176:191]
v_mfma_f32_32x32x16_bf16 v[192:207], v[36:39], v[28:31], 0
v_mfma_f32_32x32x16_bf16 v[208:223], v[36:39], v[32:35], 0
v_mfma_f32_32x32x16_bf16 v[192:207], v[80:83], a[0:3], v[192:207]
ds_read_b64_tr_b16 v[92:93], v7 offset:22528
s_mul_i32 s71, s44, 4608
s_add_u32 s71, s71, 0
v_and_b32 v36, 31, v0
v_mul_u32_u24 v36, 144, v36
v_and_b32 v38, 32, v0
v_lshl_add_u32 v36, v38, 1, v36
v_add_u32 v36, s71, v36
v_and_b32 v37, 48, v0
v_lshrrev_b32 v37, 1, v37
v_bfe_u32 v38, v0, 2, 2
v_add_u32 v37, v37, v38
v_mul_u32_u24 v37, 144, v37
v_and_b32 v38, 1, v0
v_lshl_add_u32 v37, v38, 6, v37
v_and_b32 v38, 2, v0
v_lshl_add_u32 v37, v38, 2, v37
v_add_u32 v37, s71, v37
s_and_b32 s100, s48, 1
s_mul_i32 s100, s100, 2816
s_sub_u32 s100, s41, s100
v_mfma_f32_32x32x16_bf16 v[208:223], v[80:83], a[4:7], v[208:223]
ds_read_b64_tr_b16 v[94:95], v7 offset:23040
v_mfma_f32_32x32x16_bf16 v[192:207], v[84:87], a[8:11], v[192:207]
ds_read_b64_tr_b16 v[80:81], v6 offset:32768
v_and_b32 v8, 15, v0
v_lshlrev_b32 v8, 7, v8
v_bfe_u32 v9, v0, 1, 3
v_lshrrev_b32 v10, 4, v0
v_xor_b32 v9, v9, v10
v_lshl_add_u32 v8, v9, 4, v8
v_xor_b32 v9, 64, v8
v_mfma_f32_32x32x16_bf16 v[208:223], v[84:87], a[12:15], v[208:223]
ds_read_b64_tr_b16 v[82:83], v6 offset:33280
s_waitcnt lgkmcnt(2)
v_mul_f32 v44, v160, v160
v_mul_f32 v45, v161, v161
v_mul_f32 v46, v162, v162
v_mul_f32 v47, v163, v163
v_fma_f32 v44, v44, v22, v20
v_fma_f32 v45, v45, v22, v20
v_fma_f32 v46, v46, v22, v20
v_fma_f32 v47, v47, v22, v20
v_mul_f32 v44, v44, v160
v_mfma_f32_32x32x16_bf16 v[192:207], v[88:91], a[16:19], v[192:207]
ds_read_b64_tr_b16 v[84:85], v6 offset:34816
v_mul_f32 v45, v45, v161
v_mul_f32 v46, v46, v162
v_mul_f32 v47, v47, v163
v_exp_f32 v44, v44
v_exp_f32 v45, v45
v_exp_f32 v46, v46
v_mfma_f32_32x32x16_bf16 v[208:223], v[88:91], a[20:23], v[208:223]
ds_read_b64_tr_b16 v[86:87], v6 offset:35328
v_exp_f32 v47, v47
v_fma_f32 v44, v44, v24, v24
v_fma_f32 v45, v45, v24, v24
v_fma_f32 v46, v46, v24, v24
v_fma_f32 v47, v47, v24, v24
v_rcp_f32 v44, v44
v_rcp_f32 v45, v45
v_mfma_f32_32x32x16_bf16 v[192:207], v[92:95], a[24:27], v[192:207]
ds_read_b64_tr_b16 v[88:89], v6 offset:36864
v_rcp_f32 v46, v46
v_rcp_f32 v47, v47
v_mul_f32 v160, v160, v44
v_mul_f32 v161, v161, v45
v_mul_f32 v162, v162, v46
v_mul_f32 v163, v163, v47
v_cvt_pk_bf16_f32 v160, v160, v161
v_cvt_pk_bf16_f32 v161, v162, v163
v_mfma_f32_32x32x16_bf16 v[208:223], v[92:95], a[28:31], v[208:223]
ds_read_b64_tr_b16 v[90:91], v6 offset:37376
s_waitcnt lgkmcnt(2)
v_mul_f32 v44, v164, v164
v_mul_f32 v45, v165, v165
v_mul_f32 v46, v166, v166
v_mul_f32 v47, v167, v167
v_fma_f32 v44, v44, v22, v20
v_fma_f32 v45, v45, v22, v20
v_fma_f32 v46, v46, v22, v20
v_fma_f32 v47, v47, v22, v20
v_mul_f32 v44, v44, v164
v_mfma_f32_32x32x16_bf16 v[192:207], v[80:83], a[32:35], v[192:207]
ds_read_b64_tr_b16 v[92:93], v6 offset:38912
v_mul_f32 v45, v45, v165
v_mul_f32 v46, v46, v166
v_mul_f32 v47, v47, v167
v_exp_f32 v44, v44
v_exp_f32 v45, v45
v_exp_f32 v46, v46
v_mfma_f32_32x32x16_bf16 v[208:223], v[80:83], a[36:39], v[208:223]
ds_read_b64_tr_b16 v[94:95], v6 offset:39424
v_exp_f32 v47, v47
v_fma_f32 v44, v44, v24, v24
v_fma_f32 v45, v45, v24, v24
v_fma_f32 v46, v46, v24, v24
v_fma_f32 v47, v47, v24, v24
v_rcp_f32 v44, v44
v_rcp_f32 v45, v45
v_mfma_f32_32x32x16_bf16 v[192:207], v[84:87], a[40:43], v[192:207]
ds_read_b64_tr_b16 v[80:81], v6 offset:0
s_add_u32 s63, s73, 0
s_load_dwordx8 s[52:59], s[16:17], s63 glc
v_rcp_f32 v46, v46
v_rcp_f32 v47, v47
v_mul_f32 v164, v164, v44
v_mul_f32 v165, v165, v45
v_mul_f32 v166, v166, v46
v_mul_f32 v167, v167, v47
v_cvt_pk_bf16_f32 v162, v164, v165
v_mfma_f32_32x32x16_bf16 v[208:223], v[84:87], a[44:47], v[208:223]
ds_read_b64_tr_b16 v[82:83], v6 offset:512
s_waitcnt lgkmcnt(2)
v_cvt_pk_bf16_f32 v163, v166, v167
s_add_u32 s99, s41, 58368
buffer_store_dwordx4 v[160:163], v31, s[16:19], s99 offen offset:0 sc1
v_mul_f32 v44, v168, v168
v_mul_f32 v45, v169, v169
v_mul_f32 v46, v170, v170
v_mfma_f32_32x32x16_bf16 v[192:207], v[88:91], a[48:51], v[192:207]
ds_read_b64_tr_b16 v[84:85], v6 offset:2048
v_mul_f32 v47, v171, v171
v_fma_f32 v44, v44, v22, v20
v_fma_f32 v45, v45, v22, v20
v_fma_f32 v46, v46, v22, v20
v_fma_f32 v47, v47, v22, v20
v_mul_f32 v44, v44, v168
v_mul_f32 v45, v45, v169
v_mul_f32 v46, v46, v170
v_mul_f32 v47, v47, v171
v_mfma_f32_32x32x16_bf16 v[208:223], v[88:91], a[52:55], v[208:223]
ds_read_b64_tr_b16 v[86:87], v6 offset:2560
v_exp_f32 v44, v44
v_exp_f32 v45, v45
v_exp_f32 v46, v46
v_exp_f32 v47, v47
v_fma_f32 v44, v44, v24, v24
v_fma_f32 v45, v45, v24, v24
v_mfma_f32_32x32x16_bf16 v[192:207], v[92:95], a[56:59], v[192:207]
ds_read_b64_tr_b16 v[88:89], v6 offset:4096
v_fma_f32 v46, v46, v24, v24
v_fma_f32 v47, v47, v24, v24
v_rcp_f32 v44, v44
v_rcp_f32 v45, v45
v_rcp_f32 v46, v46
v_rcp_f32 v47, v47
v_mfma_f32_32x32x16_bf16 v[208:223], v[92:95], a[60:63], v[208:223]
ds_read_b64_tr_b16 v[90:91], v6 offset:4608
s_waitcnt lgkmcnt(2)
v_mul_f32 v168, v168, v44
v_mul_f32 v169, v169, v45
v_mul_f32 v170, v170, v46
v_mul_f32 v171, v171, v47
v_cvt_pk_bf16_f32 v168, v168, v169
v_cvt_pk_bf16_f32 v169, v170, v171
v_mul_f32 v44, v172, v172
v_mul_f32 v45, v173, v173
v_mul_f32 v46, v174, v174
v_mfma_f32_32x32x16_bf16 v[192:207], v[80:83], a[64:67], v[192:207]
ds_read_b64_tr_b16 v[92:93], v6 offset:6144
v_mul_f32 v47, v175, v175
v_fma_f32 v44, v44, v22, v20
v_fma_f32 v45, v45, v22, v20
v_fma_f32 v46, v46, v22, v20
v_fma_f32 v47, v47, v22, v20
v_mul_f32 v44, v44, v172
v_mul_f32 v45, v45, v173
v_mul_f32 v46, v46, v174
v_mul_f32 v47, v47, v175
v_mfma_f32_32x32x16_bf16 v[208:223], v[80:83], a[68:71], v[208:223]
ds_read_b64_tr_b16 v[94:95], v6 offset:6656
v_exp_f32 v44, v44
v_exp_f32 v45, v45
v_exp_f32 v46, v46
v_exp_f32 v47, v47
v_fma_f32 v44, v44, v24, v24
v_fma_f32 v45, v45, v24, v24
v_fma_f32 v46, v46, v24, v24
v_mfma_f32_32x32x16_bf16 v[192:207], v[84:87], a[72:75], v[192:207]
ds_read_b64_tr_b16 v[80:81], v6 offset:8192
v_fma_f32 v47, v47, v24, v24
v_rcp_f32 v44, v44
v_rcp_f32 v45, v45
v_rcp_f32 v46, v46
v_rcp_f32 v47, v47
v_mul_f32 v172, v172, v44
v_mfma_f32_32x32x16_bf16 v[208:223], v[84:87], a[76:79], v[208:223]
ds_read_b64_tr_b16 v[82:83], v6 offset:8704
s_waitcnt lgkmcnt(2)
v_mul_f32 v173, v173, v45
v_mul_f32 v174, v174, v46
v_mul_f32 v175, v175, v47
v_cvt_pk_bf16_f32 v170, v172, v173
v_cvt_pk_bf16_f32 v171, v174, v175
s_add_u32 s99, s41, 58368
buffer_store_dwordx4 v[168:171], v31, s[16:19], s99 offen offset:256 sc1
v_mfma_f32_32x32x16_bf16 v[192:207], v[88:91], a[80:83], v[192:207]
ds_read_b64_tr_b16 v[84:85], v6 offset:10240
v_mul_f32 v44, v176, v176
v_mul_f32 v45, v177, v177
v_mul_f32 v46, v178, v178
v_mul_f32 v47, v179, v179
v_fma_f32 v44, v44, v23, v21
v_fma_f32 v45, v45, v23, v21
v_fma_f32 v46, v46, v23, v21
v_fma_f32 v47, v47, v23, v21
v_mfma_f32_32x32x16_bf16 v[208:223], v[88:91], a[84:87], v[208:223]
ds_read_b64_tr_b16 v[86:87], v6 offset:10752
v_mul_f32 v44, v44, v176
v_mul_f32 v45, v45, v177
v_mul_f32 v46, v46, v178
v_mul_f32 v47, v47, v179
v_exp_f32 v44, v44
v_exp_f32 v45, v45
v_exp_f32 v46, v46
v_mfma_f32_32x32x16_bf16 v[192:207], v[92:95], a[88:91], v[192:207]
ds_read_b64_tr_b16 v[88:89], v6 offset:12288
v_exp_f32 v47, v47
v_fma_f32 v44, v44, v25, v25
v_fma_f32 v45, v45, v25, v25
v_fma_f32 v46, v46, v25, v25
v_fma_f32 v47, v47, v25, v25
v_rcp_f32 v44, v44
v_rcp_f32 v45, v45
v_mfma_f32_32x32x16_bf16 v[208:223], v[92:95], a[92:95], v[208:223]
ds_read_b64_tr_b16 v[90:91], v6 offset:12800
s_waitcnt lgkmcnt(2)
v_rcp_f32 v46, v46
v_rcp_f32 v47, v47
v_mul_f32 v176, v176, v44
v_mul_f32 v177, v177, v45
v_mul_f32 v178, v178, v46
v_mul_f32 v179, v179, v47
v_mfma_f32_32x32x16_bf16 v[192:207], v[80:83], a[96:99], v[192:207]
ds_read_b64_tr_b16 v[92:93], v6 offset:14336
s_lshl_b32 s66, s98, 12
s_add_u32 s66, s66, 163840
s_sub_u32 s71, s46, 1
v_lshrrev_b32 v54, 5, v0
v_sub_u32 v54, s71, v54
v_and_b32 v55, 0x1f0, v1
v_lshl_add_u32 v55, v54, 9, v55
v_add_u32 v56, 4294966272, v55
v_add_u32 v57, 4294965248, v55
v_add_u32 v66, 4294964224, v55
v_min_u32 v55, 0x80000000, v55
v_min_u32 v56, 0x80000000, v56
v_min_u32 v57, 0x80000000, v57
v_min_u32 v66, 0x80000000, v66
buffer_load_dwordx4 v[68:71], v55, s[16:19], s66 offen sc1
buffer_load_dwordx4 v[72:75], v56, s[16:19], s66 offen sc1
buffer_load_dwordx4 v[76:79], v57, s[16:19], s66 offen sc1
buffer_load_dwordx4 v[40:43], v66, s[16:19], s66 offen sc1
v_mfma_f32_32x32x16_bf16 v[208:223], v[80:83], a[100:103], v[208:223]
ds_read_b64_tr_b16 v[94:95], v6 offset:14848
v_mfma_f32_32x32x16_bf16 v[192:207], v[84:87], a[104:107], v[192:207]
ds_read_b64_tr_b16 v[80:81], v5 offset:24576
v_mfma_f32_32x32x16_bf16 v[208:223], v[84:87], a[108:111], v[208:223]
ds_read_b64_tr_b16 v[82:83], v5 offset:25088
s_waitcnt lgkmcnt(2)
v_cvt_pk_bf16_f32 v176, v176, v177
v_cvt_pk_bf16_f32 v177, v178, v179
v_mul_f32 v44, v180, v180
v_mul_f32 v45, v181, v181
v_mul_f32 v46, v182, v182
v_mul_f32 v47, v183, v183
v_fma_f32 v44, v44, v23, v21
v_fma_f32 v45, v45, v23, v21
v_fma_f32 v46, v46, v23, v21
v_mfma_f32_32x32x16_bf16 v[192:207], v[88:91], a[112:115], v[192:207]
ds_read_b64_tr_b16 v[84:85], v5 offset:26624
s_waitcnt lgkmcnt(0)
s_xor_b64 s[52:53], s[52:53], s[42:43]
s_xor_b64 s[54:55], s[54:55], s[42:43]
s_or_b64 s[52:53], s[52:53], s[54:55]
s_xor_b64 s[56:57], s[56:57], s[42:43]
s_or_b64 s[52:53], s[52:53], s[56:57]
s_cbranch_scc1 fh1S_slow
fh1S_ok:
v_fma_f32 v47, v47, v23, v21
v_mul_f32 v44, v44, v180
v_mul_f32 v45, v45, v181
v_mul_f32 v46, v46, v182
v_mfma_f32_32x32x16_bf16 v[208:223], v[88:91], a[116:119], v[208:223]
s_add_u32 s0, s83, 0
buffer_load_dwordx4 a[0:3], v1, s[16:19], s0 offen offset:0 sc1
ds_read_b64_tr_b16 v[86:87], v5 offset:27136
v_mul_f32 v47, v47, v183
v_exp_f32 v44, v44
v_exp_f32 v45, v45
v_mfma_f32_32x32x16_bf16 v[192:207], v[92:95], a[120:123], v[192:207]
ds_read_b64_tr_b16 v[88:89], v5 offset:28672
s_barrier
v_exp_f32 v46, v46
v_exp_f32 v47, v47
v_fma_f32 v44, v44, v25, v25
v_fma_f32 v45, v45, v25, v25
v_fma_f32 v46, v46, v25, v25
v_fma_f32 v47, v47, v25, v25
v_mfma_f32_32x32x16_bf16 v[208:223], v[92:95], a[124:127], v[208:223]
buffer_load_dwordx4 a[4:7], v1, s[16:19], s0 offen offset:1024 sc1
ds_read_b64_tr_b16 v[90:91], v5 offset:29184
s_waitcnt lgkmcnt(2)
v_rcp_f32 v44, v44
v_rcp_f32 v45, v45
v_rcp_f32 v46, v46
v_mfma_f32_32x32x16_bf16 v[192:207], v[80:83], a[128:131], v[192:207]
ds_read_b64_tr_b16 v[92:93], v5 offset:30720
v_rcp_f32 v47, v47
v_mul_f32 v180, v180, v44
v_mul_f32 v181, v181, v45
v_mul_f32 v182, v182, v46
v_mul_f32 v183, v183, v47
v_cvt_pk_bf16_f32 v178, v180, v181
v_cvt_pk_bf16_f32 v179, v182, v183
s_add_u32 s99, s41, 146176
buffer_store_dwordx4 v[176:179], v31, s[16:19], s99 offen offset:0 sc1
v_mfma_f32_32x32x16_bf16 v[208:223], v[80:83], a[132:135], v[208:223]
buffer_load_dwordx4 a[8:11], v1, s[16:19], s0 offen offset:2048 sc1
ds_read_b64_tr_b16 v[94:95], v5 offset:31232
v_mul_f32 v44, v184, v184
v_mul_f32 v45, v185, v185
v_mfma_f32_32x32x16_bf16 v[192:207], v[84:87], a[136:139], v[192:207]
ds_read_b64_tr_b16 v[80:81], v5 offset:40960
v_mul_f32 v46, v186, v186
v_mul_f32 v47, v187, v187
v_fma_f32 v44, v44, v23, v21
v_fma_f32 v45, v45, v23, v21
v_fma_f32 v46, v46, v23, v21
v_fma_f32 v47, v47, v23, v21
v_mul_f32 v44, v44, v184
v_mul_f32 v45, v45, v185
v_mul_f32 v46, v46, v186
v_mul_f32 v47, v47, v187
v_mfma_f32_32x32x16_bf16 v[208:223], v[84:87], a[140:143], v[208:223]
buffer_load_dwordx4 a[12:15], v1, s[16:19], s0 offen offset:3072 sc1
ds_read_b64_tr_b16 v[82:83], v5 offset:41472
s_waitcnt lgkmcnt(2)
v_exp_f32 v44, v44
v_exp_f32 v45, v45
v_mfma_f32_32x32x16_bf16 v[192:207], v[88:91], a[144:147], v[192:207]
ds_read_b64_tr_b16 v[84:85], v5 offset:43008
v_exp_f32 v46, v46
v_exp_f32 v47, v47
v_fma_f32 v44, v44, v25, v25
v_fma_f32 v45, v45, v25, v25
v_fma_f32 v46, v46, v25, v25
v_fma_f32 v47, v47, v25, v25
v_rcp_f32 v44, v44
v_mfma_f32_32x32x16_bf16 v[208:223], v[88:91], a[148:151], v[208:223]
s_add_u32 s0, s86, 0
buffer_load_dwordx4 a[16:19], v1, s[16:19], s0 offen offset:0 sc1
ds_read_b64_tr_b16 v[86:87], v5 offset:43520
v_rcp_f32 v45, v45
v_rcp_f32 v46, v46
v_rcp_f32 v47, v47
v_mfma_f32_32x32x16_bf16 v[192:207], v[92:95], a[152:155], v[192:207]
ds_read_b64_tr_b16 v[88:89], v5 offset:45056
v_mul_f32 v184, v184, v44
v_mul_f32 v185, v185, v45
v_mul_f32 v186, v186, v46
v_mul_f32 v187, v187, v47
v_cvt_pk_bf16_f32 v184, v184, v185
v_cvt_pk_bf16_f32 v185, v186, v187
v_mul_f32 v44, v188, v188
v_mul_f32 v45, v189, v189
v_mul_f32 v46, v190, v190
v_mul_f32 v47, v191, v191
v_mfma_f32_32x32x16_bf16 v[208:223], v[92:95], a[156:159], v[208:223]
buffer_load_dwordx4 a[20:23], v1, s[16:19], s0 offen offset:1024 sc1
ds_read_b64_tr_b16 v[90:91], v5 offset:45568
s_waitcnt lgkmcnt(2)
v_fma_f32 v44, v44, v23, v21
v_fma_f32 v45, v45, v23, v21
v_fma_f32 v46, v46, v23, v21
v_fma_f32 v47, v47, v23, v21
v_mfma_f32_32x32x16_bf16 v[192:207], v[80:83], a[160:163], v[192:207]
ds_read_b64_tr_b16 v[92:93], v5 offset:47104
v_mul_f32 v44, v44, v188
v_mul_f32 v45, v45, v189
v_mul_f32 v46, v46, v190
v_mul_f32 v47, v47, v191
v_exp_f32 v44, v44
v_exp_f32 v45, v45
v_exp_f32 v46, v46
v_mfma_f32_32x32x16_bf16 v[208:223], v[80:83], a[164:167], v[208:223]
buffer_load_dwordx4 a[24:27], v1, s[16:19], s0 offen offset:2048 sc1
ds_read_b64_tr_b16 v[94:95], v5 offset:47616
v_exp_f32 v47, v47
v_fma_f32 v44, v44, v25, v25
v_fma_f32 v45, v45, v25, v25
v_fma_f32 v46, v46, v25, v25
v_fma_f32 v47, v47, v25, v25
v_mfma_f32_32x32x16_bf16 v[192:207], v[84:87], a[168:171], v[192:207]
ds_read_b64_tr_b16 v[80:81], v5 offset:57344
v_rcp_f32 v44, v44
v_rcp_f32 v45, v45
v_rcp_f32 v46, v46
v_rcp_f32 v47, v47
v_mul_f32 v188, v188, v44
v_mul_f32 v189, v189, v45
v_mfma_f32_32x32x16_bf16 v[208:223], v[84:87], a[172:175], v[208:223]
buffer_load_dwordx4 a[28:31], v1, s[16:19], s0 offen offset:3072 sc1
ds_read_b64_tr_b16 v[82:83], v5 offset:57856
s_waitcnt lgkmcnt(2)
v_mul_f32 v190, v190, v46
v_mul_f32 v191, v191, v47
v_cvt_pk_bf16_f32 v186, v188, v189
v_cvt_pk_bf16_f32 v187, v190, v191
v_mfma_f32_32x32x16_bf16 v[192:207], v[88:91], a[176:179], v[192:207]
ds_read_b64_tr_b16 v[84:85], v5 offset:59392
s_add_u32 s99, s41, 146176
buffer_store_dwordx4 v[184:187], v31, s[16:19], s99 offen offset:256 sc1
v_cmp_le_i32 s[68:69], 0, v54
s_waitcnt vmcnt(13)
v_cmp_ne_u32 vcc, s45, v70
s_nop 0
s_and_b64 s[78:79], vcc, s[68:69]
v_cmp_le_i32 s[68:69], 2, v54
s_waitcnt vmcnt(12)
v_cmp_ne_u32 vcc, s45, v74
s_nop 0
s_and_b64 vcc, vcc, s[68:69]
s_or_b64 s[78:79], s[78:79], vcc
v_cmp_le_i32 s[68:69], 4, v54
s_waitcnt vmcnt(11)
v_cmp_ne_u32 vcc, s45, v78
s_nop 0
s_and_b64 vcc, vcc, s[68:69]
s_or_b64 s[78:79], s[78:79], vcc
v_cmp_le_i32 s[68:69], 6, v54
L_stub10:
s_cbranch_execz L_stub15
s_waitcnt vmcnt(10)
v_cmp_ne_u32 vcc, s45, v42
s_nop 0
s_and_b64 vcc, vcc, s[68:69]
s_or_b64 s[78:79], s[78:79], vcc
s_cbranch_scc1 carSS_slow
carSS_ok:
v_mfma_f32_32x32x16_bf16 v[208:223], v[88:91], a[180:183], v[208:223]
s_add_u32 m0, s3, 147456
s_add_u32 s61, s64, 221312
buffer_load_dwordx4 v14, s[12:15], s61 offen lds
ds_read_b64_tr_b16 v[86:87], v5 offset:59904
v_mfma_f32_32x32x16_bf16 v[192:207], v[92:95], a[184:187], v[192:207]
ds_read_b64_tr_b16 v[88:89], v5 offset:61440
v_fma_f32 v76, -v63, v41, v76
v_fmac_f32 v77, v63, v40
v_fmac_f32 v76, v62, v40
v_mfma_f32_32x32x16_bf16 v[208:223], v[92:95], a[188:191], v[208:223]
buffer_load_dwordx4 v15, s[12:15], s61 offen offset:1024 lds
ds_read_b64_tr_b16 v[90:91], v5 offset:61952
s_waitcnt lgkmcnt(2)
v_fmac_f32 v77, v62, v41
v_fma_f32 v72, -v63, v77, v72
v_fmac_f32 v73, v63, v76
v_fmac_f32 v72, v62, v76
v_fmac_f32 v73, v62, v77
v_mfma_f32_32x32x16_bf16 v[192:207], v[80:83], a[192:195], v[192:207]
ds_read_b64_tr_b16 v[92:93], v5 offset:63488
v_fma_f32 v68, -v63, v73, v68
v_fmac_f32 v69, v63, v72
v_fmac_f32 v68, v62, v72
v_fmac_f32 v69, v62, v73
v_mul_f32 v72, v60, v68
v_mul_f32 v73, v60, v69
v_fma_f32 v72, -v61, v69, v72
v_fmac_f32 v73, v61, v68
v_mov_b32 v74, v72
v_mov_b32 v75, v73
v_mfma_f32_32x32x16_bf16 v[208:223], v[80:83], a[196:199], v[208:223]
s_add_u32 s0, s87, 0
buffer_load_dwordx4 a[32:35], v1, s[16:19], s0 offen offset:0 sc1
ds_read_b64_tr_b16 v[94:95], v5 offset:64000
v_permlane32_swap_b32 v72, v74
v_permlane32_swap_b32 v73, v75
v_add_f32 v72, v72, v74
v_add_f32 v73, v73, v75
v_fmac_f32 v64, v58, v72
v_mfma_f32_32x32x16_bf16 v[192:207], v[84:87], a[200:203], v[192:207]
ds_read_b64_tr_b16 v[80:81], v6 offset:16384
v_fmac_f32 v65, v58, v73
v_fma_f32 v64, -v59, v73, v64
v_fmac_f32 v65, v59, v72
v_fma_f32 v96, -v53, v65, v96
v_fma_f32 v128, v53, v64, v128
v_fmac_f32 v96, v52, v64
v_fmac_f32 v128, v52, v65
v_fma_f32 v97, -v53, v128, v97
v_fma_f32 v129, v53, v96, v129
v_fmac_f32 v97, v52, v96
v_mfma_f32_32x32x16_bf16 v[208:223], v[84:87], a[204:207], v[208:223]
buffer_load_dwordx4 a[36:39], v1, s[16:19], s0 offen offset:1024 sc1
ds_read_b64_tr_b16 v[82:83], v6 offset:16896
s_waitcnt lgkmcnt(2)
v_fmac_f32 v129, v52, v128
v_fma_f32 v98, -v53, v129, v98
v_fma_f32 v130, v53, v97, v130
v_fmac_f32 v98, v52, v97
v_fmac_f32 v130, v52, v129
v_mfma_f32_32x32x16_bf16 v[192:207], v[88:91], a[208:211], v[192:207]
ds_read_b64_tr_b16 v[84:85], v6 offset:18432
v_cvt_pk_bf16_f32 v96, v96, v97
v_cvt_pk_bf16_f32 v128, -v128, -v129
v_fma_f32 v99, -v53, v130, v99
v_fma_f32 v131, v53, v98, v131
v_fmac_f32 v99, v52, v98
v_fmac_f32 v131, v52, v130
v_fma_f32 v100, -v53, v131, v100
v_fma_f32 v132, v53, v99, v132
v_fmac_f32 v100, v52, v99
v_fmac_f32 v132, v52, v131
v_mfma_f32_32x32x16_bf16 v[208:223], v[88:91], a[212:215], v[208:223]
buffer_load_dwordx4 a[40:43], v1, s[16:19], s0 offen offset:2048 sc1
ds_read_b64_tr_b16 v[86:87], v6 offset:18944
v_cvt_pk_bf16_f32 v97, v98, v99
v_cvt_pk_bf16_f32 v129, -v130, -v131
v_fma_f32 v101, -v53, v132, v101
v_fma_f32 v133, v53, v100, v133
v_fmac_f32 v101, v52, v100
v_mfma_f32_32x32x16_bf16 v[192:207], v[92:95], a[216:219], v[192:207]
ds_read_b64_tr_b16 v[88:89], v6 offset:20480
v_fmac_f32 v133, v52, v132
v_fma_f32 v102, -v53, v133, v102
v_fma_f32 v134, v53, v101, v134
v_fmac_f32 v102, v52, v101
v_fmac_f32 v134, v52, v133
v_cvt_pk_bf16_f32 v98, v100, v101
v_cvt_pk_bf16_f32 v130, -v132, -v133
v_fma_f32 v103, -v53, v134, v103
v_fma_f32 v135, v53, v102, v135
v_fmac_f32 v103, v52, v102
v_mfma_f32_32x32x16_bf16 v[208:223], v[92:95], a[220:223], v[208:223]
buffer_load_dwordx4 a[44:47], v1, s[16:19], s0 offen offset:3072 sc1
ds_read_b64_tr_b16 v[90:91], v6 offset:20992
s_waitcnt lgkmcnt(2)
v_fmac_f32 v135, v52, v134
v_fma_f32 v104, -v53, v135, v104
v_fma_f32 v136, v53, v103, v136
v_fmac_f32 v104, v52, v103
v_fmac_f32 v136, v52, v135
v_mfma_f32_32x32x16_bf16 v[192:207], v[80:83], a[224:227], v[192:207]
ds_read_b64_tr_b16 v[92:93], v6 offset:22528
v_cvt_pk_bf16_f32 v99, v102, v103
v_cvt_pk_bf16_f32 v131, -v134, -v135
ds_write_b128 v36, v[96:99] offset:0
v_fma_f32 v105, -v53, v136, v105
v_fma_f32 v137, v53, v104, v137
v_fmac_f32 v105, v52, v104
v_fmac_f32 v137, v52, v136
v_fma_f32 v106, -v53, v137, v106
v_fma_f32 v138, v53, v105, v138
v_fmac_f32 v106, v52, v105
v_mfma_f32_32x32x16_bf16 v[208:223], v[80:83], a[228:231], v[208:223]
s_add_u32 s0, s83, 14592
buffer_load_dwordx4 a[48:51], v1, s[16:19], s0 offen offset:0 sc1
ds_read_b64_tr_b16 v[94:95], v6 offset:23040
v_fmac_f32 v138, v52, v137
v_cvt_pk_bf16_f32 v100, v104, v105
v_cvt_pk_bf16_f32 v132, -v136, -v137
v_fma_f32 v107, -v53, v138, v107
v_fma_f32 v139, v53, v106, v139
v_mfma_f32_32x32x16_bf16 v[192:207], v[84:87], a[232:235], v[192:207]
ds_read_b64_tr_b16 v[80:81], v5 offset:32768
v_fmac_f32 v107, v52, v106
v_fmac_f32 v139, v52, v138
v_fma_f32 v108, -v53, v139, v108
v_fma_f32 v140, v53, v107, v140
v_fmac_f32 v108, v52, v107
v_fmac_f32 v140, v52, v139
v_cvt_pk_bf16_f32 v101, v106, v107
v_cvt_pk_bf16_f32 v133, -v138, -v139
v_fma_f32 v109, -v53, v140, v109
v_fma_f32 v141, v53, v108, v141
v_mfma_f32_32x32x16_bf16 v[208:223], v[84:87], a[236:239], v[208:223]
buffer_load_dwordx4 a[52:55], v1, s[16:19], s0 offen offset:1024 sc1
ds_read_b64_tr_b16 v[82:83], v5 offset:33280
s_waitcnt lgkmcnt(2)
v_fmac_f32 v109, v52, v108
v_fmac_f32 v141, v52, v140
v_fma_f32 v110, -v53, v141, v110
v_fma_f32 v142, v53, v109, v142
v_fmac_f32 v110, v52, v109
v_mfma_f32_32x32x16_bf16 v[192:207], v[88:91], a[240:243], v[192:207]
ds_read_b64_tr_b16 v[84:85], v5 offset:34816
v_fmac_f32 v142, v52, v141
v_cvt_pk_bf16_f32 v102, v108, v109
v_cvt_pk_bf16_f32 v134, -v140, -v141
v_fma_f32 v111, -v53, v142, v111
v_fma_f32 v143, v53, v110, v143
v_fmac_f32 v111, v52, v110
v_fmac_f32 v143, v52, v142
v_fma_f32 v112, -v53, v143, v112
v_fma_f32 v144, v53, v111, v144
v_mfma_f32_32x32x16_bf16 v[208:223], v[88:91], a[244:247], v[208:223]
buffer_load_dwordx4 a[56:59], v1, s[16:19], s0 offen offset:2048 sc1
ds_read_b64_tr_b16 v[86:87], v5 offset:35328
v_fmac_f32 v112, v52, v111
v_fmac_f32 v144, v52, v143
v_cvt_pk_bf16_f32 v103, v110, v111
v_cvt_pk_bf16_f32 v135, -v142, -v143
ds_write_b128 v36, v[100:103] offset:16
v_fma_f32 v113, -v53, v144, v113
v_mfma_f32_32x32x16_bf16 v[192:207], v[92:95], a[248:251], v[192:207]
ds_read_b64_tr_b16 v[88:89], v5 offset:36864
v_fma_f32 v145, v53, v112, v145
v_fmac_f32 v113, v52, v112
v_fmac_f32 v145, v52, v144
v_fma_f32 v114, -v53, v145, v114
v_fma_f32 v146, v53, v113, v146
v_fmac_f32 v114, v52, v113
v_fmac_f32 v146, v52, v145
v_cvt_pk_bf16_f32 v104, v112, v113
v_cvt_pk_bf16_f32 v136, -v144, -v145
v_fma_f32 v115, -v53, v146, v115
v_mfma_f32_32x32x16_bf16 v[208:223], v[92:95], a[252:255], v[208:223]
buffer_load_dwordx4 a[60:63], v1, s[16:19], s0 offen offset:3072 sc1
ds_read_b64_tr_b16 v[90:91], v5 offset:37376
s_waitcnt lgkmcnt(3)
v_fma_f32 v147, v53, v114, v147
v_fmac_f32 v115, v52, v114
v_fmac_f32 v147, v52, v146
v_fma_f32 v116, -v53, v147, v116
v_fma_f32 v148, v53, v115, v148
v_mfma_f32_32x32x16_bf16 v[192:207], v[80:83], v[224:227], v[192:207]
ds_read_b64_tr_b16 v[92:93], v5 offset:38912
v_fmac_f32 v116, v52, v115
v_fmac_f32 v148, v52, v147
v_cvt_pk_bf16_f32 v105, v114, v115
v_cvt_pk_bf16_f32 v137, -v146, -v147
v_fma_f32 v117, -v53, v148, v117
v_fma_f32 v149, v53, v116, v149
v_fmac_f32 v117, v52, v116
v_fmac_f32 v149, v52, v148
v_fma_f32 v118, -v53, v149, v118
v_fma_f32 v150, v53, v117, v150
v_mfma_f32_32x32x16_bf16 v[208:223], v[80:83], v[228:231], v[208:223]
s_add_u32 m0, s3, 98304
s_add_u32 s61, s65, 221184
buffer_load_dwordx4 v14, s[12:15], s61 offen lds
ds_read_b64_tr_b16 v[94:95], v5 offset:39424
v_fmac_f32 v118, v52, v117
v_fmac_f32 v150, v52, v149
v_cvt_pk_bf16_f32 v106, v116, v117
v_cvt_pk_bf16_f32 v138, -v148, -v149
v_mfma_f32_32x32x16_bf16 v[192:207], v[84:87], v[232:235], v[192:207]
v_fma_f32 v119, -v53, v150, v119
v_fma_f32 v151, v53, v118, v151
v_fmac_f32 v119, v52, v118
v_fmac_f32 v151, v52, v150
v_fma_f32 v120, -v53, v151, v120
v_fma_f32 v152, v53, v119, v152
v_fmac_f32 v120, v52, v119
v_fmac_f32 v152, v52, v151
v_cvt_pk_bf16_f32 v107, v118, v119
v_cvt_pk_bf16_f32 v139, -v150, -v151
v_mfma_f32_32x32x16_bf16 v[208:223], v[84:87], v[236:239], v[208:223]
buffer_load_dwordx4 v15, s[12:15], s61 offen offset:1024 lds
s_waitcnt lgkmcnt(0)
ds_write_b128 v36, v[104:107] offset:32
v_fma_f32 v121, -v53, v152, v121
v_fma_f32 v153, v53, v120, v153
v_fmac_f32 v121, v52, v120
v_fmac_f32 v153, v52, v152
v_fma_f32 v122, -v53, v153, v122
v_mfma_f32_32x32x16_bf16 v[192:207], v[88:91], v[240:243], v[192:207]
v_fma_f32 v154, v53, v121, v154
v_fmac_f32 v122, v52, v121
v_fmac_f32 v154, v52, v153
v_cvt_pk_bf16_f32 v108, v120, v121
v_cvt_pk_bf16_f32 v140, -v152, -v153
v_fma_f32 v123, -v53, v154, v123
v_fma_f32 v155, v53, v122, v155
v_fmac_f32 v123, v52, v122
v_fmac_f32 v155, v52, v154
v_fma_f32 v124, -v53, v155, v124
v_fma_f32 v156, v53, v123, v156
v_mfma_f32_32x32x16_bf16 v[208:223], v[88:91], v[244:247], v[208:223]
s_add_u32 m0, s3, 65536
s_add_u32 s61, s65, 221312
buffer_load_dwordx4 v14, s[12:15], s61 offen lds
v_fmac_f32 v124, v52, v123
v_fmac_f32 v156, v52, v155
v_cvt_pk_bf16_f32 v109, v122, v123
v_cvt_pk_bf16_f32 v141, -v154, -v155
v_fma_f32 v125, -v53, v156, v125
v_mfma_f32_32x32x16_bf16 v[192:207], v[92:95], v[248:251], v[192:207]
s_barrier
v_fma_f32 v157, v53, v124, v157
v_fmac_f32 v125, v52, v124
v_fmac_f32 v157, v52, v156
v_fma_f32 v126, -v53, v157, v126
v_fma_f32 v158, v53, v125, v158
v_fmac_f32 v126, v52, v125
v_fmac_f32 v158, v52, v157
v_cvt_pk_bf16_f32 v110, v124, v125
v_cvt_pk_bf16_f32 v142, -v156, -v157
v_mfma_f32_32x32x16_bf16 v[208:223], v[92:95], v[252:255], v[208:223]
buffer_load_dwordx4 v15, s[12:15], s61 offen offset:1024 lds
v_fma_f32 v127, -v53, v158, v127
v_fma_f32 v159, v53, v126, v159
v_fmac_f32 v127, v52, v126
v_fmac_f32 v159, v52, v158
v_cvt_pk_bf16_f32 v111, v126, v127
v_cvt_pk_bf16_f32 v143, -v158, -v159
ds_write_b128 v36, v[108:111] offset:48
ds_read_b64_tr_b16 v[160:161], v37 offset:0
s_nop 2
v_pk_mul_f32 v[44:45], v[192:193], v[192:193]
v_pk_mul_f32 v[46:47], v[194:195], v[194:195]
v_pk_mul_f32 v[48:49], v[196:197], v[196:197]
v_pk_mul_f32 v[50:51], v[198:199], v[198:199]
v_pk_fma_f32 v[44:45], v[44:45], v[22:23], v[20:21] op_sel:[0,0,0] op_sel_hi:[1,0,0]
ds_read_b64_tr_b16 v[162:163], v37 offset:576
v_pk_fma_f32 v[46:47], v[46:47], v[22:23], v[20:21] op_sel:[0,0,0] op_sel_hi:[1,0,0]
v_pk_fma_f32 v[48:49], v[48:49], v[22:23], v[20:21] op_sel:[0,0,0] op_sel_hi:[1,0,0]
v_pk_fma_f32 v[50:51], v[50:51], v[22:23], v[20:21] op_sel:[0,0,0] op_sel_hi:[1,0,0]
v_pk_mul_f32 v[44:45], v[44:45], v[192:193]
v_pk_mul_f32 v[46:47], v[46:47], v[194:195]
ds_read_b64_tr_b16 v[164:165], v37 offset:16
v_pk_mul_f32 v[48:49], v[48:49], v[196:197]
v_pk_mul_f32 v[50:51], v[50:51], v[198:199]
v_exp_f32 v44, v44
v_exp_f32 v45, v45
v_exp_f32 v46, v46
ds_read_b64_tr_b16 v[166:167], v37 offset:592
v_exp_f32 v47, v47
v_exp_f32 v48, v48
v_exp_f32 v49, v49
v_exp_f32 v50, v50
v_exp_f32 v51, v51
ds_read_b64_tr_b16 v[168:169], v37 offset:32
v_pk_fma_f32 v[44:45], v[44:45], v[24:25], v[24:25] op_sel:[0,0,0] op_sel_hi:[1,0,0]
v_pk_fma_f32 v[46:47], v[46:47], v[24:25], v[24:25] op_sel:[0,0,0] op_sel_hi:[1,0,0]
v_pk_fma_f32 v[48:49], v[48:49], v[24:25], v[24:25] op_sel:[0,0,0] op_sel_hi:[1,0,0]
v_pk_fma_f32 v[50:51], v[50:51], v[24:25], v[24:25] op_sel:[0,0,0] op_sel_hi:[1,0,0]
v_rcp_f32 v44, v44
ds_read_b64_tr_b16 v[170:171], v37 offset:608
v_rcp_f32 v45, v45
v_rcp_f32 v46, v46
v_rcp_f32 v47, v47
v_rcp_f32 v48, v48
v_rcp_f32 v49, v49
ds_read_b64_tr_b16 v[172:173], v37 offset:48
v_rcp_f32 v50, v50
v_rcp_f32 v51, v51
v_pk_mul_f32 v[44:45], v[44:45], v[192:193]
v_pk_mul_f32 v[46:47], v[46:47], v[194:195]
v_pk_mul_f32 v[48:49], v[48:49], v[196:197]
ds_read_b64_tr_b16 v[174:175], v37 offset:624
v_pk_mul_f32 v[50:51], v[50:51], v[198:199]
v_cvt_pk_bf16_f32 v192, v44, v45
v_cvt_pk_bf16_f32 v193, v46, v47
v_cvt_pk_bf16_f32 v194, v48, v49
v_cvt_pk_bf16_f32 v195, v50, v51
ds_write_b128 v36, v[128:131] offset:0
s_add_u32 m0, s3, 73728
s_add_u32 s61, s40, 221184
buffer_load_dwordx4 v14, s[12:15], s61 offen lds
s_add_u32 s99, s41, 58368
buffer_store_dwordx4 v[192:195], v31, s[16:19], s99 offen offset:2048 sc1
v_pk_mul_f32 v[44:45], v[200:201], v[200:201]
v_pk_mul_f32 v[46:47], v[202:203], v[202:203]
v_pk_mul_f32 v[48:49], v[204:205], v[204:205]
v_pk_mul_f32 v[50:51], v[206:207], v[206:207]
ds_write_b128 v36, v[132:135] offset:16
v_pk_fma_f32 v[44:45], v[44:45], v[22:23], v[20:21] op_sel:[0,0,0] op_sel_hi:[1,0,0]
v_pk_fma_f32 v[46:47], v[46:47], v[22:23], v[20:21] op_sel:[0,0,0] op_sel_hi:[1,0,0]
v_pk_fma_f32 v[48:49], v[48:49], v[22:23], v[20:21] op_sel:[0,0,0] op_sel_hi:[1,0,0]
v_pk_fma_f32 v[50:51], v[50:51], v[22:23], v[20:21] op_sel:[0,0,0] op_sel_hi:[1,0,0]
v_pk_mul_f32 v[44:45], v[44:45], v[200:201]
ds_write_b128 v36, v[136:139] offset:32
v_pk_mul_f32 v[46:47], v[46:47], v[202:203]
v_pk_mul_f32 v[48:49], v[48:49], v[204:205]
v_pk_mul_f32 v[50:51], v[50:51], v[206:207]
v_exp_f32 v44, v44
v_exp_f32 v45, v45
ds_write_b128 v36, v[140:143] offset:48
v_exp_f32 v46, v46
v_exp_f32 v47, v47
v_exp_f32 v48, v48
v_exp_f32 v49, v49
v_exp_f32 v50, v50
ds_read_b64_tr_b16 v[176:177], v37 offset:0
v_exp_f32 v51, v51
v_pk_fma_f32 v[44:45], v[44:45], v[24:25], v[24:25] op_sel:[0,0,0] op_sel_hi:[1,0,0]
v_pk_fma_f32 v[46:47], v[46:47], v[24:25], v[24:25] op_sel:[0,0,0] op_sel_hi:[1,0,0]
v_pk_fma_f32 v[48:49], v[48:49], v[24:25], v[24:25] op_sel:[0,0,0] op_sel_hi:[1,0,0]
v_pk_fma_f32 v[50:51], v[50:51], v[24:25], v[24:25] op_sel:[0,0,0] op_sel_hi:[1,0,0]
ds_read_b64_tr_b16 v[178:179], v37 offset:576
v_rcp_f32 v44, v44
v_rcp_f32 v45, v45
v_rcp_f32 v46, v46
v_rcp_f32 v47, v47
v_rcp_f32 v48, v48
ds_read_b64_tr_b16 v[180:181], v37 offset:16
v_rcp_f32 v49, v49
v_rcp_f32 v50, v50
v_rcp_f32 v51, v51
v_pk_mul_f32 v[44:45], v[44:45], v[200:201]
v_pk_mul_f32 v[46:47], v[46:47], v[202:203]
ds_read_b64_tr_b16 v[182:183], v37 offset:592
v_pk_mul_f32 v[48:49], v[48:49], v[204:205]
v_pk_mul_f32 v[50:51], v[50:51], v[206:207]
v_cvt_pk_bf16_f32 v200, v44, v45
v_cvt_pk_bf16_f32 v201, v46, v47
v_cvt_pk_bf16_f32 v202, v48, v49
ds_read_b64_tr_b16 v[184:185], v37 offset:32
v_cvt_pk_bf16_f32 v203, v50, v51
s_add_u32 s99, s41, 58368
buffer_store_dwordx4 v[200:203], v31, s[16:19], s99 offen offset:2304 sc1
v_pk_mul_f32 v[44:45], v[208:209], v[208:209]
v_pk_mul_f32 v[46:47], v[210:211], v[210:211]
v_pk_mul_f32 v[48:49], v[212:213], v[212:213]
ds_read_b64_tr_b16 v[186:187], v37 offset:608
v_pk_mul_f32 v[50:51], v[214:215], v[214:215]
v_pk_fma_f32 v[44:45], v[44:45], v[22:23], v[20:21] op_sel:[0,1,1] op_sel_hi:[1,1,1]
buffer_load_dwordx4 v15, s[12:15], s61 offen offset:1024 lds
v_pk_fma_f32 v[46:47], v[46:47], v[22:23], v[20:21] op_sel:[0,1,1] op_sel_hi:[1,1,1]
v_pk_fma_f32 v[48:49], v[48:49], v[22:23], v[20:21] op_sel:[0,1,1] op_sel_hi:[1,1,1]
v_pk_fma_f32 v[50:51], v[50:51], v[22:23], v[20:21] op_sel:[0,1,1] op_sel_hi:[1,1,1]
ds_read_b64_tr_b16 v[188:189], v37 offset:48
v_pk_mul_f32 v[44:45], v[44:45], v[208:209]
v_pk_mul_f32 v[46:47], v[46:47], v[210:211]
v_pk_mul_f32 v[48:49], v[48:49], v[212:213]
v_pk_mul_f32 v[50:51], v[50:51], v[214:215]
v_exp_f32 v44, v44
ds_read_b64_tr_b16 v[190:191], v37 offset:624
v_exp_f32 v45, v45
v_exp_f32 v46, v46
v_exp_f32 v47, v47
v_exp_f32 v48, v48
v_exp_f32 v49, v49
v_exp_f32 v50, v50
v_exp_f32 v51, v51
v_pk_fma_f32 v[44:45], v[44:45], v[24:25], v[24:25] op_sel:[0,1,1] op_sel_hi:[1,1,1]
v_pk_fma_f32 v[46:47], v[46:47], v[24:25], v[24:25] op_sel:[0,1,1] op_sel_hi:[1,1,1]
v_pk_fma_f32 v[48:49], v[48:49], v[24:25], v[24:25] op_sel:[0,1,1] op_sel_hi:[1,1,1]
v_pk_fma_f32 v[50:51], v[50:51], v[24:25], v[24:25] op_sel:[0,1,1] op_sel_hi:[1,1,1]
v_rcp_f32 v44, v44
v_rcp_f32 v45, v45
v_rcp_f32 v46, v46
v_rcp_f32 v47, v47
v_rcp_f32 v48, v48
v_rcp_f32 v49, v49
v_rcp_f32 v50, v50
v_rcp_f32 v51, v51
v_pk_mul_f32 v[44:45], v[44:45], v[208:209]
v_pk_mul_f32 v[46:47], v[46:47], v[210:211]
v_pk_mul_f32 v[48:49], v[48:49], v[212:213]
v_pk_mul_f32 v[50:51], v[50:51], v[214:215]
v_cvt_pk_bf16_f32 v208, v44, v45
v_cvt_pk_bf16_f32 v209, v46, v47
v_cvt_pk_bf16_f32 v210, v48, v49
v_cvt_pk_bf16_f32 v211, v50, v51
s_add_u32 s99, s41, 146176
buffer_store_dwordx4 v[208:211], v31, s[16:19], s99 offen offset:2048 sc1
v_pk_mul_f32 v[44:45], v[216:217], v[216:217]
v_pk_mul_f32 v[46:47], v[218:219], v[218:219]
v_pk_mul_f32 v[48:49], v[220:221], v[220:221]
v_pk_mul_f32 v[50:51], v[222:223], v[222:223]
v_pk_fma_f32 v[44:45], v[44:45], v[22:23], v[20:21] op_sel:[0,1,1] op_sel_hi:[1,1,1]
v_pk_fma_f32 v[46:47], v[46:47], v[22:23], v[20:21] op_sel:[0,1,1] op_sel_hi:[1,1,1]
v_pk_fma_f32 v[48:49], v[48:49], v[22:23], v[20:21] op_sel:[0,1,1] op_sel_hi:[1,1,1]
v_pk_fma_f32 v[50:51], v[50:51], v[22:23], v[20:21] op_sel:[0,1,1] op_sel_hi:[1,1,1]
v_pk_mul_f32 v[44:45], v[44:45], v[216:217]
v_pk_mul_f32 v[46:47], v[46:47], v[218:219]
v_pk_mul_f32 v[48:49], v[48:49], v[220:221]
v_pk_mul_f32 v[50:51], v[50:51], v[222:223]
v_exp_f32 v44, v44
v_exp_f32 v45, v45
v_exp_f32 v46, v46
v_exp_f32 v47, v47
s_add_u32 m0, s3, 24576
s_add_u32 s61, s40, 221312
buffer_load_dwordx4 v14, s[12:15], s61 offen lds
v_exp_f32 v48, v48
v_exp_f32 v49, v49
v_exp_f32 v50, v50
v_exp_f32 v51, v51
v_pk_fma_f32 v[44:45], v[44:45], v[24:25], v[24:25] op_sel:[0,1,1] op_sel_hi:[1,1,1]
v_pk_fma_f32 v[46:47], v[46:47], v[24:25], v[24:25] op_sel:[0,1,1] op_sel_hi:[1,1,1]
v_pk_fma_f32 v[48:49], v[48:49], v[24:25], v[24:25] op_sel:[0,1,1] op_sel_hi:[1,1,1]
v_pk_fma_f32 v[50:51], v[50:51], v[24:25], v[24:25] op_sel:[0,1,1] op_sel_hi:[1,1,1]
v_rcp_f32 v44, v44
v_rcp_f32 v45, v45
v_rcp_f32 v46, v46
v_rcp_f32 v47, v47
v_rcp_f32 v48, v48
v_rcp_f32 v49, v49
v_rcp_f32 v50, v50
v_rcp_f32 v51, v51
v_pk_mul_f32 v[44:45], v[44:45], v[216:217]
v_pk_mul_f32 v[46:47], v[46:47], v[218:219]
v_pk_mul_f32 v[48:49], v[48:49], v[220:221]
v_pk_mul_f32 v[50:51], v[50:51], v[222:223]
v_cvt_pk_bf16_f32 v216, v44, v45
v_cvt_pk_bf16_f32 v217, v46, v47
v_cvt_pk_bf16_f32 v218, v48, v49
v_cvt_pk_bf16_f32 v219, v50, v51
s_add_u32 s99, s41, 146176
buffer_store_dwordx4 v[216:219], v31, s[16:19], s99 offen offset:2304 sc1
v_and_b32 v63, 16, v0
v_bfe_u32 v62, v0, 5, 1
v_lshl_add_u32 v63, v62, 2, v63
v_bfe_u32 v62, v0, 2, 2
v_add_u32 v63, v63, v62
v_lshlrev_b32 v63, 7, v63
v_bfe_u32 v62, v0, 3, 2
v_lshl_add_u32 v63, v62, 5, v63
v_and_b32 v62, 3, v0
v_lshl_add_u32 v52, v62, 3, v63
v_xor_b32 v55, 32, v52
v_xor_b32 v58, 64, v52
v_xor_b32 v61, 96, v52
v_add_u32 v53, 65536, v52
v_add_u32 v54, 131072, v52
v_add_u32 v56, 65536, v55
v_add_u32 v57, 131072, v55
v_add_u32 v59, 65536, v58
v_add_u32 v60, 131072, v58
v_add_u32 v62, 65536, v61
v_add_u32 v63, 131072, v61
ds_read_b64_tr_b16 v[64:65], v52 offset:49152
ds_read_b64_tr_b16 v[66:67], v52 offset:50176
ds_read_b64_tr_b16 v[68:69], v55 offset:49152
ds_read_b64_tr_b16 v[70:71], v55 offset:50176
ds_read_b64_tr_b16 v[72:73], v58 offset:49152
ds_read_b64_tr_b16 v[74:75], v58 offset:50176
ds_read_b64_tr_b16 v[76:77], v61 offset:49152
ds_read_b64_tr_b16 v[78:79], v61 offset:50176
buffer_load_dwordx4 v15, s[12:15], s61 offen offset:1024 lds
ds_read_b64_tr_b16 v[80:81], v52 offset:53248
ds_read_b64_tr_b16 v[82:83], v52 offset:54272
ds_read_b64_tr_b16 v[84:85], v55 offset:53248
ds_read_b64_tr_b16 v[86:87], v55 offset:54272
s_waitcnt vmcnt(30) lgkmcnt(10)
v_mfma_f32_16x16x32_bf16 v[112:115], v[64:67], a[4:7], 0
s_add_u32 s0, s86, 14592
v_mfma_f32_16x16x32_bf16 v[96:99], v[64:67], a[0:3], 0
buffer_load_dwordx4 a[64:67], v1, s[16:19], s0 offen offset:0 sc1
s_waitcnt lgkmcnt(8)
v_mfma_f32_16x16x32_bf16 v[100:103], v[68:71], a[0:3], 0
ds_read_b64_tr_b16 v[88:89], v58 offset:53248
ds_read_b64_tr_b16 v[90:91], v58 offset:54272
ds_read_b64_tr_b16 v[92:93], v61 offset:53248
v_mfma_f32_16x16x32_bf16 v[116:119], v[68:71], a[4:7], 0
ds_read_b64_tr_b16 v[94:95], v61 offset:54272
s_add_u32 s99, s100, 29184
s_waitcnt lgkmcnt(10)
v_mfma_f32_16x16x32_bf16 v[120:123], v[72:75], a[4:7], 0
buffer_store_dwordx4 v[160:163], v1, s[16:19], s99 offen offset:0 sc1
v_mfma_f32_16x16x32_bf16 v[104:107], v[72:75], a[0:3], 0
buffer_load_dwordx4 a[68:71], v1, s[16:19], s0 offen offset:1024 sc1
s_waitcnt lgkmcnt(8)
v_mfma_f32_16x16x32_bf16 v[108:111], v[76:79], a[0:3], 0
ds_read_b64_tr_b16 v[64:65], v53 offset:24576
ds_read_b64_tr_b16 v[66:67], v53 offset:25600
v_mfma_f32_16x16x32_bf16 v[124:127], v[76:79], a[4:7], 0
s_waitcnt lgkmcnt(6)
ds_read_b64_tr_b16 v[68:69], v56 offset:24576
s_waitcnt vmcnt(30)
v_mfma_f32_16x16x32_bf16 v[112:115], v[80:83], a[12:15], v[112:115]
ds_read_b64_tr_b16 v[70:71], v56 offset:25600
v_mfma_f32_16x16x32_bf16 v[96:99], v[80:83], a[8:11], v[96:99]
buffer_load_dwordx4 a[72:75], v1, s[16:19], s0 offen offset:2048 sc1
v_mfma_f32_16x16x32_bf16 v[100:103], v[84:87], a[8:11], v[100:103]
ds_read_b64_tr_b16 v[72:73], v59 offset:24576
ds_read_b64_tr_b16 v[74:75], v59 offset:25600
v_mfma_f32_16x16x32_bf16 v[116:119], v[84:87], a[12:15], v[116:119]
ds_read_b64_tr_b16 v[76:77], v62 offset:24576
ds_read_b64_tr_b16 v[78:79], v62 offset:25600
s_waitcnt lgkmcnt(10)
v_mfma_f32_16x16x32_bf16 v[120:123], v[88:91], a[12:15], v[120:123]
s_waitcnt lgkmcnt(6)
buffer_load_dwordx4 a[76:79], v1, s[16:19], s0 offen offset:3072 sc1
v_mfma_f32_16x16x32_bf16 v[104:107], v[88:91], a[8:11], v[104:107]
ds_read_b64_tr_b16 v[80:81], v53 offset:28672
ds_read_b64_tr_b16 v[82:83], v53 offset:29696
v_mfma_f32_16x16x32_bf16 v[108:111], v[92:95], a[8:11], v[108:111]
s_add_u32 s99, s100, 29184
v_mfma_f32_16x16x32_bf16 v[124:127], v[92:95], a[12:15], v[124:127]
buffer_store_dwordx4 v[164:167], v1, s[16:19], s99 offen offset:1024 sc1
v_mfma_f32_16x16x32_bf16 v[144:147], v[64:67], a[4:7], 0
ds_read_b64_tr_b16 v[84:85], v56 offset:28672
ds_read_b64_tr_b16 v[86:87], v56 offset:29696
s_add_u32 s0, s87, 14592
v_mfma_f32_16x16x32_bf16 v[128:131], v[64:67], a[0:3], 0
buffer_load_dwordx4 a[80:83], v1, s[16:19], s0 offen offset:0 sc1
s_waitcnt lgkmcnt(8)
v_mfma_f32_16x16x32_bf16 v[132:135], v[68:71], a[0:3], 0
ds_read_b64_tr_b16 v[88:89], v59 offset:28672
ds_read_b64_tr_b16 v[90:91], v59 offset:29696
v_mfma_f32_16x16x32_bf16 v[148:151], v[68:71], a[4:7], 0
s_waitcnt lgkmcnt(6)
ds_read_b64_tr_b16 v[92:93], v62 offset:28672
v_mfma_f32_16x16x32_bf16 v[152:155], v[72:75], a[4:7], 0
ds_read_b64_tr_b16 v[94:95], v62 offset:29696
v_mfma_f32_16x16x32_bf16 v[136:139], v[72:75], a[0:3], 0
buffer_load_dwordx4 a[84:87], v1, s[16:19], s0 offen offset:1024 sc1
v_mfma_f32_16x16x32_bf16 v[140:143], v[76:79], a[0:3], 0
ds_read_b64_tr_b16 v[64:65], v54 offset:8192
ds_read_b64_tr_b16 v[66:67], v54 offset:9216
v_mfma_f32_16x16x32_bf16 v[156:159], v[76:79], a[4:7], 0
ds_read_b64_tr_b16 v[68:69], v57 offset:8192
ds_read_b64_tr_b16 v[70:71], v57 offset:9216
s_waitcnt lgkmcnt(10)
v_mfma_f32_16x16x32_bf16 v[144:147], v[80:83], a[12:15], v[144:147]
s_waitcnt lgkmcnt(6)
ds_read_b64_tr_b16 v[72:73], v60 offset:8192
ds_read_b64_tr_b16 v[74:75], v60 offset:9216
v_mfma_f32_16x16x32_bf16 v[128:131], v[80:83], a[8:11], v[128:131]
s_add_u32 s63, s73, 32
s_load_dwordx8 s[52:59], s[16:17], s63 glc
v_mfma_f32_16x16x32_bf16 v[132:135], v[84:87], a[8:11], v[132:135]
buffer_load_dwordx4 a[88:91], v1, s[16:19], s0 offen offset:2048 sc1
s_add_u32 s99, s100, 116992
v_mfma_f32_16x16x32_bf16 v[148:151], v[84:87], a[12:15], v[148:151]
buffer_store_dwordx4 v[168:171], v1, s[16:19], s99 offen offset:0 sc1
v_mfma_f32_16x16x32_bf16 v[152:155], v[88:91], a[12:15], v[152:155]
ds_read_b64_tr_b16 v[76:77], v63 offset:8192
ds_read_b64_tr_b16 v[78:79], v63 offset:9216
v_mfma_f32_16x16x32_bf16 v[136:139], v[88:91], a[8:11], v[136:139]
buffer_load_dwordx4 a[92:95], v1, s[16:19], s0 offen offset:3072 sc1
s_waitcnt lgkmcnt(8)
v_mfma_f32_16x16x32_bf16 v[140:143], v[92:95], a[8:11], v[140:143]
ds_read_b64_tr_b16 v[80:81], v54 offset:12288
ds_read_b64_tr_b16 v[82:83], v54 offset:13312
v_mfma_f32_16x16x32_bf16 v[156:159], v[92:95], a[12:15], v[156:159]
s_waitcnt lgkmcnt(6)
ds_read_b64_tr_b16 v[84:85], v57 offset:12288
s_waitcnt vmcnt(36)
v_mfma_f32_16x16x32_bf16 v[112:115], v[64:67], a[20:23], v[112:115]
ds_read_b64_tr_b16 v[86:87], v57 offset:13312
s_add_u32 m0, s3, 40960
s_add_u32 s61, s97, 0
v_mfma_f32_16x16x32_bf16 v[96:99], v[64:67], a[16:19], v[96:99]
buffer_load_dwordx4 v14, s[12:15], s61 offen lds
L_stub11:
s_cbranch_execz L_stub14
v_mfma_f32_16x16x32_bf16 v[100:103], v[68:71], a[16:19], v[100:103]
ds_read_b64_tr_b16 v[88:89], v60 offset:12288
ds_read_b64_tr_b16 v[90:91], v60 offset:13312
v_mfma_f32_16x16x32_bf16 v[116:119], v[68:71], a[20:23], v[116:119]
ds_read_b64_tr_b16 v[92:93], v63 offset:12288
ds_read_b64_tr_b16 v[94:95], v63 offset:13312
s_waitcnt lgkmcnt(10)
v_mfma_f32_16x16x32_bf16 v[120:123], v[72:75], a[20:23], v[120:123]
s_waitcnt lgkmcnt(6)
buffer_load_dwordx4 v15, s[12:15], s61 offen offset:1024 lds
v_mfma_f32_16x16x32_bf16 v[104:107], v[72:75], a[16:19], v[104:107]
ds_read_b64_tr_b16 v[64:65], v53 offset:40960
ds_read_b64_tr_b16 v[66:67], v53 offset:41984
v_mfma_f32_16x16x32_bf16 v[108:111], v[76:79], a[16:19], v[108:111]
s_add_u32 s99, s100, 116992
v_mfma_f32_16x16x32_bf16 v[124:127], v[76:79], a[20:23], v[124:127]
buffer_store_dwordx4 v[172:175], v1, s[16:19], s99 offen offset:1024 sc1
s_waitcnt vmcnt(37)
v_mfma_f32_16x16x32_bf16 v[112:115], v[80:83], a[28:31], v[112:115]
ds_read_b64_tr_b16 v[68:69], v56 offset:40960
ds_read_b64_tr_b16 v[70:71], v56 offset:41984
s_add_u32 m0, s3, 57344
v_mfma_f32_16x16x32_bf16 v[96:99], v[80:83], a[24:27], v[96:99]
s_add_u32 s61, s97, 128
s_waitcnt lgkmcnt(8)
v_mfma_f32_16x16x32_bf16 v[100:103], v[84:87], a[24:27], v[100:103]
buffer_load_dwordx4 v14, s[12:15], s61 offen lds
ds_read_b64_tr_b16 v[72:73], v59 offset:40960
v_mfma_f32_16x16x32_bf16 v[116:119], v[84:87], a[28:31], v[116:119]
ds_read_b64_tr_b16 v[74:75], v59 offset:41984
s_waitcnt lgkmcnt(6)
v_mfma_f32_16x16x32_bf16 v[120:123], v[88:91], a[28:31], v[120:123]
ds_read_b64_tr_b16 v[76:77], v62 offset:40960
ds_read_b64_tr_b16 v[78:79], v62 offset:41984
ds_read_b64_tr_b16 v[80:81], v53 offset:45056
v_mfma_f32_16x16x32_bf16 v[104:107], v[88:91], a[24:27], v[104:107]
ds_read_b64_tr_b16 v[82:83], v53 offset:46080
s_waitcnt vmcnt(35)
v_mfma_f32_16x16x32_bf16 v[108:111], v[92:95], a[24:27], v[108:111]
s_barrier
v_mfma_f32_16x16x32_bf16 v[124:127], v[92:95], a[28:31], v[124:127]
buffer_load_dwordx4 v15, s[12:15], s61 offen offset:1024 lds
s_waitcnt lgkmcnt(8)
v_mfma_f32_16x16x32_bf16 v[144:147], v[64:67], a[20:23], v[144:147]
ds_read_b64_tr_b16 v[84:85], v56 offset:45056
ds_read_b64_tr_b16 v[86:87], v56 offset:46080
s_waitcnt lgkmcnt(6)
s_add_u32 m0, s3, 81920
v_mfma_f32_16x16x32_bf16 v[128:131], v[64:67], a[16:19], v[128:131]
s_add_u32 s61, s97, 73728
buffer_load_dwordx4 v14, s[12:15], s61 offen lds
v_mfma_f32_16x16x32_bf16 v[132:135], v[68:71], a[16:19], v[132:135]
ds_read_b64_tr_b16 v[88:89], v59 offset:45056
ds_read_b64_tr_b16 v[90:91], v59 offset:46080
s_add_u32 s99, s100, 34048
v_mfma_f32_16x16x32_bf16 v[148:151], v[68:71], a[20:23], v[148:151]
buffer_store_dwordx4 v[176:179], v1, s[16:19], s99 offen offset:0 sc1
v_mfma_f32_16x16x32_bf16 v[152:155], v[72:75], a[20:23], v[152:155]
ds_read_b64_tr_b16 v[92:93], v62 offset:45056
ds_read_b64_tr_b16 v[94:95], v62 offset:46080
v_mfma_f32_16x16x32_bf16 v[136:139], v[72:75], a[16:19], v[136:139]
buffer_load_dwordx4 v15, s[12:15], s61 offen offset:1024 lds
s_waitcnt lgkmcnt(8)
v_mfma_f32_16x16x32_bf16 v[140:143], v[76:79], a[16:19], v[140:143]
ds_read_b64_tr_b16 v[64:65], v53 offset:49152
ds_read_b64_tr_b16 v[66:67], v53 offset:50176
v_mfma_f32_16x16x32_bf16 v[156:159], v[76:79], a[20:23], v[156:159]
s_waitcnt lgkmcnt(6)
ds_read_b64_tr_b16 v[68:69], v56 offset:49152
v_mfma_f32_16x16x32_bf16 v[144:147], v[80:83], a[28:31], v[144:147]
ds_read_b64_tr_b16 v[70:71], v56 offset:50176
s_add_u32 m0, s3, 32768
s_add_u32 s61, s97, 73856
v_mfma_f32_16x16x32_bf16 v[128:131], v[80:83], a[24:27], v[128:131]
buffer_load_dwordx4 v14, s[12:15], s61 offen lds
v_mfma_f32_16x16x32_bf16 v[132:135], v[84:87], a[24:27], v[132:135]
ds_read_b64_tr_b16 v[72:73], v59 offset:49152
ds_read_b64_tr_b16 v[74:75], v59 offset:50176
ds_read_b64_tr_b16 v[76:77], v62 offset:49152
v_mfma_f32_16x16x32_bf16 v[148:151], v[84:87], a[28:31], v[148:151]
ds_read_b64_tr_b16 v[78:79], v62 offset:50176
s_waitcnt lgkmcnt(6)
v_mfma_f32_16x16x32_bf16 v[152:155], v[88:91], a[28:31], v[152:155]
s_add_u32 s99, s100, 34048
buffer_store_dwordx4 v[180:183], v1, s[16:19], s99 offen offset:1024 sc1
v_mfma_f32_16x16x32_bf16 v[136:139], v[88:91], a[24:27], v[136:139]
ds_read_b64_tr_b16 v[80:81], v53 offset:53248
ds_read_b64_tr_b16 v[82:83], v53 offset:54272
v_mfma_f32_16x16x32_bf16 v[140:143], v[92:95], a[24:27], v[140:143]
s_waitcnt lgkmcnt(0)
s_cmp_lg_u64 s[56:57], s[42:43]
s_cbranch_scc1 fh2S_slow
fh2S_ok:
v_mfma_f32_16x16x32_bf16 v[156:159], v[92:95], a[28:31], v[156:159]
buffer_load_dwordx4 v15, s[12:15], s61 offen offset:1024 lds
s_waitcnt vmcnt(40)
v_mfma_f32_16x16x32_bf16 v[112:115], v[64:67], a[36:39], v[112:115]
ds_read_b64_tr_b16 v[84:85], v56 offset:53248
ds_read_b64_tr_b16 v[86:87], v56 offset:54272
s_add_u32 s0, s72, 48640
v_mfma_f32_16x16x32_bf16 v[96:99], v[64:67], a[32:35], v[96:99]
buffer_load_dwordx4 a[96:99], v1, s[16:19], s0 offen offset:0 sc1
v_mfma_f32_16x16x32_bf16 v[100:103], v[68:71], a[32:35], v[100:103]
ds_read_b64_tr_b16 v[88:89], v59 offset:53248
ds_read_b64_tr_b16 v[90:91], v59 offset:54272
v_mfma_f32_16x16x32_bf16 v[116:119], v[68:71], a[36:39], v[116:119]
ds_read_b64_tr_b16 v[92:93], v62 offset:53248
v_mfma_f32_16x16x32_bf16 v[120:123], v[72:75], a[36:39], v[120:123]
ds_read_b64_tr_b16 v[94:95], v62 offset:54272
v_mfma_f32_16x16x32_bf16 v[104:107], v[72:75], a[32:35], v[104:107]
buffer_load_dwordx4 a[100:103], v1, s[16:19], s0 offen offset:1024 sc1
v_mfma_f32_16x16x32_bf16 v[108:111], v[76:79], a[32:35], v[108:111]
ds_read_b64_tr_b16 v[64:65], v53 offset:57344
ds_read_b64_tr_b16 v[66:67], v53 offset:58368
ds_read_b64_tr_b16 v[68:69], v56 offset:57344
v_mfma_f32_16x16x32_bf16 v[124:127], v[76:79], a[36:39], v[124:127]
ds_read_b64_tr_b16 v[70:71], v56 offset:58368
s_waitcnt lgkmcnt(6)
s_waitcnt vmcnt(40)
v_mfma_f32_16x16x32_bf16 v[112:115], v[80:83], a[44:47], v[112:115]
s_add_u32 s99, s100, 121856
buffer_store_dwordx4 v[184:187], v1, s[16:19], s99 offen offset:0 sc1
v_mfma_f32_16x16x32_bf16 v[96:99], v[80:83], a[40:43], v[96:99]
buffer_load_dwordx4 a[104:107], v1, s[16:19], s0 offen offset:2048 sc1
ds_read_b64_tr_b16 v[72:73], v59 offset:57344
v_mfma_f32_16x16x32_bf16 v[100:103], v[84:87], a[40:43], v[100:103]
ds_read_b64_tr_b16 v[74:75], v59 offset:58368
v_mfma_f32_16x16x32_bf16 v[116:119], v[84:87], a[44:47], v[116:119]
s_waitcnt vmcnt(27)
buffer_store_dword v13, v26, s[16:19], s60 offen offset:64 sc1
v_mfma_f32_16x16x32_bf16 v[120:123], v[88:91], a[44:47], v[120:123]
ds_read_b64_tr_b16 v[76:77], v62 offset:57344
ds_read_b64_tr_b16 v[78:79], v62 offset:58368
v_mfma_f32_16x16x32_bf16 v[104:107], v[88:91], a[40:43], v[104:107]
buffer_load_dwordx4 a[108:111], v1, s[16:19], s0 offen offset:3072 sc1
s_waitcnt lgkmcnt(8)
v_mfma_f32_16x16x32_bf16 v[108:111], v[92:95], a[40:43], v[108:111]
ds_read_b64_tr_b16 v[80:81], v53 offset:61440
ds_read_b64_tr_b16 v[82:83], v53 offset:62464
v_mfma_f32_16x16x32_bf16 v[124:127], v[92:95], a[44:47], v[124:127]
s_waitcnt lgkmcnt(6)
ds_read_b64_tr_b16 v[84:85], v56 offset:61440
v_mfma_f32_16x16x32_bf16 v[144:147], v[64:67], a[36:39], v[144:147]
ds_read_b64_tr_b16 v[86:87], v56 offset:62464
s_add_u32 s0, s72, 53504
v_mfma_f32_16x16x32_bf16 v[128:131], v[64:67], a[32:35], v[128:131]
buffer_load_dwordx4 a[112:115], v1, s[16:19], s0 offen offset:0 sc1
v_mfma_f32_16x16x32_bf16 v[132:135], v[68:71], a[32:35], v[132:135]
ds_read_b64_tr_b16 v[88:89], v59 offset:61440
ds_read_b64_tr_b16 v[90:91], v59 offset:62464
ds_read_b64_tr_b16 v[92:93], v62 offset:61440
v_mfma_f32_16x16x32_bf16 v[148:151], v[68:71], a[36:39], v[148:151]
ds_read_b64_tr_b16 v[94:95], v62 offset:62464
s_waitcnt lgkmcnt(6)
v_mfma_f32_16x16x32_bf16 v[152:155], v[72:75], a[36:39], v[152:155]
s_add_u32 s99, s100, 121856
buffer_store_dwordx4 v[188:191], v1, s[16:19], s99 offen offset:1024 sc1
v_mfma_f32_16x16x32_bf16 v[136:139], v[72:75], a[32:35], v[136:139]
buffer_load_dwordx4 a[116:119], v1, s[16:19], s0 offen offset:1024 sc1
v_mfma_f32_16x16x32_bf16 v[140:143], v[76:79], a[32:35], v[140:143]
ds_read_b64_tr_b16 v[64:65], v54 offset:0
ds_read_b64_tr_b16 v[66:67], v54 offset:1024
v_mfma_f32_16x16x32_bf16 v[156:159], v[76:79], a[36:39], v[156:159]
ds_read_b64_tr_b16 v[68:69], v57 offset:0
ds_read_b64_tr_b16 v[70:71], v57 offset:1024
v_mfma_f32_16x16x32_bf16 v[144:147], v[80:83], a[44:47], v[144:147]
buffer_load_dwordx4 a[120:123], v1, s[16:19], s0 offen offset:2048 sc1
v_mfma_f32_16x16x32_bf16 v[128:131], v[80:83], a[40:43], v[128:131]
ds_read_b64_tr_b16 v[72:73], v60 offset:0
ds_read_b64_tr_b16 v[74:75], v60 offset:1024
s_waitcnt lgkmcnt(10)
v_mfma_f32_16x16x32_bf16 v[132:135], v[84:87], a[40:43], v[132:135]
s_waitcnt lgkmcnt(6)
ds_read_b64_tr_b16 v[76:77], v63 offset:0
v_mfma_f32_16x16x32_bf16 v[148:151], v[84:87], a[44:47], v[148:151]
ds_read_b64_tr_b16 v[78:79], v63 offset:1024
v_mfma_f32_16x16x32_bf16 v[152:155], v[88:91], a[44:47], v[152:155]
buffer_load_dwordx4 a[124:127], v1, s[16:19], s0 offen offset:3072 sc1
v_mfma_f32_16x16x32_bf16 v[136:139], v[88:91], a[40:43], v[136:139]
ds_read_b64_tr_b16 v[80:81], v54 offset:4096
ds_read_b64_tr_b16 v[82:83], v54 offset:5120
v_mfma_f32_16x16x32_bf16 v[140:143], v[92:95], a[40:43], v[140:143]
ds_read_b64_tr_b16 v[84:85], v57 offset:4096
ds_read_b64_tr_b16 v[86:87], v57 offset:5120
v_mfma_f32_16x16x32_bf16 v[156:159], v[92:95], a[44:47], v[156:159]
s_waitcnt lgkmcnt(6)
L_common:
L_stub12:
s_cbranch_execz L_stub16
v_mfma_f32_16x16x32_bf16 v[112:115], v[64:67], a[52:55], v[112:115]
s_add_u32 m0, s3, 0
s_add_u32 s61, s64, 3096576
v_mfma_f32_16x16x32_bf16 v[96:99], v[64:67], a[48:51], v[96:99]
buffer_load_dwordx4 v14, s[12:15], s61 offen lds
v_mfma_f32_16x16x32_bf16 v[100:103], v[68:71], a[48:51], v[100:103]
ds_read_b64_tr_b16 v[88:89], v60 offset:4096
ds_read_b64_tr_b16 v[90:91], v60 offset:5120
v_mfma_f32_16x16x32_bf16 v[116:119], v[68:71], a[52:55], v[116:119]
ds_read_b64_tr_b16 v[92:93], v63 offset:4096
ds_read_b64_tr_b16 v[94:95], v63 offset:5120
v_mfma_f32_16x16x32_bf16 v[120:123], v[72:75], a[52:55], v[120:123]
buffer_load_dwordx4 v15, s[12:15], s61 offen offset:1024 lds
v_mfma_f32_16x16x32_bf16 v[104:107], v[72:75], a[48:51], v[104:107]
ds_read_b64_tr_b16 v[64:65], v54 offset:16384
ds_read_b64_tr_b16 v[66:67], v54 offset:17408
s_waitcnt lgkmcnt(10)
v_mfma_f32_16x16x32_bf16 v[108:111], v[76:79], a[48:51], v[108:111]
s_waitcnt lgkmcnt(6)
ds_read_b64_tr_b16 v[68:69], v57 offset:16384
v_mfma_f32_16x16x32_bf16 v[124:127], v[76:79], a[52:55], v[124:127]
ds_read_b64_tr_b16 v[70:71], v57 offset:17408
v_mfma_f32_16x16x32_bf16 v[112:115], v[80:83], a[60:63], v[112:115]
s_add_u32 m0, s3, 8192
s_add_u32 s61, s64, 3096704
v_mfma_f32_16x16x32_bf16 v[96:99], v[80:83], a[56:59], v[96:99]
buffer_load_dwordx4 v14, s[12:15], s61 offen lds
v_mfma_f32_16x16x32_bf16 v[100:103], v[84:87], a[56:59], v[100:103]
ds_read_b64_tr_b16 v[72:73], v60 offset:16384
ds_read_b64_tr_b16 v[74:75], v60 offset:17408
v_mfma_f32_16x16x32_bf16 v[116:119], v[84:87], a[60:63], v[116:119]
ds_read_b64_tr_b16 v[76:77], v63 offset:16384
ds_read_b64_tr_b16 v[78:79], v63 offset:17408
s_waitcnt lgkmcnt(10)
v_mfma_f32_16x16x32_bf16 v[120:123], v[88:91], a[60:63], v[120:123]
s_waitcnt lgkmcnt(6)
ds_read_b64_tr_b16 v[80:81], v54 offset:20480
ds_read_b64_tr_b16 v[82:83], v54 offset:21504
v_mfma_f32_16x16x32_bf16 v[104:107], v[88:91], a[56:59], v[104:107]
s_waitcnt vmcnt(28)
s_barrier
v_mfma_f32_16x16x32_bf16 v[108:111], v[92:95], a[56:59], v[108:111]
buffer_load_dwordx4 v15, s[12:15], s61 offen offset:1024 lds
v_mfma_f32_16x16x32_bf16 v[124:127], v[92:95], a[60:63], v[124:127]
ds_read_b64_tr_b16 v[84:85], v57 offset:20480
ds_read_b64_tr_b16 v[86:87], v57 offset:21504
v_mfma_f32_16x16x32_bf16 v[144:147], v[64:67], a[52:55], v[144:147]
s_add_u32 m0, s3, 16384
s_add_u32 s61, s65, 3096576
v_mfma_f32_16x16x32_bf16 v[128:131], v[64:67], a[48:51], v[128:131]
buffer_load_dwordx4 v14, s[12:15], s61 offen lds
s_waitcnt lgkmcnt(8)
v_mfma_f32_16x16x32_bf16 v[132:135], v[68:71], a[48:51], v[132:135]
ds_read_b64_tr_b16 v[88:89], v60 offset:20480
ds_read_b64_tr_b16 v[90:91], v60 offset:21504
v_mfma_f32_16x16x32_bf16 v[148:151], v[68:71], a[52:55], v[148:151]
s_waitcnt lgkmcnt(6)
ds_read_b64_tr_b16 v[92:93], v63 offset:20480
v_mfma_f32_16x16x32_bf16 v[152:155], v[72:75], a[52:55], v[152:155]
ds_read_b64_tr_b16 v[94:95], v63 offset:21504
v_mfma_f32_16x16x32_bf16 v[136:139], v[72:75], a[48:51], v[136:139]
buffer_load_dwordx4 v15, s[12:15], s61 offen offset:1024 lds
v_mfma_f32_16x16x32_bf16 v[140:143], v[76:79], a[48:51], v[140:143]
ds_read_b64_tr_b16 v[64:65], v53 offset:32768
ds_read_b64_tr_b16 v[66:67], v53 offset:33792
v_mfma_f32_16x16x32_bf16 v[156:159], v[76:79], a[52:55], v[156:159]
ds_read_b64_tr_b16 v[68:69], v56 offset:32768
ds_read_b64_tr_b16 v[70:71], v56 offset:33792
s_waitcnt lgkmcnt(10)
v_mfma_f32_16x16x32_bf16 v[144:147], v[80:83], a[60:63], v[144:147]
s_waitcnt lgkmcnt(6)
s_add_u32 m0, s3, 49152
s_add_u32 s61, s65, 3096704
v_mfma_f32_16x16x32_bf16 v[128:131], v[80:83], a[56:59], v[128:131]
buffer_load_dwordx4 v14, s[12:15], s61 offen lds
v_mfma_f32_16x16x32_bf16 v[132:135], v[84:87], a[56:59], v[132:135]
ds_read_b64_tr_b16 v[72:73], v59 offset:32768
ds_read_b64_tr_b16 v[74:75], v59 offset:33792
v_mfma_f32_16x16x32_bf16 v[148:151], v[84:87], a[60:63], v[148:151]
ds_read_b64_tr_b16 v[76:77], v62 offset:32768
ds_read_b64_tr_b16 v[78:79], v62 offset:33792
v_mfma_f32_16x16x32_bf16 v[152:155], v[88:91], a[60:63], v[152:155]
buffer_load_dwordx4 v15, s[12:15], s61 offen offset:1024 lds
v_mfma_f32_16x16x32_bf16 v[136:139], v[88:91], a[56:59], v[136:139]
ds_read_b64_tr_b16 v[80:81], v53 offset:36864
ds_read_b64_tr_b16 v[82:83], v53 offset:37888
s_waitcnt lgkmcnt(10)
v_mfma_f32_16x16x32_bf16 v[140:143], v[92:95], a[56:59], v[140:143]
s_waitcnt lgkmcnt(6)
ds_read_b64_tr_b16 v[84:85], v56 offset:36864
v_mfma_f32_16x16x32_bf16 v[156:159], v[92:95], a[60:63], v[156:159]
ds_read_b64_tr_b16 v[86:87], v56 offset:37888
s_waitcnt vmcnt(31)
v_mfma_f32_16x16x32_bf16 v[112:115], v[64:67], a[68:71], v[112:115]
s_add_u32 m0, s3, 90112
s_add_u32 s61, s40, 3096576
v_mfma_f32_16x16x32_bf16 v[96:99], v[64:67], a[64:67], v[96:99]
buffer_load_dwordx4 v14, s[12:15], s61 offen lds
v_mfma_f32_16x16x32_bf16 v[100:103], v[68:71], a[64:67], v[100:103]
ds_read_b64_tr_b16 v[88:89], v59 offset:36864
ds_read_b64_tr_b16 v[90:91], v59 offset:37888
v_mfma_f32_16x16x32_bf16 v[116:119], v[68:71], a[68:71], v[116:119]
ds_read_b64_tr_b16 v[92:93], v62 offset:36864
ds_read_b64_tr_b16 v[94:95], v62 offset:37888
s_waitcnt lgkmcnt(10)
v_mfma_f32_16x16x32_bf16 v[120:123], v[72:75], a[68:71], v[120:123]
s_waitcnt lgkmcnt(6)
v_mfma_f32_16x16x32_bf16 v[104:107], v[72:75], a[64:67], v[104:107]
buffer_load_dwordx4 v15, s[12:15], s61 offen offset:1024 lds
v_mfma_f32_16x16x32_bf16 v[108:111], v[76:79], a[64:67], v[108:111]
ds_read_b64_tr_b16 v[64:65], v53 offset:0
ds_read_b64_tr_b16 v[66:67], v53 offset:1024
v_mfma_f32_16x16x32_bf16 v[124:127], v[76:79], a[68:71], v[124:127]
ds_read_b64_tr_b16 v[68:69], v56 offset:0
ds_read_b64_tr_b16 v[70:71], v56 offset:1024
s_waitcnt vmcnt(31)
v_mfma_f32_16x16x32_bf16 v[112:115], v[80:83], a[76:79], v[112:115]
s_add_u32 m0, s3, 139264
s_add_u32 s61, s40, 3096704
v_mfma_f32_16x16x32_bf16 v[96:99], v[80:83], a[72:75], v[96:99]
buffer_load_dwordx4 v14, s[12:15], s61 offen lds
s_waitcnt lgkmcnt(8)
v_mfma_f32_16x16x32_bf16 v[100:103], v[84:87], a[72:75], v[100:103]
ds_read_b64_tr_b16 v[72:73], v59 offset:0
ds_read_b64_tr_b16 v[74:75], v59 offset:1024
v_mfma_f32_16x16x32_bf16 v[116:119], v[84:87], a[76:79], v[116:119]
s_waitcnt lgkmcnt(6)
ds_read_b64_tr_b16 v[76:77], v62 offset:0
v_mfma_f32_16x16x32_bf16 v[120:123], v[88:91], a[76:79], v[120:123]
ds_read_b64_tr_b16 v[78:79], v62 offset:1024
v_mfma_f32_16x16x32_bf16 v[104:107], v[88:91], a[72:75], v[104:107]
buffer_load_dwordx4 v15, s[12:15], s61 offen offset:1024 lds
v_mfma_f32_16x16x32_bf16 v[108:111], v[92:95], a[72:75], v[108:111]
ds_read_b64_tr_b16 v[80:81], v53 offset:4096
ds_read_b64_tr_b16 v[82:83], v53 offset:5120
v_mfma_f32_16x16x32_bf16 v[124:127], v[92:95], a[76:79], v[124:127]
ds_read_b64_tr_b16 v[84:85], v56 offset:4096
ds_read_b64_tr_b16 v[86:87], v56 offset:5120
s_waitcnt lgkmcnt(10)
v_mfma_f32_16x16x32_bf16 v[144:147], v[64:67], a[68:71], v[144:147]
s_waitcnt lgkmcnt(6)
ds_read_b64_tr_b16 v[88:89], v59 offset:4096
ds_read_b64_tr_b16 v[90:91], v59 offset:5120
v_mfma_f32_16x16x32_bf16 v[128:131], v[64:67], a[64:67], v[128:131]
s_add_u32 s63, s73, 64
s_load_dwordx8 s[52:59], s[16:17], s63 glc
v_mfma_f32_16x16x32_bf16 v[132:135], v[68:71], a[64:67], v[132:135]
s_add_u32 m0, s3, 106496
s_add_u32 s61, s64, 3317760
v_mfma_f32_16x16x32_bf16 v[148:151], v[68:71], a[68:71], v[148:151]
buffer_load_dwordx4 v14, s[12:15], s61 offen lds
v_mfma_f32_16x16x32_bf16 v[152:155], v[72:75], a[68:71], v[152:155]
ds_read_b64_tr_b16 v[92:93], v62 offset:4096
ds_read_b64_tr_b16 v[94:95], v62 offset:5120
v_mfma_f32_16x16x32_bf16 v[136:139], v[72:75], a[64:67], v[136:139]
buffer_load_dwordx4 v15, s[12:15], s61 offen offset:1024 lds
s_waitcnt lgkmcnt(8)
v_mfma_f32_16x16x32_bf16 v[140:143], v[76:79], a[64:67], v[140:143]
ds_read_b64_tr_b16 v[64:65], v53 offset:8192
ds_read_b64_tr_b16 v[66:67], v53 offset:9216
v_mfma_f32_16x16x32_bf16 v[156:159], v[76:79], a[68:71], v[156:159]
s_waitcnt lgkmcnt(6)
ds_read_b64_tr_b16 v[68:69], v56 offset:8192
v_mfma_f32_16x16x32_bf16 v[144:147], v[80:83], a[76:79], v[144:147]
ds_read_b64_tr_b16 v[70:71], v56 offset:9216
s_add_u32 m0, s3, 114688
s_add_u32 s61, s64, 3317888
v_mfma_f32_16x16x32_bf16 v[128:131], v[80:83], a[72:75], v[128:131]
buffer_load_dwordx4 v14, s[12:15], s61 offen lds
v_mfma_f32_16x16x32_bf16 v[132:135], v[84:87], a[72:75], v[132:135]
ds_read_b64_tr_b16 v[72:73], v59 offset:8192
ds_read_b64_tr_b16 v[74:75], v59 offset:9216
v_mfma_f32_16x16x32_bf16 v[148:151], v[84:87], a[76:79], v[148:151]
ds_read_b64_tr_b16 v[76:77], v62 offset:8192
ds_read_b64_tr_b16 v[78:79], v62 offset:9216
s_waitcnt lgkmcnt(10)
v_mfma_f32_16x16x32_bf16 v[152:155], v[88:91], a[76:79], v[152:155]
s_waitcnt lgkmcnt(6)
v_mfma_f32_16x16x32_bf16 v[136:139], v[88:91], a[72:75], v[136:139]
buffer_load_dwordx4 v15, s[12:15], s61 offen offset:1024 lds
v_mfma_f32_16x16x32_bf16 v[140:143], v[92:95], a[72:75], v[140:143]
ds_read_b64_tr_b16 v[80:81], v53 offset:12288
ds_read_b64_tr_b16 v[82:83], v53 offset:13312
v_mfma_f32_16x16x32_bf16 v[156:159], v[92:95], a[76:79], v[156:159]
ds_read_b64_tr_b16 v[84:85], v56 offset:12288
ds_read_b64_tr_b16 v[86:87], v56 offset:13312
s_waitcnt vmcnt(35)
v_mfma_f32_16x16x32_bf16 v[112:115], v[64:67], a[84:87], v[112:115]
s_add_u32 m0, s3, 122880
s_add_u32 s61, s65, 3317760
v_mfma_f32_16x16x32_bf16 v[96:99], v[64:67], a[80:83], v[96:99]
buffer_load_dwordx4 v14, s[12:15], s61 offen lds
s_waitcnt lgkmcnt(8)
v_mfma_f32_16x16x32_bf16 v[100:103], v[68:71], a[80:83], v[100:103]
ds_read_b64_tr_b16 v[88:89], v59 offset:12288
ds_read_b64_tr_b16 v[90:91], v59 offset:13312
v_mfma_f32_16x16x32_bf16 v[116:119], v[68:71], a[84:87], v[116:119]
s_waitcnt lgkmcnt(6)
ds_read_b64_tr_b16 v[92:93], v62 offset:12288
v_mfma_f32_16x16x32_bf16 v[120:123], v[72:75], a[84:87], v[120:123]
ds_read_b64_tr_b16 v[94:95], v62 offset:13312
v_mfma_f32_16x16x32_bf16 v[104:107], v[72:75], a[80:83], v[104:107]
buffer_load_dwordx4 v15, s[12:15], s61 offen offset:1024 lds
v_mfma_f32_16x16x32_bf16 v[108:111], v[76:79], a[80:83], v[108:111]
ds_read_b64_tr_b16 v[64:65], v52 offset:24576
ds_read_b64_tr_b16 v[66:67], v52 offset:25600
v_mfma_f32_16x16x32_bf16 v[124:127], v[76:79], a[84:87], v[124:127]
ds_read_b64_tr_b16 v[68:69], v55 offset:24576
ds_read_b64_tr_b16 v[70:71], v55 offset:25600
s_waitcnt vmcnt(35) lgkmcnt(10)
v_mfma_f32_16x16x32_bf16 v[112:115], v[80:83], a[92:95], v[112:115]
s_waitcnt lgkmcnt(6)
ds_read_b64_tr_b16 v[72:73], v58 offset:24576
v_mfma_f32_16x16x32_bf16 v[96:99], v[80:83], a[88:91], v[96:99]
ds_read_b64_tr_b16 v[74:75], v58 offset:25600
v_mfma_f32_16x16x32_bf16 v[100:103], v[84:87], a[88:91], v[100:103]
ds_read_b64_tr_b16 v[76:77], v61 offset:24576
ds_read_b64_tr_b16 v[78:79], v61 offset:25600
v_mfma_f32_16x16x32_bf16 v[116:119], v[84:87], a[92:95], v[116:119]
v_mfma_f32_16x16x32_bf16 v[120:123], v[88:91], a[92:95], v[120:123]
ds_read_b64_tr_b16 v[80:81], v52 offset:28672
ds_read_b64_tr_b16 v[82:83], v52 offset:29696
v_mfma_f32_16x16x32_bf16 v[104:107], v[88:91], a[88:91], v[104:107]
s_waitcnt lgkmcnt(6)
s_waitcnt vmcnt(27)
v_mfma_f32_16x16x32_bf16 v[108:111], v[92:95], a[88:91], v[108:111]
s_barrier
s_add_u32 m0, s3, 131072
s_add_u32 s61, s65, 3317888
v_mfma_f32_16x16x32_bf16 v[124:127], v[92:95], a[92:95], v[124:127]
buffer_load_dwordx4 v14, s[12:15], s61 offen lds
v_mfma_f32_16x16x32_bf16 v[144:147], v[64:67], a[84:87], v[144:147]
ds_read_b64_tr_b16 v[84:85], v55 offset:28672
ds_read_b64_tr_b16 v[86:87], v55 offset:29696
ds_read_b64_tr_b16 v[88:89], v58 offset:28672
v_mfma_f32_16x16x32_bf16 v[128:131], v[64:67], a[80:83], v[128:131]
ds_read_b64_tr_b16 v[90:91], v58 offset:29696
v_mfma_f32_16x16x32_bf16 v[132:135], v[68:71], a[80:83], v[132:135]
s_waitcnt vmcnt(22)
buffer_store_dword v13, v26, s[16:19], s60 offen offset:32 sc1
v_mfma_f32_16x16x32_bf16 v[148:151], v[68:71], a[84:87], v[148:151]
buffer_load_dwordx4 v15, s[12:15], s61 offen offset:1024 lds
s_waitcnt lgkmcnt(8)
v_mfma_f32_16x16x32_bf16 v[152:155], v[72:75], a[84:87], v[152:155]
ds_read_b64_tr_b16 v[92:93], v61 offset:28672
ds_read_b64_tr_b16 v[94:95], v61 offset:29696
s_waitcnt lgkmcnt(6)
ds_read_b64_tr_b16 v[64:65], v52 offset:40960
v_mfma_f32_16x16x32_bf16 v[136:139], v[72:75], a[80:83], v[136:139]
ds_read_b64_tr_b16 v[66:67], v52 offset:41984
v_mfma_f32_16x16x32_bf16 v[140:143], v[76:79], a[80:83], v[140:143]
s_waitcnt lgkmcnt(0)
s_xor_b64 s[52:53], s[52:53], s[42:43]
s_xor_b64 s[54:55], s[54:55], s[42:43]
s_or_b64 s[52:53], s[52:53], s[54:55]
s_xor_b64 s[56:57], s[56:57], s[42:43]
s_or_b64 s[52:53], s[52:53], s[56:57]
s_cbranch_scc1 fh3_slow
fh3_ok:
v_mfma_f32_16x16x32_bf16 v[156:159], v[76:79], a[84:87], v[156:159]
s_add_u32 s0, s83, 58368
v_mfma_f32_16x16x32_bf16 v[144:147], v[80:83], a[92:95], v[144:147]
buffer_load_dwordx4 a[128:131], v1, s[16:19], s0 offen offset:0 sc1
ds_read_b64_tr_b16 v[68:69], v55 offset:40960
v_mfma_f32_16x16x32_bf16 v[128:131], v[80:83], a[88:91], v[128:131]
ds_read_b64_tr_b16 v[70:71], v55 offset:41984
ds_read_b64_tr_b16 v[72:73], v58 offset:40960
v_mfma_f32_16x16x32_bf16 v[132:135], v[84:87], a[88:91], v[132:135]
ds_read_b64_tr_b16 v[74:75], v58 offset:41984
v_mfma_f32_16x16x32_bf16 v[148:151], v[84:87], a[92:95], v[148:151]
buffer_load_dwordx4 a[132:135], v1, s[16:19], s0 offen offset:1024 sc1
v_mfma_f32_16x16x32_bf16 v[152:155], v[88:91], a[92:95], v[152:155]
ds_read_b64_tr_b16 v[76:77], v61 offset:40960
ds_read_b64_tr_b16 v[78:79], v61 offset:41984
v_mfma_f32_16x16x32_bf16 v[136:139], v[88:91], a[88:91], v[136:139]
ds_read_b64_tr_b16 v[80:81], v52 offset:45056
ds_read_b64_tr_b16 v[82:83], v52 offset:46080
v_mfma_f32_16x16x32_bf16 v[140:143], v[92:95], a[88:91], v[140:143]
buffer_load_dwordx4 a[136:139], v1, s[16:19], s0 offen offset:2048 sc1
v_mfma_f32_16x16x32_bf16 v[156:159], v[92:95], a[92:95], v[156:159]
ds_read_b64_tr_b16 v[84:85], v55 offset:45056
ds_read_b64_tr_b16 v[86:87], v55 offset:46080
v_mfma_f32_16x16x32_bf16 v[112:115], v[64:67], a[100:103], v[112:115]
s_waitcnt lgkmcnt(6)
ds_read_b64_tr_b16 v[88:89], v58 offset:45056
v_mfma_f32_16x16x32_bf16 v[96:99], v[64:67], a[96:99], v[96:99]
ds_read_b64_tr_b16 v[90:91], v58 offset:46080
v_mfma_f32_16x16x32_bf16 v[100:103], v[68:71], a[96:99], v[100:103]
buffer_load_dwordx4 a[140:143], v1, s[16:19], s0 offen offset:3072 sc1
v_mfma_f32_16x16x32_bf16 v[116:119], v[68:71], a[100:103], v[116:119]
ds_read_b64_tr_b16 v[92:93], v61 offset:45056
ds_read_b64_tr_b16 v[94:95], v61 offset:46080
v_mfma_f32_16x16x32_bf16 v[120:123], v[72:75], a[100:103], v[120:123]
ds_read_b64_tr_b16 v[64:65], v52 offset:57344
ds_read_b64_tr_b16 v[66:67], v52 offset:58368
v_mfma_f32_16x16x32_bf16 v[104:107], v[72:75], a[96:99], v[104:107]
s_waitcnt lgkmcnt(6)
v_mfma_f32_16x16x32_bf16 v[108:111], v[76:79], a[96:99], v[108:111]
s_add_u32 s0, s86, 58368
v_mfma_f32_16x16x32_bf16 v[124:127], v[76:79], a[100:103], v[124:127]
buffer_load_dwordx4 a[144:147], v1, s[16:19], s0 offen offset:0 sc1
v_mfma_f32_16x16x32_bf16 v[112:115], v[80:83], a[108:111], v[112:115]
ds_read_b64_tr_b16 v[68:69], v55 offset:57344
ds_read_b64_tr_b16 v[70:71], v55 offset:58368
v_mfma_f32_16x16x32_bf16 v[96:99], v[80:83], a[104:107], v[96:99]
ds_read_b64_tr_b16 v[72:73], v58 offset:57344
ds_read_b64_tr_b16 v[74:75], v58 offset:58368
v_mfma_f32_16x16x32_bf16 v[100:103], v[84:87], a[104:107], v[100:103]
buffer_load_dwordx4 a[148:151], v1, s[16:19], s0 offen offset:1024 sc1
v_mfma_f32_16x16x32_bf16 v[116:119], v[84:87], a[108:111], v[116:119]
ds_read_b64_tr_b16 v[76:77], v61 offset:57344
ds_read_b64_tr_b16 v[78:79], v61 offset:58368
s_waitcnt lgkmcnt(10)
v_mfma_f32_16x16x32_bf16 v[120:123], v[88:91], a[108:111], v[120:123]
s_waitcnt lgkmcnt(6)
ds_read_b64_tr_b16 v[80:81], v52 offset:61440
v_mfma_f32_16x16x32_bf16 v[104:107], v[88:91], a[104:107], v[104:107]
ds_read_b64_tr_b16 v[82:83], v52 offset:62464
v_mfma_f32_16x16x32_bf16 v[108:111], v[92:95], a[104:107], v[108:111]
buffer_load_dwordx4 a[152:155], v1, s[16:19], s0 offen offset:2048 sc1
v_mfma_f32_16x16x32_bf16 v[124:127], v[92:95], a[108:111], v[124:127]
ds_read_b64_tr_b16 v[84:85], v55 offset:61440
ds_read_b64_tr_b16 v[86:87], v55 offset:62464
v_mfma_f32_16x16x32_bf16 v[144:147], v[64:67], a[100:103], v[144:147]
ds_read_b64_tr_b16 v[88:89], v58 offset:61440
ds_read_b64_tr_b16 v[90:91], v58 offset:62464
v_mfma_f32_16x16x32_bf16 v[128:131], v[64:67], a[96:99], v[128:131]
s_waitcnt lgkmcnt(6)
v_mfma_f32_16x16x32_bf16 v[132:135], v[68:71], a[96:99], v[132:135]
buffer_load_dwordx4 a[156:159], v1, s[16:19], s0 offen offset:3072 sc1
v_mfma_f32_16x16x32_bf16 v[148:151], v[68:71], a[100:103], v[148:151]
ds_read_b64_tr_b16 v[92:93], v61 offset:61440
ds_read_b64_tr_b16 v[94:95], v61 offset:62464
v_mfma_f32_16x16x32_bf16 v[152:155], v[72:75], a[100:103], v[152:155]
ds_read_b64_tr_b16 v[64:65], v53 offset:16384
ds_read_b64_tr_b16 v[66:67], v53 offset:17408
v_mfma_f32_16x16x32_bf16 v[136:139], v[72:75], a[96:99], v[136:139]
v_mfma_f32_16x16x32_bf16 v[140:143], v[76:79], a[96:99], v[140:143]
s_add_u32 s0, s87, 58368
v_mfma_f32_16x16x32_bf16 v[156:159], v[76:79], a[100:103], v[156:159]
buffer_load_dwordx4 a[160:163], v1, s[16:19], s0 offen offset:0 sc1
s_waitcnt lgkmcnt(8)
v_mfma_f32_16x16x32_bf16 v[144:147], v[80:83], a[108:111], v[144:147]
ds_read_b64_tr_b16 v[68:69], v56 offset:16384
ds_read_b64_tr_b16 v[70:71], v56 offset:17408
v_mfma_f32_16x16x32_bf16 v[128:131], v[80:83], a[104:107], v[128:131]
s_waitcnt lgkmcnt(6)
ds_read_b64_tr_b16 v[72:73], v59 offset:16384
v_mfma_f32_16x16x32_bf16 v[132:135], v[84:87], a[104:107], v[132:135]
ds_read_b64_tr_b16 v[74:75], v59 offset:17408
v_mfma_f32_16x16x32_bf16 v[148:151], v[84:87], a[108:111], v[148:151]
buffer_load_dwordx4 a[164:167], v1, s[16:19], s0 offen offset:1024 sc1
v_mfma_f32_16x16x32_bf16 v[152:155], v[88:91], a[108:111], v[152:155]
ds_read_b64_tr_b16 v[76:77], v62 offset:16384
ds_read_b64_tr_b16 v[78:79], v62 offset:17408
v_mfma_f32_16x16x32_bf16 v[136:139], v[88:91], a[104:107], v[136:139]
ds_read_b64_tr_b16 v[80:81], v53 offset:20480
ds_read_b64_tr_b16 v[82:83], v53 offset:21504
s_waitcnt lgkmcnt(10)
v_mfma_f32_16x16x32_bf16 v[140:143], v[92:95], a[104:107], v[140:143]
s_waitcnt lgkmcnt(6)
v_mfma_f32_16x16x32_bf16 v[156:159], v[92:95], a[108:111], v[156:159]
buffer_load_dwordx4 a[168:171], v1, s[16:19], s0 offen offset:2048 sc1
s_waitcnt vmcnt(34)
v_mfma_f32_16x16x32_bf16 v[112:115], v[64:67], a[116:119], v[112:115]
ds_read_b64_tr_b16 v[84:85], v56 offset:20480
ds_read_b64_tr_b16 v[86:87], v56 offset:21504
L_stub13:
s_cbranch_execz L_stub17
v_mfma_f32_16x16x32_bf16 v[96:99], v[64:67], a[112:115], v[96:99]
ds_read_b64_tr_b16 v[88:89], v59 offset:20480
ds_read_b64_tr_b16 v[90:91], v59 offset:21504
v_mfma_f32_16x16x32_bf16 v[100:103], v[68:71], a[112:115], v[100:103]
buffer_load_dwordx4 a[172:175], v1, s[16:19], s0 offen offset:3072 sc1
v_mfma_f32_16x16x32_bf16 v[116:119], v[68:71], a[116:119], v[116:119]
ds_read_b64_tr_b16 v[92:93], v62 offset:20480
ds_read_b64_tr_b16 v[94:95], v62 offset:21504
s_waitcnt lgkmcnt(10)
v_mfma_f32_16x16x32_bf16 v[120:123], v[72:75], a[116:119], v[120:123]
s_waitcnt lgkmcnt(6)
ds_read_b64_tr_b16 v[64:65], v52 offset:32768
v_mfma_f32_16x16x32_bf16 v[104:107], v[72:75], a[112:115], v[104:107]
ds_read_b64_tr_b16 v[66:67], v52 offset:33792
v_mfma_f32_16x16x32_bf16 v[108:111], v[76:79], a[112:115], v[108:111]
s_add_u32 s0, s83, 72960
v_mfma_f32_16x16x32_bf16 v[124:127], v[76:79], a[116:119], v[124:127]
buffer_load_dwordx4 a[176:179], v1, s[16:19], s0 offen offset:0 sc1
s_waitcnt vmcnt(34)
v_mfma_f32_16x16x32_bf16 v[112:115], v[80:83], a[124:127], v[112:115]
ds_read_b64_tr_b16 v[68:69], v55 offset:32768
ds_read_b64_tr_b16 v[70:71], v55 offset:33792
v_mfma_f32_16x16x32_bf16 v[96:99], v[80:83], a[120:123], v[96:99]
ds_read_b64_tr_b16 v[72:73], v58 offset:32768
ds_read_b64_tr_b16 v[74:75], v58 offset:33792
s_waitcnt lgkmcnt(10)
v_mfma_f32_16x16x32_bf16 v[100:103], v[84:87], a[120:123], v[100:103]
s_waitcnt lgkmcnt(6)
v_mfma_f32_16x16x32_bf16 v[116:119], v[84:87], a[124:127], v[116:119]
buffer_load_dwordx4 a[180:183], v1, s[16:19], s0 offen offset:1024 sc1
v_mfma_f32_16x16x32_bf16 v[120:123], v[88:91], a[124:127], v[120:123]
ds_read_b64_tr_b16 v[76:77], v61 offset:32768
ds_read_b64_tr_b16 v[78:79], v61 offset:33792
v_mfma_f32_16x16x32_bf16 v[104:107], v[88:91], a[120:123], v[104:107]
ds_read_b64_tr_b16 v[80:81], v52 offset:36864
ds_read_b64_tr_b16 v[82:83], v52 offset:37888
v_mfma_f32_16x16x32_bf16 v[108:111], v[92:95], a[120:123], v[108:111]
s_waitcnt vmcnt(27)
s_barrier
v_mfma_f32_16x16x32_bf16 v[124:127], v[92:95], a[124:127], v[124:127]
buffer_load_dwordx4 a[184:187], v1, s[16:19], s0 offen offset:2048 sc1
s_waitcnt lgkmcnt(8)
v_mfma_f32_16x16x32_bf16 v[144:147], v[64:67], a[116:119], v[144:147]
ds_read_b64_tr_b16 v[84:85], v55 offset:36864
ds_read_b64_tr_b16 v[86:87], v55 offset:37888
v_mfma_f32_16x16x32_bf16 v[128:131], v[64:67], a[112:115], v[128:131]
s_waitcnt lgkmcnt(6)
ds_read_b64_tr_b16 v[88:89], v58 offset:36864
v_mfma_f32_16x16x32_bf16 v[132:135], v[68:71], a[112:115], v[132:135]
ds_read_b64_tr_b16 v[90:91], v58 offset:37888
v_mfma_f32_16x16x32_bf16 v[148:151], v[68:71], a[116:119], v[148:151]
buffer_load_dwordx4 a[188:191], v1, s[16:19], s0 offen offset:3072 sc1
v_mfma_f32_16x16x32_bf16 v[152:155], v[72:75], a[116:119], v[152:155]
ds_read_b64_tr_b16 v[92:93], v61 offset:36864
ds_read_b64_tr_b16 v[94:95], v61 offset:37888
v_mfma_f32_16x16x32_bf16 v[136:139], v[72:75], a[112:115], v[136:139]
ds_read_b64_tr_b16 v[64:65], v52 offset:0
ds_read_b64_tr_b16 v[66:67], v52 offset:1024
s_waitcnt lgkmcnt(10)
v_mfma_f32_16x16x32_bf16 v[140:143], v[76:79], a[112:115], v[140:143]
s_waitcnt lgkmcnt(6)
s_add_u32 m0, s3, 147456
s_add_u32 s61, s40, 3317760
v_mfma_f32_16x16x32_bf16 v[156:159], v[76:79], a[116:119], v[156:159]
buffer_load_dwordx4 v14, s[12:15], s61 offen lds
v_mfma_f32_16x16x32_bf16 v[144:147], v[80:83], a[124:127], v[144:147]
ds_read_b64_tr_b16 v[68:69], v55 offset:0
ds_read_b64_tr_b16 v[70:71], v55 offset:1024
v_mfma_f32_16x16x32_bf16 v[128:131], v[80:83], a[120:123], v[128:131]
ds_read_b64_tr_b16 v[72:73], v58 offset:0
ds_read_b64_tr_b16 v[74:75], v58 offset:1024
v_mfma_f32_16x16x32_bf16 v[132:135], v[84:87], a[120:123], v[132:135]
buffer_load_dwordx4 v15, s[12:15], s61 offen offset:1024 lds
v_mfma_f32_16x16x32_bf16 v[148:151], v[84:87], a[124:127], v[148:151]
ds_read_b64_tr_b16 v[76:77], v61 offset:0
ds_read_b64_tr_b16 v[78:79], v61 offset:1024
s_waitcnt lgkmcnt(10)
v_mfma_f32_16x16x32_bf16 v[152:155], v[88:91], a[124:127], v[152:155]
s_waitcnt lgkmcnt(6)
ds_read_b64_tr_b16 v[80:81], v52 offset:4096
v_mfma_f32_16x16x32_bf16 v[136:139], v[88:91], a[120:123], v[136:139]
ds_read_b64_tr_b16 v[82:83], v52 offset:5120
v_mfma_f32_16x16x32_bf16 v[140:143], v[92:95], a[120:123], v[140:143]
s_add_u32 m0, s3, 98304
s_add_u32 s61, s40, 3317888
v_mfma_f32_16x16x32_bf16 v[156:159], v[92:95], a[124:127], v[156:159]
buffer_load_dwordx4 v14, s[12:15], s61 offen lds
s_waitcnt vmcnt(17)
v_mfma_f32_16x16x32_bf16 v[112:115], v[64:67], a[132:135], v[112:115]
ds_read_b64_tr_b16 v[84:85], v55 offset:4096
ds_read_b64_tr_b16 v[86:87], v55 offset:5120
v_mfma_f32_16x16x32_bf16 v[96:99], v[64:67], a[128:131], v[96:99]
ds_read_b64_tr_b16 v[88:89], v58 offset:4096
ds_read_b64_tr_b16 v[90:91], v58 offset:5120
s_waitcnt lgkmcnt(10)
v_mfma_f32_16x16x32_bf16 v[100:103], v[68:71], a[128:131], v[100:103]
s_waitcnt lgkmcnt(6)
v_mfma_f32_16x16x32_bf16 v[116:119], v[68:71], a[132:135], v[116:119]
buffer_load_dwordx4 v15, s[12:15], s61 offen offset:1024 lds
v_mfma_f32_16x16x32_bf16 v[120:123], v[72:75], a[132:135], v[120:123]
ds_read_b64_tr_b16 v[92:93], v61 offset:4096
ds_read_b64_tr_b16 v[94:95], v61 offset:5120
v_mfma_f32_16x16x32_bf16 v[104:107], v[72:75], a[128:131], v[104:107]
ds_read_b64_tr_b16 v[64:65], v52 offset:8192
ds_read_b64_tr_b16 v[66:67], v52 offset:9216
v_mfma_f32_16x16x32_bf16 v[108:111], v[76:79], a[128:131], v[108:111]
s_add_u32 s0, s86, 72960
v_mfma_f32_16x16x32_bf16 v[124:127], v[76:79], a[132:135], v[124:127]
buffer_load_dwordx4 a[192:195], v1, s[16:19], s0 offen offset:0 sc1
s_waitcnt vmcnt(17) lgkmcnt(8)
v_mfma_f32_16x16x32_bf16 v[112:115], v[80:83], a[140:143], v[112:115]
ds_read_b64_tr_b16 v[68:69], v55 offset:8192
ds_read_b64_tr_b16 v[70:71], v55 offset:9216
s_waitcnt lgkmcnt(6)
v_mfma_f32_16x16x32_bf16 v[96:99], v[80:83], a[136:139], v[96:99]
ds_read_b64_tr_b16 v[72:73], v58 offset:8192
ds_read_b64_tr_b16 v[74:75], v58 offset:9216
v_mfma_f32_16x16x32_bf16 v[100:103], v[84:87], a[136:139], v[100:103]
s_add_u32 s63, s73, 32
s_load_dwordx8 s[52:59], s[16:17], s63 glc
v_mfma_f32_16x16x32_bf16 v[116:119], v[84:87], a[140:143], v[116:119]
buffer_load_dwordx4 a[196:199], v1, s[16:19], s0 offen offset:1024 sc1
v_mfma_f32_16x16x32_bf16 v[120:123], v[88:91], a[140:143], v[120:123]
ds_read_b64_tr_b16 v[76:77], v61 offset:8192
ds_read_b64_tr_b16 v[78:79], v61 offset:9216
v_mfma_f32_16x16x32_bf16 v[104:107], v[88:91], a[136:139], v[104:107]
ds_read_b64_tr_b16 v[80:81], v52 offset:12288
ds_read_b64_tr_b16 v[82:83], v52 offset:13312
s_waitcnt lgkmcnt(10)
v_mfma_f32_16x16x32_bf16 v[108:111], v[92:95], a[136:139], v[108:111]
s_waitcnt lgkmcnt(6)
v_mfma_f32_16x16x32_bf16 v[124:127], v[92:95], a[140:143], v[124:127]
buffer_load_dwordx4 a[200:203], v1, s[16:19], s0 offen offset:2048 sc1
v_mfma_f32_16x16x32_bf16 v[144:147], v[64:67], a[132:135], v[144:147]
ds_read_b64_tr_b16 v[84:85], v55 offset:12288
ds_read_b64_tr_b16 v[86:87], v55 offset:13312
v_mfma_f32_16x16x32_bf16 v[128:131], v[64:67], a[128:131], v[128:131]
ds_read_b64_tr_b16 v[88:89], v58 offset:12288
ds_read_b64_tr_b16 v[90:91], v58 offset:13312
v_mfma_f32_16x16x32_bf16 v[132:135], v[68:71], a[128:131], v[132:135]
buffer_load_dwordx4 a[204:207], v1, s[16:19], s0 offen offset:3072 sc1
v_mfma_f32_16x16x32_bf16 v[148:151], v[68:71], a[132:135], v[148:151]
ds_read_b64_tr_b16 v[92:93], v61 offset:12288
ds_read_b64_tr_b16 v[94:95], v61 offset:13312
s_waitcnt lgkmcnt(10)
v_mfma_f32_16x16x32_bf16 v[152:155], v[72:75], a[132:135], v[152:155]
s_waitcnt lgkmcnt(6)
ds_read_b64_tr_b16 v[64:65], v52 offset:16384
v_mfma_f32_16x16x32_bf16 v[136:139], v[72:75], a[128:131], v[136:139]
ds_read_b64_tr_b16 v[66:67], v52 offset:17408
v_mfma_f32_16x16x32_bf16 v[140:143], v[76:79], a[128:131], v[140:143]
s_add_u32 s0, s87, 72960
v_mfma_f32_16x16x32_bf16 v[156:159], v[76:79], a[132:135], v[156:159]
buffer_load_dwordx4 a[208:211], v1, s[16:19], s0 offen offset:0 sc1
v_mfma_f32_16x16x32_bf16 v[144:147], v[80:83], a[140:143], v[144:147]
ds_read_b64_tr_b16 v[68:69], v55 offset:16384
ds_read_b64_tr_b16 v[70:71], v55 offset:17408
v_mfma_f32_16x16x32_bf16 v[128:131], v[80:83], a[136:139], v[128:131]
ds_read_b64_tr_b16 v[72:73], v58 offset:16384
ds_read_b64_tr_b16 v[74:75], v58 offset:17408
s_waitcnt lgkmcnt(10)
v_mfma_f32_16x16x32_bf16 v[132:135], v[84:87], a[136:139], v[132:135]
s_waitcnt lgkmcnt(6)
v_mfma_f32_16x16x32_bf16 v[148:151], v[84:87], a[140:143], v[148:151]
buffer_load_dwordx4 a[212:215], v1, s[16:19], s0 offen offset:1024 sc1
v_mfma_f32_16x16x32_bf16 v[152:155], v[88:91], a[140:143], v[152:155]
ds_read_b64_tr_b16 v[76:77], v61 offset:16384
ds_read_b64_tr_b16 v[78:79], v61 offset:17408
v_mfma_f32_16x16x32_bf16 v[136:139], v[88:91], a[136:139], v[136:139]
ds_read_b64_tr_b16 v[80:81], v52 offset:20480
ds_read_b64_tr_b16 v[82:83], v52 offset:21504
v_mfma_f32_16x16x32_bf16 v[140:143], v[92:95], a[136:139], v[140:143]
buffer_load_dwordx4 a[216:219], v1, s[16:19], s0 offen offset:2048 sc1
v_mfma_f32_16x16x32_bf16 v[156:159], v[92:95], a[140:143], v[156:159]
ds_read_b64_tr_b16 v[84:85], v55 offset:20480
ds_read_b64_tr_b16 v[86:87], v55 offset:21504
s_waitcnt vmcnt(21) lgkmcnt(10)
v_mfma_f32_16x16x32_bf16 v[112:115], v[64:67], a[148:151], v[112:115]
s_waitcnt lgkmcnt(6)
ds_read_b64_tr_b16 v[88:89], v58 offset:20480
v_mfma_f32_16x16x32_bf16 v[96:99], v[64:67], a[144:147], v[96:99]
ds_read_b64_tr_b16 v[90:91], v58 offset:21504
v_mfma_f32_16x16x32_bf16 v[100:103], v[68:71], a[144:147], v[100:103]
buffer_load_dwordx4 a[220:223], v1, s[16:19], s0 offen offset:3072 sc1
v_mfma_f32_16x16x32_bf16 v[116:119], v[68:71], a[148:151], v[116:119]
ds_read_b64_tr_b16 v[92:93], v61 offset:20480
ds_read_b64_tr_b16 v[94:95], v61 offset:21504
v_mfma_f32_16x16x32_bf16 v[120:123], v[72:75], a[148:151], v[120:123]
ds_read_b64_tr_b16 v[64:65], v52 offset:49152
ds_read_b64_tr_b16 v[66:67], v52 offset:50176
v_mfma_f32_16x16x32_bf16 v[104:107], v[72:75], a[144:147], v[104:107]
s_waitcnt lgkmcnt(6)
v_mfma_f32_16x16x32_bf16 v[108:111], v[76:79], a[144:147], v[108:111]
s_add_u32 m0, s3, 65536
s_mov_b32 s61, s74
v_mfma_f32_16x16x32_bf16 v[124:127], v[76:79], a[148:151], v[124:127]
buffer_load_dwordx4 v18, s[36:39], s61 offen lds
s_waitcnt vmcnt(21)
v_mfma_f32_16x16x32_bf16 v[112:115], v[80:83], a[156:159], v[112:115]
ds_read_b64_tr_b16 v[68:69], v55 offset:49152
ds_read_b64_tr_b16 v[70:71], v55 offset:50176
v_mfma_f32_16x16x32_bf16 v[96:99], v[80:83], a[152:155], v[96:99]
ds_read_b64_tr_b16 v[72:73], v58 offset:49152
ds_read_b64_tr_b16 v[74:75], v58 offset:50176
v_mfma_f32_16x16x32_bf16 v[100:103], v[84:87], a[152:155], v[100:103]
buffer_load_dwordx4 v19, s[36:39], s61 offen offset:1024 lds
v_mfma_f32_16x16x32_bf16 v[116:119], v[84:87], a[156:159], v[116:119]
ds_read_b64_tr_b16 v[76:77], v61 offset:49152
ds_read_b64_tr_b16 v[78:79], v61 offset:50176
s_waitcnt lgkmcnt(10)
v_mfma_f32_16x16x32_bf16 v[120:123], v[88:91], a[156:159], v[120:123]
s_waitcnt lgkmcnt(6)
ds_read_b64_tr_b16 v[80:81], v52 offset:53248
ds_read_b64_tr_b16 v[82:83], v52 offset:54272
v_mfma_f32_16x16x32_bf16 v[104:107], v[88:91], a[152:155], v[104:107]
s_barrier
v_mfma_f32_16x16x32_bf16 v[108:111], v[92:95], a[152:155], v[108:111]
s_waitcnt lgkmcnt(0)
s_xor_b64 s[52:53], s[52:53], s[42:43]
s_xor_b64 s[54:55], s[54:55], s[42:43]
s_or_b64 s[52:53], s[52:53], s[54:55]
s_xor_b64 s[56:57], s[56:57], s[42:43]
s_or_b64 s[52:53], s[52:53], s[56:57]
s_cbranch_scc1 fh4_slow
fh4_ok:
v_mfma_f32_16x16x32_bf16 v[124:127], v[92:95], a[156:159], v[124:127]
s_add_u32 m0, s3, 73728
s_mov_b32 s61, s75
v_mfma_f32_16x16x32_bf16 v[144:147], v[64:67], a[148:151], v[144:147]
buffer_load_dwordx4 v18, s[24:27], s61 offen lds
ds_read_b64_tr_b16 v[84:85], v55 offset:53248
v_mfma_f32_16x16x32_bf16 v[128:131], v[64:67], a[144:147], v[128:131]
ds_read_b64_tr_b16 v[86:87], v55 offset:54272
ds_read_b64_tr_b16 v[88:89], v58 offset:53248
v_mfma_f32_16x16x32_bf16 v[132:135], v[68:71], a[144:147], v[132:135]
ds_read_b64_tr_b16 v[90:91], v58 offset:54272
v_mfma_f32_16x16x32_bf16 v[148:151], v[68:71], a[148:151], v[148:151]
buffer_load_dwordx4 v19, s[24:27], s61 offen offset:1024 lds
v_mfma_f32_16x16x32_bf16 v[152:155], v[72:75], a[148:151], v[152:155]
ds_read_b64_tr_b16 v[92:93], v61 offset:53248
ds_read_b64_tr_b16 v[94:95], v61 offset:54272
v_mfma_f32_16x16x32_bf16 v[136:139], v[72:75], a[144:147], v[136:139]
ds_read_b64_tr_b16 v[64:65], v53 offset:24576
ds_read_b64_tr_b16 v[66:67], v53 offset:25600
v_mfma_f32_16x16x32_bf16 v[140:143], v[76:79], a[144:147], v[140:143]
s_add_u32 m0, s3, 24576
s_add_u32 s61, s77, 0
v_mfma_f32_16x16x32_bf16 v[156:159], v[76:79], a[148:151], v[156:159]
buffer_load_dwordx4 v16, s[28:31], s61 offen lds
v_mfma_f32_16x16x32_bf16 v[144:147], v[80:83], a[156:159], v[144:147]
ds_read_b64_tr_b16 v[68:69], v56 offset:24576
ds_read_b64_tr_b16 v[70:71], v56 offset:25600
v_mfma_f32_16x16x32_bf16 v[128:131], v[80:83], a[152:155], v[128:131]
s_waitcnt lgkmcnt(6)
ds_read_b64_tr_b16 v[72:73], v59 offset:24576
v_mfma_f32_16x16x32_bf16 v[132:135], v[84:87], a[152:155], v[132:135]
ds_read_b64_tr_b16 v[74:75], v59 offset:25600
v_mfma_f32_16x16x32_bf16 v[148:151], v[84:87], a[156:159], v[148:151]
buffer_load_dwordx4 v17, s[28:31], s61 offen offset:1024 lds
v_mfma_f32_16x16x32_bf16 v[152:155], v[88:91], a[156:159], v[152:155]
ds_read_b64_tr_b16 v[76:77], v62 offset:24576
ds_read_b64_tr_b16 v[78:79], v62 offset:25600
v_mfma_f32_16x16x32_bf16 v[136:139], v[88:91], a[152:155], v[136:139]
ds_read_b64_tr_b16 v[80:81], v53 offset:28672
ds_read_b64_tr_b16 v[82:83], v53 offset:29696
s_waitcnt lgkmcnt(10)
v_mfma_f32_16x16x32_bf16 v[140:143], v[92:95], a[152:155], v[140:143]
s_waitcnt lgkmcnt(6)
s_add_u32 m0, s3, 40960
s_add_u32 s61, s77, 0
v_mfma_f32_16x16x32_bf16 v[156:159], v[92:95], a[156:159], v[156:159]
buffer_load_dwordx4 v16, s[32:35], s61 offen lds
s_waitcnt vmcnt(25)
v_mfma_f32_16x16x32_bf16 v[112:115], v[64:67], a[164:167], v[112:115]
ds_read_b64_tr_b16 v[84:85], v56 offset:28672
ds_read_b64_tr_b16 v[86:87], v56 offset:29696
v_mfma_f32_16x16x32_bf16 v[96:99], v[64:67], a[160:163], v[96:99]
ds_read_b64_tr_b16 v[88:89], v59 offset:28672
ds_read_b64_tr_b16 v[90:91], v59 offset:29696
v_mfma_f32_16x16x32_bf16 v[100:103], v[68:71], a[160:163], v[100:103]
buffer_load_dwordx4 v17, s[32:35], s61 offen offset:1024 lds
v_mfma_f32_16x16x32_bf16 v[116:119], v[68:71], a[164:167], v[116:119]
ds_read_b64_tr_b16 v[92:93], v62 offset:28672
ds_read_b64_tr_b16 v[94:95], v62 offset:29696
s_waitcnt lgkmcnt(10)
v_mfma_f32_16x16x32_bf16 v[120:123], v[72:75], a[164:167], v[120:123]
s_waitcnt lgkmcnt(6)
ds_read_b64_tr_b16 v[64:65], v54 offset:8192
v_mfma_f32_16x16x32_bf16 v[104:107], v[72:75], a[160:163], v[104:107]
ds_read_b64_tr_b16 v[66:67], v54 offset:9216
v_mfma_f32_16x16x32_bf16 v[108:111], v[76:79], a[160:163], v[108:111]
s_add_u32 s0, s72, 38912
v_mfma_f32_16x16x32_bf16 v[124:127], v[76:79], a[164:167], v[124:127]
buffer_load_dwordx4 a[224:227], v1, s[16:19], s0 offen offset:0 sc1
s_waitcnt vmcnt(25)
v_mfma_f32_16x16x32_bf16 v[112:115], v[80:83], a[172:175], v[112:115]
ds_read_b64_tr_b16 v[68:69], v57 offset:8192
ds_read_b64_tr_b16 v[70:71], v57 offset:9216
v_mfma_f32_16x16x32_bf16 v[96:99], v[80:83], a[168:171], v[96:99]
ds_read_b64_tr_b16 v[72:73], v60 offset:8192
ds_read_b64_tr_b16 v[74:75], v60 offset:9216
s_waitcnt lgkmcnt(10)
v_mfma_f32_16x16x32_bf16 v[100:103], v[84:87], a[168:171], v[100:103]
s_waitcnt lgkmcnt(6)
v_mfma_f32_16x16x32_bf16 v[116:119], v[84:87], a[172:175], v[116:119]
buffer_load_dwordx4 a[228:231], v1, s[16:19], s0 offen offset:1024 sc1
v_mfma_f32_16x16x32_bf16 v[120:123], v[88:91], a[172:175], v[120:123]
ds_read_b64_tr_b16 v[76:77], v63 offset:8192
ds_read_b64_tr_b16 v[78:79], v63 offset:9216
v_mfma_f32_16x16x32_bf16 v[104:107], v[88:91], a[168:171], v[104:107]
ds_read_b64_tr_b16 v[80:81], v54 offset:12288
ds_read_b64_tr_b16 v[82:83], v54 offset:13312
v_mfma_f32_16x16x32_bf16 v[108:111], v[92:95], a[168:171], v[108:111]
buffer_load_dwordx4 a[232:235], v1, s[16:19], s0 offen offset:2048 sc1
v_mfma_f32_16x16x32_bf16 v[124:127], v[92:95], a[172:175], v[124:127]
ds_read_b64_tr_b16 v[84:85], v57 offset:12288
ds_read_b64_tr_b16 v[86:87], v57 offset:13312
s_waitcnt lgkmcnt(10)
v_mfma_f32_16x16x32_bf16 v[144:147], v[64:67], a[164:167], v[144:147]
s_waitcnt lgkmcnt(6)
ds_read_b64_tr_b16 v[88:89], v60 offset:12288
v_mfma_f32_16x16x32_bf16 v[128:131], v[64:67], a[160:163], v[128:131]
ds_read_b64_tr_b16 v[90:91], v60 offset:13312
v_mfma_f32_16x16x32_bf16 v[132:135], v[68:71], a[160:163], v[132:135]
buffer_load_dwordx4 a[236:239], v1, s[16:19], s0 offen offset:3072 sc1
v_mfma_f32_16x16x32_bf16 v[148:151], v[68:71], a[164:167], v[148:151]
ds_read_b64_tr_b16 v[92:93], v63 offset:12288
ds_read_b64_tr_b16 v[94:95], v63 offset:13312
v_mfma_f32_16x16x32_bf16 v[152:155], v[72:75], a[164:167], v[152:155]
ds_read_b64_tr_b16 v[64:65], v53 offset:40960
ds_read_b64_tr_b16 v[66:67], v53 offset:41984
v_mfma_f32_16x16x32_bf16 v[136:139], v[72:75], a[160:163], v[136:139]
s_waitcnt lgkmcnt(6)
v_mfma_f32_16x16x32_bf16 v[140:143], v[76:79], a[160:163], v[140:143]
s_add_u32 s0, s72, 43776
v_mfma_f32_16x16x32_bf16 v[156:159], v[76:79], a[164:167], v[156:159]
buffer_load_dwordx4 a[240:243], v1, s[16:19], s0 offen offset:0 sc1
v_mfma_f32_16x16x32_bf16 v[144:147], v[80:83], a[172:175], v[144:147]
ds_read_b64_tr_b16 v[68:69], v56 offset:40960
ds_read_b64_tr_b16 v[70:71], v56 offset:41984
v_mfma_f32_16x16x32_bf16 v[128:131], v[80:83], a[168:171], v[128:131]
ds_read_b64_tr_b16 v[72:73], v59 offset:40960
ds_read_b64_tr_b16 v[74:75], v59 offset:41984
v_mfma_f32_16x16x32_bf16 v[132:135], v[84:87], a[168:171], v[132:135]
buffer_load_dwordx4 a[244:247], v1, s[16:19], s0 offen offset:1024 sc1
v_mfma_f32_16x16x32_bf16 v[148:151], v[84:87], a[172:175], v[148:151]
ds_read_b64_tr_b16 v[76:77], v62 offset:40960
ds_read_b64_tr_b16 v[78:79], v62 offset:41984
s_waitcnt lgkmcnt(10)
v_mfma_f32_16x16x32_bf16 v[152:155], v[88:91], a[172:175], v[152:155]
s_waitcnt lgkmcnt(6)
ds_read_b64_tr_b16 v[80:81], v53 offset:45056
v_mfma_f32_16x16x32_bf16 v[136:139], v[88:91], a[168:171], v[136:139]
ds_read_b64_tr_b16 v[82:83], v53 offset:46080
v_mfma_f32_16x16x32_bf16 v[140:143], v[92:95], a[168:171], v[140:143]
buffer_load_dwordx4 a[248:251], v1, s[16:19], s0 offen offset:2048 sc1
v_mfma_f32_16x16x32_bf16 v[156:159], v[92:95], a[172:175], v[156:159]
ds_read_b64_tr_b16 v[84:85], v56 offset:45056
ds_read_b64_tr_b16 v[86:87], v56 offset:46080
s_waitcnt vmcnt(29)
v_mfma_f32_16x16x32_bf16 v[112:115], v[64:67], a[180:183], v[112:115]
ds_read_b64_tr_b16 v[88:89], v59 offset:45056
ds_read_b64_tr_b16 v[90:91], v59 offset:46080
v_mfma_f32_16x16x32_bf16 v[96:99], v[64:67], a[176:179], v[96:99]
s_waitcnt lgkmcnt(6)
v_mfma_f32_16x16x32_bf16 v[100:103], v[68:71], a[176:179], v[100:103]
buffer_load_dwordx4 a[252:255], v1, s[16:19], s0 offen offset:3072 sc1
v_mfma_f32_16x16x32_bf16 v[116:119], v[68:71], a[180:183], v[116:119]
ds_read_b64_tr_b16 v[92:93], v62 offset:45056
ds_read_b64_tr_b16 v[94:95], v62 offset:46080
v_mfma_f32_16x16x32_bf16 v[120:123], v[72:75], a[180:183], v[120:123]
ds_read_b64_tr_b16 v[64:65], v53 offset:49152
ds_read_b64_tr_b16 v[66:67], v53 offset:50176
v_mfma_f32_16x16x32_bf16 v[104:107], v[72:75], a[176:179], v[104:107]
v_bfe_u32 v2, v0, 2, 1
v_lshlrev_b32 v2, 5, v2
v_mfma_f32_16x16x32_bf16 v[108:111], v[76:79], a[176:179], v[108:111]
v_bfe_u32 v24, v0, 3, 1
s_add_u32 s0, s72, 29184
v_mfma_f32_16x16x32_bf16 v[124:127], v[76:79], a[180:183], v[124:127]
buffer_load_dwordx4 v[224:227], v1, s[16:19], s0 offen offset:0 sc1
s_waitcnt vmcnt(29) lgkmcnt(8)
v_mfma_f32_16x16x32_bf16 v[112:115], v[80:83], a[188:191], v[112:115]
ds_read_b64_tr_b16 v[68:69], v56 offset:49152
ds_read_b64_tr_b16 v[70:71], v56 offset:50176
s_waitcnt lgkmcnt(6)
v_mfma_f32_16x16x32_bf16 v[96:99], v[80:83], a[184:187], v[96:99]
ds_read_b64_tr_b16 v[72:73], v59 offset:49152
ds_read_b64_tr_b16 v[74:75], v59 offset:50176
v_mfma_f32_16x16x32_bf16 v[100:103], v[84:87], a[184:187], v[100:103]
v_lshl_add_u32 v2, v24, 2, v2
v_and_b32 v24, 3, v0
v_mfma_f32_16x16x32_bf16 v[116:119], v[84:87], a[188:191], v[116:119]
buffer_load_dwordx4 v[228:231], v1, s[16:19], s0 offen offset:1024 sc1
v_mfma_f32_16x16x32_bf16 v[120:123], v[88:91], a[188:191], v[120:123]
ds_read_b64_tr_b16 v[76:77], v62 offset:49152
ds_read_b64_tr_b16 v[78:79], v62 offset:50176
ds_read_b64_tr_b16 v[80:81], v53 offset:53248
v_mfma_f32_16x16x32_bf16 v[104:107], v[88:91], a[184:187], v[104:107]
ds_read_b64_tr_b16 v[82:83], v53 offset:54272
s_waitcnt lgkmcnt(6)
v_mfma_f32_16x16x32_bf16 v[108:111], v[92:95], a[184:187], v[108:111]
s_waitcnt vmcnt(26)
s_barrier
v_mfma_f32_16x16x32_bf16 v[124:127], v[92:95], a[188:191], v[124:127]
buffer_load_dwordx4 v[232:235], v1, s[16:19], s0 offen offset:2048 sc1
v_mfma_f32_16x16x32_bf16 v[144:147], v[64:67], a[180:183], v[144:147]
ds_read_b64_tr_b16 v[84:85], v56 offset:53248
ds_read_b64_tr_b16 v[86:87], v56 offset:54272
ds_read_b64_tr_b16 v[88:89], v59 offset:53248
v_mfma_f32_16x16x32_bf16 v[128:131], v[64:67], a[176:179], v[128:131]
ds_read_b64_tr_b16 v[90:91], v59 offset:54272
v_add_u32 v2, v2, v24
v_mfma_f32_16x16x32_bf16 v[132:135], v[68:71], a[176:179], v[132:135]
s_cmp_ge_u32 s48, 3
s_cselect_b32 s71, 128, 0
v_mfma_f32_16x16x32_bf16 v[148:151], v[68:71], a[180:183], v[148:151]
buffer_load_dwordx4 v[236:239], v1, s[16:19], s0 offen offset:3072 sc1
s_waitcnt lgkmcnt(8)
v_mfma_f32_16x16x32_bf16 v[152:155], v[72:75], a[180:183], v[152:155]
ds_read_b64_tr_b16 v[92:93], v62 offset:53248
ds_read_b64_tr_b16 v[94:95], v62 offset:54272
s_waitcnt lgkmcnt(6)
v_mfma_f32_16x16x32_bf16 v[136:139], v[72:75], a[176:179], v[136:139]
ds_read_b64_tr_b16 v[64:65], v53 offset:57344
ds_read_b64_tr_b16 v[66:67], v53 offset:58368
v_mfma_f32_16x16x32_bf16 v[140:143], v[76:79], a[176:179], v[140:143]
s_lshr_b32 s92, s47, 1
s_lshl_b32 s92, s92, 6
s_add_u32 m0, s3, 57344
v_mfma_f32_16x16x32_bf16 v[156:159], v[76:79], a[180:183], v[156:159]
s_add_u32 s61, s74, s76
v_mfma_f32_16x16x32_bf16 v[144:147], v[80:83], a[188:191], v[144:147]
buffer_load_dwordx4 v18, s[36:39], s61 offen lds
ds_read_b64_tr_b16 v[68:69], v56 offset:57344
v_mfma_f32_16x16x32_bf16 v[128:131], v[80:83], a[184:187], v[128:131]
ds_read_b64_tr_b16 v[70:71], v56 offset:58368
ds_read_b64_tr_b16 v[72:73], v59 offset:57344
s_waitcnt lgkmcnt(9)
v_mfma_f32_16x16x32_bf16 v[132:135], v[84:87], a[184:187], v[132:135]
ds_read_b64_tr_b16 v[74:75], v59 offset:58368
s_waitcnt lgkmcnt(6)
s_add_u32 s71, s71, s92
v_mfma_f32_16x16x32_bf16 v[148:151], v[84:87], a[188:191], v[148:151]
s_and_b32 s92, s47, 1
v_mfma_f32_16x16x32_bf16 v[152:155], v[88:91], a[188:191], v[152:155]
buffer_load_dwordx4 v19, s[36:39], s61 offen offset:1024 lds
ds_read_b64_tr_b16 v[76:77], v62 offset:57344
v_mfma_f32_16x16x32_bf16 v[136:139], v[88:91], a[184:187], v[136:139]
ds_read_b64_tr_b16 v[78:79], v62 offset:58368
ds_read_b64_tr_b16 v[80:81], v53 offset:61440
v_mfma_f32_16x16x32_bf16 v[140:143], v[92:95], a[184:187], v[140:143]
ds_read_b64_tr_b16 v[82:83], v53 offset:62464
s_lshl_b32 s92, s92, 4
s_add_u32 s71, s71, s92
s_add_u32 m0, s3, 81920
v_mfma_f32_16x16x32_bf16 v[156:159], v[92:95], a[188:191], v[156:159]
s_add_u32 s61, s75, s76
s_waitcnt vmcnt(28) lgkmcnt(8)
v_mfma_f32_16x16x32_bf16 v[112:115], v[64:67], a[196:199], v[112:115]
buffer_load_dwordx4 v18, s[24:27], s61 offen lds
ds_read_b64_tr_b16 v[84:85], v56 offset:61440
ds_read_b64_tr_b16 v[86:87], v56 offset:62464
v_mfma_f32_16x16x32_bf16 v[96:99], v[64:67], a[192:195], v[96:99]
s_waitcnt lgkmcnt(6)
ds_read_b64_tr_b16 v[88:89], v59 offset:61440
v_mfma_f32_16x16x32_bf16 v[100:103], v[68:71], a[192:195], v[100:103]
ds_read_b64_tr_b16 v[90:91], v59 offset:62464
s_and_b32 s92, s44, 1
s_lshl_b32 s92, s92, 3
v_mfma_f32_16x16x32_bf16 v[116:119], v[68:71], a[196:199], v[116:119]
s_add_u32 s71, s71, s92
v_mfma_f32_16x16x32_bf16 v[120:123], v[72:75], a[196:199], v[120:123]
buffer_load_dwordx4 v19, s[24:27], s61 offen offset:1024 lds
ds_read_b64_tr_b16 v[92:93], v62 offset:61440
v_mfma_f32_16x16x32_bf16 v[104:107], v[72:75], a[192:195], v[104:107]
ds_read_b64_tr_b16 v[94:95], v62 offset:62464
ds_read_b64_tr_b16 v[64:65], v54 offset:0
s_waitcnt lgkmcnt(9)
v_mfma_f32_16x16x32_bf16 v[108:111], v[76:79], a[192:195], v[108:111]
ds_read_b64_tr_b16 v[66:67], v54 offset:1024
s_waitcnt lgkmcnt(6)
v_add_u32 v2, s71, v2
v_mfma_f32_16x16x32_bf16 v[124:127], v[76:79], a[196:199], v[124:127]
s_add_u32 m0, s3, 32768
s_add_u32 s61, s77, 73728
s_waitcnt vmcnt(28)
v_mfma_f32_16x16x32_bf16 v[112:115], v[80:83], a[204:207], v[112:115]
buffer_load_dwordx4 v16, s[28:31], s61 offen lds
ds_read_b64_tr_b16 v[68:69], v57 offset:0
v_mfma_f32_16x16x32_bf16 v[96:99], v[80:83], a[200:203], v[96:99]
ds_read_b64_tr_b16 v[70:71], v57 offset:1024
ds_read_b64_tr_b16 v[72:73], v60 offset:0
v_mfma_f32_16x16x32_bf16 v[100:103], v[84:87], a[200:203], v[100:103]
ds_read_b64_tr_b16 v[74:75], v60 offset:1024
v_and_b32 v2, 255, v2
v_lshlrev_b32 v24, 2, v2
v_mfma_f32_16x16x32_bf16 v[116:119], v[84:87], a[204:207], v[116:119]
v_add_u32 v24, 155648, v24
s_waitcnt lgkmcnt(8)
v_mfma_f32_16x16x32_bf16 v[120:123], v[88:91], a[204:207], v[120:123]
buffer_load_dwordx4 v17, s[28:31], s61 offen offset:1024 lds
ds_read_b64_tr_b16 v[76:77], v63 offset:0
v_mfma_f32_16x16x32_bf16 v[104:107], v[88:91], a[200:203], v[104:107]
ds_read_b64_tr_b16 v[78:79], v63 offset:1024
s_waitcnt lgkmcnt(6)
v_mfma_f32_16x16x32_bf16 v[108:111], v[92:95], a[200:203], v[108:111]
ds_read_b64_tr_b16 v[80:81], v54 offset:4096
ds_read_b64_tr_b16 v[82:83], v54 offset:5120
ds_read_b32 v25, v24
ds_read_b32 v12, v24 offset:1024
v_mfma_f32_16x16x32_bf16 v[124:127], v[92:95], a[204:207], v[124:127]
s_add_u32 m0, s3, 0
s_add_u32 s61, s77, 73728
v_mfma_f32_16x16x32_bf16 v[144:147], v[64:67], a[196:199], v[144:147]
buffer_load_dwordx4 v16, s[32:35], s61 offen lds
ds_read_b64_tr_b16 v[84:85], v57 offset:4096
v_mfma_f32_16x16x32_bf16 v[128:131], v[64:67], a[192:195], v[128:131]
ds_read_b64_tr_b16 v[86:87], v57 offset:5120
ds_read_b64_tr_b16 v[88:89], v60 offset:4096
s_waitcnt lgkmcnt(11)
v_mfma_f32_16x16x32_bf16 v[132:135], v[68:71], a[192:195], v[132:135]
ds_read_b64_tr_b16 v[90:91], v60 offset:5120
s_waitcnt lgkmcnt(8)
v_lshrrev_b32 v3, 4, v0
v_mfma_f32_16x16x32_bf16 v[148:151], v[68:71], a[196:199], v[148:151]
v_lshlrev_b32 v3, 3, v3
v_mfma_f32_16x16x32_bf16 v[152:155], v[72:75], a[196:199], v[152:155]
buffer_load_dwordx4 v17, s[32:35], s61 offen offset:1024 lds
ds_read_b64_tr_b16 v[92:93], v63 offset:4096
v_mfma_f32_16x16x32_bf16 v[136:139], v[72:75], a[192:195], v[136:139]
ds_read_b64_tr_b16 v[94:95], v63 offset:5120
ds_read_b64_tr_b16 v[64:65], v54 offset:16384
v_mfma_f32_16x16x32_bf16 v[140:143], v[76:79], a[192:195], v[140:143]
ds_read_b64_tr_b16 v[66:67], v54 offset:17408
s_mul_i32 s71, s88, 384
v_add_u32 v3, s71, v3
v_mfma_f32_16x16x32_bf16 v[156:159], v[76:79], a[196:199], v[156:159]
s_add_u32 s0, s72, 34048
s_waitcnt lgkmcnt(10)
v_mfma_f32_16x16x32_bf16 v[144:147], v[80:83], a[204:207], v[144:147]
buffer_load_dwordx4 v[240:243], v1, s[16:19], s0 offen offset:0 sc1
ds_read_b64_tr_b16 v[68:69], v57 offset:16384
ds_read_b64_tr_b16 v[70:71], v57 offset:17408
v_mfma_f32_16x16x32_bf16 v[128:131], v[80:83], a[200:203], v[128:131]
s_waitcnt lgkmcnt(6)
ds_read_b64_tr_b16 v[72:73], v60 offset:16384
v_mfma_f32_16x16x32_bf16 v[132:135], v[84:87], a[200:203], v[132:135]
ds_read_b64_tr_b16 v[74:75], v60 offset:17408
s_lshl_b32 s71, s46, 8
v_add_u32 v2, s71, v2
v_mfma_f32_16x16x32_bf16 v[148:151], v[84:87], a[204:207], v[148:151]
v_mul_u32_u24 v2, 1152, v2
v_mfma_f32_16x16x32_bf16 v[152:155], v[88:91], a[204:207], v[152:155]
buffer_load_dwordx4 v[244:247], v1, s[16:19], s0 offen offset:1024 sc1
ds_read_b64_tr_b16 v[76:77], v63 offset:16384
v_mfma_f32_16x16x32_bf16 v[136:139], v[88:91], a[200:203], v[136:139]
ds_read_b64_tr_b16 v[78:79], v63 offset:17408
ds_read_b64_tr_b16 v[80:81], v54 offset:20480
s_waitcnt lgkmcnt(9)
v_mfma_f32_16x16x32_bf16 v[140:143], v[92:95], a[200:203], v[140:143]
ds_read_b64_tr_b16 v[82:83], v54 offset:21504
s_waitcnt lgkmcnt(6)
s_lshr_b32 s92, s44, 1
v_mfma_f32_16x16x32_bf16 v[156:159], v[92:95], a[204:207], v[156:159]
L_stub14:
s_cbranch_execz L_stub18
buffer_load_dwordx4 v[248:251], v1, s[16:19], s0 offen offset:2048 sc1
s_waitcnt vmcnt(33)
v_mfma_f32_16x16x32_bf16 v[112:115], v[64:67], a[212:215], v[112:115]
ds_read_b64_tr_b16 v[84:85], v57 offset:20480
ds_read_b64_tr_b16 v[86:87], v57 offset:21504
ds_read_b64_tr_b16 v[88:89], v60 offset:20480
v_mfma_f32_16x16x32_bf16 v[96:99], v[64:67], a[208:211], v[96:99]
ds_read_b64_tr_b16 v[90:91], v60 offset:21504
s_lshl_b32 s71, s92, 7
v_mfma_f32_16x16x32_bf16 v[100:103], v[68:71], a[208:211], v[100:103]
v_add_u32 v24, s71, v3
v_add_u32 v10, v2, v24
v_mfma_f32_16x16x32_bf16 v[116:119], v[68:71], a[212:215], v[116:119]
buffer_load_dwordx4 v[252:255], v1, s[16:19], s0 offen offset:3072 sc1
s_waitcnt lgkmcnt(8)
v_mfma_f32_16x16x32_bf16 v[120:123], v[72:75], a[212:215], v[120:123]
ds_read_b64_tr_b16 v[92:93], v63 offset:20480
ds_read_b64_tr_b16 v[94:95], v63 offset:21504
s_waitcnt lgkmcnt(6)
v_mfma_f32_16x16x32_bf16 v[104:107], v[72:75], a[208:211], v[104:107]
ds_read_b64_tr_b16 v[64:65], v53 offset:32768
ds_read_b64_tr_b16 v[66:67], v53 offset:33792
v_mfma_f32_16x16x32_bf16 v[108:111], v[76:79], a[208:211], v[108:111]
s_lshl_b32 s71, s92, 6
s_add_u32 s71, s71, 256
s_add_u32 m0, s3, 8192
v_mfma_f32_16x16x32_bf16 v[124:127], v[76:79], a[212:215], v[124:127]
s_add_u32 s61, s64, 256
s_waitcnt vmcnt(32)
v_mfma_f32_16x16x32_bf16 v[112:115], v[80:83], a[220:223], v[112:115]
buffer_load_dwordx4 v14, s[12:15], s61 offen lds
ds_read_b64_tr_b16 v[68:69], v56 offset:32768
v_mfma_f32_16x16x32_bf16 v[96:99], v[80:83], a[216:219], v[96:99]
ds_read_b64_tr_b16 v[70:71], v56 offset:33792
ds_read_b64_tr_b16 v[72:73], v59 offset:32768
s_waitcnt lgkmcnt(9)
v_mfma_f32_16x16x32_bf16 v[100:103], v[84:87], a[216:219], v[100:103]
ds_read_b64_tr_b16 v[74:75], v59 offset:33792
s_waitcnt lgkmcnt(6)
v_add_u32 v3, s71, v3
v_mfma_f32_16x16x32_bf16 v[116:119], v[84:87], a[220:223], v[116:119]
v_add_u32 v11, v2, v3
v_mfma_f32_16x16x32_bf16 v[120:123], v[88:91], a[220:223], v[120:123]
buffer_load_dwordx4 v15, s[12:15], s61 offen offset:1024 lds
ds_read_b64_tr_b16 v[76:77], v62 offset:32768
v_mfma_f32_16x16x32_bf16 v[104:107], v[88:91], a[216:219], v[104:107]
ds_read_b64_tr_b16 v[78:79], v62 offset:33792
ds_read_b64_tr_b16 v[80:81], v53 offset:36864
v_mfma_f32_16x16x32_bf16 v[108:111], v[92:95], a[216:219], v[108:111]
ds_read_b64_tr_b16 v[82:83], v53 offset:37888
s_waitcnt vmcnt(26)
s_barrier
s_add_u32 m0, s3, 16384
v_mfma_f32_16x16x32_bf16 v[124:127], v[92:95], a[220:223], v[124:127]
s_add_u32 s61, s65, 256
s_waitcnt lgkmcnt(8)
v_mfma_f32_16x16x32_bf16 v[144:147], v[64:67], a[212:215], v[144:147]
buffer_load_dwordx4 v14, s[12:15], s61 offen lds
ds_read_b64_tr_b16 v[84:85], v56 offset:36864
v_mfma_f32_16x16x32_bf16 v[128:131], v[64:67], a[208:211], v[128:131]
ds_read_b64_tr_b16 v[86:87], v56 offset:37888
s_waitcnt lgkmcnt(6)
v_mfma_f32_16x16x32_bf16 v[132:135], v[68:71], a[208:211], v[132:135]
ds_read_b64_tr_b16 v[88:89], v59 offset:36864
ds_read_b64_tr_b16 v[90:91], v59 offset:37888
ds_read_b64_tr_b16 v[92:93], v62 offset:36864
v_mfma_f32_16x16x32_bf16 v[148:151], v[68:71], a[212:215], v[148:151]
ds_read_b64_tr_b16 v[94:95], v62 offset:37888
v_add_u32 v8, 65536, v8
v_add_u32 v9, 65536, v9
buffer_load_dwordx4 v15, s[12:15], s61 offen offset:1024 lds
s_cmp_eq_u32 s47, 4
s_cbranch_scc1 A1_B
v_mfma_f32_16x16x32_bf16 v[152:155], v[72:75], a[212:215], v[152:155]
ds_read_b128 v[64:67], v8 offset:0
s_waitcnt lgkmcnt(5)
v_mfma_f32_16x16x32_bf16 v[136:139], v[72:75], a[208:211], v[136:139]
v_mfma_f32_16x16x32_bf16 v[140:143], v[76:79], a[208:211], v[140:143]
s_add_u32 m0, s3, 49152
s_add_u32 s61, s40, 256
v_mfma_f32_16x16x32_bf16 v[156:159], v[76:79], a[212:215], v[156:159]
buffer_load_dwordx4 v14, s[12:15], s61 offen lds
v_mfma_f32_16x16x32_bf16 v[144:147], v[80:83], a[220:223], v[144:147]
ds_read_b128 v[68:71], v8 offset:2048
ds_read_b128 v[72:75], v8 offset:4096
v_mfma_f32_16x16x32_bf16 v[128:131], v[80:83], a[216:219], v[128:131]
v_mfma_f32_16x16x32_bf16 v[132:135], v[84:87], a[216:219], v[132:135]
buffer_load_dwordx4 v15, s[12:15], s61 offen offset:1024 lds
v_mfma_f32_16x16x32_bf16 v[148:151], v[84:87], a[220:223], v[148:151]
ds_read_b128 v[76:79], v8 offset:6144
s_waitcnt lgkmcnt(3)
v_mfma_f32_16x16x32_bf16 v[152:155], v[88:91], a[220:223], v[152:155]
ds_read_b128 v[80:83], v9 offset:0
v_mfma_f32_16x16x32_bf16 v[136:139], v[88:91], a[216:219], v[136:139]
v_mfma_f32_16x16x32_bf16 v[140:143], v[92:95], a[216:219], v[140:143]
s_add_u32 m0, s3, 90112
s_add_u32 s61, s64, 221440
v_mfma_f32_16x16x32_bf16 v[156:159], v[92:95], a[220:223], v[156:159]
buffer_load_dwordx4 v14, s[12:15], s61 offen lds
s_waitcnt vmcnt(29)
v_mfma_f32_16x16x32_bf16 v[112:115], v[64:67], a[228:231], v[112:115]
ds_read_b128 v[84:87], v9 offset:2048
ds_read_b128 v[88:91], v9 offset:4096
v_mfma_f32_16x16x32_bf16 v[96:99], v[64:67], a[224:227], v[96:99]
s_waitcnt lgkmcnt(3)
v_mfma_f32_16x16x32_bf16 v[100:103], v[68:71], a[224:227], v[100:103]
ds_read_b128 v[92:95], v9 offset:6144
v_add_u32 v8, 8192, v8
v_mfma_f32_16x16x32_bf16 v[116:119], v[68:71], a[228:231], v[116:119]
v_add_u32 v9, 8192, v9
v_mfma_f32_16x16x32_bf16 v[120:123], v[72:75], a[228:231], v[120:123]
buffer_load_dwordx4 v15, s[12:15], s61 offen offset:1024 lds
v_mfma_f32_16x16x32_bf16 v[104:107], v[72:75], a[224:227], v[104:107]
ds_read_b128 v[64:67], v8 offset:0
v_mfma_f32_16x16x32_bf16 v[108:111], v[76:79], a[224:227], v[108:111]
s_add_u32 m0, s3, 139264
s_add_u32 s61, s65, 221440
v_mfma_f32_16x16x32_bf16 v[124:127], v[76:79], a[228:231], v[124:127]
buffer_load_dwordx4 v14, s[12:15], s61 offen lds
s_waitcnt vmcnt(29) lgkmcnt(4)
v_mfma_f32_16x16x32_bf16 v[112:115], v[80:83], a[236:239], v[112:115]
ds_read_b128 v[68:71], v8 offset:2048
s_waitcnt lgkmcnt(3)
v_mfma_f32_16x16x32_bf16 v[96:99], v[80:83], a[232:235], v[96:99]
ds_read_b128 v[72:75], v8 offset:4096
v_mfma_f32_16x16x32_bf16 v[100:103], v[84:87], a[232:235], v[100:103]
buffer_load_dwordx4 v15, s[12:15], s61 offen offset:1024 lds
v_mfma_f32_16x16x32_bf16 v[116:119], v[84:87], a[236:239], v[116:119]
ds_read_b128 v[76:79], v8 offset:6144
v_mfma_f32_16x16x32_bf16 v[120:123], v[88:91], a[236:239], v[120:123]
ds_read_b128 v[80:83], v9 offset:0
s_waitcnt lgkmcnt(3)
v_mfma_f32_16x16x32_bf16 v[104:107], v[88:91], a[232:235], v[104:107]
v_mfma_f32_16x16x32_bf16 v[108:111], v[92:95], a[232:235], v[108:111]
s_add_u32 m0, s3, 106496
s_add_u32 s61, s40, 221440
v_mfma_f32_16x16x32_bf16 v[124:127], v[92:95], a[236:239], v[124:127]
buffer_load_dwordx4 v14, s[12:15], s61 offen lds
s_waitcnt vmcnt(29)
v_mfma_f32_16x16x32_bf16 v[112:115], v[64:67], a[244:247], v[112:115]
ds_read_b128 v[84:87], v9 offset:2048
ds_read_b128 v[88:91], v9 offset:4096
v_mfma_f32_16x16x32_bf16 v[96:99], v[64:67], a[240:243], v[96:99]
v_mfma_f32_16x16x32_bf16 v[100:103], v[68:71], a[240:243], v[100:103]
ds_read_b128 v[92:95], v9 offset:6144
s_waitcnt lgkmcnt(3)
v_mfma_f32_16x16x32_bf16 v[116:119], v[68:71], a[244:247], v[116:119]
v_add_u32 v8, 4294918144, v8
v_add_u32 v9, 4294918144, v9
v_mfma_f32_16x16x32_bf16 v[120:123], v[72:75], a[244:247], v[120:123]
buffer_load_dwordx4 v15, s[12:15], s61 offen offset:1024 lds
v_mfma_f32_16x16x32_bf16 v[104:107], v[72:75], a[240:243], v[104:107]
ds_read_b128 v[64:67], v8 offset:0
v_mfma_f32_16x16x32_bf16 v[108:111], v[76:79], a[240:243], v[108:111]
s_add_u32 m0, s3, 114688
s_add_u32 s61, s97, 256
v_mfma_f32_16x16x32_bf16 v[124:127], v[76:79], a[244:247], v[124:127]
buffer_load_dwordx4 v14, s[12:15], s61 offen lds
s_waitcnt vmcnt(29)
v_mfma_f32_16x16x32_bf16 v[112:115], v[80:83], a[252:255], v[112:115]
ds_read_b128 v[68:71], v8 offset:2048
ds_read_b128 v[72:75], v8 offset:4096
v_mfma_f32_16x16x32_bf16 v[96:99], v[80:83], a[248:251], v[96:99]
s_waitcnt lgkmcnt(3)
v_mfma_f32_16x16x32_bf16 v[100:103], v[84:87], a[248:251], v[100:103]
buffer_load_dwordx4 v15, s[12:15], s61 offen offset:1024 lds
v_mfma_f32_16x16x32_bf16 v[116:119], v[84:87], a[252:255], v[116:119]
ds_read_b128 v[76:79], v8 offset:6144
v_mfma_f32_16x16x32_bf16 v[120:123], v[88:91], a[252:255], v[120:123]
ds_read_b128 v[80:83], v9 offset:0
v_mfma_f32_16x16x32_bf16 v[104:107], v[88:91], a[248:251], v[104:107]
v_mfma_f32_16x16x32_bf16 v[108:111], v[92:95], a[248:251], v[108:111]
s_add_u32 m0, s3, 122880
s_add_u32 s61, s97, 73984
v_mfma_f32_16x16x32_bf16 v[124:127], v[92:95], a[252:255], v[124:127]
buffer_load_dwordx4 v14, s[12:15], s61 offen lds
s_waitcnt vmcnt(29) lgkmcnt(4)
v_mfma_f32_16x16x32_bf16 v[112:115], v[64:67], v[228:231], v[112:115]
ds_read_b128 v[84:87], v9 offset:2048
s_waitcnt lgkmcnt(3)
v_mfma_f32_16x16x32_bf16 v[96:99], v[64:67], v[224:227], v[96:99]
ds_read_b128 v[88:91], v9 offset:4096
v_mfma_f32_16x16x32_bf16 v[100:103], v[68:71], v[224:227], v[100:103]
ds_read_b128 v[92:95], v9 offset:6144
v_add_u32 v8, 16384, v8
v_mfma_f32_16x16x32_bf16 v[116:119], v[68:71], v[228:231], v[116:119]
v_add_u32 v9, 16384, v9
v_mfma_f32_16x16x32_bf16 v[120:123], v[72:75], v[228:231], v[120:123]
buffer_load_dwordx4 v15, s[12:15], s61 offen offset:1024 lds
v_mfma_f32_16x16x32_bf16 v[104:107], v[72:75], v[224:227], v[104:107]
ds_read_b128 v[64:67], v8 offset:0
s_waitcnt lgkmcnt(3)
v_mfma_f32_16x16x32_bf16 v[108:111], v[76:79], v[224:227], v[108:111]
s_add_u32 m0, s3, 131072
s_add_u32 s61, s64, 3096832
v_mfma_f32_16x16x32_bf16 v[124:127], v[76:79], v[228:231], v[124:127]
buffer_load_dwordx4 v14, s[12:15], s61 offen lds
s_waitcnt vmcnt(29)
v_mfma_f32_16x16x32_bf16 v[112:115], v[80:83], v[236:239], v[112:115]
ds_read_b128 v[68:71], v8 offset:2048
ds_read_b128 v[72:75], v8 offset:4096
v_mfma_f32_16x16x32_bf16 v[96:99], v[80:83], v[232:235], v[96:99]
v_mfma_f32_16x16x32_bf16 v[100:103], v[84:87], v[232:235], v[100:103]
buffer_load_dwordx4 v15, s[12:15], s61 offen offset:1024 lds
v_mfma_f32_16x16x32_bf16 v[116:119], v[84:87], v[236:239], v[116:119]
ds_read_b128 v[76:79], v8 offset:6144
s_waitcnt lgkmcnt(3)
v_mfma_f32_16x16x32_bf16 v[120:123], v[88:91], v[236:239], v[120:123]
ds_read_b128 v[80:83], v9 offset:0
s_waitcnt vmcnt(22)
v_mfma_f32_16x16x32_bf16 v[104:107], v[88:91], v[232:235], v[104:107]
s_barrier
v_mfma_f32_16x16x32_bf16 v[108:111], v[92:95], v[232:235], v[108:111]
s_add_u32 m0, s3, 147456
s_add_u32 s61, s65, 3096832
v_mfma_f32_16x16x32_bf16 v[124:127], v[92:95], v[236:239], v[124:127]
buffer_load_dwordx4 v14, s[12:15], s61 offen lds
s_waitcnt vmcnt(21)
v_mfma_f32_16x16x32_bf16 v[112:115], v[64:67], v[244:247], v[112:115]
ds_read_b128 v[84:87], v9 offset:2048
ds_read_b128 v[88:91], v9 offset:4096
v_mfma_f32_16x16x32_bf16 v[96:99], v[64:67], v[240:243], v[96:99]
s_waitcnt lgkmcnt(3)
v_mfma_f32_16x16x32_bf16 v[100:103], v[68:71], v[240:243], v[100:103]
ds_read_b128 v[92:95], v9 offset:6144
v_add_u32 v8, 16384, v8
v_mfma_f32_16x16x32_bf16 v[116:119], v[68:71], v[244:247], v[116:119]
v_add_u32 v9, 16384, v9
v_mfma_f32_16x16x32_bf16 v[120:123], v[72:75], v[244:247], v[120:123]
buffer_load_dwordx4 v15, s[12:15], s61 offen offset:1024 lds
v_mfma_f32_16x16x32_bf16 v[104:107], v[72:75], v[240:243], v[104:107]
ds_read_b128 v[64:67], v8 offset:0
v_mfma_f32_16x16x32_bf16 v[108:111], v[76:79], v[240:243], v[108:111]
s_add_u32 m0, s3, 98304
s_add_u32 s61, s40, 3096832
v_mfma_f32_16x16x32_bf16 v[124:127], v[76:79], v[244:247], v[124:127]
buffer_load_dwordx4 v14, s[12:15], s61 offen lds
s_waitcnt vmcnt(21) lgkmcnt(4)
v_mfma_f32_16x16x32_bf16 v[112:115], v[80:83], v[252:255], v[112:115]
ds_read_b128 v[68:71], v8 offset:2048
s_waitcnt lgkmcnt(3)
v_mfma_f32_16x16x32_bf16 v[96:99], v[80:83], v[248:251], v[96:99]
ds_read_b128 v[72:75], v8 offset:4096
v_mfma_f32_16x16x32_bf16 v[100:103], v[84:87], v[248:251], v[100:103]
buffer_load_dwordx4 v15, s[12:15], s61 offen offset:1024 lds
v_mfma_f32_16x16x32_bf16 v[116:119], v[84:87], v[252:255], v[116:119]
ds_read_b128 v[76:79], v8 offset:6144
v_mfma_f32_16x16x32_bf16 v[120:123], v[88:91], v[252:255], v[120:123]
ds_read_b128 v[80:83], v9 offset:0
s_waitcnt lgkmcnt(3)
v_mfma_f32_16x16x32_bf16 v[104:107], v[88:91], v[248:251], v[104:107]
v_mfma_f32_16x16x32_bf16 v[108:111], v[92:95], v[248:251], v[108:111]
s_add_u32 m0, s3, 65536
s_add_u32 s61, s64, 3318016
v_mfma_f32_16x16x32_bf16 v[124:127], v[92:95], v[252:255], v[124:127]
buffer_load_dwordx4 v14, s[12:15], s61 offen lds
v_mfma_f32_16x16x32_bf16 v[144:147], v[64:67], a[228:231], v[144:147]
ds_read_b128 v[84:87], v9 offset:2048
ds_read_b128 v[88:91], v9 offset:4096
v_mfma_f32_16x16x32_bf16 v[128:131], v[64:67], a[224:227], v[128:131]
v_mfma_f32_16x16x32_bf16 v[132:135], v[68:71], a[224:227], v[132:135]
ds_read_b128 v[92:95], v9 offset:6144
s_waitcnt lgkmcnt(3)
v_mfma_f32_16x16x32_bf16 v[148:151], v[68:71], a[228:231], v[148:151]
v_add_u32 v8, 24576, v8
v_add_u32 v9, 24576, v9
v_mfma_f32_16x16x32_bf16 v[152:155], v[72:75], a[228:231], v[152:155]
buffer_load_dwordx4 v15, s[12:15], s61 offen offset:1024 lds
v_mfma_f32_16x16x32_bf16 v[136:139], v[72:75], a[224:227], v[136:139]
ds_read_b128 v[64:67], v8 offset:0
v_mfma_f32_16x16x32_bf16 v[140:143], v[76:79], a[224:227], v[140:143]
s_add_u32 m0, s3, 73728
s_add_u32 s61, s65, 3318016
v_mfma_f32_16x16x32_bf16 v[156:159], v[76:79], a[228:231], v[156:159]
buffer_load_dwordx4 v14, s[12:15], s61 offen lds
v_mfma_f32_16x16x32_bf16 v[144:147], v[80:83], a[236:239], v[144:147]
ds_read_b128 v[68:71], v8 offset:2048
ds_read_b128 v[72:75], v8 offset:4096
s_waitcnt lgkmcnt(3)
v_cvt_pk_bf16_f32 v96, v96, v97
v_mfma_f32_16x16x32_bf16 v[128:131], v[80:83], a[232:235], v[128:131]
v_cvt_pk_bf16_f32 v97, v98, v99
v_cvt_pk_bf16_f32 v98, v100, v101
v_mfma_f32_16x16x32_bf16 v[132:135], v[84:87], a[232:235], v[132:135]
v_cvt_pk_bf16_f32 v99, v102, v103
s_add_u32 s99, s82, 0
v_mfma_f32_16x16x32_bf16 v[148:151], v[84:87], a[236:239], v[148:151]
buffer_store_dwordx4 v[96:99], v1, s[16:19], s99 offen offset:0 sc1
v_mfma_f32_16x16x32_bf16 v[152:155], v[88:91], a[236:239], v[152:155]
buffer_load_dwordx4 v15, s[12:15], s61 offen offset:1024 lds
v_mfma_f32_16x16x32_bf16 v[136:139], v[88:91], a[232:235], v[136:139]
ds_read_b128 v[76:79], v8 offset:6144
ds_read_b128 v[80:83], v9 offset:0
v_mfma_f32_16x16x32_bf16 v[140:143], v[92:95], a[232:235], v[140:143]
ds_read_b128 v[84:87], v9 offset:2048
s_waitcnt lgkmcnt(3)
v_mfma_f32_16x16x32_bf16 v[156:159], v[92:95], a[236:239], v[156:159]
v_mfma_f32_16x16x32_bf16 v[144:147], v[64:67], a[244:247], v[144:147]
ds_read_b128 v[88:91], v9 offset:4096
v_mfma_f32_16x16x32_bf16 v[128:131], v[64:67], a[240:243], v[128:131]
v_mfma_f32_16x16x32_bf16 v[132:135], v[68:71], a[240:243], v[132:135]
ds_read_b128 v[92:95], v9 offset:6144
v_add_u32 v8, 4294918144, v8
v_mfma_f32_16x16x32_bf16 v[148:151], v[68:71], a[244:247], v[148:151]
v_add_u32 v9, 4294918144, v9
s_branch A1_E
A1_B:
L_stub15:
s_cbranch_execz L_stub19
v_mfma_f32_16x16x32_bf16 v[152:155], v[72:75], a[212:215], v[152:155]
ds_read_b64_tr_b16 v[64:65], v53 offset:0
ds_read_b64_tr_b16 v[66:67], v53 offset:1024
v_mfma_f32_16x16x32_bf16 v[136:139], v[72:75], a[208:211], v[136:139]
s_waitcnt lgkmcnt(6)
v_mfma_f32_16x16x32_bf16 v[140:143], v[76:79], a[208:211], v[140:143]
s_add_u32 m0, s3, 49152
s_add_u32 s61, s40, 256
v_mfma_f32_16x16x32_bf16 v[156:159], v[76:79], a[212:215], v[156:159]
buffer_load_dwordx4 v14, s[12:15], s61 offen lds
v_mfma_f32_16x16x32_bf16 v[144:147], v[80:83], a[220:223], v[144:147]
ds_read_b64_tr_b16 v[68:69], v56 offset:0
ds_read_b64_tr_b16 v[70:71], v56 offset:1024
v_mfma_f32_16x16x32_bf16 v[128:131], v[80:83], a[216:219], v[128:131]
ds_read_b64_tr_b16 v[72:73], v59 offset:0
ds_read_b64_tr_b16 v[74:75], v59 offset:1024
v_mfma_f32_16x16x32_bf16 v[132:135], v[84:87], a[216:219], v[132:135]
buffer_load_dwordx4 v15, s[12:15], s61 offen offset:1024 lds
v_mfma_f32_16x16x32_bf16 v[148:151], v[84:87], a[220:223], v[148:151]
ds_read_b64_tr_b16 v[76:77], v62 offset:0
ds_read_b64_tr_b16 v[78:79], v62 offset:1024
s_waitcnt lgkmcnt(10)
v_mfma_f32_16x16x32_bf16 v[152:155], v[88:91], a[220:223], v[152:155]
s_waitcnt lgkmcnt(6)
ds_read_b64_tr_b16 v[80:81], v53 offset:4096
v_mfma_f32_16x16x32_bf16 v[136:139], v[88:91], a[216:219], v[136:139]
ds_read_b64_tr_b16 v[82:83], v53 offset:5120
v_mfma_f32_16x16x32_bf16 v[140:143], v[92:95], a[216:219], v[140:143]
s_add_u32 m0, s3, 90112
s_add_u32 s61, s64, 221440
v_mfma_f32_16x16x32_bf16 v[156:159], v[92:95], a[220:223], v[156:159]
buffer_load_dwordx4 v14, s[12:15], s61 offen lds
s_waitcnt vmcnt(29)
v_mfma_f32_16x16x32_bf16 v[112:115], v[64:67], a[228:231], v[112:115]
ds_read_b64_tr_b16 v[84:85], v56 offset:4096
ds_read_b64_tr_b16 v[86:87], v56 offset:5120
v_mfma_f32_16x16x32_bf16 v[96:99], v[64:67], a[224:227], v[96:99]
ds_read_b64_tr_b16 v[88:89], v59 offset:4096
ds_read_b64_tr_b16 v[90:91], v59 offset:5120
s_waitcnt lgkmcnt(10)
v_mfma_f32_16x16x32_bf16 v[100:103], v[68:71], a[224:227], v[100:103]
s_waitcnt lgkmcnt(6)
ds_read_b64_tr_b16 v[92:93], v62 offset:4096
ds_read_b64_tr_b16 v[94:95], v62 offset:5120
v_mfma_f32_16x16x32_bf16 v[116:119], v[68:71], a[228:231], v[116:119]
v_add_u32 v8, 8192, v8
v_add_u32 v9, 8192, v9
v_mfma_f32_16x16x32_bf16 v[120:123], v[72:75], a[228:231], v[120:123]
buffer_load_dwordx4 v15, s[12:15], s61 offen offset:1024 lds
v_mfma_f32_16x16x32_bf16 v[104:107], v[72:75], a[224:227], v[104:107]
ds_read_b64_tr_b16 v[64:65], v53 offset:8192
ds_read_b64_tr_b16 v[66:67], v53 offset:9216
v_mfma_f32_16x16x32_bf16 v[108:111], v[76:79], a[224:227], v[108:111]
s_add_u32 m0, s3, 139264
s_add_u32 s61, s65, 221440
v_mfma_f32_16x16x32_bf16 v[124:127], v[76:79], a[228:231], v[124:127]
buffer_load_dwordx4 v14, s[12:15], s61 offen lds
s_waitcnt vmcnt(29) lgkmcnt(8)
v_mfma_f32_16x16x32_bf16 v[112:115], v[80:83], a[236:239], v[112:115]
ds_read_b64_tr_b16 v[68:69], v56 offset:8192
ds_read_b64_tr_b16 v[70:71], v56 offset:9216
v_mfma_f32_16x16x32_bf16 v[96:99], v[80:83], a[232:235], v[96:99]
s_waitcnt lgkmcnt(6)
ds_read_b64_tr_b16 v[72:73], v59 offset:8192
v_mfma_f32_16x16x32_bf16 v[100:103], v[84:87], a[232:235], v[100:103]
ds_read_b64_tr_b16 v[74:75], v59 offset:9216
v_mfma_f32_16x16x32_bf16 v[116:119], v[84:87], a[236:239], v[116:119]
buffer_load_dwordx4 v15, s[12:15], s61 offen offset:1024 lds
v_mfma_f32_16x16x32_bf16 v[120:123], v[88:91], a[236:239], v[120:123]
ds_read_b64_tr_b16 v[76:77], v62 offset:8192
ds_read_b64_tr_b16 v[78:79], v62 offset:9216
v_mfma_f32_16x16x32_bf16 v[104:107], v[88:91], a[232:235], v[104:107]
ds_read_b64_tr_b16 v[80:81], v53 offset:12288
ds_read_b64_tr_b16 v[82:83], v53 offset:13312
s_waitcnt lgkmcnt(10)
v_mfma_f32_16x16x32_bf16 v[108:111], v[92:95], a[232:235], v[108:111]
s_waitcnt lgkmcnt(6)
s_add_u32 m0, s3, 106496
s_add_u32 s61, s40, 221440
v_mfma_f32_16x16x32_bf16 v[124:127], v[92:95], a[236:239], v[124:127]
buffer_load_dwordx4 v14, s[12:15], s61 offen lds
s_waitcnt vmcnt(29)
v_mfma_f32_16x16x32_bf16 v[112:115], v[64:67], a[244:247], v[112:115]
ds_read_b64_tr_b16 v[84:85], v56 offset:12288
ds_read_b64_tr_b16 v[86:87], v56 offset:13312
v_mfma_f32_16x16x32_bf16 v[96:99], v[64:67], a[240:243], v[96:99]
ds_read_b64_tr_b16 v[88:89], v59 offset:12288
ds_read_b64_tr_b16 v[90:91], v59 offset:13312
v_mfma_f32_16x16x32_bf16 v[100:103], v[68:71], a[240:243], v[100:103]
ds_read_b64_tr_b16 v[92:93], v62 offset:12288
ds_read_b64_tr_b16 v[94:95], v62 offset:13312
s_waitcnt lgkmcnt(6)
v_mfma_f32_16x16x32_bf16 v[116:119], v[68:71], a[244:247], v[116:119]
v_add_u32 v8, 4294918144, v8
v_add_u32 v9, 4294918144, v9
v_mfma_f32_16x16x32_bf16 v[120:123], v[72:75], a[244:247], v[120:123]
buffer_load_dwordx4 v15, s[12:15], s61 offen offset:1024 lds
v_mfma_f32_16x16x32_bf16 v[104:107], v[72:75], a[240:243], v[104:107]
ds_read_b128 v[64:67], v8 offset:0
v_mfma_f32_16x16x32_bf16 v[108:111], v[76:79], a[240:243], v[108:111]
s_add_u32 m0, s3, 114688
s_add_u32 s61, s97, 256
v_mfma_f32_16x16x32_bf16 v[124:127], v[76:79], a[244:247], v[124:127]
buffer_load_dwordx4 v14, s[12:15], s61 offen lds
s_waitcnt vmcnt(29)
v_mfma_f32_16x16x32_bf16 v[112:115], v[80:83], a[252:255], v[112:115]
ds_read_b128 v[68:71], v8 offset:2048
ds_read_b128 v[72:75], v8 offset:4096
v_mfma_f32_16x16x32_bf16 v[96:99], v[80:83], a[248:251], v[96:99]
s_waitcnt lgkmcnt(3)
v_mfma_f32_16x16x32_bf16 v[100:103], v[84:87], a[248:251], v[100:103]
buffer_load_dwordx4 v15, s[12:15], s61 offen offset:1024 lds
v_mfma_f32_16x16x32_bf16 v[116:119], v[84:87], a[252:255], v[116:119]
ds_read_b128 v[76:79], v8 offset:6144
v_mfma_f32_16x16x32_bf16 v[120:123], v[88:91], a[252:255], v[120:123]
ds_read_b128 v[80:83], v9 offset:0
v_mfma_f32_16x16x32_bf16 v[104:107], v[88:91], a[248:251], v[104:107]
v_mfma_f32_16x16x32_bf16 v[108:111], v[92:95], a[248:251], v[108:111]
s_add_u32 m0, s3, 122880
s_add_u32 s61, s97, 73984
v_mfma_f32_16x16x32_bf16 v[124:127], v[92:95], a[252:255], v[124:127]
buffer_load_dwordx4 v14, s[12:15], s61 offen lds
s_waitcnt vmcnt(29) lgkmcnt(4)
v_mfma_f32_16x16x32_bf16 v[112:115], v[64:67], v[228:231], v[112:115]
ds_read_b128 v[84:87], v9 offset:2048
s_waitcnt lgkmcnt(3)
v_mfma_f32_16x16x32_bf16 v[96:99], v[64:67], v[224:227], v[96:99]
ds_read_b128 v[88:91], v9 offset:4096
v_mfma_f32_16x16x32_bf16 v[100:103], v[68:71], v[224:227], v[100:103]
ds_read_b128 v[92:95], v9 offset:6144
v_add_u32 v8, 16384, v8
v_mfma_f32_16x16x32_bf16 v[116:119], v[68:71], v[228:231], v[116:119]
v_add_u32 v9, 16384, v9
v_mfma_f32_16x16x32_bf16 v[120:123], v[72:75], v[228:231], v[120:123]
buffer_load_dwordx4 v15, s[12:15], s61 offen offset:1024 lds
v_mfma_f32_16x16x32_bf16 v[104:107], v[72:75], v[224:227], v[104:107]
ds_read_b128 v[64:67], v8 offset:0
s_waitcnt lgkmcnt(3)
v_mfma_f32_16x16x32_bf16 v[108:111], v[76:79], v[224:227], v[108:111]
s_add_u32 m0, s3, 131072
s_add_u32 s61, s64, 3096832
v_mfma_f32_16x16x32_bf16 v[124:127], v[76:79], v[228:231], v[124:127]
buffer_load_dwordx4 v14, s[12:15], s61 offen lds
s_waitcnt vmcnt(29)
v_mfma_f32_16x16x32_bf16 v[112:115], v[80:83], v[236:239], v[112:115]
ds_read_b128 v[68:71], v8 offset:2048
ds_read_b128 v[72:75], v8 offset:4096
v_mfma_f32_16x16x32_bf16 v[96:99], v[80:83], v[232:235], v[96:99]
v_mfma_f32_16x16x32_bf16 v[100:103], v[84:87], v[232:235], v[100:103]
buffer_load_dwordx4 v15, s[12:15], s61 offen offset:1024 lds
v_mfma_f32_16x16x32_bf16 v[116:119], v[84:87], v[236:239], v[116:119]
ds_read_b128 v[76:79], v8 offset:6144
s_waitcnt lgkmcnt(3)
v_mfma_f32_16x16x32_bf16 v[120:123], v[88:91], v[236:239], v[120:123]
ds_read_b128 v[80:83], v9 offset:0
s_waitcnt vmcnt(22)
v_mfma_f32_16x16x32_bf16 v[104:107], v[88:91], v[232:235], v[104:107]
s_barrier
v_mfma_f32_16x16x32_bf16 v[108:111], v[92:95], v[232:235], v[108:111]
s_add_u32 m0, s3, 147456
s_add_u32 s61, s65, 3096832
v_mfma_f32_16x16x32_bf16 v[124:127], v[92:95], v[236:239], v[124:127]
buffer_load_dwordx4 v14, s[12:15], s61 offen lds
s_waitcnt vmcnt(21)
v_mfma_f32_16x16x32_bf16 v[112:115], v[64:67], v[244:247], v[112:115]
ds_read_b128 v[84:87], v9 offset:2048
ds_read_b128 v[88:91], v9 offset:4096
v_mfma_f32_16x16x32_bf16 v[96:99], v[64:67], v[240:243], v[96:99]
s_waitcnt lgkmcnt(3)
v_mfma_f32_16x16x32_bf16 v[100:103], v[68:71], v[240:243], v[100:103]
ds_read_b128 v[92:95], v9 offset:6144
v_add_u32 v8, 16384, v8
v_mfma_f32_16x16x32_bf16 v[116:119], v[68:71], v[244:247], v[116:119]
v_add_u32 v9, 16384, v9
v_mfma_f32_16x16x32_bf16 v[120:123], v[72:75], v[244:247], v[120:123]
buffer_load_dwordx4 v15, s[12:15], s61 offen offset:1024 lds
v_mfma_f32_16x16x32_bf16 v[104:107], v[72:75], v[240:243], v[104:107]
ds_read_b64_tr_b16 v[64:65], v52 offset:57344
ds_read_b64_tr_b16 v[66:67], v52 offset:58368
v_mfma_f32_16x16x32_bf16 v[108:111], v[76:79], v[240:243], v[108:111]
s_add_u32 m0, s3, 98304
s_add_u32 s61, s40, 3096832
v_mfma_f32_16x16x32_bf16 v[124:127], v[76:79], v[244:247], v[124:127]
buffer_load_dwordx4 v14, s[12:15], s61 offen lds
s_waitcnt vmcnt(21) lgkmcnt(5)
v_mfma_f32_16x16x32_bf16 v[112:115], v[80:83], v[252:255], v[112:115]
ds_read_b64_tr_b16 v[68:69], v55 offset:57344
ds_read_b64_tr_b16 v[70:71], v55 offset:58368
v_mfma_f32_16x16x32_bf16 v[96:99], v[80:83], v[248:251], v[96:99]
s_waitcnt lgkmcnt(5)
ds_read_b64_tr_b16 v[72:73], v58 offset:57344
v_mfma_f32_16x16x32_bf16 v[100:103], v[84:87], v[248:251], v[100:103]
ds_read_b64_tr_b16 v[74:75], v58 offset:58368
v_mfma_f32_16x16x32_bf16 v[116:119], v[84:87], v[252:255], v[116:119]
buffer_load_dwordx4 v15, s[12:15], s61 offen offset:1024 lds
v_mfma_f32_16x16x32_bf16 v[120:123], v[88:91], v[252:255], v[120:123]
ds_read_b64_tr_b16 v[76:77], v61 offset:57344
ds_read_b64_tr_b16 v[78:79], v61 offset:58368
v_mfma_f32_16x16x32_bf16 v[104:107], v[88:91], v[248:251], v[104:107]
ds_read_b64_tr_b16 v[80:81], v52 offset:61440
ds_read_b64_tr_b16 v[82:83], v52 offset:62464
s_waitcnt lgkmcnt(10)
v_mfma_f32_16x16x32_bf16 v[108:111], v[92:95], v[248:251], v[108:111]
s_waitcnt lgkmcnt(6)
s_add_u32 m0, s3, 65536
s_add_u32 s61, s64, 3318016
v_mfma_f32_16x16x32_bf16 v[124:127], v[92:95], v[252:255], v[124:127]
buffer_load_dwordx4 v14, s[12:15], s61 offen lds
v_mfma_f32_16x16x32_bf16 v[144:147], v[64:67], a[228:231], v[144:147]
ds_read_b64_tr_b16 v[84:85], v55 offset:61440
ds_read_b64_tr_b16 v[86:87], v55 offset:62464
v_mfma_f32_16x16x32_bf16 v[128:131], v[64:67], a[224:227], v[128:131]
ds_read_b64_tr_b16 v[88:89], v58 offset:61440
ds_read_b64_tr_b16 v[90:91], v58 offset:62464
v_mfma_f32_16x16x32_bf16 v[132:135], v[68:71], a[224:227], v[132:135]
ds_read_b64_tr_b16 v[92:93], v61 offset:61440
ds_read_b64_tr_b16 v[94:95], v61 offset:62464
s_waitcnt lgkmcnt(6)
v_mfma_f32_16x16x32_bf16 v[148:151], v[68:71], a[228:231], v[148:151]
v_add_u32 v8, 24576, v8
v_add_u32 v9, 24576, v9
v_mfma_f32_16x16x32_bf16 v[152:155], v[72:75], a[228:231], v[152:155]
buffer_load_dwordx4 v15, s[12:15], s61 offen offset:1024 lds
v_mfma_f32_16x16x32_bf16 v[136:139], v[72:75], a[224:227], v[136:139]
ds_read_b64_tr_b16 v[64:65], v53 offset:16384
ds_read_b64_tr_b16 v[66:67], v53 offset:17408
v_mfma_f32_16x16x32_bf16 v[140:143], v[76:79], a[224:227], v[140:143]
s_add_u32 m0, s3, 73728
s_add_u32 s61, s65, 3318016
v_mfma_f32_16x16x32_bf16 v[156:159], v[76:79], a[228:231], v[156:159]
buffer_load_dwordx4 v14, s[12:15], s61 offen lds
v_mfma_f32_16x16x32_bf16 v[144:147], v[80:83], a[236:239], v[144:147]
ds_read_b64_tr_b16 v[68:69], v56 offset:16384
ds_read_b64_tr_b16 v[70:71], v56 offset:17408
ds_read_b64_tr_b16 v[72:73], v59 offset:16384
ds_read_b64_tr_b16 v[74:75], v59 offset:17408
v_mfma_f32_16x16x32_bf16 v[128:131], v[80:83], a[232:235], v[128:131]
s_waitcnt lgkmcnt(6)
v_cvt_pk_bf16_f32 v96, v96, v97
v_cvt_pk_bf16_f32 v97, v98, v99
v_mfma_f32_16x16x32_bf16 v[132:135], v[84:87], a[232:235], v[132:135]
v_cvt_pk_bf16_f32 v98, v100, v101
L_stub16:
s_cbranch_execz L_stub20
v_cvt_pk_bf16_f32 v99, v102, v103
s_add_u32 s99, s82, 0
v_mfma_f32_16x16x32_bf16 v[148:151], v[84:87], a[236:239], v[148:151]
buffer_store_dwordx4 v[96:99], v1, s[16:19], s99 offen offset:0 sc1
v_mfma_f32_16x16x32_bf16 v[152:155], v[88:91], a[236:239], v[152:155]
buffer_load_dwordx4 v15, s[12:15], s61 offen offset:1024 lds
v_mfma_f32_16x16x32_bf16 v[136:139], v[88:91], a[232:235], v[136:139]
ds_read_b64_tr_b16 v[76:77], v62 offset:16384
ds_read_b64_tr_b16 v[78:79], v62 offset:17408
v_mfma_f32_16x16x32_bf16 v[140:143], v[92:95], a[232:235], v[140:143]
ds_read_b64_tr_b16 v[80:81], v53 offset:20480
ds_read_b64_tr_b16 v[82:83], v53 offset:21504
v_mfma_f32_16x16x32_bf16 v[156:159], v[92:95], a[236:239], v[156:159]
ds_read_b64_tr_b16 v[84:85], v56 offset:20480
ds_read_b64_tr_b16 v[86:87], v56 offset:21504
s_waitcnt lgkmcnt(10)
v_mfma_f32_16x16x32_bf16 v[144:147], v[64:67], a[244:247], v[144:147]
s_waitcnt lgkmcnt(6)
ds_read_b64_tr_b16 v[88:89], v59 offset:20480
v_mfma_f32_16x16x32_bf16 v[128:131], v[64:67], a[240:243], v[128:131]
ds_read_b64_tr_b16 v[90:91], v59 offset:21504
v_mfma_f32_16x16x32_bf16 v[132:135], v[68:71], a[240:243], v[132:135]
ds_read_b64_tr_b16 v[92:93], v62 offset:20480
ds_read_b64_tr_b16 v[94:95], v62 offset:21504
v_mfma_f32_16x16x32_bf16 v[148:151], v[68:71], a[244:247], v[148:151]
v_add_u32 v8, 4294918144, v8
v_add_u32 v9, 4294918144, v9
A1_E:
L_stub17:
s_cbranch_execz L_visit_end
v_mfma_f32_16x16x32_bf16 v[152:155], v[72:75], a[244:247], v[152:155]
ds_read_b128 v[64:67], v8 offset:0
s_waitcnt lgkmcnt(3)
v_mfma_f32_16x16x32_bf16 v[136:139], v[72:75], a[240:243], v[136:139]
v_mfma_f32_16x16x32_bf16 v[140:143], v[76:79], a[240:243], v[140:143]
ds_read_b128 v[68:71], v8 offset:2048
v_cvt_pk_bf16_f32 v104, v104, v105
v_cvt_pk_bf16_f32 v105, v106, v107
v_mfma_f32_16x16x32_bf16 v[156:159], v[76:79], a[244:247], v[156:159]
v_cvt_pk_bf16_f32 v106, v108, v109
v_cvt_pk_bf16_f32 v107, v110, v111
v_mfma_f32_16x16x32_bf16 v[144:147], v[80:83], a[252:255], v[144:147]
s_add_u32 s99, s82, 0
v_mfma_f32_16x16x32_bf16 v[128:131], v[80:83], a[248:251], v[128:131]
buffer_store_dwordx4 v[104:107], v1, s[16:19], s99 offen offset:1024 sc1
v_mfma_f32_16x16x32_bf16 v[132:135], v[84:87], a[248:251], v[132:135]
ds_read_b128 v[72:75], v8 offset:4096
ds_read_b128 v[76:79], v8 offset:6144
v_mfma_f32_16x16x32_bf16 v[148:151], v[84:87], a[252:255], v[148:151]
s_waitcnt lgkmcnt(3)
v_mfma_f32_16x16x32_bf16 v[152:155], v[88:91], a[252:255], v[152:155]
ds_read_b128 v[80:83], v9 offset:0
v_mfma_f32_16x16x32_bf16 v[136:139], v[88:91], a[248:251], v[136:139]
v_mfma_f32_16x16x32_bf16 v[140:143], v[92:95], a[248:251], v[140:143]
ds_read_b128 v[84:87], v9 offset:2048
v_mfma_f32_16x16x32_bf16 v[156:159], v[92:95], a[252:255], v[156:159]
v_mfma_f32_16x16x32_bf16 v[144:147], v[64:67], v[228:231], v[144:147]
ds_read_b128 v[88:91], v9 offset:4096
s_waitcnt lgkmcnt(3)
v_mfma_f32_16x16x32_bf16 v[128:131], v[64:67], v[224:227], v[128:131]
v_mfma_f32_16x16x32_bf16 v[132:135], v[68:71], v[224:227], v[132:135]
ds_read_b128 v[92:95], v9 offset:6144
v_add_u32 v8, 4294934528, v8
v_mfma_f32_16x16x32_bf16 v[148:151], v[68:71], v[228:231], v[148:151]
v_add_u32 v9, 4294934528, v9
v_mfma_f32_16x16x32_bf16 v[152:155], v[72:75], v[228:231], v[152:155]
ds_read_b128 v[64:67], v8 offset:0
v_cvt_pk_bf16_f32 v112, v112, v113
v_cvt_pk_bf16_f32 v113, v114, v115
v_mfma_f32_16x16x32_bf16 v[136:139], v[72:75], v[224:227], v[136:139]
v_cvt_pk_bf16_f32 v114, v116, v117
v_cvt_pk_bf16_f32 v115, v118, v119
v_mfma_f32_16x16x32_bf16 v[140:143], v[76:79], v[224:227], v[140:143]
s_add_u32 s99, s82, 0
v_mfma_f32_16x16x32_bf16 v[156:159], v[76:79], v[228:231], v[156:159]
buffer_store_dwordx4 v[112:115], v1, s[16:19], s99 offen offset:2048 sc1
s_waitcnt lgkmcnt(4)
v_mfma_f32_16x16x32_bf16 v[144:147], v[80:83], v[236:239], v[144:147]
ds_read_b128 v[68:71], v8 offset:2048
s_waitcnt lgkmcnt(3)
v_mfma_f32_16x16x32_bf16 v[128:131], v[80:83], v[232:235], v[128:131]
ds_read_b128 v[72:75], v8 offset:4096
v_mfma_f32_16x16x32_bf16 v[132:135], v[84:87], v[232:235], v[132:135]
ds_read_b128 v[76:79], v8 offset:6144
v_mfma_f32_16x16x32_bf16 v[148:151], v[84:87], v[236:239], v[148:151]
v_mfma_f32_16x16x32_bf16 v[152:155], v[88:91], v[236:239], v[152:155]
ds_read_b128 v[80:83], v9 offset:0
s_waitcnt lgkmcnt(3)
v_mfma_f32_16x16x32_bf16 v[136:139], v[88:91], v[232:235], v[136:139]
s_waitcnt vmcnt(21)
s_barrier
v_mfma_f32_16x16x32_bf16 v[140:143], v[92:95], v[232:235], v[140:143]
s_add_u32 m0, s3, 24576
s_add_u32 s61, s40, 3318016
v_mfma_f32_16x16x32_bf16 v[156:159], v[92:95], v[236:239], v[156:159]
buffer_load_dwordx4 v14, s[12:15], s61 offen lds
v_mfma_f32_16x16x32_bf16 v[144:147], v[64:67], v[244:247], v[144:147]
ds_read_b128 v[84:87], v9 offset:2048
ds_read_b128 v[88:91], v9 offset:4096
v_mfma_f32_16x16x32_bf16 v[128:131], v[64:67], v[240:243], v[128:131]
v_mfma_f32_16x16x32_bf16 v[132:135], v[68:71], v[240:243], v[132:135]
buffer_load_dwordx4 v15, s[12:15], s61 offen offset:1024 lds
ds_read_b128 v[92:95], v9 offset:6144
s_waitcnt lgkmcnt(3)
v_mfma_f32_16x16x32_bf16 v[148:151], v[68:71], v[244:247], v[148:151]
v_cvt_pk_bf16_f32 v120, v120, v121
v_cvt_pk_bf16_f32 v121, v122, v123
v_cvt_pk_bf16_f32 v122, v124, v125
v_mfma_f32_16x16x32_bf16 v[152:155], v[72:75], v[244:247], v[152:155]
v_cvt_pk_bf16_f32 v123, v126, v127
s_add_u32 s99, s82, 0
v_mfma_f32_16x16x32_bf16 v[136:139], v[72:75], v[240:243], v[136:139]
buffer_store_dwordx4 v[120:123], v1, s[16:19], s99 offen offset:3072 sc1
v_mfma_f32_16x16x32_bf16 v[140:143], v[76:79], v[240:243], v[140:143]
ds_read_b64_tr_b16 v[64:65], v52 offset:8192
ds_read_b64_tr_b16 v[66:67], v52 offset:9216
s_add_u32 m0, s3, 40960
v_mfma_f32_16x16x32_bf16 v[156:159], v[76:79], v[244:247], v[156:159]
s_lshl_b32 s61, s76, 1
s_add_u32 s61, s61, s74
v_mfma_f32_16x16x32_bf16 v[144:147], v[80:83], v[252:255], v[144:147]
buffer_load_dwordx4 v18, s[36:39], s61 offen lds
ds_read_b64_tr_b16 v[68:69], v55 offset:8192
v_mfma_f32_16x16x32_bf16 v[128:131], v[80:83], v[248:251], v[128:131]
ds_read_b64_tr_b16 v[70:71], v55 offset:9216
ds_read_b64_tr_b16 v[72:73], v52 offset:12288
s_waitcnt lgkmcnt(7)
v_mfma_f32_16x16x32_bf16 v[132:135], v[84:87], v[248:251], v[132:135]
ds_read_b64_tr_b16 v[74:75], v52 offset:13312
s_waitcnt lgkmcnt(6)
v_mfma_f32_16x16x32_bf16 v[148:151], v[84:87], v[252:255], v[148:151]
buffer_load_dwordx4 v19, s[36:39], s61 offen offset:1024 lds
v_mfma_f32_16x16x32_bf16 v[152:155], v[88:91], v[252:255], v[152:155]
ds_read_b64_tr_b16 v[76:77], v55 offset:12288
ds_read_b64_tr_b16 v[78:79], v55 offset:13312
v_mfma_f32_16x16x32_bf16 v[136:139], v[88:91], v[248:251], v[136:139]
ds_read_b64_tr_b16 v[80:81], v52 offset:16384
ds_read_b64_tr_b16 v[82:83], v52 offset:17408
v_mfma_f32_16x16x32_bf16 v[140:143], v[92:95], v[248:251], v[140:143]
s_add_u32 m0, s3, 57344
s_lshl_b32 s61, s76, 1
s_add_u32 s61, s61, s75
v_mfma_f32_16x16x32_bf16 v[156:159], v[92:95], v[252:255], v[156:159]
buffer_load_dwordx4 v18, s[24:27], s61 offen lds
s_waitcnt lgkmcnt(8)
v_mfma_f32_16x16x32_bf16 v[176:179], v[64:67], a[4:7], 0
ds_read_b64_tr_b16 v[84:85], v55 offset:16384
ds_read_b64_tr_b16 v[86:87], v55 offset:17408
v_mfma_f32_16x16x32_bf16 v[160:163], v[64:67], a[0:3], 0
s_waitcnt lgkmcnt(6)
ds_read_b64_tr_b16 v[88:89], v52 offset:20480
v_mfma_f32_16x16x32_bf16 v[164:167], v[68:71], a[0:3], 0
ds_read_b64_tr_b16 v[90:91], v52 offset:21504
v_mfma_f32_16x16x32_bf16 v[180:183], v[68:71], a[4:7], 0
buffer_load_dwordx4 v19, s[24:27], s61 offen offset:1024 lds
v_mfma_f32_16x16x32_bf16 v[176:179], v[72:75], a[12:15], v[176:179]
ds_read_b64_tr_b16 v[92:93], v55 offset:20480
ds_read_b64_tr_b16 v[94:95], v55 offset:21504
v_mfma_f32_16x16x32_bf16 v[160:163], v[72:75], a[8:11], v[160:163]
ds_read_b64_tr_b16 v[64:65], v52 offset:49152
ds_read_b64_tr_b16 v[66:67], v52 offset:50176
s_waitcnt lgkmcnt(10)
v_mfma_f32_16x16x32_bf16 v[164:167], v[76:79], a[8:11], v[164:167]
s_waitcnt lgkmcnt(6)
s_add_u32 m0, s3, 81920
s_add_u32 s61, s77, 147456
v_mfma_f32_16x16x32_bf16 v[180:183], v[76:79], a[12:15], v[180:183]
buffer_load_dwordx4 v16, s[28:31], s61 offen lds
v_mfma_f32_16x16x32_bf16 v[176:179], v[80:83], a[20:23], v[176:179]
ds_read_b64_tr_b16 v[68:69], v55 offset:49152
ds_read_b64_tr_b16 v[70:71], v55 offset:50176
ds_read_b64_tr_b16 v[72:73], v52 offset:53248
ds_read_b64_tr_b16 v[74:75], v52 offset:54272
v_mfma_f32_16x16x32_bf16 v[160:163], v[80:83], a[16:19], v[160:163]
v_cvt_pk_bf16_f32 v128, v128, v129
v_cvt_pk_bf16_f32 v129, v130, v131
v_cvt_pk_bf16_f32 v130, v132, v133
v_mfma_f32_16x16x32_bf16 v[164:167], v[84:87], a[16:19], v[164:167]
v_cvt_pk_bf16_f32 v131, v134, v135
s_add_u32 s99, s82, 4096
v_mfma_f32_16x16x32_bf16 v[180:183], v[84:87], a[20:23], v[180:183]
buffer_store_dwordx4 v[128:131], v1, s[16:19], s99 offen offset:0 sc1
s_waitcnt lgkmcnt(8)
v_mfma_f32_16x16x32_bf16 v[176:179], v[88:91], a[28:31], v[176:179]
buffer_load_dwordx4 v17, s[28:31], s61 offen offset:1024 lds
ds_read_b64_tr_b16 v[76:77], v55 offset:53248
v_mfma_f32_16x16x32_bf16 v[160:163], v[88:91], a[24:27], v[160:163]
ds_read_b64_tr_b16 v[78:79], v55 offset:54272
s_waitcnt lgkmcnt(6)
v_mfma_f32_16x16x32_bf16 v[164:167], v[92:95], a[24:27], v[164:167]
ds_read_b64_tr_b16 v[80:81], v53 offset:24576
ds_read_b64_tr_b16 v[82:83], v53 offset:25600
s_waitcnt vmcnt(23)
s_barrier
v_mfma_f32_16x16x32_bf16 v[180:183], v[92:95], a[28:31], v[180:183]
s_add_u32 m0, s3, 32768
s_add_u32 s61, s77, 147456
v_mfma_f32_16x16x32_bf16 v[176:179], v[64:67], a[36:39], v[176:179]
buffer_load_dwordx4 v16, s[32:35], s61 offen lds
ds_read_b64_tr_b16 v[84:85], v56 offset:24576
v_mfma_f32_16x16x32_bf16 v[160:163], v[64:67], a[32:35], v[160:163]
ds_read_b64_tr_b16 v[86:87], v56 offset:25600
ds_read_b64_tr_b16 v[88:89], v53 offset:28672
s_waitcnt lgkmcnt(9)
v_mfma_f32_16x16x32_bf16 v[164:167], v[68:71], a[32:35], v[164:167]
ds_read_b64_tr_b16 v[90:91], v53 offset:29696
s_waitcnt lgkmcnt(6)
buffer_load_dwordx4 v17, s[32:35], s61 offen offset:1024 lds
ds_read_b64_tr_b16 v[92:93], v56 offset:28672
v_mfma_f32_16x16x32_bf16 v[180:183], v[68:71], a[36:39], v[180:183]
ds_read_b64_tr_b16 v[94:95], v56 offset:29696
v_cvt_pk_bf16_f32 v136, v136, v137
v_cvt_pk_bf16_f32 v137, v138, v139
v_mfma_f32_16x16x32_bf16 v[176:179], v[72:75], a[44:47], v[176:179]
v_cvt_pk_bf16_f32 v138, v140, v141
v_cvt_pk_bf16_f32 v139, v142, v143
s_add_u32 s99, s82, 4096
v_mfma_f32_16x16x32_bf16 v[160:163], v[72:75], a[40:43], v[160:163]
buffer_store_dwordx4 v[136:139], v1, s[16:19], s99 offen offset:1024 sc1
v_mfma_f32_16x16x32_bf16 v[164:167], v[76:79], a[40:43], v[164:167]
ds_read_b64_tr_b16 v[64:65], v54 offset:8192
ds_read_b64_tr_b16 v[66:67], v54 offset:9216
v_mfma_f32_16x16x32_bf16 v[180:183], v[76:79], a[44:47], v[180:183]
ds_read_b64_tr_b16 v[68:69], v57 offset:8192
ds_read_b64_tr_b16 v[70:71], v57 offset:9216
s_waitcnt lgkmcnt(10)
v_mfma_f32_16x16x32_bf16 v[176:179], v[80:83], a[52:55], v[176:179]
s_waitcnt lgkmcnt(6)
ds_read_b64_tr_b16 v[72:73], v54 offset:12288
v_mfma_f32_16x16x32_bf16 v[160:163], v[80:83], a[48:51], v[160:163]
ds_read_b64_tr_b16 v[74:75], v54 offset:13312
v_mfma_f32_16x16x32_bf16 v[164:167], v[84:87], a[48:51], v[164:167]
ds_read_b64_tr_b16 v[76:77], v57 offset:12288
ds_read_b64_tr_b16 v[78:79], v57 offset:13312
v_mfma_f32_16x16x32_bf16 v[180:183], v[84:87], a[52:55], v[180:183]
v_mfma_f32_16x16x32_bf16 v[176:179], v[88:91], a[60:63], v[176:179]
ds_read_b64_tr_b16 v[80:81], v53 offset:40960
ds_read_b64_tr_b16 v[82:83], v53 offset:41984
s_waitcnt lgkmcnt(6)
v_cvt_pk_bf16_f32 v144, v144, v145
v_mfma_f32_16x16x32_bf16 v[160:163], v[88:91], a[56:59], v[160:163]
v_cvt_pk_bf16_f32 v145, v146, v147
v_cvt_pk_bf16_f32 v146, v148, v149
v_mfma_f32_16x16x32_bf16 v[164:167], v[92:95], a[56:59], v[164:167]
v_cvt_pk_bf16_f32 v147, v150, v151
s_add_u32 s99, s82, 4096
v_mfma_f32_16x16x32_bf16 v[180:183], v[92:95], a[60:63], v[180:183]
buffer_store_dwordx4 v[144:147], v1, s[16:19], s99 offen offset:2048 sc1
v_mfma_f32_16x16x32_bf16 v[176:179], v[64:67], a[68:71], v[176:179]
ds_read_b64_tr_b16 v[84:85], v56 offset:40960
ds_read_b64_tr_b16 v[86:87], v56 offset:41984
v_mfma_f32_16x16x32_bf16 v[160:163], v[64:67], a[64:67], v[160:163]
ds_read_b64_tr_b16 v[88:89], v53 offset:45056
ds_read_b64_tr_b16 v[90:91], v53 offset:46080
v_mfma_f32_16x16x32_bf16 v[164:167], v[68:71], a[64:67], v[164:167]
ds_read_b64_tr_b16 v[92:93], v56 offset:45056
ds_read_b64_tr_b16 v[94:95], v56 offset:46080
v_mfma_f32_16x16x32_bf16 v[180:183], v[68:71], a[68:71], v[180:183]
s_waitcnt lgkmcnt(6)
v_mfma_f32_16x16x32_bf16 v[176:179], v[72:75], a[76:79], v[176:179]
ds_read_b64_tr_b16 v[64:65], v53 offset:49152
ds_read_b64_tr_b16 v[66:67], v53 offset:50176
v_mfma_f32_16x16x32_bf16 v[160:163], v[72:75], a[72:75], v[160:163]
v_mfma_f32_16x16x32_bf16 v[164:167], v[76:79], a[72:75], v[164:167]
ds_read_b64_tr_b16 v[68:69], v56 offset:49152
ds_read_b64_tr_b16 v[70:71], v56 offset:50176
v_cvt_pk_bf16_f32 v152, v152, v153
v_mfma_f32_16x16x32_bf16 v[180:183], v[76:79], a[76:79], v[180:183]
v_cvt_pk_bf16_f32 v153, v154, v155
v_cvt_pk_bf16_f32 v154, v156, v157
v_mfma_f32_16x16x32_bf16 v[176:179], v[80:83], a[84:87], v[176:179]
v_cvt_pk_bf16_f32 v155, v158, v159
s_add_u32 s99, s82, 4096
v_mfma_f32_16x16x32_bf16 v[160:163], v[80:83], a[80:83], v[160:163]
buffer_store_dwordx4 v[152:155], v1, s[16:19], s99 offen offset:3072 sc1
s_waitcnt lgkmcnt(8)
v_mfma_f32_16x16x32_bf16 v[164:167], v[84:87], a[80:83], v[164:167]
ds_read_b64_tr_b16 v[72:73], v53 offset:53248
ds_read_b64_tr_b16 v[74:75], v53 offset:54272
v_mfma_f32_16x16x32_bf16 v[180:183], v[84:87], a[84:87], v[180:183]
s_waitcnt lgkmcnt(6)
ds_read_b64_tr_b16 v[76:77], v56 offset:53248
v_mfma_f32_16x16x32_bf16 v[176:179], v[88:91], a[92:95], v[176:179]
ds_read_b64_tr_b16 v[78:79], v56 offset:54272
ds_read_b64_tr_b16 v[80:81], v53 offset:57344
v_mfma_f32_16x16x32_bf16 v[160:163], v[88:91], a[88:91], v[160:163]
ds_read_b64_tr_b16 v[82:83], v53 offset:58368
v_mfma_f32_16x16x32_bf16 v[164:167], v[92:95], a[88:91], v[164:167]
ds_read_b64_tr_b16 v[84:85], v56 offset:57344
ds_read_b64_tr_b16 v[86:87], v56 offset:58368
v_mfma_f32_16x16x32_bf16 v[180:183], v[92:95], a[92:95], v[180:183]
s_waitcnt lgkmcnt(6)
v_mfma_f32_16x16x32_bf16 v[176:179], v[64:67], a[100:103], v[176:179]
ds_read_b64_tr_b16 v[88:89], v53 offset:61440
ds_read_b64_tr_b16 v[90:91], v53 offset:62464
v_mfma_f32_16x16x32_bf16 v[160:163], v[64:67], a[96:99], v[160:163]
s_waitcnt vmcnt(17)
s_barrier
v_mfma_f32_16x16x32_bf16 v[164:167], v[68:71], a[96:99], v[164:167]
ds_read_b64_tr_b16 v[92:93], v56 offset:61440
ds_read_b64_tr_b16 v[94:95], v56 offset:62464
v_mfma_f32_16x16x32_bf16 v[180:183], v[68:71], a[100:103], v[180:183]
v_mfma_f32_16x16x32_bf16 v[176:179], v[72:75], a[108:111], v[176:179]
ds_read_b64_tr_b16 v[64:65], v54 offset:0
ds_read_b64_tr_b16 v[66:67], v54 offset:1024
v_mfma_f32_16x16x32_bf16 v[160:163], v[72:75], a[104:107], v[160:163]
s_waitcnt lgkmcnt(6)
v_mfma_f32_16x16x32_bf16 v[164:167], v[76:79], a[104:107], v[164:167]
ds_read_b64_tr_b16 v[68:69], v57 offset:0
ds_read_b64_tr_b16 v[70:71], v57 offset:1024
v_mfma_f32_16x16x32_bf16 v[180:183], v[76:79], a[108:111], v[180:183]
v_mfma_f32_16x16x32_bf16 v[176:179], v[80:83], a[116:119], v[176:179]
ds_read_b64_tr_b16 v[72:73], v54 offset:4096
ds_read_b64_tr_b16 v[74:75], v54 offset:5120
v_mfma_f32_16x16x32_bf16 v[160:163], v[80:83], a[112:115], v[160:163]
v_mfma_f32_16x16x32_bf16 v[164:167], v[84:87], a[112:115], v[164:167]
ds_read_b64_tr_b16 v[76:77], v57 offset:4096
ds_read_b64_tr_b16 v[78:79], v57 offset:5120
v_mfma_f32_16x16x32_bf16 v[180:183], v[84:87], a[116:119], v[180:183]
s_waitcnt lgkmcnt(6)
v_mfma_f32_16x16x32_bf16 v[176:179], v[88:91], a[124:127], v[176:179]
ds_read_b64_tr_b16 v[80:81], v54 offset:16384
ds_read_b64_tr_b16 v[82:83], v54 offset:17408
v_mfma_f32_16x16x32_bf16 v[160:163], v[88:91], a[120:123], v[160:163]
v_mfma_f32_16x16x32_bf16 v[164:167], v[92:95], a[120:123], v[164:167]
ds_read_b64_tr_b16 v[84:85], v57 offset:16384
ds_read_b64_tr_b16 v[86:87], v57 offset:17408
v_mfma_f32_16x16x32_bf16 v[180:183], v[92:95], a[124:127], v[180:183]
v_mfma_f32_16x16x32_bf16 v[176:179], v[64:67], a[132:135], v[176:179]
ds_read_b64_tr_b16 v[88:89], v54 offset:20480
ds_read_b64_tr_b16 v[90:91], v54 offset:21504
v_mfma_f32_16x16x32_bf16 v[160:163], v[64:67], a[128:131], v[160:163]
s_waitcnt lgkmcnt(6)
v_mfma_f32_16x16x32_bf16 v[164:167], v[68:71], a[128:131], v[164:167]
ds_read_b64_tr_b16 v[92:93], v57 offset:20480
ds_read_b64_tr_b16 v[94:95], v57 offset:21504
v_mfma_f32_16x16x32_bf16 v[180:183], v[68:71], a[132:135], v[180:183]
v_mfma_f32_16x16x32_bf16 v[176:179], v[72:75], a[140:143], v[176:179]
ds_read_b64_tr_b16 v[64:65], v53 offset:32768
ds_read_b64_tr_b16 v[66:67], v53 offset:33792
v_mfma_f32_16x16x32_bf16 v[160:163], v[72:75], a[136:139], v[160:163]
v_mfma_f32_16x16x32_bf16 v[164:167], v[76:79], a[136:139], v[164:167]
ds_read_b64_tr_b16 v[68:69], v56 offset:32768
ds_read_b64_tr_b16 v[70:71], v56 offset:33792
v_mfma_f32_16x16x32_bf16 v[180:183], v[76:79], a[140:143], v[180:183]
s_waitcnt lgkmcnt(6)
v_mfma_f32_16x16x32_bf16 v[176:179], v[80:83], a[148:151], v[176:179]
ds_read_b64_tr_b16 v[72:73], v53 offset:36864
ds_read_b64_tr_b16 v[74:75], v53 offset:37888
v_mfma_f32_16x16x32_bf16 v[160:163], v[80:83], a[144:147], v[160:163]
v_mfma_f32_16x16x32_bf16 v[164:167], v[84:87], a[144:147], v[164:167]
ds_read_b64_tr_b16 v[76:77], v56 offset:36864
ds_read_b64_tr_b16 v[78:79], v56 offset:37888
v_mfma_f32_16x16x32_bf16 v[180:183], v[84:87], a[148:151], v[180:183]
v_mfma_f32_16x16x32_bf16 v[176:179], v[88:91], a[156:159], v[176:179]
ds_read_b64_tr_b16 v[80:81], v53 offset:0
ds_read_b64_tr_b16 v[82:83], v53 offset:1024
v_mfma_f32_16x16x32_bf16 v[160:163], v[88:91], a[152:155], v[160:163]
s_waitcnt lgkmcnt(6)
v_mfma_f32_16x16x32_bf16 v[164:167], v[92:95], a[152:155], v[164:167]
ds_read_b64_tr_b16 v[84:85], v56 offset:0
ds_read_b64_tr_b16 v[86:87], v56 offset:1024
v_mfma_f32_16x16x32_bf16 v[180:183], v[92:95], a[156:159], v[180:183]
v_mfma_f32_16x16x32_bf16 v[176:179], v[64:67], a[164:167], v[176:179]
ds_read_b64_tr_b16 v[88:89], v53 offset:4096
ds_read_b64_tr_b16 v[90:91], v53 offset:5120
v_mfma_f32_16x16x32_bf16 v[160:163], v[64:67], a[160:163], v[160:163]
v_mfma_f32_16x16x32_bf16 v[164:167], v[68:71], a[160:163], v[164:167]
ds_read_b64_tr_b16 v[92:93], v56 offset:4096
ds_read_b64_tr_b16 v[94:95], v56 offset:5120
v_mfma_f32_16x16x32_bf16 v[180:183], v[68:71], a[164:167], v[180:183]
s_waitcnt lgkmcnt(6)
v_mfma_f32_16x16x32_bf16 v[176:179], v[72:75], a[172:175], v[176:179]
ds_read_b64_tr_b16 v[64:65], v53 offset:8192
ds_read_b64_tr_b16 v[66:67], v53 offset:9216
v_mfma_f32_16x16x32_bf16 v[160:163], v[72:75], a[168:171], v[160:163]
s_waitcnt vmcnt(3)
s_barrier
v_mfma_f32_16x16x32_bf16 v[164:167], v[76:79], a[168:171], v[164:167]
ds_read_b64_tr_b16 v[68:69], v56 offset:8192
ds_read_b64_tr_b16 v[70:71], v56 offset:9216
v_mfma_f32_16x16x32_bf16 v[180:183], v[76:79], a[172:175], v[180:183]
v_mfma_f32_16x16x32_bf16 v[176:179], v[80:83], a[180:183], v[176:179]
ds_read_b64_tr_b16 v[72:73], v53 offset:12288
ds_read_b64_tr_b16 v[74:75], v53 offset:13312
v_mfma_f32_16x16x32_bf16 v[160:163], v[80:83], a[176:179], v[160:163]
s_waitcnt lgkmcnt(6)
v_mfma_f32_16x16x32_bf16 v[164:167], v[84:87], a[176:179], v[164:167]
ds_read_b64_tr_b16 v[76:77], v56 offset:12288
ds_read_b64_tr_b16 v[78:79], v56 offset:13312
v_mfma_f32_16x16x32_bf16 v[180:183], v[84:87], a[180:183], v[180:183]
s_cmp_eq_u32 s47, 4
s_cbranch_scc1 L_endN
v_mfma_f32_16x16x32_bf16 v[176:179], v[88:91], a[188:191], v[176:179]
ds_read_b64_tr_b16 v[80:81], v52 offset:24576
ds_read_b64_tr_b16 v[82:83], v52 offset:25600
v_mfma_f32_16x16x32_bf16 v[160:163], v[88:91], a[184:187], v[160:163]
v_mfma_f32_16x16x32_bf16 v[164:167], v[92:95], a[184:187], v[164:167]
ds_read_b64_tr_b16 v[84:85], v55 offset:24576
ds_read_b64_tr_b16 v[86:87], v55 offset:25600
v_mfma_f32_16x16x32_bf16 v[180:183], v[92:95], a[188:191], v[180:183]
s_waitcnt lgkmcnt(6)
v_mfma_f32_16x16x32_bf16 v[176:179], v[64:67], a[196:199], v[176:179]
buffer_load_dwordx2 v[28:29], v10, s[4:7], 0 offen offset:0
v_mfma_f32_16x16x32_bf16 v[160:163], v[64:67], a[192:195], v[160:163]
ds_read_b64_tr_b16 v[88:89], v52 offset:28672
ds_read_b64_tr_b16 v[90:91], v52 offset:29696
v_mfma_f32_16x16x32_bf16 v[164:167], v[68:71], a[192:195], v[164:167]
ds_read_b64_tr_b16 v[92:93], v55 offset:28672
ds_read_b64_tr_b16 v[94:95], v55 offset:29696
v_mfma_f32_16x16x32_bf16 v[180:183], v[68:71], a[196:199], v[180:183]
v_add_u32 v8, 40960, v8
v_add_u32 v9, 40960, v9
v_mfma_f32_16x16x32_bf16 v[176:179], v[72:75], a[204:207], v[176:179]
ds_read_b128 v[64:67], v8 offset:0
s_waitcnt lgkmcnt(5)
v_mfma_f32_16x16x32_bf16 v[160:163], v[72:75], a[200:203], v[160:163]
global_load_dwordx2 v[36:37], v24, s[80:81] offset:0
v_mfma_f32_16x16x32_bf16 v[164:167], v[76:79], a[200:203], v[164:167]
ds_read_b128 v[68:71], v8 offset:2048
v_mfma_f32_16x16x32_bf16 v[180:183], v[76:79], a[204:207], v[180:183]
v_mfma_f32_16x16x32_bf16 v[176:179], v[80:83], a[212:215], v[176:179]
ds_read_b128 v[72:75], v9 offset:0
v_mfma_f32_16x16x32_bf16 v[160:163], v[80:83], a[208:211], v[160:163]
s_waitcnt vmcnt(2)
buffer_store_dword v13, v26, s[16:19], s94 offen offset:0 sc1
v_mfma_f32_16x16x32_bf16 v[164:167], v[84:87], a[208:211], v[164:167]
ds_read_b128 v[76:79], v9 offset:2048
s_waitcnt lgkmcnt(3)
v_mfma_f32_16x16x32_bf16 v[180:183], v[84:87], a[212:215], v[180:183]
v_add_u32 v8, 16384, v8
v_add_u32 v9, 16384, v9
v_mfma_f32_16x16x32_bf16 v[176:179], v[88:91], a[220:223], v[176:179]
ds_read_b128 v[80:83], v8 offset:0
v_mfma_f32_16x16x32_bf16 v[160:163], v[88:91], a[216:219], v[160:163]
global_load_dwordx2 v[216:217], v24, s[90:91] offset:0
v_mfma_f32_16x16x32_bf16 v[164:167], v[92:95], a[216:219], v[164:167]
ds_read_b128 v[84:87], v8 offset:2048
v_mfma_f32_16x16x32_bf16 v[180:183], v[92:95], a[220:223], v[180:183]
v_mfma_f32_16x16x32_bf16 v[176:179], v[64:67], a[228:231], v[176:179]
ds_read_b128 v[88:91], v9 offset:0
s_waitcnt lgkmcnt(3)
v_mfma_f32_16x16x32_bf16 v[160:163], v[64:67], a[224:227], v[160:163]
v_mfma_f32_16x16x32_bf16 v[164:167], v[68:71], a[224:227], v[164:167]
ds_read_b128 v[92:95], v9 offset:2048
v_add_u32 v8, 24576, v8
v_mfma_f32_16x16x32_bf16 v[180:183], v[68:71], a[228:231], v[180:183]
v_add_u32 v9, 24576, v9
v_mfma_f32_16x16x32_bf16 v[176:179], v[72:75], a[236:239], v[176:179]
buffer_load_dwordx2 v[30:31], v10, s[4:7], 0 offen offset:32
v_mfma_f32_16x16x32_bf16 v[160:163], v[72:75], a[232:235], v[160:163]
ds_read_b128 v[64:67], v8 offset:0
v_mfma_f32_16x16x32_bf16 v[164:167], v[76:79], a[232:235], v[164:167]
ds_read_b128 v[68:71], v8 offset:2048
s_waitcnt lgkmcnt(3)
v_mfma_f32_16x16x32_bf16 v[180:183], v[76:79], a[236:239], v[180:183]
v_mfma_f32_16x16x32_bf16 v[176:179], v[80:83], a[244:247], v[176:179]
ds_read_b128 v[72:75], v9 offset:0
v_mfma_f32_16x16x32_bf16 v[160:163], v[80:83], a[240:243], v[160:163]
v_mfma_f32_16x16x32_bf16 v[164:167], v[84:87], a[240:243], v[164:167]
ds_read_b128 v[76:79], v9 offset:2048
v_add_u32 v8, 4294918144, v8
v_mfma_f32_16x16x32_bf16 v[180:183], v[84:87], a[244:247], v[180:183]
v_add_u32 v9, 4294918144, v9
v_mfma_f32_16x16x32_bf16 v[176:179], v[88:91], a[252:255], v[176:179]
global_load_dwordx2 v[38:39], v24, s[80:81] offset:32
v_mfma_f32_16x16x32_bf16 v[160:163], v[88:91], a[248:251], v[160:163]
ds_read_b128 v[80:83], v8 offset:0
s_waitcnt lgkmcnt(3)
v_mfma_f32_16x16x32_bf16 v[164:167], v[92:95], a[248:251], v[164:167]
ds_read_b128 v[84:87], v8 offset:2048
v_mfma_f32_16x16x32_bf16 v[180:183], v[92:95], a[252:255], v[180:183]
v_mfma_f32_16x16x32_bf16 v[176:179], v[64:67], v[228:231], v[176:179]
ds_read_b128 v[88:91], v9 offset:0
v_mfma_f32_16x16x32_bf16 v[160:163], v[64:67], v[224:227], v[160:163]
global_load_dwordx2 v[218:219], v24, s[90:91] offset:32
v_mfma_f32_16x16x32_bf16 v[164:167], v[68:71], v[224:227], v[164:167]
ds_read_b128 v[92:95], v9 offset:2048
s_waitcnt lgkmcnt(3)
v_mfma_f32_16x16x32_bf16 v[180:183], v[68:71], v[228:231], v[180:183]
v_mfma_f32_16x16x32_bf16 v[176:179], v[72:75], v[236:239], v[176:179]
ds_read_b64_tr_b16 v[64:65], v58 offset:8192
ds_read_b64_tr_b16 v[66:67], v58 offset:9216
v_mfma_f32_16x16x32_bf16 v[160:163], v[72:75], v[232:235], v[160:163]
v_mfma_f32_16x16x32_bf16 v[164:167], v[76:79], v[232:235], v[164:167]
ds_read_b64_tr_b16 v[68:69], v61 offset:8192
ds_read_b64_tr_b16 v[70:71], v61 offset:9216
v_mfma_f32_16x16x32_bf16 v[180:183], v[76:79], v[236:239], v[180:183]
v_mfma_f32_16x16x32_bf16 v[176:179], v[80:83], v[244:247], v[176:179]
ds_read_b64_tr_b16 v[72:73], v58 offset:12288
ds_read_b64_tr_b16 v[74:75], v58 offset:13312
v_mfma_f32_16x16x32_bf16 v[160:163], v[80:83], v[240:243], v[160:163]
s_waitcnt lgkmcnt(6)
v_mfma_f32_16x16x32_bf16 v[164:167], v[84:87], v[240:243], v[164:167]
buffer_load_dwordx2 v[32:33], v10, s[4:7], 0 offen offset:64
v_mfma_f32_16x16x32_bf16 v[180:183], v[84:87], v[244:247], v[180:183]
ds_read_b64_tr_b16 v[76:77], v61 offset:12288
ds_read_b64_tr_b16 v[78:79], v61 offset:13312
v_mfma_f32_16x16x32_bf16 v[176:179], v[88:91], v[252:255], v[176:179]
ds_read_b64_tr_b16 v[80:81], v58 offset:16384
ds_read_b64_tr_b16 v[82:83], v58 offset:17408
v_mfma_f32_16x16x32_bf16 v[160:163], v[88:91], v[248:251], v[160:163]
v_mfma_f32_16x16x32_bf16 v[164:167], v[92:95], v[248:251], v[164:167]
ds_read_b64_tr_b16 v[84:85], v61 offset:16384
ds_read_b64_tr_b16 v[86:87], v61 offset:17408
v_mfma_f32_16x16x32_bf16 v[180:183], v[92:95], v[252:255], v[180:183]
s_waitcnt lgkmcnt(6)
v_mfma_f32_16x16x32_bf16 v[184:187], v[64:67], a[4:7], 0
global_load_dwordx2 v[40:41], v24, s[80:81] offset:64
v_mfma_f32_16x16x32_bf16 v[168:171], v[64:67], a[0:3], 0
ds_read_b64_tr_b16 v[88:89], v58 offset:20480
ds_read_b64_tr_b16 v[90:91], v58 offset:21504
v_mfma_f32_16x16x32_bf16 v[172:175], v[68:71], a[0:3], 0
ds_read_b64_tr_b16 v[92:93], v61 offset:20480
ds_read_b64_tr_b16 v[94:95], v61 offset:21504
v_mfma_f32_16x16x32_bf16 v[188:191], v[68:71], a[4:7], 0
v_mfma_f32_16x16x32_bf16 v[184:187], v[72:75], a[12:15], v[184:187]
ds_read_b64_tr_b16 v[64:65], v58 offset:49152
ds_read_b64_tr_b16 v[66:67], v58 offset:50176
v_mfma_f32_16x16x32_bf16 v[168:171], v[72:75], a[8:11], v[168:171]
s_waitcnt lgkmcnt(6)
v_mfma_f32_16x16x32_bf16 v[172:175], v[76:79], a[8:11], v[172:175]
ds_read_b64_tr_b16 v[68:69], v61 offset:49152
ds_read_b64_tr_b16 v[70:71], v61 offset:50176
v_mfma_f32_16x16x32_bf16 v[188:191], v[76:79], a[12:15], v[188:191]
global_load_dwordx2 v[220:221], v24, s[90:91] offset:64
v_mfma_f32_16x16x32_bf16 v[184:187], v[80:83], a[20:23], v[184:187]
ds_read_b64_tr_b16 v[72:73], v58 offset:53248
ds_read_b64_tr_b16 v[74:75], v58 offset:54272
v_cvt_pk_bf16_f32 v160, v160, v161
v_mfma_f32_16x16x32_bf16 v[168:171], v[80:83], a[16:19], v[168:171]
v_cvt_pk_bf16_f32 v161, v162, v163
v_cvt_pk_bf16_f32 v162, v164, v165
v_mfma_f32_16x16x32_bf16 v[172:175], v[84:87], a[16:19], v[172:175]
v_cvt_pk_bf16_f32 v163, v166, v167
s_add_u32 s99, s82, 8192
v_mfma_f32_16x16x32_bf16 v[188:191], v[84:87], a[20:23], v[188:191]
buffer_store_dwordx4 v[160:163], v1, s[16:19], s99 offen offset:0 sc1
s_waitcnt lgkmcnt(8)
v_mfma_f32_16x16x32_bf16 v[184:187], v[88:91], a[28:31], v[184:187]
ds_read_b64_tr_b16 v[76:77], v61 offset:53248
ds_read_b64_tr_b16 v[78:79], v61 offset:54272
s_waitcnt lgkmcnt(6)
v_mfma_f32_16x16x32_bf16 v[168:171], v[88:91], a[24:27], v[168:171]
ds_read_b64_tr_b16 v[80:81], v59 offset:24576
ds_read_b64_tr_b16 v[82:83], v59 offset:25600
L_stub18:
s_cbranch_execz L_visit_end
v_mfma_f32_16x16x32_bf16 v[172:175], v[92:95], a[24:27], v[172:175]
buffer_load_dwordx2 v[34:35], v10, s[4:7], 0 offen offset:96
v_mfma_f32_16x16x32_bf16 v[188:191], v[92:95], a[28:31], v[188:191]
s_add_u32 s63, s96, 0
s_load_dwordx8 s[52:59], s[16:17], s63 glc
v_mfma_f32_16x16x32_bf16 v[184:187], v[64:67], a[36:39], v[184:187]
ds_read_b64_tr_b16 v[84:85], v62 offset:24576
ds_read_b64_tr_b16 v[86:87], v62 offset:25600
ds_read_b64_tr_b16 v[88:89], v59 offset:28672
ds_read_b64_tr_b16 v[90:91], v59 offset:29696
v_mfma_f32_16x16x32_bf16 v[168:171], v[64:67], a[32:35], v[168:171]
s_waitcnt lgkmcnt(6)
v_cvt_pk_bf16_f32 v176, v176, v177
v_cvt_pk_bf16_f32 v177, v178, v179
v_mfma_f32_16x16x32_bf16 v[172:175], v[68:71], a[32:35], v[172:175]
v_cvt_pk_bf16_f32 v178, v180, v181
v_cvt_pk_bf16_f32 v179, v182, v183
s_add_u32 s99, s82, 8192
v_mfma_f32_16x16x32_bf16 v[188:191], v[68:71], a[36:39], v[188:191]
buffer_store_dwordx4 v[176:179], v1, s[16:19], s99 offen offset:2048 sc1
v_mfma_f32_16x16x32_bf16 v[184:187], v[72:75], a[44:47], v[184:187]
ds_read_b64_tr_b16 v[92:93], v62 offset:28672
ds_read_b64_tr_b16 v[94:95], v62 offset:29696
v_mfma_f32_16x16x32_bf16 v[168:171], v[72:75], a[40:43], v[168:171]
ds_read_b64_tr_b16 v[64:65], v60 offset:8192
ds_read_b64_tr_b16 v[66:67], v60 offset:9216
v_mfma_f32_16x16x32_bf16 v[172:175], v[76:79], a[40:43], v[172:175]
global_load_dwordx2 v[42:43], v24, s[80:81] offset:96
v_mfma_f32_16x16x32_bf16 v[188:191], v[76:79], a[44:47], v[188:191]
ds_read_b64_tr_b16 v[68:69], v63 offset:8192
ds_read_b64_tr_b16 v[70:71], v63 offset:9216
s_waitcnt lgkmcnt(10)
v_mfma_f32_16x16x32_bf16 v[184:187], v[80:83], a[52:55], v[184:187]
s_waitcnt lgkmcnt(6)
ds_read_b64_tr_b16 v[72:73], v60 offset:12288
v_mfma_f32_16x16x32_bf16 v[168:171], v[80:83], a[48:51], v[168:171]
ds_read_b64_tr_b16 v[74:75], v60 offset:13312
v_mfma_f32_16x16x32_bf16 v[172:175], v[84:87], a[48:51], v[172:175]
ds_read_b64_tr_b16 v[76:77], v63 offset:12288
ds_read_b64_tr_b16 v[78:79], v63 offset:13312
v_mfma_f32_16x16x32_bf16 v[188:191], v[84:87], a[52:55], v[188:191]
global_load_dwordx2 v[222:223], v24, s[90:91] offset:96
v_mfma_f32_16x16x32_bf16 v[184:187], v[88:91], a[60:63], v[184:187]
ds_read_b64_tr_b16 v[80:81], v59 offset:40960
ds_read_b64_tr_b16 v[82:83], v59 offset:41984
v_mfma_f32_16x16x32_bf16 v[168:171], v[88:91], a[56:59], v[168:171]
s_waitcnt lgkmcnt(6)
v_mfma_f32_16x16x32_bf16 v[172:175], v[92:95], a[56:59], v[172:175]
ds_read_b64_tr_b16 v[84:85], v62 offset:40960
ds_read_b64_tr_b16 v[86:87], v62 offset:41984
v_mfma_f32_16x16x32_bf16 v[188:191], v[92:95], a[60:63], v[188:191]
v_mfma_f32_16x16x32_bf16 v[184:187], v[64:67], a[68:71], v[184:187]
ds_read_b64_tr_b16 v[88:89], v59 offset:45056
ds_read_b64_tr_b16 v[90:91], v59 offset:46080
v_mfma_f32_16x16x32_bf16 v[168:171], v[64:67], a[64:67], v[168:171]
v_mfma_f32_16x16x32_bf16 v[172:175], v[68:71], a[64:67], v[172:175]
ds_read_b64_tr_b16 v[92:93], v62 offset:45056
ds_read_b64_tr_b16 v[94:95], v62 offset:46080
v_mfma_f32_16x16x32_bf16 v[188:191], v[68:71], a[68:71], v[188:191]
s_waitcnt lgkmcnt(6)
v_mfma_f32_16x16x32_bf16 v[184:187], v[72:75], a[76:79], v[184:187]
buffer_load_dwordx2 v[20:21], v11, s[4:7], 0 offen offset:0
v_mfma_f32_16x16x32_bf16 v[168:171], v[72:75], a[72:75], v[168:171]
ds_read_b64_tr_b16 v[64:65], v59 offset:49152
ds_read_b64_tr_b16 v[66:67], v59 offset:50176
v_mfma_f32_16x16x32_bf16 v[172:175], v[76:79], a[72:75], v[172:175]
ds_read_b64_tr_b16 v[68:69], v62 offset:49152
ds_read_b64_tr_b16 v[70:71], v62 offset:50176
v_mfma_f32_16x16x32_bf16 v[188:191], v[76:79], a[76:79], v[188:191]
v_mfma_f32_16x16x32_bf16 v[184:187], v[80:83], a[84:87], v[184:187]
ds_read_b64_tr_b16 v[72:73], v59 offset:53248
ds_read_b64_tr_b16 v[74:75], v59 offset:54272
v_mfma_f32_16x16x32_bf16 v[168:171], v[80:83], a[80:83], v[168:171]
s_waitcnt lgkmcnt(6)
v_mfma_f32_16x16x32_bf16 v[172:175], v[84:87], a[80:83], v[172:175]
global_load_dwordx2 v[44:45], v3, s[80:81] offset:0
v_mfma_f32_16x16x32_bf16 v[188:191], v[84:87], a[84:87], v[188:191]
ds_read_b64_tr_b16 v[76:77], v62 offset:53248
ds_read_b64_tr_b16 v[78:79], v62 offset:54272
v_mfma_f32_16x16x32_bf16 v[184:187], v[88:91], a[92:95], v[184:187]
ds_read_b64_tr_b16 v[80:81], v59 offset:57344
ds_read_b64_tr_b16 v[82:83], v59 offset:58368
s_lshl_b32 s1, s44, 11
s_add_u32 s1, s1, s95
v_mfma_f32_16x16x32_bf16 v[168:171], v[88:91], a[88:91], v[168:171]
s_and_b32 s0, s44, 1
s_lshl_b32 s0, s0, 1
s_lshr_b32 s92, s44, 1
v_mfma_f32_16x16x32_bf16 v[172:175], v[92:95], a[88:91], v[172:175]
s_add_u32 s0, s0, s92
s_add_u32 s0, s0, 8
s_lshl_b32 s0, s0, 10
v_mfma_f32_16x16x32_bf16 v[188:191], v[92:95], a[92:95], v[188:191]
s_add_u32 s0, s0, s95
ds_read_b64_tr_b16 v[84:85], v62 offset:57344
s_waitcnt lgkmcnt(9)
v_mfma_f32_16x16x32_bf16 v[184:187], v[64:67], a[100:103], v[184:187]
ds_read_b64_tr_b16 v[86:87], v62 offset:58368
s_waitcnt lgkmcnt(6)
ds_read_b64_tr_b16 v[88:89], v59 offset:61440
ds_read_b64_tr_b16 v[90:91], v59 offset:62464
v_mfma_f32_16x16x32_bf16 v[168:171], v[64:67], a[96:99], v[168:171]
global_load_dwordx2 v[4:5], v3, s[90:91] offset:0
v_mfma_f32_16x16x32_bf16 v[172:175], v[68:71], a[96:99], v[172:175]
s_waitcnt lgkmcnt(0)
s_xor_b64 s[52:53], s[52:53], s[42:43]
s_xor_b64 s[54:55], s[54:55], s[42:43]
s_or_b64 s[52:53], s[52:53], s[54:55]
s_xor_b32 s56, s56, s45
s_or_b32 s52, s52, s56
s_or_b32 s52, s52, s53
s_cbranch_scc1 fp1_slow
fp1_ok:
v_mfma_f32_16x16x32_bf16 v[188:191], v[68:71], a[100:103], v[188:191]
ds_read_b64_tr_b16 v[92:93], v62 offset:61440
ds_read_b64_tr_b16 v[94:95], v62 offset:62464
v_mfma_f32_16x16x32_bf16 v[184:187], v[72:75], a[108:111], v[184:187]
ds_read_b64_tr_b16 v[64:65], v60 offset:0
ds_read_b64_tr_b16 v[66:67], v60 offset:1024
v_mfma_f32_16x16x32_bf16 v[168:171], v[72:75], a[104:107], v[168:171]
v_mfma_f32_16x16x32_bf16 v[172:175], v[76:79], a[104:107], v[172:175]
ds_read_b64_tr_b16 v[68:69], v63 offset:0
ds_read_b64_tr_b16 v[70:71], v63 offset:1024
v_mfma_f32_16x16x32_bf16 v[188:191], v[76:79], a[108:111], v[188:191]
buffer_load_dwordx2 v[22:23], v11, s[4:7], 0 offen offset:32
v_mfma_f32_16x16x32_bf16 v[184:187], v[80:83], a[116:119], v[184:187]
ds_read_b64_tr_b16 v[72:73], v60 offset:4096
ds_read_b64_tr_b16 v[74:75], v60 offset:5120
v_mfma_f32_16x16x32_bf16 v[168:171], v[80:83], a[112:115], v[168:171]
v_mfma_f32_16x16x32_bf16 v[172:175], v[84:87], a[112:115], v[172:175]
ds_read_b64_tr_b16 v[76:77], v63 offset:4096
ds_read_b64_tr_b16 v[78:79], v63 offset:5120
v_mfma_f32_16x16x32_bf16 v[188:191], v[84:87], a[116:119], v[188:191]
s_waitcnt lgkmcnt(6)
s_add_u32 s93, s1, 0
v_mfma_f32_16x16x32_bf16 v[184:187], v[88:91], a[124:127], v[184:187]
buffer_load_dwordx4 v[96:99], v1, s[16:19], s93 offen offset:0 sc1
v_mfma_f32_16x16x32_bf16 v[168:171], v[88:91], a[120:123], v[168:171]
ds_read_b64_tr_b16 v[80:81], v60 offset:16384
ds_read_b64_tr_b16 v[82:83], v60 offset:17408
v_mfma_f32_16x16x32_bf16 v[172:175], v[92:95], a[120:123], v[172:175]
buffer_load_dwordx4 v[100:103], v1, s[16:19], s93 offen offset:1024 sc1
v_mfma_f32_16x16x32_bf16 v[188:191], v[92:95], a[124:127], v[188:191]
ds_read_b64_tr_b16 v[84:85], v63 offset:16384
ds_read_b64_tr_b16 v[86:87], v63 offset:17408
v_mfma_f32_16x16x32_bf16 v[184:187], v[64:67], a[132:135], v[184:187]
global_load_dwordx2 v[46:47], v3, s[80:81] offset:32
ds_read_b64_tr_b16 v[88:89], v60 offset:20480
v_mfma_f32_16x16x32_bf16 v[168:171], v[64:67], a[128:131], v[168:171]
ds_read_b64_tr_b16 v[90:91], v60 offset:21504
s_waitcnt lgkmcnt(6)
v_mfma_f32_16x16x32_bf16 v[172:175], v[68:71], a[128:131], v[172:175]
s_add_u32 s93, s1, 54272
v_mfma_f32_16x16x32_bf16 v[188:191], v[68:71], a[132:135], v[188:191]
buffer_load_dwordx4 v[104:107], v1, s[16:19], s93 offen offset:0 sc1
v_mfma_f32_16x16x32_bf16 v[184:187], v[72:75], a[140:143], v[184:187]
ds_read_b64_tr_b16 v[92:93], v63 offset:20480
ds_read_b64_tr_b16 v[94:95], v63 offset:21504
ds_read_b64_tr_b16 v[64:65], v59 offset:32768
ds_read_b64_tr_b16 v[66:67], v59 offset:33792
v_mfma_f32_16x16x32_bf16 v[168:171], v[72:75], a[136:139], v[168:171]
global_load_dwordx2 v[6:7], v3, s[90:91] offset:32
v_lshlrev_b32 v10, 1, v10
v_lshlrev_b32 v11, 1, v11
v_mul_f32 v24, -v12, v25
v_mfma_f32_16x16x32_bf16 v[172:175], v[76:79], a[136:139], v[172:175]
buffer_load_dwordx4 v[108:111], v1, s[16:19], s93 offen offset:1024 sc1
v_mfma_f32_16x16x32_bf16 v[188:191], v[76:79], a[140:143], v[188:191]
ds_read_b64_tr_b16 v[68:69], v62 offset:32768
ds_read_b64_tr_b16 v[70:71], v62 offset:33792
s_waitcnt lgkmcnt(10)
v_mfma_f32_16x16x32_bf16 v[184:187], v[80:83], a[148:151], v[184:187]
s_waitcnt lgkmcnt(6)
ds_read_b64_tr_b16 v[72:73], v59 offset:36864
v_mfma_f32_16x16x32_bf16 v[168:171], v[80:83], a[144:147], v[168:171]
ds_read_b64_tr_b16 v[74:75], v59 offset:37888
s_add_u32 s93, s1, 108544
v_mfma_f32_16x16x32_bf16 v[172:175], v[84:87], a[144:147], v[172:175]
buffer_load_dwordx4 v[112:115], v1, s[16:19], s93 offen offset:0 sc1
v_mfma_f32_16x16x32_bf16 v[188:191], v[84:87], a[148:151], v[188:191]
ds_read_b64_tr_b16 v[76:77], v62 offset:36864
ds_read_b64_tr_b16 v[78:79], v62 offset:37888
v_mfma_f32_16x16x32_bf16 v[184:187], v[88:91], a[156:159], v[184:187]
ds_read_b64_tr_b16 v[80:81], v59 offset:0
ds_read_b64_tr_b16 v[82:83], v59 offset:1024
v_mfma_f32_16x16x32_bf16 v[168:171], v[88:91], a[152:155], v[168:171]
s_waitcnt lgkmcnt(6)
v_mfma_f32_16x16x32_bf16 v[172:175], v[92:95], a[152:155], v[172:175]
buffer_load_dwordx4 v[116:119], v1, s[16:19], s93 offen offset:1024 sc1
v_mfma_f32_16x16x32_bf16 v[188:191], v[92:95], a[156:159], v[188:191]
ds_read_b64_tr_b16 v[84:85], v62 offset:0
ds_read_b64_tr_b16 v[86:87], v62 offset:1024
v_mfma_f32_16x16x32_bf16 v[184:187], v[64:67], a[164:167], v[184:187]
ds_read_b64_tr_b16 v[88:89], v59 offset:4096
ds_read_b64_tr_b16 v[90:91], v59 offset:5120
v_mfma_f32_16x16x32_bf16 v[168:171], v[64:67], a[160:163], v[168:171]
s_add_u32 s93, s1, 162816
v_mfma_f32_16x16x32_bf16 v[172:175], v[68:71], a[160:163], v[172:175]
buffer_load_dwordx4 v[120:123], v1, s[16:19], s93 offen offset:0 sc1
v_mfma_f32_16x16x32_bf16 v[188:191], v[68:71], a[164:167], v[188:191]
ds_read_b64_tr_b16 v[92:93], v62 offset:4096
ds_read_b64_tr_b16 v[94:95], v62 offset:5120
s_waitcnt lgkmcnt(10)
v_mfma_f32_16x16x32_bf16 v[184:187], v[72:75], a[172:175], v[184:187]
s_waitcnt lgkmcnt(6)
ds_read_b64_tr_b16 v[64:65], v59 offset:8192
v_mfma_f32_16x16x32_bf16 v[168:171], v[72:75], a[168:171], v[168:171]
ds_read_b64_tr_b16 v[66:67], v59 offset:9216
v_mfma_f32_16x16x32_bf16 v[172:175], v[76:79], a[168:171], v[172:175]
buffer_load_dwordx4 v[124:127], v1, s[16:19], s93 offen offset:1024 sc1
v_mfma_f32_16x16x32_bf16 v[188:191], v[76:79], a[172:175], v[188:191]
ds_read_b64_tr_b16 v[68:69], v62 offset:8192
ds_read_b64_tr_b16 v[70:71], v62 offset:9216
v_mfma_f32_16x16x32_bf16 v[184:187], v[80:83], a[180:183], v[184:187]
ds_read_b64_tr_b16 v[72:73], v59 offset:12288
ds_read_b64_tr_b16 v[74:75], v59 offset:13312
v_mfma_f32_16x16x32_bf16 v[168:171], v[80:83], a[176:179], v[168:171]
s_waitcnt lgkmcnt(6)
s_add_u32 s93, s1, 217088
v_mfma_f32_16x16x32_bf16 v[172:175], v[84:87], a[176:179], v[172:175]
buffer_load_dwordx4 v[128:131], v1, s[16:19], s93 offen offset:0 sc1
v_mfma_f32_16x16x32_bf16 v[188:191], v[84:87], a[180:183], v[188:191]
ds_read_b64_tr_b16 v[76:77], v62 offset:12288
ds_read_b64_tr_b16 v[78:79], v62 offset:13312
v_mfma_f32_16x16x32_bf16 v[184:187], v[88:91], a[188:191], v[184:187]
ds_read_b64_tr_b16 v[80:81], v58 offset:24576
ds_read_b64_tr_b16 v[82:83], v58 offset:25600
v_mfma_f32_16x16x32_bf16 v[168:171], v[88:91], a[184:187], v[168:171]
buffer_load_dwordx4 v[132:135], v1, s[16:19], s93 offen offset:1024 sc1
v_mfma_f32_16x16x32_bf16 v[172:175], v[92:95], a[184:187], v[172:175]
ds_read_b64_tr_b16 v[84:85], v61 offset:24576
ds_read_b64_tr_b16 v[86:87], v61 offset:25600
v_mfma_f32_16x16x32_bf16 v[188:191], v[92:95], a[188:191], v[188:191]
s_waitcnt lgkmcnt(6)
v_mfma_f32_16x16x32_bf16 v[184:187], v[64:67], a[196:199], v[184:187]
ds_read_b64_tr_b16 v[88:89], v58 offset:28672
ds_read_b64_tr_b16 v[90:91], v58 offset:29696
v_mfma_f32_16x16x32_bf16 v[168:171], v[64:67], a[192:195], v[168:171]
v_mfma_f32_16x16x32_bf16 v[172:175], v[68:71], a[192:195], v[172:175]
ds_read_b64_tr_b16 v[92:93], v61 offset:28672
ds_read_b64_tr_b16 v[94:95], v61 offset:29696
v_mfma_f32_16x16x32_bf16 v[188:191], v[68:71], a[196:199], v[188:191]
v_add_u32 v8, 8192, v8
v_add_u32 v9, 8192, v9
v_mfma_f32_16x16x32_bf16 v[184:187], v[72:75], a[204:207], v[184:187]
ds_read_b128 v[64:67], v8 offset:4096
s_waitcnt lgkmcnt(5)
v_mfma_f32_16x16x32_bf16 v[168:171], v[72:75], a[200:203], v[168:171]
v_mfma_f32_16x16x32_bf16 v[172:175], v[76:79], a[200:203], v[172:175]
ds_read_b128 v[68:71], v8 offset:6144
v_mfma_f32_16x16x32_bf16 v[188:191], v[76:79], a[204:207], v[188:191]
v_mfma_f32_16x16x32_bf16 v[184:187], v[80:83], a[212:215], v[184:187]
ds_read_b128 v[72:75], v9 offset:4096
v_mfma_f32_16x16x32_bf16 v[168:171], v[80:83], a[208:211], v[168:171]
v_mfma_f32_16x16x32_bf16 v[172:175], v[84:87], a[208:211], v[172:175]
ds_read_b128 v[76:79], v9 offset:6144
s_waitcnt lgkmcnt(3)
v_mfma_f32_16x16x32_bf16 v[188:191], v[84:87], a[212:215], v[188:191]
v_add_u32 v8, 16384, v8
v_add_u32 v9, 16384, v9
v_mfma_f32_16x16x32_bf16 v[184:187], v[88:91], a[220:223], v[184:187]
ds_read_b128 v[80:83], v8 offset:4096
v_mfma_f32_16x16x32_bf16 v[168:171], v[88:91], a[216:219], v[168:171]
v_mfma_f32_16x16x32_bf16 v[172:175], v[92:95], a[216:219], v[172:175]
ds_read_b128 v[84:87], v8 offset:6144
v_mfma_f32_16x16x32_bf16 v[188:191], v[92:95], a[220:223], v[188:191]
v_mfma_f32_16x16x32_bf16 v[184:187], v[64:67], a[228:231], v[184:187]
ds_read_b128 v[88:91], v9 offset:4096
s_waitcnt lgkmcnt(3)
v_mfma_f32_16x16x32_bf16 v[168:171], v[64:67], a[224:227], v[168:171]
v_mfma_f32_16x16x32_bf16 v[172:175], v[68:71], a[224:227], v[172:175]
ds_read_b128 v[92:95], v9 offset:6144
v_add_u32 v8, 24576, v8
v_mfma_f32_16x16x32_bf16 v[188:191], v[68:71], a[228:231], v[188:191]
v_add_u32 v9, 24576, v9
v_mfma_f32_16x16x32_bf16 v[184:187], v[72:75], a[236:239], v[184:187]
ds_read_b128 v[64:67], v8 offset:4096
v_mfma_f32_16x16x32_bf16 v[168:171], v[72:75], a[232:235], v[168:171]
v_mfma_f32_16x16x32_bf16 v[172:175], v[76:79], a[232:235], v[172:175]
ds_read_b128 v[68:71], v8 offset:6144
s_waitcnt lgkmcnt(3)
v_mfma_f32_16x16x32_bf16 v[188:191], v[76:79], a[236:239], v[188:191]
v_mfma_f32_16x16x32_bf16 v[184:187], v[80:83], a[244:247], v[184:187]
ds_read_b128 v[72:75], v9 offset:4096
v_mfma_f32_16x16x32_bf16 v[168:171], v[80:83], a[240:243], v[168:171]
v_mfma_f32_16x16x32_bf16 v[172:175], v[84:87], a[240:243], v[172:175]
ds_read_b128 v[76:79], v9 offset:6144
v_add_u32 v8, 4294918144, v8
v_mfma_f32_16x16x32_bf16 v[188:191], v[84:87], a[244:247], v[188:191]
v_add_u32 v9, 4294918144, v9
v_mfma_f32_16x16x32_bf16 v[184:187], v[88:91], a[252:255], v[184:187]
ds_read_b128 v[80:83], v8 offset:4096
s_waitcnt lgkmcnt(3)
v_mfma_f32_16x16x32_bf16 v[168:171], v[88:91], a[248:251], v[168:171]
v_mfma_f32_16x16x32_bf16 v[172:175], v[92:95], a[248:251], v[172:175]
ds_read_b128 v[84:87], v8 offset:6144
v_mfma_f32_16x16x32_bf16 v[188:191], v[92:95], a[252:255], v[188:191]
v_mfma_f32_16x16x32_bf16 v[184:187], v[64:67], v[228:231], v[184:187]
ds_read_b128 v[88:91], v9 offset:4096
v_mfma_f32_16x16x32_bf16 v[168:171], v[64:67], v[224:227], v[168:171]
v_mfma_f32_16x16x32_bf16 v[172:175], v[68:71], v[224:227], v[172:175]
ds_read_b128 v[92:95], v9 offset:6144
s_waitcnt lgkmcnt(3)
v_mfma_f32_16x16x32_bf16 v[188:191], v[68:71], v[228:231], v[188:191]
v_mfma_f32_16x16x32_bf16 v[184:187], v[72:75], v[236:239], v[184:187]
v_mfma_f32_16x16x32_bf16 v[168:171], v[72:75], v[232:235], v[168:171]
v_mfma_f32_16x16x32_bf16 v[172:175], v[76:79], v[232:235], v[172:175]
v_mfma_f32_16x16x32_bf16 v[188:191], v[76:79], v[236:239], v[188:191]
v_mfma_f32_16x16x32_bf16 v[184:187], v[80:83], v[244:247], v[184:187]
s_waitcnt lgkmcnt(0)
v_mfma_f32_16x16x32_bf16 v[168:171], v[80:83], v[240:243], v[168:171]
v_mfma_f32_16x16x32_bf16 v[172:175], v[84:87], v[240:243], v[172:175]
v_mfma_f32_16x16x32_bf16 v[188:191], v[84:87], v[244:247], v[188:191]
v_mfma_f32_16x16x32_bf16 v[184:187], v[88:91], v[252:255], v[184:187]
v_mfma_f32_16x16x32_bf16 v[168:171], v[88:91], v[248:251], v[168:171]
v_mfma_f32_16x16x32_bf16 v[172:175], v[92:95], v[248:251], v[172:175]
v_mfma_f32_16x16x32_bf16 v[188:191], v[92:95], v[252:255], v[188:191]
s_nop 5
v_cvt_pk_bf16_f32 v168, v168, v169
v_cvt_pk_bf16_f32 v169, v170, v171
v_cvt_pk_bf16_f32 v170, v172, v173
v_cvt_pk_bf16_f32 v171, v174, v175
s_add_u32 s99, s82, 8192
buffer_store_dwordx4 v[168:171], v1, s[16:19], s99 offen offset:1024 sc1
v_cvt_pk_bf16_f32 v184, v184, v185
v_cvt_pk_bf16_f32 v185, v186, v187
v_cvt_pk_bf16_f32 v186, v188, v189
v_cvt_pk_bf16_f32 v187, v190, v191
s_add_u32 s99, s82, 8192
buffer_store_dwordx4 v[184:187], v1, s[16:19], s99 offen offset:3072 sc1
s_waitcnt vmcnt(13)
v_lshlrev_b32 v192, 16, v96
v_and_b32 v193, 0xffff0000, v96
v_lshlrev_b32 v194, 16, v97
v_and_b32 v195, 0xffff0000, v97
v_lshlrev_b32 v196, 16, v98
v_and_b32 v197, 0xffff0000, v98
v_lshlrev_b32 v198, 16, v99
v_and_b32 v199, 0xffff0000, v99
s_waitcnt vmcnt(12)
v_lshlrev_b32 v200, 16, v100
v_and_b32 v201, 0xffff0000, v100
v_lshlrev_b32 v202, 16, v101
v_and_b32 v203, 0xffff0000, v101
v_lshlrev_b32 v204, 16, v102
v_and_b32 v205, 0xffff0000, v102
v_lshlrev_b32 v206, 16, v103
v_and_b32 v207, 0xffff0000, v103
s_waitcnt vmcnt(10)
v_lshlrev_b32 v88, 16, v104
v_and_b32 v89, 0xffff0000, v104
v_lshlrev_b32 v90, 16, v105
v_and_b32 v91, 0xffff0000, v105
v_lshlrev_b32 v92, 16, v106
v_and_b32 v93, 0xffff0000, v106
v_lshlrev_b32 v94, 16, v107
v_and_b32 v95, 0xffff0000, v107
v_pk_add_f32 v[192:193], v[192:193], v[88:89]
v_pk_add_f32 v[194:195], v[194:195], v[90:91]
v_pk_add_f32 v[196:197], v[196:197], v[92:93]
v_pk_add_f32 v[198:199], v[198:199], v[94:95]
s_waitcnt vmcnt(8)
v_lshlrev_b32 v88, 16, v108
v_and_b32 v89, 0xffff0000, v108
v_lshlrev_b32 v90, 16, v109
v_and_b32 v91, 0xffff0000, v109
v_lshlrev_b32 v92, 16, v110
v_and_b32 v93, 0xffff0000, v110
v_lshlrev_b32 v94, 16, v111
v_and_b32 v95, 0xffff0000, v111
v_pk_add_f32 v[200:201], v[200:201], v[88:89]
v_pk_add_f32 v[202:203], v[202:203], v[90:91]
v_pk_add_f32 v[204:205], v[204:205], v[92:93]
v_pk_add_f32 v[206:207], v[206:207], v[94:95]
s_waitcnt vmcnt(7)
v_lshlrev_b32 v88, 16, v112
v_and_b32 v89, 0xffff0000, v112
v_lshlrev_b32 v90, 16, v113
v_and_b32 v91, 0xffff0000, v113
v_lshlrev_b32 v92, 16, v114
v_and_b32 v93, 0xffff0000, v114
v_lshlrev_b32 v94, 16, v115
v_and_b32 v95, 0xffff0000, v115
v_pk_add_f32 v[192:193], v[192:193], v[88:89]
v_pk_add_f32 v[194:195], v[194:195], v[90:91]
v_pk_add_f32 v[196:197], v[196:197], v[92:93]
v_pk_add_f32 v[198:199], v[198:199], v[94:95]
s_waitcnt vmcnt(6)
v_lshlrev_b32 v88, 16, v116
v_and_b32 v89, 0xffff0000, v116
v_lshlrev_b32 v90, 16, v117
v_and_b32 v91, 0xffff0000, v117
v_lshlrev_b32 v92, 16, v118
v_and_b32 v93, 0xffff0000, v118
v_lshlrev_b32 v94, 16, v119
v_and_b32 v95, 0xffff0000, v119
v_pk_add_f32 v[200:201], v[200:201], v[88:89]
v_pk_add_f32 v[202:203], v[202:203], v[90:91]
v_pk_add_f32 v[204:205], v[204:205], v[92:93]
v_pk_add_f32 v[206:207], v[206:207], v[94:95]
s_waitcnt vmcnt(5)
v_lshlrev_b32 v88, 16, v120
v_and_b32 v89, 0xffff0000, v120
v_lshlrev_b32 v90, 16, v121
v_and_b32 v91, 0xffff0000, v121
v_lshlrev_b32 v92, 16, v122
v_and_b32 v93, 0xffff0000, v122
v_lshlrev_b32 v94, 16, v123
v_and_b32 v95, 0xffff0000, v123
v_pk_add_f32 v[192:193], v[192:193], v[88:89]
v_pk_add_f32 v[194:195], v[194:195], v[90:91]
v_pk_add_f32 v[196:197], v[196:197], v[92:93]
v_pk_add_f32 v[198:199], v[198:199], v[94:95]
s_waitcnt vmcnt(4)
v_lshlrev_b32 v88, 16, v124
v_and_b32 v89, 0xffff0000, v124
v_lshlrev_b32 v90, 16, v125
v_and_b32 v91, 0xffff0000, v125
v_lshlrev_b32 v92, 16, v126
v_and_b32 v93, 0xffff0000, v126
v_lshlrev_b32 v94, 16, v127
v_and_b32 v95, 0xffff0000, v127
v_pk_add_f32 v[200:201], v[200:201], v[88:89]
v_pk_add_f32 v[202:203], v[202:203], v[90:91]
v_pk_add_f32 v[204:205], v[204:205], v[92:93]
v_pk_add_f32 v[206:207], v[206:207], v[94:95]
s_waitcnt vmcnt(3)
v_lshlrev_b32 v88, 16, v128
v_and_b32 v89, 0xffff0000, v128
v_lshlrev_b32 v90, 16, v129
v_and_b32 v91, 0xffff0000, v129
v_lshlrev_b32 v92, 16, v130
v_and_b32 v93, 0xffff0000, v130
v_lshlrev_b32 v94, 16, v131
v_and_b32 v95, 0xffff0000, v131
v_pk_add_f32 v[192:193], v[192:193], v[88:89]
v_pk_add_f32 v[194:195], v[194:195], v[90:91]
v_pk_add_f32 v[196:197], v[196:197], v[92:93]
v_pk_add_f32 v[198:199], v[198:199], v[94:95]
s_waitcnt vmcnt(2)
v_lshlrev_b32 v88, 16, v132
v_and_b32 v89, 0xffff0000, v132
v_lshlrev_b32 v90, 16, v133
v_and_b32 v91, 0xffff0000, v133
v_lshlrev_b32 v92, 16, v134
v_and_b32 v93, 0xffff0000, v134
v_lshlrev_b32 v94, 16, v135
v_and_b32 v95, 0xffff0000, v135
v_pk_add_f32 v[200:201], v[200:201], v[88:89]
v_pk_add_f32 v[202:203], v[202:203], v[90:91]
v_pk_add_f32 v[204:205], v[204:205], v[92:93]
v_pk_add_f32 v[206:207], v[206:207], v[94:95]
s_add_u32 s93, s0, 0
buffer_load_dwordx4 v[136:139], v1, s[16:19], s93 offen offset:0 sc1
s_add_u32 s93, s0, 54272
buffer_load_dwordx4 v[140:143], v1, s[16:19], s93 offen offset:0 sc1
s_add_u32 s93, s0, 108544
buffer_load_dwordx4 v[144:147], v1, s[16:19], s93 offen offset:0 sc1
s_add_u32 s93, s0, 162816
buffer_load_dwordx4 v[148:151], v1, s[16:19], s93 offen offset:0 sc1
s_add_u32 s93, s0, 217088
buffer_load_dwordx4 v[152:155], v1, s[16:19], s93 offen offset:0 sc1
v_lshlrev_b32 v64, 16, v28
v_and_b32 v65, 0xffff0000, v28
v_lshlrev_b32 v68, 16, v216
v_and_b32 v69, 0xffff0000, v216
v_lshlrev_b32 v66, 16, v36
v_and_b32 v67, 0xffff0000, v36
v_pk_add_f32 v[68:69], v[68:69], v[64:65]
v_pk_fma_f32 v[64:65], v[64:65], v[24:25], v[24:25] op_sel:[0,1,0] op_sel_hi:[1,1,0]
v_pk_add_f32 v[192:193], v[192:193], v[68:69]
v_pk_fma_f32 v[192:193], v[64:65], v[66:67], v[192:193]
v_lshlrev_b32 v70, 16, v29
v_and_b32 v71, 0xffff0000, v29
v_lshlrev_b32 v74, 16, v217
v_and_b32 v75, 0xffff0000, v217
v_lshlrev_b32 v72, 16, v37
v_and_b32 v73, 0xffff0000, v37
v_pk_add_f32 v[74:75], v[74:75], v[70:71]
v_pk_fma_f32 v[70:71], v[70:71], v[24:25], v[24:25] op_sel:[0,1,0] op_sel_hi:[1,1,0]
v_pk_add_f32 v[194:195], v[194:195], v[74:75]
v_pk_fma_f32 v[194:195], v[70:71], v[72:73], v[194:195]
v_lshlrev_b32 v76, 16, v30
v_and_b32 v77, 0xffff0000, v30
v_lshlrev_b32 v80, 16, v218
v_and_b32 v81, 0xffff0000, v218
v_lshlrev_b32 v78, 16, v38
v_and_b32 v79, 0xffff0000, v38
v_pk_add_f32 v[80:81], v[80:81], v[76:77]
v_pk_fma_f32 v[76:77], v[76:77], v[24:25], v[24:25] op_sel:[0,1,0] op_sel_hi:[1,1,0]
v_pk_add_f32 v[196:197], v[196:197], v[80:81]
v_pk_fma_f32 v[196:197], v[76:77], v[78:79], v[196:197]
v_lshlrev_b32 v82, 16, v31
v_and_b32 v83, 0xffff0000, v31
v_lshlrev_b32 v86, 16, v219
v_and_b32 v87, 0xffff0000, v219
v_lshlrev_b32 v84, 16, v39
v_and_b32 v85, 0xffff0000, v39
v_pk_add_f32 v[86:87], v[86:87], v[82:83]
v_pk_fma_f32 v[82:83], v[82:83], v[24:25], v[24:25] op_sel:[0,1,0] op_sel_hi:[1,1,0]
v_pk_add_f32 v[198:199], v[198:199], v[86:87]
v_pk_fma_f32 v[198:199], v[82:83], v[84:85], v[198:199]
v_lshlrev_b32 v64, 16, v32
v_and_b32 v65, 0xffff0000, v32
v_lshlrev_b32 v68, 16, v220
v_and_b32 v69, 0xffff0000, v220
v_lshlrev_b32 v66, 16, v40
v_and_b32 v67, 0xffff0000, v40
v_pk_add_f32 v[68:69], v[68:69], v[64:65]
v_pk_fma_f32 v[64:65], v[64:65], v[24:25], v[24:25] op_sel:[0,1,0] op_sel_hi:[1,1,0]
v_pk_add_f32 v[200:201], v[200:201], v[68:69]
v_pk_fma_f32 v[200:201], v[64:65], v[66:67], v[200:201]
v_lshlrev_b32 v70, 16, v33
v_and_b32 v71, 0xffff0000, v33
v_lshlrev_b32 v74, 16, v221
v_and_b32 v75, 0xffff0000, v221
v_lshlrev_b32 v72, 16, v41
v_and_b32 v73, 0xffff0000, v41
v_pk_add_f32 v[74:75], v[74:75], v[70:71]
v_pk_fma_f32 v[70:71], v[70:71], v[24:25], v[24:25] op_sel:[0,1,0] op_sel_hi:[1,1,0]
v_pk_add_f32 v[202:203], v[202:203], v[74:75]
v_pk_fma_f32 v[202:203], v[70:71], v[72:73], v[202:203]
v_lshlrev_b32 v76, 16, v34
v_and_b32 v77, 0xffff0000, v34
v_lshlrev_b32 v80, 16, v222
v_and_b32 v81, 0xffff0000, v222
v_lshlrev_b32 v78, 16, v42
v_and_b32 v79, 0xffff0000, v42
v_pk_add_f32 v[80:81], v[80:81], v[76:77]
v_pk_fma_f32 v[76:77], v[76:77], v[24:25], v[24:25] op_sel:[0,1,0] op_sel_hi:[1,1,0]
v_pk_add_f32 v[204:205], v[204:205], v[80:81]
v_pk_fma_f32 v[204:205], v[76:77], v[78:79], v[204:205]
v_lshlrev_b32 v82, 16, v35
v_and_b32 v83, 0xffff0000, v35
v_lshlrev_b32 v86, 16, v223
v_and_b32 v87, 0xffff0000, v223
v_lshlrev_b32 v84, 16, v43
v_and_b32 v85, 0xffff0000, v43
v_pk_add_f32 v[86:87], v[86:87], v[82:83]
v_pk_fma_f32 v[82:83], v[82:83], v[24:25], v[24:25] op_sel:[0,1,0] op_sel_hi:[1,1,0]
v_pk_add_f32 v[206:207], v[206:207], v[86:87]
v_pk_fma_f32 v[206:207], v[82:83], v[84:85], v[206:207]
buffer_store_dwordx4 v[192:195], v10, s[20:23], 0 offen offset:0 sc1
buffer_store_dwordx4 v[196:199], v10, s[20:23], 0 offen offset:64 sc1
buffer_store_dwordx4 v[200:203], v10, s[20:23], 0 offen offset:128 sc1
buffer_store_dwordx4 v[204:207], v10, s[20:23], 0 offen offset:192 sc1
v_lshlrev_b32 v64, 16, v20
v_and_b32 v65, 0xffff0000, v20
v_lshlrev_b32 v68, 16, v4
v_and_b32 v69, 0xffff0000, v4
v_lshlrev_b32 v66, 16, v44
v_and_b32 v67, 0xffff0000, v44
v_pk_add_f32 v[68:69], v[68:69], v[64:65]
v_pk_fma_f32 v[64:65], v[64:65], v[24:25], v[24:25] op_sel:[0,1,0] op_sel_hi:[1,1,0]
v_pk_fma_f32 v[208:209], v[64:65], v[66:67], v[68:69]
v_lshlrev_b32 v70, 16, v21
v_and_b32 v71, 0xffff0000, v21
v_lshlrev_b32 v74, 16, v5
v_and_b32 v75, 0xffff0000, v5
v_lshlrev_b32 v72, 16, v45
v_and_b32 v73, 0xffff0000, v45
v_pk_add_f32 v[74:75], v[74:75], v[70:71]
v_pk_fma_f32 v[70:71], v[70:71], v[24:25], v[24:25] op_sel:[0,1,0] op_sel_hi:[1,1,0]
v_pk_fma_f32 v[210:211], v[70:71], v[72:73], v[74:75]
v_lshlrev_b32 v76, 16, v22
v_and_b32 v77, 0xffff0000, v22
v_lshlrev_b32 v80, 16, v6
v_and_b32 v81, 0xffff0000, v6
v_lshlrev_b32 v78, 16, v46
v_and_b32 v79, 0xffff0000, v46
v_pk_add_f32 v[80:81], v[80:81], v[76:77]
v_pk_fma_f32 v[76:77], v[76:77], v[24:25], v[24:25] op_sel:[0,1,0] op_sel_hi:[1,1,0]
v_pk_fma_f32 v[212:213], v[76:77], v[78:79], v[80:81]
v_lshlrev_b32 v82, 16, v23
v_and_b32 v83, 0xffff0000, v23
v_lshlrev_b32 v86, 16, v7
v_and_b32 v87, 0xffff0000, v7
v_lshlrev_b32 v84, 16, v47
v_and_b32 v85, 0xffff0000, v47
L_stub19:
s_cbranch_execz L_visit_end
v_pk_add_f32 v[86:87], v[86:87], v[82:83]
v_pk_fma_f32 v[82:83], v[82:83], v[24:25], v[24:25] op_sel:[0,1,0] op_sel_hi:[1,1,0]
v_pk_fma_f32 v[214:215], v[82:83], v[84:85], v[86:87]
s_waitcnt vmcnt(8)
v_max3_u32 v88, v136, v137, v138
s_waitcnt vmcnt(7)
v_max3_u32 v89, v139, v140, v141
v_max3_u32 v88, v88, v142, v143
s_waitcnt vmcnt(6)
v_max3_u32 v89, v89, v144, v145
v_max3_u32 v88, v88, v146, v147
s_waitcnt vmcnt(5)
v_max3_u32 v89, v89, v148, v149
v_max3_u32 v88, v88, v150, v151
s_waitcnt vmcnt(4)
v_max3_u32 v89, v89, v152, v153
v_max3_u32 v88, v88, v154, v155
v_max_u32 v88, v88, v89
v_cmp_eq_u32 vcc, -1, v88
s_nop 0
s_cmp_lg_u64 vcc, 0
s_cbranch_scc1 fp2_slow
fp2_ok:
v_lshlrev_b32 v88, 16, v136
v_and_b32 v89, 0xffff0000, v136
v_lshlrev_b32 v90, 16, v137
v_and_b32 v91, 0xffff0000, v137
v_lshlrev_b32 v92, 16, v138
v_and_b32 v93, 0xffff0000, v138
v_lshlrev_b32 v94, 16, v139
v_and_b32 v95, 0xffff0000, v139
v_pk_add_f32 v[208:209], v[208:209], v[88:89]
v_pk_add_f32 v[210:211], v[210:211], v[90:91]
v_pk_add_f32 v[212:213], v[212:213], v[92:93]
v_pk_add_f32 v[214:215], v[214:215], v[94:95]
v_lshlrev_b32 v88, 16, v140
v_and_b32 v89, 0xffff0000, v140
v_lshlrev_b32 v90, 16, v141
v_and_b32 v91, 0xffff0000, v141
v_lshlrev_b32 v92, 16, v142
v_and_b32 v93, 0xffff0000, v142
v_lshlrev_b32 v94, 16, v143
v_and_b32 v95, 0xffff0000, v143
v_pk_add_f32 v[208:209], v[208:209], v[88:89]
v_pk_add_f32 v[210:211], v[210:211], v[90:91]
v_pk_add_f32 v[212:213], v[212:213], v[92:93]
v_pk_add_f32 v[214:215], v[214:215], v[94:95]
v_lshlrev_b32 v88, 16, v144
v_and_b32 v89, 0xffff0000, v144
v_lshlrev_b32 v90, 16, v145
v_and_b32 v91, 0xffff0000, v145
v_lshlrev_b32 v92, 16, v146
v_and_b32 v93, 0xffff0000, v146
v_lshlrev_b32 v94, 16, v147
v_and_b32 v95, 0xffff0000, v147
v_pk_add_f32 v[208:209], v[208:209], v[88:89]
v_pk_add_f32 v[210:211], v[210:211], v[90:91]
v_pk_add_f32 v[212:213], v[212:213], v[92:93]
v_pk_add_f32 v[214:215], v[214:215], v[94:95]
v_lshlrev_b32 v88, 16, v148
v_and_b32 v89, 0xffff0000, v148
v_lshlrev_b32 v90, 16, v149
v_and_b32 v91, 0xffff0000, v149
v_lshlrev_b32 v92, 16, v150
v_and_b32 v93, 0xffff0000, v150
v_lshlrev_b32 v94, 16, v151
v_and_b32 v95, 0xffff0000, v151
v_pk_add_f32 v[208:209], v[208:209], v[88:89]
v_pk_add_f32 v[210:211], v[210:211], v[90:91]
v_pk_add_f32 v[212:213], v[212:213], v[92:93]
v_pk_add_f32 v[214:215], v[214:215], v[94:95]
v_lshlrev_b32 v88, 16, v152
v_and_b32 v89, 0xffff0000, v152
v_lshlrev_b32 v90, 16, v153
v_and_b32 v91, 0xffff0000, v153
v_lshlrev_b32 v92, 16, v154
v_and_b32 v93, 0xffff0000, v154
v_lshlrev_b32 v94, 16, v155
v_and_b32 v95, 0xffff0000, v155
v_pk_add_f32 v[208:209], v[208:209], v[88:89]
v_pk_add_f32 v[210:211], v[210:211], v[90:91]
v_pk_add_f32 v[212:213], v[212:213], v[92:93]
v_pk_add_f32 v[214:215], v[214:215], v[94:95]
buffer_store_dwordx4 v[208:211], v11, s[20:23], 0 offen offset:0 sc1
buffer_store_dwordx4 v[212:215], v11, s[20:23], 0 offen offset:64 sc1
s_waitcnt vmcnt(0)
s_endpgm
L_endN:
L_stub20:
s_cbranch_execz L_visit_end
v_mfma_f32_16x16x32_bf16 v[176:179], v[88:91], a[188:191], v[176:179]
ds_read_b64_tr_b16 v[80:81], v52 offset:24576
ds_read_b64_tr_b16 v[82:83], v52 offset:25600
v_mfma_f32_16x16x32_bf16 v[160:163], v[88:91], a[184:187], v[160:163]
v_mfma_f32_16x16x32_bf16 v[164:167], v[92:95], a[184:187], v[164:167]
ds_read_b64_tr_b16 v[84:85], v55 offset:24576
ds_read_b64_tr_b16 v[86:87], v55 offset:25600
v_mfma_f32_16x16x32_bf16 v[180:183], v[92:95], a[188:191], v[180:183]
s_waitcnt lgkmcnt(6)
v_mfma_f32_16x16x32_bf16 v[176:179], v[64:67], a[196:199], v[176:179]
ds_read_b64_tr_b16 v[88:89], v52 offset:28672
ds_read_b64_tr_b16 v[90:91], v52 offset:29696
v_mfma_f32_16x16x32_bf16 v[160:163], v[64:67], a[192:195], v[160:163]
v_mfma_f32_16x16x32_bf16 v[164:167], v[68:71], a[192:195], v[164:167]
ds_read_b64_tr_b16 v[92:93], v55 offset:28672
ds_read_b64_tr_b16 v[94:95], v55 offset:29696
v_mfma_f32_16x16x32_bf16 v[180:183], v[68:71], a[196:199], v[180:183]
v_add_u32 v8, 40960, v8
v_add_u32 v9, 40960, v9
v_mfma_f32_16x16x32_bf16 v[176:179], v[72:75], a[204:207], v[176:179]
ds_read_b64_tr_b16 v[64:65], v52 offset:40960
ds_read_b64_tr_b16 v[66:67], v52 offset:41984
v_mfma_f32_16x16x32_bf16 v[160:163], v[72:75], a[200:203], v[160:163]
s_waitcnt lgkmcnt(6)
v_mfma_f32_16x16x32_bf16 v[164:167], v[76:79], a[200:203], v[164:167]
ds_read_b64_tr_b16 v[68:69], v55 offset:40960
ds_read_b64_tr_b16 v[70:71], v55 offset:41984
v_mfma_f32_16x16x32_bf16 v[180:183], v[76:79], a[204:207], v[180:183]
v_mfma_f32_16x16x32_bf16 v[176:179], v[80:83], a[212:215], v[176:179]
ds_read_b64_tr_b16 v[72:73], v52 offset:45056
ds_read_b64_tr_b16 v[74:75], v52 offset:46080
v_mfma_f32_16x16x32_bf16 v[160:163], v[80:83], a[208:211], v[160:163]
s_waitcnt vmcnt(0)
buffer_store_dword v13, v26, s[16:19], s94 offen offset:0 sc1
v_mfma_f32_16x16x32_bf16 v[164:167], v[84:87], a[208:211], v[164:167]
ds_read_b64_tr_b16 v[76:77], v55 offset:45056
ds_read_b64_tr_b16 v[78:79], v55 offset:46080
v_mfma_f32_16x16x32_bf16 v[180:183], v[84:87], a[212:215], v[180:183]
s_waitcnt lgkmcnt(6)
v_add_u32 v8, 16384, v8
v_mfma_f32_16x16x32_bf16 v[176:179], v[88:91], a[220:223], v[176:179]
v_add_u32 v9, 16384, v9
ds_read_b64_tr_b16 v[80:81], v52 offset:57344
v_mfma_f32_16x16x32_bf16 v[160:163], v[88:91], a[216:219], v[160:163]
ds_read_b64_tr_b16 v[82:83], v52 offset:58368
v_mfma_f32_16x16x32_bf16 v[164:167], v[92:95], a[216:219], v[164:167]
ds_read_b64_tr_b16 v[84:85], v55 offset:57344
ds_read_b64_tr_b16 v[86:87], v55 offset:58368
v_mfma_f32_16x16x32_bf16 v[180:183], v[92:95], a[220:223], v[180:183]
v_mfma_f32_16x16x32_bf16 v[176:179], v[64:67], a[228:231], v[176:179]
ds_read_b64_tr_b16 v[88:89], v52 offset:61440
ds_read_b64_tr_b16 v[90:91], v52 offset:62464
v_mfma_f32_16x16x32_bf16 v[160:163], v[64:67], a[224:227], v[160:163]
s_waitcnt lgkmcnt(6)
v_mfma_f32_16x16x32_bf16 v[164:167], v[68:71], a[224:227], v[164:167]
ds_read_b64_tr_b16 v[92:93], v55 offset:61440
ds_read_b64_tr_b16 v[94:95], v55 offset:62464
v_mfma_f32_16x16x32_bf16 v[180:183], v[68:71], a[228:231], v[180:183]
v_add_u32 v8, 24576, v8
v_add_u32 v9, 24576, v9
v_mfma_f32_16x16x32_bf16 v[176:179], v[72:75], a[236:239], v[176:179]
ds_read_b128 v[64:67], v8 offset:0
v_mfma_f32_16x16x32_bf16 v[160:163], v[72:75], a[232:235], v[160:163]
v_mfma_f32_16x16x32_bf16 v[164:167], v[76:79], a[232:235], v[164:167]
ds_read_b128 v[68:71], v8 offset:2048
s_waitcnt lgkmcnt(4)
v_mfma_f32_16x16x32_bf16 v[180:183], v[76:79], a[236:239], v[180:183]
v_mfma_f32_16x16x32_bf16 v[176:179], v[80:83], a[244:247], v[176:179]
ds_read_b128 v[72:75], v9 offset:0
v_mfma_f32_16x16x32_bf16 v[160:163], v[80:83], a[240:243], v[160:163]
v_mfma_f32_16x16x32_bf16 v[164:167], v[84:87], a[240:243], v[164:167]
ds_read_b128 v[76:79], v9 offset:2048
v_add_u32 v8, 4294918144, v8
v_mfma_f32_16x16x32_bf16 v[180:183], v[84:87], a[244:247], v[180:183]
v_add_u32 v9, 4294918144, v9
v_mfma_f32_16x16x32_bf16 v[176:179], v[88:91], a[252:255], v[176:179]
ds_read_b128 v[80:83], v8 offset:0
s_waitcnt lgkmcnt(3)
v_mfma_f32_16x16x32_bf16 v[160:163], v[88:91], a[248:251], v[160:163]
v_mfma_f32_16x16x32_bf16 v[164:167], v[92:95], a[248:251], v[164:167]
ds_read_b128 v[84:87], v8 offset:2048
v_mfma_f32_16x16x32_bf16 v[180:183], v[92:95], a[252:255], v[180:183]
v_mfma_f32_16x16x32_bf16 v[176:179], v[64:67], v[228:231], v[176:179]
ds_read_b128 v[88:91], v9 offset:0
v_mfma_f32_16x16x32_bf16 v[160:163], v[64:67], v[224:227], v[160:163]
v_mfma_f32_16x16x32_bf16 v[164:167], v[68:71], v[224:227], v[164:167]
ds_read_b128 v[92:95], v9 offset:2048
s_waitcnt lgkmcnt(3)
v_mfma_f32_16x16x32_bf16 v[180:183], v[68:71], v[228:231], v[180:183]
v_mfma_f32_16x16x32_bf16 v[176:179], v[72:75], v[236:239], v[176:179]
ds_read_b64_tr_b16 v[64:65], v58 offset:8192
ds_read_b64_tr_b16 v[66:67], v58 offset:9216
v_mfma_f32_16x16x32_bf16 v[160:163], v[72:75], v[232:235], v[160:163]
v_mfma_f32_16x16x32_bf16 v[164:167], v[76:79], v[232:235], v[164:167]
ds_read_b64_tr_b16 v[68:69], v61 offset:8192
ds_read_b64_tr_b16 v[70:71], v61 offset:9216
v_mfma_f32_16x16x32_bf16 v[180:183], v[76:79], v[236:239], v[180:183]
v_mfma_f32_16x16x32_bf16 v[176:179], v[80:83], v[244:247], v[176:179]
ds_read_b64_tr_b16 v[72:73], v58 offset:12288
ds_read_b64_tr_b16 v[74:75], v58 offset:13312
v_mfma_f32_16x16x32_bf16 v[160:163], v[80:83], v[240:243], v[160:163]
s_waitcnt lgkmcnt(6)
v_mfma_f32_16x16x32_bf16 v[164:167], v[84:87], v[240:243], v[164:167]
ds_read_b64_tr_b16 v[76:77], v61 offset:12288
ds_read_b64_tr_b16 v[78:79], v61 offset:13312
v_mfma_f32_16x16x32_bf16 v[180:183], v[84:87], v[244:247], v[180:183]
v_mfma_f32_16x16x32_bf16 v[176:179], v[88:91], v[252:255], v[176:179]
ds_read_b64_tr_b16 v[80:81], v58 offset:16384
ds_read_b64_tr_b16 v[82:83], v58 offset:17408
v_mfma_f32_16x16x32_bf16 v[160:163], v[88:91], v[248:251], v[160:163]
v_mfma_f32_16x16x32_bf16 v[164:167], v[92:95], v[248:251], v[164:167]
ds_read_b64_tr_b16 v[84:85], v61 offset:16384
ds_read_b64_tr_b16 v[86:87], v61 offset:17408
v_mfma_f32_16x16x32_bf16 v[180:183], v[92:95], v[252:255], v[180:183]
s_waitcnt lgkmcnt(6)
v_mfma_f32_16x16x32_bf16 v[184:187], v[64:67], a[4:7], 0
ds_read_b64_tr_b16 v[88:89], v58 offset:20480
ds_read_b64_tr_b16 v[90:91], v58 offset:21504
v_mfma_f32_16x16x32_bf16 v[168:171], v[64:67], a[0:3], 0
v_mfma_f32_16x16x32_bf16 v[172:175], v[68:71], a[0:3], 0
ds_read_b64_tr_b16 v[92:93], v61 offset:20480
ds_read_b64_tr_b16 v[94:95], v61 offset:21504
v_mfma_f32_16x16x32_bf16 v[188:191], v[68:71], a[4:7], 0
v_mfma_f32_16x16x32_bf16 v[184:187], v[72:75], a[12:15], v[184:187]
ds_read_b64_tr_b16 v[64:65], v58 offset:49152
ds_read_b64_tr_b16 v[66:67], v58 offset:50176
v_mfma_f32_16x16x32_bf16 v[168:171], v[72:75], a[8:11], v[168:171]
s_waitcnt lgkmcnt(6)
v_mfma_f32_16x16x32_bf16 v[172:175], v[76:79], a[8:11], v[172:175]
ds_read_b64_tr_b16 v[68:69], v61 offset:49152
ds_read_b64_tr_b16 v[70:71], v61 offset:50176
v_mfma_f32_16x16x32_bf16 v[188:191], v[76:79], a[12:15], v[188:191]
v_mfma_f32_16x16x32_bf16 v[184:187], v[80:83], a[20:23], v[184:187]
ds_read_b64_tr_b16 v[72:73], v58 offset:53248
ds_read_b64_tr_b16 v[74:75], v58 offset:54272
v_cvt_pk_bf16_f32 v160, v160, v161
v_mfma_f32_16x16x32_bf16 v[168:171], v[80:83], a[16:19], v[168:171]
v_cvt_pk_bf16_f32 v161, v162, v163
v_cvt_pk_bf16_f32 v162, v164, v165
v_mfma_f32_16x16x32_bf16 v[172:175], v[84:87], a[16:19], v[172:175]
v_cvt_pk_bf16_f32 v163, v166, v167
s_add_u32 s99, s82, 8192
v_mfma_f32_16x16x32_bf16 v[188:191], v[84:87], a[20:23], v[188:191]
buffer_store_dwordx4 v[160:163], v1, s[16:19], s99 offen offset:0 sc1
s_waitcnt lgkmcnt(8)
v_mfma_f32_16x16x32_bf16 v[184:187], v[88:91], a[28:31], v[184:187]
ds_read_b64_tr_b16 v[76:77], v61 offset:53248
ds_read_b64_tr_b16 v[78:79], v61 offset:54272
v_mfma_f32_16x16x32_bf16 v[168:171], v[88:91], a[24:27], v[168:171]
s_waitcnt lgkmcnt(6)
ds_read_b64_tr_b16 v[80:81], v59 offset:24576
v_mfma_f32_16x16x32_bf16 v[172:175], v[92:95], a[24:27], v[172:175]
ds_read_b64_tr_b16 v[82:83], v59 offset:25600
ds_read_b64_tr_b16 v[84:85], v62 offset:24576
v_mfma_f32_16x16x32_bf16 v[188:191], v[92:95], a[28:31], v[188:191]
ds_read_b64_tr_b16 v[86:87], v62 offset:25600
v_mfma_f32_16x16x32_bf16 v[184:187], v[64:67], a[36:39], v[184:187]
ds_read_b64_tr_b16 v[88:89], v59 offset:28672
ds_read_b64_tr_b16 v[90:91], v59 offset:29696
s_waitcnt lgkmcnt(6)
v_cvt_pk_bf16_f32 v176, v176, v177
v_mfma_f32_16x16x32_bf16 v[168:171], v[64:67], a[32:35], v[168:171]
v_cvt_pk_bf16_f32 v177, v178, v179
v_cvt_pk_bf16_f32 v178, v180, v181
v_mfma_f32_16x16x32_bf16 v[172:175], v[68:71], a[32:35], v[172:175]
v_cvt_pk_bf16_f32 v179, v182, v183
s_add_u32 s99, s82, 8192
v_mfma_f32_16x16x32_bf16 v[188:191], v[68:71], a[36:39], v[188:191]
buffer_store_dwordx4 v[176:179], v1, s[16:19], s99 offen offset:2048 sc1
v_mfma_f32_16x16x32_bf16 v[184:187], v[72:75], a[44:47], v[184:187]
ds_read_b64_tr_b16 v[92:93], v62 offset:28672
ds_read_b64_tr_b16 v[94:95], v62 offset:29696
v_mfma_f32_16x16x32_bf16 v[168:171], v[72:75], a[40:43], v[168:171]
ds_read_b64_tr_b16 v[64:65], v60 offset:8192
ds_read_b64_tr_b16 v[66:67], v60 offset:9216
v_mfma_f32_16x16x32_bf16 v[172:175], v[76:79], a[40:43], v[172:175]
ds_read_b64_tr_b16 v[68:69], v63 offset:8192
ds_read_b64_tr_b16 v[70:71], v63 offset:9216
v_mfma_f32_16x16x32_bf16 v[188:191], v[76:79], a[44:47], v[188:191]
s_waitcnt lgkmcnt(6)
v_mfma_f32_16x16x32_bf16 v[184:187], v[80:83], a[52:55], v[184:187]
ds_read_b64_tr_b16 v[72:73], v60 offset:12288
ds_read_b64_tr_b16 v[74:75], v60 offset:13312
v_mfma_f32_16x16x32_bf16 v[168:171], v[80:83], a[48:51], v[168:171]
v_mfma_f32_16x16x32_bf16 v[172:175], v[84:87], a[48:51], v[172:175]
ds_read_b64_tr_b16 v[76:77], v63 offset:12288
ds_read_b64_tr_b16 v[78:79], v63 offset:13312
v_mfma_f32_16x16x32_bf16 v[188:191], v[84:87], a[52:55], v[188:191]
v_mfma_f32_16x16x32_bf16 v[184:187], v[88:91], a[60:63], v[184:187]
ds_read_b64_tr_b16 v[80:81], v59 offset:40960
ds_read_b64_tr_b16 v[82:83], v59 offset:41984
v_mfma_f32_16x16x32_bf16 v[168:171], v[88:91], a[56:59], v[168:171]
s_waitcnt lgkmcnt(6)
v_mfma_f32_16x16x32_bf16 v[172:175], v[92:95], a[56:59], v[172:175]
ds_read_b64_tr_b16 v[84:85], v62 offset:40960
ds_read_b64_tr_b16 v[86:87], v62 offset:41984
v_mfma_f32_16x16x32_bf16 v[188:191], v[92:95], a[60:63], v[188:191]
v_mfma_f32_16x16x32_bf16 v[184:187], v[64:67], a[68:71], v[184:187]
ds_read_b64_tr_b16 v[88:89], v59 offset:45056
ds_read_b64_tr_b16 v[90:91], v59 offset:46080
v_mfma_f32_16x16x32_bf16 v[168:171], v[64:67], a[64:67], v[168:171]
v_mfma_f32_16x16x32_bf16 v[172:175], v[68:71], a[64:67], v[172:175]
ds_read_b64_tr_b16 v[92:93], v62 offset:45056
ds_read_b64_tr_b16 v[94:95], v62 offset:46080
v_mfma_f32_16x16x32_bf16 v[188:191], v[68:71], a[68:71], v[188:191]
s_waitcnt lgkmcnt(6)
v_mfma_f32_16x16x32_bf16 v[184:187], v[72:75], a[76:79], v[184:187]
ds_read_b64_tr_b16 v[64:65], v59 offset:49152
ds_read_b64_tr_b16 v[66:67], v59 offset:50176
v_mfma_f32_16x16x32_bf16 v[168:171], v[72:75], a[72:75], v[168:171]
v_mfma_f32_16x16x32_bf16 v[172:175], v[76:79], a[72:75], v[172:175]
ds_read_b64_tr_b16 v[68:69], v62 offset:49152
ds_read_b64_tr_b16 v[70:71], v62 offset:50176
v_mfma_f32_16x16x32_bf16 v[188:191], v[76:79], a[76:79], v[188:191]
v_mfma_f32_16x16x32_bf16 v[184:187], v[80:83], a[84:87], v[184:187]
ds_read_b64_tr_b16 v[72:73], v59 offset:53248
ds_read_b64_tr_b16 v[74:75], v59 offset:54272
v_mfma_f32_16x16x32_bf16 v[168:171], v[80:83], a[80:83], v[168:171]
s_waitcnt lgkmcnt(6)
v_mfma_f32_16x16x32_bf16 v[172:175], v[84:87], a[80:83], v[172:175]
ds_read_b64_tr_b16 v[76:77], v62 offset:53248
ds_read_b64_tr_b16 v[78:79], v62 offset:54272
v_mfma_f32_16x16x32_bf16 v[188:191], v[84:87], a[84:87], v[188:191]
v_mfma_f32_16x16x32_bf16 v[184:187], v[88:91], a[92:95], v[184:187]
ds_read_b64_tr_b16 v[80:81], v59 offset:57344
ds_read_b64_tr_b16 v[82:83], v59 offset:58368
v_mfma_f32_16x16x32_bf16 v[168:171], v[88:91], a[88:91], v[168:171]
v_mfma_f32_16x16x32_bf16 v[172:175], v[92:95], a[88:91], v[172:175]
ds_read_b64_tr_b16 v[84:85], v62 offset:57344
ds_read_b64_tr_b16 v[86:87], v62 offset:58368
v_mfma_f32_16x16x32_bf16 v[188:191], v[92:95], a[92:95], v[188:191]
s_waitcnt lgkmcnt(6)
v_mfma_f32_16x16x32_bf16 v[184:187], v[64:67], a[100:103], v[184:187]
ds_read_b64_tr_b16 v[88:89], v59 offset:61440
ds_read_b64_tr_b16 v[90:91], v59 offset:62464
v_mfma_f32_16x16x32_bf16 v[168:171], v[64:67], a[96:99], v[168:171]
v_mfma_f32_16x16x32_bf16 v[172:175], v[68:71], a[96:99], v[172:175]
ds_read_b64_tr_b16 v[92:93], v62 offset:61440
ds_read_b64_tr_b16 v[94:95], v62 offset:62464
v_mfma_f32_16x16x32_bf16 v[188:191], v[68:71], a[100:103], v[188:191]
v_mfma_f32_16x16x32_bf16 v[184:187], v[72:75], a[108:111], v[184:187]
ds_read_b64_tr_b16 v[64:65], v60 offset:0
ds_read_b64_tr_b16 v[66:67], v60 offset:1024
v_mfma_f32_16x16x32_bf16 v[168:171], v[72:75], a[104:107], v[168:171]
s_waitcnt lgkmcnt(6)
v_mfma_f32_16x16x32_bf16 v[172:175], v[76:79], a[104:107], v[172:175]
ds_read_b64_tr_b16 v[68:69], v63 offset:0
ds_read_b64_tr_b16 v[70:71], v63 offset:1024
v_mfma_f32_16x16x32_bf16 v[188:191], v[76:79], a[108:111], v[188:191]
v_mfma_f32_16x16x32_bf16 v[184:187], v[80:83], a[116:119], v[184:187]
ds_read_b64_tr_b16 v[72:73], v60 offset:4096
ds_read_b64_tr_b16 v[74:75], v60 offset:5120
v_mfma_f32_16x16x32_bf16 v[168:171], v[80:83], a[112:115], v[168:171]
v_mfma_f32_16x16x32_bf16 v[172:175], v[84:87], a[112:115], v[172:175]
ds_read_b64_tr_b16 v[76:77], v63 offset:4096
ds_read_b64_tr_b16 v[78:79], v63 offset:5120
v_mfma_f32_16x16x32_bf16 v[188:191], v[84:87], a[116:119], v[188:191]
s_waitcnt lgkmcnt(6)
v_mfma_f32_16x16x32_bf16 v[184:187], v[88:91], a[124:127], v[184:187]
ds_read_b64_tr_b16 v[80:81], v60 offset:16384
ds_read_b64_tr_b16 v[82:83], v60 offset:17408
v_mfma_f32_16x16x32_bf16 v[168:171], v[88:91], a[120:123], v[168:171]
v_mfma_f32_16x16x32_bf16 v[172:175], v[92:95], a[120:123], v[172:175]
ds_read_b64_tr_b16 v[84:85], v63 offset:16384
ds_read_b64_tr_b16 v[86:87], v63 offset:17408
v_mfma_f32_16x16x32_bf16 v[188:191], v[92:95], a[124:127], v[188:191]
v_mfma_f32_16x16x32_bf16 v[184:187], v[64:67], a[132:135], v[184:187]
ds_read_b64_tr_b16 v[88:89], v60 offset:20480
ds_read_b64_tr_b16 v[90:91], v60 offset:21504
v_mfma_f32_16x16x32_bf16 v[168:171], v[64:67], a[128:131], v[168:171]
s_waitcnt lgkmcnt(6)
v_mfma_f32_16x16x32_bf16 v[172:175], v[68:71], a[128:131], v[172:175]
ds_read_b64_tr_b16 v[92:93], v63 offset:20480
ds_read_b64_tr_b16 v[94:95], v63 offset:21504
v_mfma_f32_16x16x32_bf16 v[188:191], v[68:71], a[132:135], v[188:191]
v_mfma_f32_16x16x32_bf16 v[184:187], v[72:75], a[140:143], v[184:187]
ds_read_b64_tr_b16 v[64:65], v59 offset:32768
ds_read_b64_tr_b16 v[66:67], v59 offset:33792
v_mfma_f32_16x16x32_bf16 v[168:171], v[72:75], a[136:139], v[168:171]
v_mfma_f32_16x16x32_bf16 v[172:175], v[76:79], a[136:139], v[172:175]
ds_read_b64_tr_b16 v[68:69], v62 offset:32768
ds_read_b64_tr_b16 v[70:71], v62 offset:33792
v_mfma_f32_16x16x32_bf16 v[188:191], v[76:79], a[140:143], v[188:191]
s_waitcnt lgkmcnt(6)
v_mfma_f32_16x16x32_bf16 v[184:187], v[80:83], a[148:151], v[184:187]
ds_read_b64_tr_b16 v[72:73], v59 offset:36864
ds_read_b64_tr_b16 v[74:75], v59 offset:37888
v_mfma_f32_16x16x32_bf16 v[168:171], v[80:83], a[144:147], v[168:171]
v_mfma_f32_16x16x32_bf16 v[172:175], v[84:87], a[144:147], v[172:175]
ds_read_b64_tr_b16 v[76:77], v62 offset:36864
ds_read_b64_tr_b16 v[78:79], v62 offset:37888
v_mfma_f32_16x16x32_bf16 v[188:191], v[84:87], a[148:151], v[188:191]
v_mfma_f32_16x16x32_bf16 v[184:187], v[88:91], a[156:159], v[184:187]
ds_read_b64_tr_b16 v[80:81], v59 offset:0
ds_read_b64_tr_b16 v[82:83], v59 offset:1024
v_mfma_f32_16x16x32_bf16 v[168:171], v[88:91], a[152:155], v[168:171]
s_waitcnt lgkmcnt(6)
v_mfma_f32_16x16x32_bf16 v[172:175], v[92:95], a[152:155], v[172:175]
ds_read_b64_tr_b16 v[84:85], v62 offset:0
ds_read_b64_tr_b16 v[86:87], v62 offset:1024
v_mfma_f32_16x16x32_bf16 v[188:191], v[92:95], a[156:159], v[188:191]
v_mfma_f32_16x16x32_bf16 v[184:187], v[64:67], a[164:167], v[184:187]
ds_read_b64_tr_b16 v[88:89], v59 offset:4096
ds_read_b64_tr_b16 v[90:91], v59 offset:5120
v_mfma_f32_16x16x32_bf16 v[168:171], v[64:67], a[160:163], v[168:171]
v_mfma_f32_16x16x32_bf16 v[172:175], v[68:71], a[160:163], v[172:175]
ds_read_b64_tr_b16 v[92:93], v62 offset:4096
ds_read_b64_tr_b16 v[94:95], v62 offset:5120
v_mfma_f32_16x16x32_bf16 v[188:191], v[68:71], a[164:167], v[188:191]
s_waitcnt lgkmcnt(6)
v_mfma_f32_16x16x32_bf16 v[184:187], v[72:75], a[172:175], v[184:187]
ds_read_b64_tr_b16 v[64:65], v59 offset:8192
ds_read_b64_tr_b16 v[66:67], v59 offset:9216
v_mfma_f32_16x16x32_bf16 v[168:171], v[72:75], a[168:171], v[168:171]
v_mfma_f32_16x16x32_bf16 v[172:175], v[76:79], a[168:171], v[172:175]
ds_read_b64_tr_b16 v[68:69], v62 offset:8192
ds_read_b64_tr_b16 v[70:71], v62 offset:9216
v_mfma_f32_16x16x32_bf16 v[188:191], v[76:79], a[172:175], v[188:191]
v_mfma_f32_16x16x32_bf16 v[184:187], v[80:83], a[180:183], v[184:187]
ds_read_b64_tr_b16 v[72:73], v59 offset:12288
ds_read_b64_tr_b16 v[74:75], v59 offset:13312
v_mfma_f32_16x16x32_bf16 v[168:171], v[80:83], a[176:179], v[168:171]
s_waitcnt lgkmcnt(6)
v_mfma_f32_16x16x32_bf16 v[172:175], v[84:87], a[176:179], v[172:175]
ds_read_b64_tr_b16 v[76:77], v62 offset:12288
ds_read_b64_tr_b16 v[78:79], v62 offset:13312
v_mfma_f32_16x16x32_bf16 v[188:191], v[84:87], a[180:183], v[188:191]
v_mfma_f32_16x16x32_bf16 v[184:187], v[88:91], a[188:191], v[184:187]
ds_read_b64_tr_b16 v[80:81], v58 offset:24576
ds_read_b64_tr_b16 v[82:83], v58 offset:25600
v_mfma_f32_16x16x32_bf16 v[168:171], v[88:91], a[184:187], v[168:171]
v_mfma_f32_16x16x32_bf16 v[172:175], v[92:95], a[184:187], v[172:175]
ds_read_b64_tr_b16 v[84:85], v61 offset:24576
ds_read_b64_tr_b16 v[86:87], v61 offset:25600
v_mfma_f32_16x16x32_bf16 v[188:191], v[92:95], a[188:191], v[188:191]
s_waitcnt lgkmcnt(6)
v_mfma_f32_16x16x32_bf16 v[184:187], v[64:67], a[196:199], v[184:187]
ds_read_b64_tr_b16 v[88:89], v58 offset:28672
ds_read_b64_tr_b16 v[90:91], v58 offset:29696
v_mfma_f32_16x16x32_bf16 v[168:171], v[64:67], a[192:195], v[168:171]
v_mfma_f32_16x16x32_bf16 v[172:175], v[68:71], a[192:195], v[172:175]
ds_read_b64_tr_b16 v[92:93], v61 offset:28672
ds_read_b64_tr_b16 v[94:95], v61 offset:29696
v_mfma_f32_16x16x32_bf16 v[188:191], v[68:71], a[196:199], v[188:191]
v_add_u32 v8, 8192, v8
v_add_u32 v9, 8192, v9
v_mfma_f32_16x16x32_bf16 v[184:187], v[72:75], a[204:207], v[184:187]
ds_read_b64_tr_b16 v[64:65], v58 offset:40960
ds_read_b64_tr_b16 v[66:67], v58 offset:41984
v_mfma_f32_16x16x32_bf16 v[168:171], v[72:75], a[200:203], v[168:171]
s_waitcnt lgkmcnt(6)
v_mfma_f32_16x16x32_bf16 v[172:175], v[76:79], a[200:203], v[172:175]
ds_read_b64_tr_b16 v[68:69], v61 offset:40960
ds_read_b64_tr_b16 v[70:71], v61 offset:41984
v_mfma_f32_16x16x32_bf16 v[188:191], v[76:79], a[204:207], v[188:191]
v_mfma_f32_16x16x32_bf16 v[184:187], v[80:83], a[212:215], v[184:187]
ds_read_b64_tr_b16 v[72:73], v58 offset:45056
ds_read_b64_tr_b16 v[74:75], v58 offset:46080
v_mfma_f32_16x16x32_bf16 v[168:171], v[80:83], a[208:211], v[168:171]
v_mfma_f32_16x16x32_bf16 v[172:175], v[84:87], a[208:211], v[172:175]
ds_read_b64_tr_b16 v[76:77], v61 offset:45056
ds_read_b64_tr_b16 v[78:79], v61 offset:46080
v_mfma_f32_16x16x32_bf16 v[188:191], v[84:87], a[212:215], v[188:191]
s_waitcnt lgkmcnt(6)
v_add_u32 v8, 16384, v8
v_mfma_f32_16x16x32_bf16 v[184:187], v[88:91], a[220:223], v[184:187]
v_add_u32 v9, 16384, v9
ds_read_b64_tr_b16 v[80:81], v58 offset:57344
v_mfma_f32_16x16x32_bf16 v[168:171], v[88:91], a[216:219], v[168:171]
ds_read_b64_tr_b16 v[82:83], v58 offset:58368
v_mfma_f32_16x16x32_bf16 v[172:175], v[92:95], a[216:219], v[172:175]
ds_read_b64_tr_b16 v[84:85], v61 offset:57344
ds_read_b64_tr_b16 v[86:87], v61 offset:58368
v_mfma_f32_16x16x32_bf16 v[188:191], v[92:95], a[220:223], v[188:191]
v_mfma_f32_16x16x32_bf16 v[184:187], v[64:67], a[228:231], v[184:187]
ds_read_b64_tr_b16 v[88:89], v58 offset:61440
ds_read_b64_tr_b16 v[90:91], v58 offset:62464
v_mfma_f32_16x16x32_bf16 v[168:171], v[64:67], a[224:227], v[168:171]
s_waitcnt lgkmcnt(6)
v_mfma_f32_16x16x32_bf16 v[172:175], v[68:71], a[224:227], v[172:175]
ds_read_b64_tr_b16 v[92:93], v61 offset:61440
ds_read_b64_tr_b16 v[94:95], v61 offset:62464
v_mfma_f32_16x16x32_bf16 v[188:191], v[68:71], a[228:231], v[188:191]
v_add_u32 v8, 24576, v8
v_add_u32 v9, 24576, v9
v_mfma_f32_16x16x32_bf16 v[184:187], v[72:75], a[236:239], v[184:187]
ds_read_b128 v[64:67], v8 offset:4096
v_mfma_f32_16x16x32_bf16 v[168:171], v[72:75], a[232:235], v[168:171]
v_mfma_f32_16x16x32_bf16 v[172:175], v[76:79], a[232:235], v[172:175]
ds_read_b128 v[68:71], v8 offset:6144
s_waitcnt lgkmcnt(4)
v_mfma_f32_16x16x32_bf16 v[188:191], v[76:79], a[236:239], v[188:191]
v_mfma_f32_16x16x32_bf16 v[184:187], v[80:83], a[244:247], v[184:187]
ds_read_b128 v[72:75], v9 offset:4096
v_mfma_f32_16x16x32_bf16 v[168:171], v[80:83], a[240:243], v[168:171]
v_mfma_f32_16x16x32_bf16 v[172:175], v[84:87], a[240:243], v[172:175]
ds_read_b128 v[76:79], v9 offset:6144
v_add_u32 v8, 4294918144, v8
v_mfma_f32_16x16x32_bf16 v[188:191], v[84:87], a[244:247], v[188:191]
v_add_u32 v9, 4294918144, v9
v_mfma_f32_16x16x32_bf16 v[184:187], v[88:91], a[252:255], v[184:187]
ds_read_b128 v[80:83], v8 offset:4096
s_waitcnt lgkmcnt(3)
v_mfma_f32_16x16x32_bf16 v[168:171], v[88:91], a[248:251], v[168:171]
v_mfma_f32_16x16x32_bf16 v[172:175], v[92:95], a[248:251], v[172:175]
ds_read_b128 v[84:87], v8 offset:6144
v_mfma_f32_16x16x32_bf16 v[188:191], v[92:95], a[252:255], v[188:191]
v_mfma_f32_16x16x32_bf16 v[184:187], v[64:67], v[228:231], v[184:187]
ds_read_b128 v[88:91], v9 offset:4096
v_mfma_f32_16x16x32_bf16 v[168:171], v[64:67], v[224:227], v[168:171]
v_mfma_f32_16x16x32_bf16 v[172:175], v[68:71], v[224:227], v[172:175]
ds_read_b128 v[92:95], v9 offset:6144
s_waitcnt lgkmcnt(3)
v_mfma_f32_16x16x32_bf16 v[188:191], v[68:71], v[228:231], v[188:191]
v_mfma_f32_16x16x32_bf16 v[184:187], v[72:75], v[236:239], v[184:187]
v_mfma_f32_16x16x32_bf16 v[168:171], v[72:75], v[232:235], v[168:171]
v_mfma_f32_16x16x32_bf16 v[172:175], v[76:79], v[232:235], v[172:175]
v_mfma_f32_16x16x32_bf16 v[188:191], v[76:79], v[236:239], v[188:191]
v_mfma_f32_16x16x32_bf16 v[184:187], v[80:83], v[244:247], v[184:187]
s_waitcnt lgkmcnt(0)
v_mfma_f32_16x16x32_bf16 v[168:171], v[80:83], v[240:243], v[168:171]
v_mfma_f32_16x16x32_bf16 v[172:175], v[84:87], v[240:243], v[172:175]
v_mfma_f32_16x16x32_bf16 v[188:191], v[84:87], v[244:247], v[188:191]
v_mfma_f32_16x16x32_bf16 v[184:187], v[88:91], v[252:255], v[184:187]
v_mfma_f32_16x16x32_bf16 v[168:171], v[88:91], v[248:251], v[168:171]
v_mfma_f32_16x16x32_bf16 v[172:175], v[92:95], v[248:251], v[172:175]
v_mfma_f32_16x16x32_bf16 v[188:191], v[92:95], v[252:255], v[188:191]
s_nop 5
v_cvt_pk_bf16_f32 v168, v168, v169
v_cvt_pk_bf16_f32 v169, v170, v171
v_cvt_pk_bf16_f32 v170, v172, v173
v_cvt_pk_bf16_f32 v171, v174, v175
s_add_u32 s99, s82, 8192
buffer_store_dwordx4 v[168:171], v1, s[16:19], s99 offen offset:1024 sc1
v_cvt_pk_bf16_f32 v184, v184, v185
v_cvt_pk_bf16_f32 v185, v186, v187
v_cvt_pk_bf16_f32 v186, v188, v189
v_cvt_pk_bf16_f32 v187, v190, v191
s_add_u32 s99, s82, 8192
buffer_store_dwordx4 v[184:187], v1, s[16:19], s99 offen offset:3072 sc1
s_waitcnt vmcnt(0)
s_endpgm
L_slow:
L_helper:
s_and_b32 s46, s2, 7
s_lshl_b32 s46, s46, 1
s_lshr_b32 s61, s2, 3
s_add_u32 s46, s46, s61
s_sub_u32 s46, s46, 30
s_waitcnt lgkmcnt(0)
s_mov_b32 s4, s64
s_mov_b32 s5, s65
s_mov_b32 s6, 2359296
s_mov_b32 s7, 0x20000
s_mov_b32 s8, s84
s_mov_b32 s9, s85
s_mov_b32 s10, 5308416
s_mov_b32 s11, 0x20000
s_load_dword s45, s[96:97], 0
s_cmp_lt_u32 s44, 2
s_cselect_b32 s24, s70, s72
s_cselect_b32 s25, s71, s73
s_mov_b32 s26, 663552
s_mov_b32 s27, 0x20000
s_mov_b64 s[40:41], s[70:71]
s_mov_b64 s[42:43], s[72:73]
v_lshrrev_b32 v233, 5, v0
s_lshl_b32 s63, s2, 2
s_add_u32 s63, s63, s44
s_lshl_b32 s63, s63, 1
v_add_u32 v233, s63, v233
v_mul_u32_u24 v251, 1152, v233
v_and_b32 v234, 31, v0
v_lshl_add_u32 v251, v234, 2, v251
buffer_load_dword v224, v251, s[4:7], 0 offen offset:0
buffer_load_dword v225, v251, s[4:7], 0 offen offset:128
buffer_load_dword v226, v251, s[4:7], 0 offen offset:256
buffer_load_dword v227, v251, s[4:7], 0 offen offset:384
buffer_load_dword v228, v251, s[4:7], 0 offen offset:512
buffer_load_dword v229, v251, s[4:7], 0 offen offset:640
buffer_load_dword v230, v251, s[4:7], 0 offen offset:768
buffer_load_dword v231, v251, s[4:7], 0 offen offset:896
buffer_load_dword v232, v251, s[4:7], 0 offen offset:1024
s_cmp_lt_u32 s2, 72
s_cselect_b32 s36, s70, s72
s_cselect_b32 s37, s71, s73
s_mov_b32 s38, 663552
s_mov_b32 s39, 0x20000
s_cmp_lt_u32 s2, 72
s_cselect_b32 s63, 0, 663552
v_subrev_u32 v251, s63, v251
buffer_load_dword v36, v251, s[36:39], 0 offen offset:0
buffer_load_dword v37, v251, s[36:39], 0 offen offset:128
buffer_load_dword v38, v251, s[36:39], 0 offen offset:256
buffer_load_dword v39, v251, s[36:39], 0 offen offset:384
buffer_load_dword v40, v251, s[36:39], 0 offen offset:512
buffer_load_dword v41, v251, s[36:39], 0 offen offset:640
buffer_load_dword v42, v251, s[36:39], 0 offen offset:768
buffer_load_dword v43, v251, s[36:39], 0 offen offset:896
buffer_load_dword v44, v251, s[36:39], 0 offen offset:1024
s_mov_b32 s16, s96
s_mov_b32 s17, s97
s_mov_b32 s18, 268435456
s_mov_b32 s19, 0x20000
s_mov_b32 s12, s88
s_mov_b32 s13, s89
s_mov_b32 s14, 5308416
s_mov_b32 s15, 0x20000
s_mov_b32 s20, s92
s_mov_b32 s21, s93
s_mov_b32 s22, 4718592
s_mov_b32 s23, 0x20000
s_mov_b32 s28, s74
s_mov_b32 s29, s75
s_mov_b32 s30, 663552
s_mov_b32 s31, 0x20000
s_mov_b32 s32, s76
s_mov_b32 s33, s77
s_mov_b32 s34, 663552
s_mov_b32 s35, 0x20000
s_mov_b32 s39, 0x20000
v_cmp_eq_u32 vcc, 0, v0
v_mov_b32 v26, 0x80000000
s_nop 0
v_cndmask_b32 v26, v26, v0, vcc
s_waitcnt lgkmcnt(0)
s_add_u32 s45, s45, 16
s_lshl_b32 s61, s46, 2
s_add_u32 s61, s61, s44
s_lshl_b32 s61, s61, 10
v_add_u32 v24, s61, v1
v_min_u32 v25, 8, v0
v_lshlrev_b32 v25, 7, v25
global_load_dword v32, v25, s[80:81]
global_load_dword v33, v25, s[90:91]
v_lshrrev_b32 v2, 3, v0
s_lshl_b32 s61, s44, 3
v_add_u32 v2, s61, v2
v_mul_u32_u24 v2, 9216, v2
v_and_b32 v3, 7, v0
v_lshl_add_u32 v2, v3, 4, v2
s_mov_b32 s47, s46
s_lshl_b32 s63, s47, 7
s_cmp_lt_u32 s47, 72
s_cselect_b32 s63, s63, 0
buffer_load_dwordx4 v[80:83], v2, s[8:11], s63 offen
s_add_u32 s63, s63, 294912
buffer_load_dwordx4 v[84:87], v2, s[8:11], s63 offen
s_add_u32 s63, s63, 294912
buffer_load_dwordx4 v[88:91], v2, s[8:11], s63 offen
s_add_u32 s63, s63, 294912
buffer_load_dwordx4 v[92:95], v2, s[8:11], s63 offen
s_add_u32 s63, s63, 294912
buffer_load_dwordx4 v[96:99], v2, s[8:11], s63 offen
s_add_u32 s63, s63, 294912
buffer_load_dwordx4 v[100:103], v2, s[8:11], s63 offen
s_add_u32 s63, s63, 294912
buffer_load_dwordx4 v[104:107], v2, s[8:11], s63 offen
s_add_u32 s63, s63, 294912
buffer_load_dwordx4 v[108:111], v2, s[8:11], s63 offen
s_add_u32 s63, s63, 294912
buffer_load_dwordx4 v[112:115], v2, s[8:11], s63 offen
s_add_u32 s63, s63, 294912
buffer_load_dwordx4 v[116:119], v2, s[8:11], s63 offen
s_add_u32 s63, s63, 294912
buffer_load_dwordx4 v[120:123], v2, s[8:11], s63 offen
s_add_u32 s63, s63, 294912
buffer_load_dwordx4 v[124:127], v2, s[8:11], s63 offen
s_add_u32 s63, s63, 294912
buffer_load_dwordx4 v[128:131], v2, s[8:11], s63 offen
s_add_u32 s63, s63, 294912
buffer_load_dwordx4 v[132:135], v2, s[8:11], s63 offen
s_add_u32 s63, s63, 294912
buffer_load_dwordx4 v[136:139], v2, s[8:11], s63 offen
s_add_u32 s63, s63, 294912
buffer_load_dwordx4 v[140:143], v2, s[8:11], s63 offen
s_add_u32 s63, s63, 294912
buffer_load_dwordx4 v[144:147], v2, s[8:11], s63 offen
s_add_u32 s63, s63, 294912
buffer_load_dwordx4 v[148:151], v2, s[8:11], s63 offen
s_waitcnt vmcnt(37)
v_lshlrev_b32 v242, 16, v224
v_and_b32 v224, 0xffff0000, v224
s_waitcnt vmcnt(36)
v_lshlrev_b32 v243, 16, v225
v_and_b32 v225, 0xffff0000, v225
s_waitcnt vmcnt(35)
v_lshlrev_b32 v244, 16, v226
v_and_b32 v226, 0xffff0000, v226
s_waitcnt vmcnt(34)
v_lshlrev_b32 v245, 16, v227
v_and_b32 v227, 0xffff0000, v227
s_waitcnt vmcnt(33)
v_lshlrev_b32 v246, 16, v228
v_and_b32 v228, 0xffff0000, v228
s_waitcnt vmcnt(32)
v_lshlrev_b32 v247, 16, v229
v_and_b32 v229, 0xffff0000, v229
s_waitcnt vmcnt(31)
v_lshlrev_b32 v248, 16, v230
v_and_b32 v230, 0xffff0000, v230
s_waitcnt vmcnt(30)
v_lshlrev_b32 v249, 16, v231
v_and_b32 v231, 0xffff0000, v231
s_waitcnt vmcnt(29)
v_lshlrev_b32 v250, 16, v232
v_and_b32 v232, 0xffff0000, v232
v_add_f32 v235, v242, v243
v_add_f32 v236, v224, v225
v_add_f32 v235, v235, v244
v_add_f32 v236, v236, v226
v_add_f32 v235, v235, v245
v_add_f32 v236, v236, v227
v_add_f32 v235, v235, v246
v_add_f32 v236, v236, v228
v_add_f32 v235, v235, v247
v_add_f32 v236, v236, v229
v_add_f32 v235, v235, v248
v_add_f32 v236, v236, v230
v_add_f32 v235, v235, v249
v_add_f32 v236, v236, v231
v_add_f32 v235, v235, v250
v_add_f32 v236, v236, v232
v_add_f32 v235, v235, v236
s_nop 1
v_add_f32_dpp v235, v235, v235 quad_perm:[1,0,3,2] row_mask:0xf bank_mask:0xf
s_nop 1
v_add_f32_dpp v235, v235, v235 quad_perm:[2,3,0,1] row_mask:0xf bank_mask:0xf
s_nop 1
v_add_f32_dpp v235, v235, v235 row_half_mirror row_mask:0xf bank_mask:0xf
s_nop 1
v_add_f32_dpp v235, v235, v235 row_mirror row_mask:0xf bank_mask:0xf
v_mov_b32 v236, v235
s_nop 1
v_permlane16_swap_b32 v235, v236
v_add_f32 v235, v235, v236
v_mul_f32 v252, 0x3ae38e39, v235
v_sub_f32 v242, v242, v252
v_sub_f32 v224, v224, v252
v_sub_f32 v243, v243, v252
v_sub_f32 v225, v225, v252
v_sub_f32 v244, v244, v252
v_sub_f32 v226, v226, v252
v_sub_f32 v245, v245, v252
v_sub_f32 v227, v227, v252
v_sub_f32 v246, v246, v252
v_sub_f32 v228, v228, v252
v_sub_f32 v247, v247, v252
v_sub_f32 v229, v229, v252
v_sub_f32 v248, v248, v252
v_sub_f32 v230, v230, v252
v_sub_f32 v249, v249, v252
v_sub_f32 v231, v231, v252
v_sub_f32 v250, v250, v252
v_sub_f32 v232, v232, v252
v_mul_f32 v235, v242, v242
v_mul_f32 v236, v224, v224
v_fmac_f32 v235, v243, v243
v_fmac_f32 v236, v225, v225
v_fmac_f32 v235, v244, v244
v_fmac_f32 v236, v226, v226
v_fmac_f32 v235, v245, v245
v_fmac_f32 v236, v227, v227
v_fmac_f32 v235, v246, v246
v_fmac_f32 v236, v228, v228
v_fmac_f32 v235, v247, v247
v_fmac_f32 v236, v229, v229
v_fmac_f32 v235, v248, v248
v_fmac_f32 v236, v230, v230
v_fmac_f32 v235, v249, v249
v_fmac_f32 v236, v231, v231
v_fmac_f32 v235, v250, v250
v_fmac_f32 v236, v232, v232
v_add_f32 v235, v235, v236
s_nop 1
v_add_f32_dpp v235, v235, v235 quad_perm:[1,0,3,2] row_mask:0xf bank_mask:0xf
s_nop 1
v_add_f32_dpp v235, v235, v235 quad_perm:[2,3,0,1] row_mask:0xf bank_mask:0xf
s_nop 1
v_add_f32_dpp v235, v235, v235 row_half_mirror row_mask:0xf bank_mask:0xf
s_nop 1
v_add_f32_dpp v235, v235, v235 row_mirror row_mask:0xf bank_mask:0xf
v_mov_b32 v236, v235
s_nop 1
v_permlane16_swap_b32 v235, v236
v_add_f32 v235, v235, v236
v_mul_f32 v235, 0x3ae38e39, v235
v_add_f32 v236, 0x3727c5ac, v235
v_rsq_f32 v253, v236
s_nop 0
v_mul_f32 v235, v235, v253
v_mul_f32 v235, v235, v253
v_add_f32 v235, 0x3727c5ac, v235
v_rsq_f32 v254, v235
v_mov_b32 v255, s45
v_lshlrev_b32 v237, 4, v233
v_mov_b32 v238, 0x80000000
v_cmp_eq_u32 vcc, 0, v234
s_mov_b32 s71, 65536
s_nop 0
v_cndmask_b32 v237, v238, v237, vcc
buffer_store_dwordx4 v[252:255], v237, s[16:19], s71 offen sc1
s_waitcnt vmcnt(29)
v_lshlrev_b32 v242, 16, v36
v_and_b32 v36, 0xffff0000, v36
s_waitcnt vmcnt(28)
v_lshlrev_b32 v243, 16, v37
v_and_b32 v37, 0xffff0000, v37
s_waitcnt vmcnt(27)
v_lshlrev_b32 v244, 16, v38
v_and_b32 v38, 0xffff0000, v38
s_waitcnt vmcnt(26)
v_lshlrev_b32 v245, 16, v39
v_and_b32 v39, 0xffff0000, v39
s_waitcnt vmcnt(25)
v_lshlrev_b32 v246, 16, v40
v_and_b32 v40, 0xffff0000, v40
s_waitcnt vmcnt(24)
v_lshlrev_b32 v247, 16, v41
v_and_b32 v41, 0xffff0000, v41
s_waitcnt vmcnt(23)
v_lshlrev_b32 v248, 16, v42
v_and_b32 v42, 0xffff0000, v42
s_waitcnt vmcnt(22)
v_lshlrev_b32 v249, 16, v43
v_and_b32 v43, 0xffff0000, v43
s_waitcnt vmcnt(21)
v_lshlrev_b32 v250, 16, v44
v_and_b32 v44, 0xffff0000, v44
v_add_f32 v235, v242, v243
v_add_f32 v236, v36, v37
v_add_f32 v235, v235, v244
v_add_f32 v236, v236, v38
v_add_f32 v235, v235, v245
v_add_f32 v236, v236, v39
v_add_f32 v235, v235, v246
v_add_f32 v236, v236, v40
v_add_f32 v235, v235, v247
v_add_f32 v236, v236, v41
v_add_f32 v235, v235, v248
v_add_f32 v236, v236, v42
v_add_f32 v235, v235, v249
v_add_f32 v236, v236, v43
v_add_f32 v235, v235, v250
v_add_f32 v236, v236, v44
v_add_f32 v36, v235, v236
s_nop 1
v_add_f32_dpp v36, v36, v36 quad_perm:[1,0,3,2] row_mask:0xf bank_mask:0xf
s_nop 1
v_add_f32_dpp v36, v36, v36 quad_perm:[2,3,0,1] row_mask:0xf bank_mask:0xf
s_nop 1
v_add_f32_dpp v36, v36, v36 row_half_mirror row_mask:0xf bank_mask:0xf
s_nop 1
v_add_f32_dpp v36, v36, v36 row_mirror row_mask:0xf bank_mask:0xf
v_mov_b32 v236, v36
s_nop 1
v_permlane16_swap_b32 v36, v236
v_add_f32 v36, v36, v236
v_mov_b32 v37, s45
v_lshrrev_b32 v237, 1, v237
v_cmp_gt_u32 vcc, 1152, v233
s_mov_b32 s71, 139264
s_nop 0
v_cndmask_b32 v237, v238, v237, vcc
buffer_store_dwordx2 v[36:37], v237, s[16:19], s71 offen sc1
v_mov_b32 v4, 0x3f80
v_mov_b32 v5, 0x3f800000
v_lshlrev_b32 v6, 5, v3
v_bfe_u32 v7, v0, 4, 2
v_lshl_add_u32 v6, v7, 3, v6
s_lshl_b32 s61, s44, 8
v_add_u32 v6, s61, v6
v_lshlrev_b32 v7, 2, v0
v_lshlrev_b32 v20, 3, v0
s_lshl_b32 s61, s44, 29
v_or_b32 v20, s61, v20
v_mov_b32 v23, s45
s_mov_b32 s48, s47
s_add_u32 s47, s47, 16
v_mov_b32 v8, 0
v_mov_b32 v9, 0
v_mov_b32 v10, 0
v_mov_b32 v11, 0
v_mov_b32 v12, 0
v_mov_b32 v13, 0
v_mov_b32 v14, 0
v_mov_b32 v15, 0
s_waitcnt vmcnt(19)
v_dot2_f32_bf16 v8, v80, v4, v8
v_dot2_f32_bf16 v9, v80, v5, v9
v_dot2_f32_bf16 v10, v81, v4, v10
v_dot2_f32_bf16 v11, v81, v5, v11
v_dot2_f32_bf16 v12, v82, v4, v12
v_dot2_f32_bf16 v13, v82, v5, v13
v_dot2_f32_bf16 v14, v83, v4, v14
v_dot2_f32_bf16 v15, v83, v5, v15
s_lshl_b32 s63, s47, 7
s_cmp_lt_u32 s47, 72
s_cselect_b32 s63, s63, 0
buffer_load_dwordx4 v[152:155], v2, s[8:11], s63 offen
s_waitcnt vmcnt(19)
v_dot2_f32_bf16 v8, v84, v4, v8
v_dot2_f32_bf16 v9, v84, v5, v9
v_dot2_f32_bf16 v10, v85, v4, v10
v_dot2_f32_bf16 v11, v85, v5, v11
v_dot2_f32_bf16 v12, v86, v4, v12
v_dot2_f32_bf16 v13, v86, v5, v13
v_dot2_f32_bf16 v14, v87, v4, v14
v_dot2_f32_bf16 v15, v87, v5, v15
s_add_u32 s63, s63, 294912
buffer_load_dwordx4 v[156:159], v2, s[8:11], s63 offen
s_waitcnt vmcnt(19)
v_dot2_f32_bf16 v8, v88, v4, v8
v_dot2_f32_bf16 v9, v88, v5, v9
v_dot2_f32_bf16 v10, v89, v4, v10
v_dot2_f32_bf16 v11, v89, v5, v11
v_dot2_f32_bf16 v12, v90, v4, v12
v_dot2_f32_bf16 v13, v90, v5, v13
v_dot2_f32_bf16 v14, v91, v4, v14
v_dot2_f32_bf16 v15, v91, v5, v15
s_add_u32 s63, s63, 294912
buffer_load_dwordx4 v[160:163], v2, s[8:11], s63 offen
s_waitcnt vmcnt(19)
v_dot2_f32_bf16 v8, v92, v4, v8
v_dot2_f32_bf16 v9, v92, v5, v9
v_dot2_f32_bf16 v10, v93, v4, v10
v_dot2_f32_bf16 v11, v93, v5, v11
v_dot2_f32_bf16 v12, v94, v4, v12
v_dot2_f32_bf16 v13, v94, v5, v13
v_dot2_f32_bf16 v14, v95, v4, v14
v_dot2_f32_bf16 v15, v95, v5, v15
s_add_u32 s63, s63, 294912
buffer_load_dwordx4 v[164:167], v2, s[8:11], s63 offen
s_waitcnt vmcnt(19)
v_dot2_f32_bf16 v8, v96, v4, v8
v_dot2_f32_bf16 v9, v96, v5, v9
v_dot2_f32_bf16 v10, v97, v4, v10
v_dot2_f32_bf16 v11, v97, v5, v11
v_dot2_f32_bf16 v12, v98, v4, v12
v_dot2_f32_bf16 v13, v98, v5, v13
v_dot2_f32_bf16 v14, v99, v4, v14
v_dot2_f32_bf16 v15, v99, v5, v15
s_add_u32 s63, s63, 294912
buffer_load_dwordx4 v[168:171], v2, s[8:11], s63 offen
s_waitcnt vmcnt(19)
v_dot2_f32_bf16 v8, v100, v4, v8
v_dot2_f32_bf16 v9, v100, v5, v9
v_dot2_f32_bf16 v10, v101, v4, v10
v_dot2_f32_bf16 v11, v101, v5, v11
v_dot2_f32_bf16 v12, v102, v4, v12
v_dot2_f32_bf16 v13, v102, v5, v13
v_dot2_f32_bf16 v14, v103, v4, v14
v_dot2_f32_bf16 v15, v103, v5, v15
s_add_u32 s63, s63, 294912
buffer_load_dwordx4 v[172:175], v2, s[8:11], s63 offen
s_waitcnt vmcnt(19)
v_dot2_f32_bf16 v8, v104, v4, v8
v_dot2_f32_bf16 v9, v104, v5, v9
v_dot2_f32_bf16 v10, v105, v4, v10
v_dot2_f32_bf16 v11, v105, v5, v11
v_dot2_f32_bf16 v12, v106, v4, v12
v_dot2_f32_bf16 v13, v106, v5, v13
v_dot2_f32_bf16 v14, v107, v4, v14
v_dot2_f32_bf16 v15, v107, v5, v15
s_add_u32 s63, s63, 294912
buffer_load_dwordx4 v[176:179], v2, s[8:11], s63 offen
s_waitcnt vmcnt(19)
v_dot2_f32_bf16 v8, v108, v4, v8
v_dot2_f32_bf16 v9, v108, v5, v9
v_dot2_f32_bf16 v10, v109, v4, v10
v_dot2_f32_bf16 v11, v109, v5, v11
v_dot2_f32_bf16 v12, v110, v4, v12
v_dot2_f32_bf16 v13, v110, v5, v13
v_dot2_f32_bf16 v14, v111, v4, v14
v_dot2_f32_bf16 v15, v111, v5, v15
s_add_u32 s63, s63, 294912
buffer_load_dwordx4 v[180:183], v2, s[8:11], s63 offen
s_waitcnt vmcnt(19)
v_dot2_f32_bf16 v8, v112, v4, v8
v_dot2_f32_bf16 v9, v112, v5, v9
v_dot2_f32_bf16 v10, v113, v4, v10
v_dot2_f32_bf16 v11, v113, v5, v11
v_dot2_f32_bf16 v12, v114, v4, v12
v_dot2_f32_bf16 v13, v114, v5, v13
v_dot2_f32_bf16 v14, v115, v4, v14
v_dot2_f32_bf16 v15, v115, v5, v15
s_add_u32 s63, s63, 294912
buffer_load_dwordx4 v[184:187], v2, s[8:11], s63 offen
s_waitcnt vmcnt(19)
v_dot2_f32_bf16 v8, v116, v4, v8
v_dot2_f32_bf16 v9, v116, v5, v9
v_dot2_f32_bf16 v10, v117, v4, v10
v_dot2_f32_bf16 v11, v117, v5, v11
v_dot2_f32_bf16 v12, v118, v4, v12
v_dot2_f32_bf16 v13, v118, v5, v13
v_dot2_f32_bf16 v14, v119, v4, v14
v_dot2_f32_bf16 v15, v119, v5, v15
s_add_u32 s63, s63, 294912
buffer_load_dwordx4 v[188:191], v2, s[8:11], s63 offen
s_waitcnt vmcnt(19)
v_dot2_f32_bf16 v8, v120, v4, v8
v_dot2_f32_bf16 v9, v120, v5, v9
v_dot2_f32_bf16 v10, v121, v4, v10
v_dot2_f32_bf16 v11, v121, v5, v11
v_dot2_f32_bf16 v12, v122, v4, v12
v_dot2_f32_bf16 v13, v122, v5, v13
v_dot2_f32_bf16 v14, v123, v4, v14
v_dot2_f32_bf16 v15, v123, v5, v15
s_add_u32 s63, s63, 294912
buffer_load_dwordx4 v[192:195], v2, s[8:11], s63 offen
s_waitcnt vmcnt(19)
v_dot2_f32_bf16 v8, v124, v4, v8
v_dot2_f32_bf16 v9, v124, v5, v9
v_dot2_f32_bf16 v10, v125, v4, v10
v_dot2_f32_bf16 v11, v125, v5, v11
v_dot2_f32_bf16 v12, v126, v4, v12
v_dot2_f32_bf16 v13, v126, v5, v13
v_dot2_f32_bf16 v14, v127, v4, v14
v_dot2_f32_bf16 v15, v127, v5, v15
s_add_u32 s63, s63, 294912
buffer_load_dwordx4 v[196:199], v2, s[8:11], s63 offen
s_waitcnt vmcnt(19)
v_dot2_f32_bf16 v8, v128, v4, v8
v_dot2_f32_bf16 v9, v128, v5, v9
v_dot2_f32_bf16 v10, v129, v4, v10
v_dot2_f32_bf16 v11, v129, v5, v11
v_dot2_f32_bf16 v12, v130, v4, v12
v_dot2_f32_bf16 v13, v130, v5, v13
v_dot2_f32_bf16 v14, v131, v4, v14
v_dot2_f32_bf16 v15, v131, v5, v15
s_add_u32 s63, s63, 294912
buffer_load_dwordx4 v[200:203], v2, s[8:11], s63 offen
s_waitcnt vmcnt(19)
v_dot2_f32_bf16 v8, v132, v4, v8
v_dot2_f32_bf16 v9, v132, v5, v9
v_dot2_f32_bf16 v10, v133, v4, v10
v_dot2_f32_bf16 v11, v133, v5, v11
v_dot2_f32_bf16 v12, v134, v4, v12
v_dot2_f32_bf16 v13, v134, v5, v13
v_dot2_f32_bf16 v14, v135, v4, v14
v_dot2_f32_bf16 v15, v135, v5, v15
s_add_u32 s63, s63, 294912
buffer_load_dwordx4 v[204:207], v2, s[8:11], s63 offen
s_waitcnt vmcnt(19)
v_dot2_f32_bf16 v8, v136, v4, v8
v_dot2_f32_bf16 v9, v136, v5, v9
v_dot2_f32_bf16 v10, v137, v4, v10
v_dot2_f32_bf16 v11, v137, v5, v11
v_dot2_f32_bf16 v12, v138, v4, v12
v_dot2_f32_bf16 v13, v138, v5, v13
v_dot2_f32_bf16 v14, v139, v4, v14
v_dot2_f32_bf16 v15, v139, v5, v15
s_waitcnt vmcnt(18)
v_dot2_f32_bf16 v8, v140, v4, v8
v_dot2_f32_bf16 v9, v140, v5, v9
v_dot2_f32_bf16 v10, v141, v4, v10
v_dot2_f32_bf16 v11, v141, v5, v11
v_dot2_f32_bf16 v12, v142, v4, v12
v_dot2_f32_bf16 v13, v142, v5, v13
v_dot2_f32_bf16 v14, v143, v4, v14
v_dot2_f32_bf16 v15, v143, v5, v15
s_waitcnt vmcnt(17)
v_dot2_f32_bf16 v8, v144, v4, v8
v_dot2_f32_bf16 v9, v144, v5, v9
v_dot2_f32_bf16 v10, v145, v4, v10
v_dot2_f32_bf16 v11, v145, v5, v11
v_dot2_f32_bf16 v12, v146, v4, v12
v_dot2_f32_bf16 v13, v146, v5, v13
v_dot2_f32_bf16 v14, v147, v4, v14
v_dot2_f32_bf16 v15, v147, v5, v15
s_waitcnt vmcnt(16)
v_dot2_f32_bf16 v8, v148, v4, v8
v_dot2_f32_bf16 v9, v148, v5, v9
v_dot2_f32_bf16 v10, v149, v4, v10
v_dot2_f32_bf16 v11, v149, v5, v11
v_dot2_f32_bf16 v12, v150, v4, v12
v_dot2_f32_bf16 v13, v150, v5, v13
v_dot2_f32_bf16 v14, v151, v4, v14
v_dot2_f32_bf16 v15, v151, v5, v15
v_permlane32_swap_b32 v8, v12
v_permlane32_swap_b32 v9, v13
v_permlane32_swap_b32 v10, v14
v_permlane32_swap_b32 v11, v15
v_add_f32 v8, v8, v12
v_add_f32 v9, v9, v13
v_add_f32 v10, v10, v14
v_add_f32 v11, v11, v15
s_nop 0
v_permlane16_swap_b32 v8, v10
v_permlane16_swap_b32 v9, v11
v_add_f32 v8, v8, v10
v_add_f32 v9, v9, v11
s_nop 0
v_add_f32_dpp v8, v8, v8 row_ror:8 row_mask:0xf bank_mask:0xf
v_add_f32_dpp v9, v9, v9 row_ror:8 row_mask:0xf bank_mask:0xf
ds_write_b64 v6, v[8:9] offset:0
s_waitcnt lgkmcnt(0)
s_barrier
ds_read_b32 v12, v7 offset:0
ds_read_b32 v13, v7 offset:256
ds_read_b32 v14, v7 offset:512
ds_read_b32 v15, v7 offset:768
s_waitcnt lgkmcnt(2)
v_add_f32 v12, v12, v13
s_waitcnt lgkmcnt(0)
v_add_f32 v14, v14, v15
v_add_f32 v22, v12, v14
s_lshl_b32 s62, s48, 9
s_add_u32 s62, s62, 98304
buffer_store_dwordx2 v[22:23], v20, s[16:19], s62 offen sc1
s_add_u32 s63, s63, 294912
buffer_load_dwordx4 v[208:211], v2, s[8:11], s63 offen
s_add_u32 s63, s63, 294912
buffer_load_dwordx4 v[212:215], v2, s[8:11], s63 offen
s_add_u32 s63, s63, 294912
buffer_load_dwordx4 v[216:219], v2, s[8:11], s63 offen
s_add_u32 s63, s63, 294912
buffer_load_dwordx4 v[220:223], v2, s[8:11], s63 offen
s_mov_b32 s48, s47
s_add_u32 s47, s47, 16
v_mov_b32 v8, 0
v_mov_b32 v9, 0
v_mov_b32 v10, 0
v_mov_b32 v11, 0
v_mov_b32 v12, 0
v_mov_b32 v13, 0
v_mov_b32 v14, 0
v_mov_b32 v15, 0
s_waitcnt vmcnt(18)
v_dot2_f32_bf16 v8, v152, v4, v8
v_dot2_f32_bf16 v9, v152, v5, v9
v_dot2_f32_bf16 v10, v153, v4, v10
v_dot2_f32_bf16 v11, v153, v5, v11
v_dot2_f32_bf16 v12, v154, v4, v12
v_dot2_f32_bf16 v13, v154, v5, v13
v_dot2_f32_bf16 v14, v155, v4, v14
v_dot2_f32_bf16 v15, v155, v5, v15
s_lshl_b32 s63, s47, 7
s_cmp_lt_u32 s47, 72
s_cselect_b32 s63, s63, 0
buffer_load_dwordx4 v[80:83], v2, s[8:11], s63 offen
s_waitcnt vmcnt(18)
v_dot2_f32_bf16 v8, v156, v4, v8
v_dot2_f32_bf16 v9, v156, v5, v9
v_dot2_f32_bf16 v10, v157, v4, v10
v_dot2_f32_bf16 v11, v157, v5, v11
v_dot2_f32_bf16 v12, v158, v4, v12
v_dot2_f32_bf16 v13, v158, v5, v13
v_dot2_f32_bf16 v14, v159, v4, v14
v_dot2_f32_bf16 v15, v159, v5, v15
s_add_u32 s63, s63, 294912
buffer_load_dwordx4 v[84:87], v2, s[8:11], s63 offen
s_waitcnt vmcnt(18)
v_dot2_f32_bf16 v8, v160, v4, v8
v_dot2_f32_bf16 v9, v160, v5, v9
v_dot2_f32_bf16 v10, v161, v4, v10
v_dot2_f32_bf16 v11, v161, v5, v11
v_dot2_f32_bf16 v12, v162, v4, v12
v_dot2_f32_bf16 v13, v162, v5, v13
v_dot2_f32_bf16 v14, v163, v4, v14
v_dot2_f32_bf16 v15, v163, v5, v15
s_add_u32 s63, s63, 294912
buffer_load_dwordx4 v[88:91], v2, s[8:11], s63 offen
s_waitcnt vmcnt(18)
v_dot2_f32_bf16 v8, v164, v4, v8
v_dot2_f32_bf16 v9, v164, v5, v9
v_dot2_f32_bf16 v10, v165, v4, v10
v_dot2_f32_bf16 v11, v165, v5, v11
v_dot2_f32_bf16 v12, v166, v4, v12
v_dot2_f32_bf16 v13, v166, v5, v13
v_dot2_f32_bf16 v14, v167, v4, v14
v_dot2_f32_bf16 v15, v167, v5, v15
s_add_u32 s63, s63, 294912
buffer_load_dwordx4 v[92:95], v2, s[8:11], s63 offen
s_waitcnt vmcnt(18)
v_dot2_f32_bf16 v8, v168, v4, v8
v_dot2_f32_bf16 v9, v168, v5, v9
v_dot2_f32_bf16 v10, v169, v4, v10
v_dot2_f32_bf16 v11, v169, v5, v11
v_dot2_f32_bf16 v12, v170, v4, v12
v_dot2_f32_bf16 v13, v170, v5, v13
v_dot2_f32_bf16 v14, v171, v4, v14
v_dot2_f32_bf16 v15, v171, v5, v15
s_add_u32 s63, s63, 294912
buffer_load_dwordx4 v[96:99], v2, s[8:11], s63 offen
s_waitcnt vmcnt(18)
v_dot2_f32_bf16 v8, v172, v4, v8
v_dot2_f32_bf16 v9, v172, v5, v9
v_dot2_f32_bf16 v10, v173, v4, v10
v_dot2_f32_bf16 v11, v173, v5, v11
v_dot2_f32_bf16 v12, v174, v4, v12
v_dot2_f32_bf16 v13, v174, v5, v13
v_dot2_f32_bf16 v14, v175, v4, v14
v_dot2_f32_bf16 v15, v175, v5, v15
s_add_u32 s63, s63, 294912
buffer_load_dwordx4 v[100:103], v2, s[8:11], s63 offen
s_waitcnt vmcnt(18)
v_dot2_f32_bf16 v8, v176, v4, v8
v_dot2_f32_bf16 v9, v176, v5, v9
v_dot2_f32_bf16 v10, v177, v4, v10
v_dot2_f32_bf16 v11, v177, v5, v11
v_dot2_f32_bf16 v12, v178, v4, v12
v_dot2_f32_bf16 v13, v178, v5, v13
v_dot2_f32_bf16 v14, v179, v4, v14
v_dot2_f32_bf16 v15, v179, v5, v15
s_add_u32 s63, s63, 294912
buffer_load_dwordx4 v[104:107], v2, s[8:11], s63 offen
s_waitcnt vmcnt(18)
v_dot2_f32_bf16 v8, v180, v4, v8
v_dot2_f32_bf16 v9, v180, v5, v9
v_dot2_f32_bf16 v10, v181, v4, v10
v_dot2_f32_bf16 v11, v181, v5, v11
v_dot2_f32_bf16 v12, v182, v4, v12
v_dot2_f32_bf16 v13, v182, v5, v13
v_dot2_f32_bf16 v14, v183, v4, v14
v_dot2_f32_bf16 v15, v183, v5, v15
s_add_u32 s63, s63, 294912
buffer_load_dwordx4 v[108:111], v2, s[8:11], s63 offen
s_waitcnt vmcnt(18)
v_dot2_f32_bf16 v8, v184, v4, v8
v_dot2_f32_bf16 v9, v184, v5, v9
v_dot2_f32_bf16 v10, v185, v4, v10
v_dot2_f32_bf16 v11, v185, v5, v11
v_dot2_f32_bf16 v12, v186, v4, v12
v_dot2_f32_bf16 v13, v186, v5, v13
v_dot2_f32_bf16 v14, v187, v4, v14
v_dot2_f32_bf16 v15, v187, v5, v15
s_add_u32 s63, s63, 294912
buffer_load_dwordx4 v[112:115], v2, s[8:11], s63 offen
s_waitcnt vmcnt(18)
v_dot2_f32_bf16 v8, v188, v4, v8
v_dot2_f32_bf16 v9, v188, v5, v9
v_dot2_f32_bf16 v10, v189, v4, v10
v_dot2_f32_bf16 v11, v189, v5, v11
v_dot2_f32_bf16 v12, v190, v4, v12
v_dot2_f32_bf16 v13, v190, v5, v13
v_dot2_f32_bf16 v14, v191, v4, v14
v_dot2_f32_bf16 v15, v191, v5, v15
s_add_u32 s63, s63, 294912
buffer_load_dwordx4 v[116:119], v2, s[8:11], s63 offen
s_waitcnt vmcnt(18)
v_dot2_f32_bf16 v8, v192, v4, v8
v_dot2_f32_bf16 v9, v192, v5, v9
v_dot2_f32_bf16 v10, v193, v4, v10
v_dot2_f32_bf16 v11, v193, v5, v11
v_dot2_f32_bf16 v12, v194, v4, v12
v_dot2_f32_bf16 v13, v194, v5, v13
v_dot2_f32_bf16 v14, v195, v4, v14
v_dot2_f32_bf16 v15, v195, v5, v15
s_add_u32 s63, s63, 294912
buffer_load_dwordx4 v[120:123], v2, s[8:11], s63 offen
s_waitcnt vmcnt(18)
v_dot2_f32_bf16 v8, v196, v4, v8
v_dot2_f32_bf16 v9, v196, v5, v9
v_dot2_f32_bf16 v10, v197, v4, v10
v_dot2_f32_bf16 v11, v197, v5, v11
v_dot2_f32_bf16 v12, v198, v4, v12
v_dot2_f32_bf16 v13, v198, v5, v13
v_dot2_f32_bf16 v14, v199, v4, v14
v_dot2_f32_bf16 v15, v199, v5, v15
s_add_u32 s63, s63, 294912
buffer_load_dwordx4 v[124:127], v2, s[8:11], s63 offen
s_waitcnt vmcnt(18)
v_dot2_f32_bf16 v8, v200, v4, v8
v_dot2_f32_bf16 v9, v200, v5, v9
v_dot2_f32_bf16 v10, v201, v4, v10
v_dot2_f32_bf16 v11, v201, v5, v11
v_dot2_f32_bf16 v12, v202, v4, v12
v_dot2_f32_bf16 v13, v202, v5, v13
v_dot2_f32_bf16 v14, v203, v4, v14
v_dot2_f32_bf16 v15, v203, v5, v15
s_add_u32 s63, s63, 294912
buffer_load_dwordx4 v[128:131], v2, s[8:11], s63 offen
s_waitcnt vmcnt(18)
v_dot2_f32_bf16 v8, v204, v4, v8
v_dot2_f32_bf16 v9, v204, v5, v9
v_dot2_f32_bf16 v10, v205, v4, v10
v_dot2_f32_bf16 v11, v205, v5, v11
v_dot2_f32_bf16 v12, v206, v4, v12
v_dot2_f32_bf16 v13, v206, v5, v13
v_dot2_f32_bf16 v14, v207, v4, v14
v_dot2_f32_bf16 v15, v207, v5, v15
s_add_u32 s63, s63, 294912
buffer_load_dwordx4 v[132:135], v2, s[8:11], s63 offen
s_waitcnt vmcnt(17)
v_dot2_f32_bf16 v8, v208, v4, v8
v_dot2_f32_bf16 v9, v208, v5, v9
v_dot2_f32_bf16 v10, v209, v4, v10
v_dot2_f32_bf16 v11, v209, v5, v11
v_dot2_f32_bf16 v12, v210, v4, v12
v_dot2_f32_bf16 v13, v210, v5, v13
v_dot2_f32_bf16 v14, v211, v4, v14
v_dot2_f32_bf16 v15, v211, v5, v15
s_waitcnt vmcnt(16)
v_dot2_f32_bf16 v8, v212, v4, v8
v_dot2_f32_bf16 v9, v212, v5, v9
v_dot2_f32_bf16 v10, v213, v4, v10
v_dot2_f32_bf16 v11, v213, v5, v11
v_dot2_f32_bf16 v12, v214, v4, v12
v_dot2_f32_bf16 v13, v214, v5, v13
v_dot2_f32_bf16 v14, v215, v4, v14
v_dot2_f32_bf16 v15, v215, v5, v15
s_waitcnt vmcnt(15)
v_dot2_f32_bf16 v8, v216, v4, v8
v_dot2_f32_bf16 v9, v216, v5, v9
v_dot2_f32_bf16 v10, v217, v4, v10
v_dot2_f32_bf16 v11, v217, v5, v11
v_dot2_f32_bf16 v12, v218, v4, v12
v_dot2_f32_bf16 v13, v218, v5, v13
v_dot2_f32_bf16 v14, v219, v4, v14
v_dot2_f32_bf16 v15, v219, v5, v15
s_waitcnt vmcnt(14)
v_dot2_f32_bf16 v8, v220, v4, v8
v_dot2_f32_bf16 v9, v220, v5, v9
v_dot2_f32_bf16 v10, v221, v4, v10
v_dot2_f32_bf16 v11, v221, v5, v11
v_dot2_f32_bf16 v12, v222, v4, v12
v_dot2_f32_bf16 v13, v222, v5, v13
v_dot2_f32_bf16 v14, v223, v4, v14
v_dot2_f32_bf16 v15, v223, v5, v15
v_permlane32_swap_b32 v8, v12
v_permlane32_swap_b32 v9, v13
v_permlane32_swap_b32 v10, v14
v_permlane32_swap_b32 v11, v15
v_add_f32 v8, v8, v12
v_add_f32 v9, v9, v13
v_add_f32 v10, v10, v14
v_add_f32 v11, v11, v15
s_nop 0
v_permlane16_swap_b32 v8, v10
v_permlane16_swap_b32 v9, v11
v_add_f32 v8, v8, v10
v_add_f32 v9, v9, v11
s_nop 0
v_add_f32_dpp v8, v8, v8 row_ror:8 row_mask:0xf bank_mask:0xf
v_add_f32_dpp v9, v9, v9 row_ror:8 row_mask:0xf bank_mask:0xf
ds_write_b64 v6, v[8:9] offset:1024
s_waitcnt lgkmcnt(0)
s_barrier
ds_read_b32 v12, v7 offset:1024
ds_read_b32 v13, v7 offset:1280
ds_read_b32 v14, v7 offset:1536
ds_read_b32 v15, v7 offset:1792
s_waitcnt lgkmcnt(2)
v_add_f32 v12, v12, v13
s_waitcnt lgkmcnt(0)
v_add_f32 v14, v14, v15
v_add_f32 v22, v12, v14
s_lshl_b32 s62, s48, 9
s_add_u32 s62, s62, 98304
buffer_store_dwordx2 v[22:23], v20, s[16:19], s62 offen sc1
s_add_u32 s63, s63, 294912
buffer_load_dwordx4 v[136:139], v2, s[8:11], s63 offen
s_add_u32 s63, s63, 294912
buffer_load_dwordx4 v[140:143], v2, s[8:11], s63 offen
s_add_u32 s63, s63, 294912
buffer_load_dwordx4 v[144:147], v2, s[8:11], s63 offen
s_add_u32 s63, s63, 294912
buffer_load_dwordx4 v[148:151], v2, s[8:11], s63 offen
s_mov_b32 s48, s47
s_add_u32 s47, s47, 16
v_mov_b32 v8, 0
v_mov_b32 v9, 0
v_mov_b32 v10, 0
v_mov_b32 v11, 0
v_mov_b32 v12, 0
v_mov_b32 v13, 0
v_mov_b32 v14, 0
v_mov_b32 v15, 0
s_waitcnt vmcnt(18)
v_dot2_f32_bf16 v8, v80, v4, v8
v_dot2_f32_bf16 v9, v80, v5, v9
v_dot2_f32_bf16 v10, v81, v4, v10
v_dot2_f32_bf16 v11, v81, v5, v11
v_dot2_f32_bf16 v12, v82, v4, v12
v_dot2_f32_bf16 v13, v82, v5, v13
v_dot2_f32_bf16 v14, v83, v4, v14
v_dot2_f32_bf16 v15, v83, v5, v15
s_lshl_b32 s63, s47, 7
s_cmp_lt_u32 s47, 72
s_cselect_b32 s63, s63, 0
buffer_load_dwordx4 v[152:155], v2, s[8:11], s63 offen
s_waitcnt vmcnt(18)
v_dot2_f32_bf16 v8, v84, v4, v8
v_dot2_f32_bf16 v9, v84, v5, v9
v_dot2_f32_bf16 v10, v85, v4, v10
v_dot2_f32_bf16 v11, v85, v5, v11
v_dot2_f32_bf16 v12, v86, v4, v12
v_dot2_f32_bf16 v13, v86, v5, v13
v_dot2_f32_bf16 v14, v87, v4, v14
v_dot2_f32_bf16 v15, v87, v5, v15
s_add_u32 s63, s63, 294912
buffer_load_dwordx4 v[156:159], v2, s[8:11], s63 offen
s_waitcnt vmcnt(18)
v_dot2_f32_bf16 v8, v88, v4, v8
v_dot2_f32_bf16 v9, v88, v5, v9
v_dot2_f32_bf16 v10, v89, v4, v10
v_dot2_f32_bf16 v11, v89, v5, v11
v_dot2_f32_bf16 v12, v90, v4, v12
v_dot2_f32_bf16 v13, v90, v5, v13
v_dot2_f32_bf16 v14, v91, v4, v14
v_dot2_f32_bf16 v15, v91, v5, v15
s_add_u32 s63, s63, 294912
buffer_load_dwordx4 v[160:163], v2, s[8:11], s63 offen
s_waitcnt vmcnt(18)
v_dot2_f32_bf16 v8, v92, v4, v8
v_dot2_f32_bf16 v9, v92, v5, v9
v_dot2_f32_bf16 v10, v93, v4, v10
v_dot2_f32_bf16 v11, v93, v5, v11
v_dot2_f32_bf16 v12, v94, v4, v12
v_dot2_f32_bf16 v13, v94, v5, v13
v_dot2_f32_bf16 v14, v95, v4, v14
v_dot2_f32_bf16 v15, v95, v5, v15
s_add_u32 s63, s63, 294912
buffer_load_dwordx4 v[164:167], v2, s[8:11], s63 offen
s_waitcnt vmcnt(18)
v_dot2_f32_bf16 v8, v96, v4, v8
v_dot2_f32_bf16 v9, v96, v5, v9
v_dot2_f32_bf16 v10, v97, v4, v10
v_dot2_f32_bf16 v11, v97, v5, v11
v_dot2_f32_bf16 v12, v98, v4, v12
v_dot2_f32_bf16 v13, v98, v5, v13
v_dot2_f32_bf16 v14, v99, v4, v14
v_dot2_f32_bf16 v15, v99, v5, v15
s_add_u32 s63, s63, 294912
buffer_load_dwordx4 v[168:171], v2, s[8:11], s63 offen
s_waitcnt vmcnt(18)
v_dot2_f32_bf16 v8, v100, v4, v8
v_dot2_f32_bf16 v9, v100, v5, v9
v_dot2_f32_bf16 v10, v101, v4, v10
v_dot2_f32_bf16 v11, v101, v5, v11
v_dot2_f32_bf16 v12, v102, v4, v12
v_dot2_f32_bf16 v13, v102, v5, v13
v_dot2_f32_bf16 v14, v103, v4, v14
v_dot2_f32_bf16 v15, v103, v5, v15
s_add_u32 s63, s63, 294912
buffer_load_dwordx4 v[172:175], v2, s[8:11], s63 offen
s_waitcnt vmcnt(18)
v_dot2_f32_bf16 v8, v104, v4, v8
v_dot2_f32_bf16 v9, v104, v5, v9
v_dot2_f32_bf16 v10, v105, v4, v10
v_dot2_f32_bf16 v11, v105, v5, v11
v_dot2_f32_bf16 v12, v106, v4, v12
v_dot2_f32_bf16 v13, v106, v5, v13
v_dot2_f32_bf16 v14, v107, v4, v14
v_dot2_f32_bf16 v15, v107, v5, v15
s_add_u32 s63, s63, 294912
buffer_load_dwordx4 v[176:179], v2, s[8:11], s63 offen
s_waitcnt vmcnt(18)
v_dot2_f32_bf16 v8, v108, v4, v8
v_dot2_f32_bf16 v9, v108, v5, v9
v_dot2_f32_bf16 v10, v109, v4, v10
v_dot2_f32_bf16 v11, v109, v5, v11
v_dot2_f32_bf16 v12, v110, v4, v12
v_dot2_f32_bf16 v13, v110, v5, v13
v_dot2_f32_bf16 v14, v111, v4, v14
v_dot2_f32_bf16 v15, v111, v5, v15
s_add_u32 s63, s63, 294912
buffer_load_dwordx4 v[180:183], v2, s[8:11], s63 offen
s_waitcnt vmcnt(18)
v_dot2_f32_bf16 v8, v112, v4, v8
v_dot2_f32_bf16 v9, v112, v5, v9
v_dot2_f32_bf16 v10, v113, v4, v10
v_dot2_f32_bf16 v11, v113, v5, v11
v_dot2_f32_bf16 v12, v114, v4, v12
v_dot2_f32_bf16 v13, v114, v5, v13
v_dot2_f32_bf16 v14, v115, v4, v14
v_dot2_f32_bf16 v15, v115, v5, v15
s_add_u32 s63, s63, 294912
buffer_load_dwordx4 v[184:187], v2, s[8:11], s63 offen
s_waitcnt vmcnt(18)
v_dot2_f32_bf16 v8, v116, v4, v8
v_dot2_f32_bf16 v9, v116, v5, v9
v_dot2_f32_bf16 v10, v117, v4, v10
v_dot2_f32_bf16 v11, v117, v5, v11
v_dot2_f32_bf16 v12, v118, v4, v12
v_dot2_f32_bf16 v13, v118, v5, v13
v_dot2_f32_bf16 v14, v119, v4, v14
v_dot2_f32_bf16 v15, v119, v5, v15
s_add_u32 s63, s63, 294912
buffer_load_dwordx4 v[188:191], v2, s[8:11], s63 offen
s_waitcnt vmcnt(18)
v_dot2_f32_bf16 v8, v120, v4, v8
v_dot2_f32_bf16 v9, v120, v5, v9
v_dot2_f32_bf16 v10, v121, v4, v10
v_dot2_f32_bf16 v11, v121, v5, v11
v_dot2_f32_bf16 v12, v122, v4, v12
v_dot2_f32_bf16 v13, v122, v5, v13
v_dot2_f32_bf16 v14, v123, v4, v14
v_dot2_f32_bf16 v15, v123, v5, v15
s_add_u32 s63, s63, 294912
buffer_load_dwordx4 v[192:195], v2, s[8:11], s63 offen
s_waitcnt vmcnt(18)
v_dot2_f32_bf16 v8, v124, v4, v8
v_dot2_f32_bf16 v9, v124, v5, v9
v_dot2_f32_bf16 v10, v125, v4, v10
v_dot2_f32_bf16 v11, v125, v5, v11
v_dot2_f32_bf16 v12, v126, v4, v12
v_dot2_f32_bf16 v13, v126, v5, v13
v_dot2_f32_bf16 v14, v127, v4, v14
v_dot2_f32_bf16 v15, v127, v5, v15
s_add_u32 s63, s63, 294912
buffer_load_dwordx4 v[196:199], v2, s[8:11], s63 offen
s_waitcnt vmcnt(18)
v_dot2_f32_bf16 v8, v128, v4, v8
v_dot2_f32_bf16 v9, v128, v5, v9
v_dot2_f32_bf16 v10, v129, v4, v10
v_dot2_f32_bf16 v11, v129, v5, v11
v_dot2_f32_bf16 v12, v130, v4, v12
v_dot2_f32_bf16 v13, v130, v5, v13
v_dot2_f32_bf16 v14, v131, v4, v14
v_dot2_f32_bf16 v15, v131, v5, v15
s_add_u32 s63, s63, 294912
buffer_load_dwordx4 v[200:203], v2, s[8:11], s63 offen
s_waitcnt vmcnt(18)
v_dot2_f32_bf16 v8, v132, v4, v8
v_dot2_f32_bf16 v9, v132, v5, v9
v_dot2_f32_bf16 v10, v133, v4, v10
v_dot2_f32_bf16 v11, v133, v5, v11
v_dot2_f32_bf16 v12, v134, v4, v12
v_dot2_f32_bf16 v13, v134, v5, v13
v_dot2_f32_bf16 v14, v135, v4, v14
v_dot2_f32_bf16 v15, v135, v5, v15
s_add_u32 s63, s63, 294912
buffer_load_dwordx4 v[204:207], v2, s[8:11], s63 offen
s_waitcnt vmcnt(17)
v_dot2_f32_bf16 v8, v136, v4, v8
v_dot2_f32_bf16 v9, v136, v5, v9
v_dot2_f32_bf16 v10, v137, v4, v10
v_dot2_f32_bf16 v11, v137, v5, v11
v_dot2_f32_bf16 v12, v138, v4, v12
v_dot2_f32_bf16 v13, v138, v5, v13
v_dot2_f32_bf16 v14, v139, v4, v14
v_dot2_f32_bf16 v15, v139, v5, v15
s_waitcnt vmcnt(16)
v_dot2_f32_bf16 v8, v140, v4, v8
v_dot2_f32_bf16 v9, v140, v5, v9
v_dot2_f32_bf16 v10, v141, v4, v10
v_dot2_f32_bf16 v11, v141, v5, v11
v_dot2_f32_bf16 v12, v142, v4, v12
v_dot2_f32_bf16 v13, v142, v5, v13
v_dot2_f32_bf16 v14, v143, v4, v14
v_dot2_f32_bf16 v15, v143, v5, v15
s_waitcnt vmcnt(15)
v_dot2_f32_bf16 v8, v144, v4, v8
v_dot2_f32_bf16 v9, v144, v5, v9
v_dot2_f32_bf16 v10, v145, v4, v10
v_dot2_f32_bf16 v11, v145, v5, v11
v_dot2_f32_bf16 v12, v146, v4, v12
v_dot2_f32_bf16 v13, v146, v5, v13
v_dot2_f32_bf16 v14, v147, v4, v14
v_dot2_f32_bf16 v15, v147, v5, v15
s_waitcnt vmcnt(14)
v_dot2_f32_bf16 v8, v148, v4, v8
v_dot2_f32_bf16 v9, v148, v5, v9
v_dot2_f32_bf16 v10, v149, v4, v10
v_dot2_f32_bf16 v11, v149, v5, v11
v_dot2_f32_bf16 v12, v150, v4, v12
v_dot2_f32_bf16 v13, v150, v5, v13
v_dot2_f32_bf16 v14, v151, v4, v14
v_dot2_f32_bf16 v15, v151, v5, v15
v_permlane32_swap_b32 v8, v12
v_permlane32_swap_b32 v9, v13
v_permlane32_swap_b32 v10, v14
v_permlane32_swap_b32 v11, v15
v_add_f32 v8, v8, v12
v_add_f32 v9, v9, v13
v_add_f32 v10, v10, v14
v_add_f32 v11, v11, v15
s_nop 0
v_permlane16_swap_b32 v8, v10
v_permlane16_swap_b32 v9, v11
v_add_f32 v8, v8, v10
v_add_f32 v9, v9, v11
s_nop 0
v_add_f32_dpp v8, v8, v8 row_ror:8 row_mask:0xf bank_mask:0xf
v_add_f32_dpp v9, v9, v9 row_ror:8 row_mask:0xf bank_mask:0xf
ds_write_b64 v6, v[8:9] offset:0
s_waitcnt lgkmcnt(0)
s_barrier
ds_read_b32 v12, v7 offset:0
ds_read_b32 v13, v7 offset:256
ds_read_b32 v14, v7 offset:512
ds_read_b32 v15, v7 offset:768
s_waitcnt lgkmcnt(2)
v_add_f32 v12, v12, v13
s_waitcnt lgkmcnt(0)
v_add_f32 v14, v14, v15
v_add_f32 v22, v12, v14
s_lshl_b32 s62, s48, 9
s_add_u32 s62, s62, 98304
buffer_store_dwordx2 v[22:23], v20, s[16:19], s62 offen sc1
s_add_u32 s63, s63, 294912
buffer_load_dwordx4 v[208:211], v2, s[8:11], s63 offen
s_add_u32 s63, s63, 294912
buffer_load_dwordx4 v[212:215], v2, s[8:11], s63 offen
s_add_u32 s63, s63, 294912
buffer_load_dwordx4 v[216:219], v2, s[8:11], s63 offen
s_add_u32 s63, s63, 294912
buffer_load_dwordx4 v[220:223], v2, s[8:11], s63 offen
s_mov_b32 s48, s47
s_add_u32 s47, s47, 16
v_mov_b32 v8, 0
v_mov_b32 v9, 0
v_mov_b32 v10, 0
v_mov_b32 v11, 0
v_mov_b32 v12, 0
v_mov_b32 v13, 0
v_mov_b32 v14, 0
v_mov_b32 v15, 0
s_waitcnt vmcnt(18)
v_dot2_f32_bf16 v8, v152, v4, v8
v_dot2_f32_bf16 v9, v152, v5, v9
v_dot2_f32_bf16 v10, v153, v4, v10
v_dot2_f32_bf16 v11, v153, v5, v11
v_dot2_f32_bf16 v12, v154, v4, v12
v_dot2_f32_bf16 v13, v154, v5, v13
v_dot2_f32_bf16 v14, v155, v4, v14
v_dot2_f32_bf16 v15, v155, v5, v15
s_lshl_b32 s63, s47, 7
s_cmp_lt_u32 s47, 72
s_cselect_b32 s63, s63, 0
buffer_load_dwordx4 v[80:83], v2, s[8:11], s63 offen
s_waitcnt vmcnt(18)
v_dot2_f32_bf16 v8, v156, v4, v8
v_dot2_f32_bf16 v9, v156, v5, v9
v_dot2_f32_bf16 v10, v157, v4, v10
v_dot2_f32_bf16 v11, v157, v5, v11
v_dot2_f32_bf16 v12, v158, v4, v12
v_dot2_f32_bf16 v13, v158, v5, v13
v_dot2_f32_bf16 v14, v159, v4, v14
v_dot2_f32_bf16 v15, v159, v5, v15
s_add_u32 s63, s63, 294912
buffer_load_dwordx4 v[84:87], v2, s[8:11], s63 offen
s_waitcnt vmcnt(18)
v_dot2_f32_bf16 v8, v160, v4, v8
v_dot2_f32_bf16 v9, v160, v5, v9
v_dot2_f32_bf16 v10, v161, v4, v10
v_dot2_f32_bf16 v11, v161, v5, v11
v_dot2_f32_bf16 v12, v162, v4, v12
v_dot2_f32_bf16 v13, v162, v5, v13
v_dot2_f32_bf16 v14, v163, v4, v14
v_dot2_f32_bf16 v15, v163, v5, v15
s_add_u32 s63, s63, 294912
buffer_load_dwordx4 v[88:91], v2, s[8:11], s63 offen
s_waitcnt vmcnt(18)
v_dot2_f32_bf16 v8, v164, v4, v8
v_dot2_f32_bf16 v9, v164, v5, v9
v_dot2_f32_bf16 v10, v165, v4, v10
v_dot2_f32_bf16 v11, v165, v5, v11
v_dot2_f32_bf16 v12, v166, v4, v12
v_dot2_f32_bf16 v13, v166, v5, v13
v_dot2_f32_bf16 v14, v167, v4, v14
v_dot2_f32_bf16 v15, v167, v5, v15
s_add_u32 s63, s63, 294912
buffer_load_dwordx4 v[92:95], v2, s[8:11], s63 offen
s_waitcnt vmcnt(18)
v_dot2_f32_bf16 v8, v168, v4, v8
v_dot2_f32_bf16 v9, v168, v5, v9
v_dot2_f32_bf16 v10, v169, v4, v10
v_dot2_f32_bf16 v11, v169, v5, v11
v_dot2_f32_bf16 v12, v170, v4, v12
v_dot2_f32_bf16 v13, v170, v5, v13
v_dot2_f32_bf16 v14, v171, v4, v14
v_dot2_f32_bf16 v15, v171, v5, v15
s_add_u32 s63, s63, 294912
buffer_load_dwordx4 v[96:99], v2, s[8:11], s63 offen
s_waitcnt vmcnt(18)
v_dot2_f32_bf16 v8, v172, v4, v8
v_dot2_f32_bf16 v9, v172, v5, v9
v_dot2_f32_bf16 v10, v173, v4, v10
v_dot2_f32_bf16 v11, v173, v5, v11
v_dot2_f32_bf16 v12, v174, v4, v12
v_dot2_f32_bf16 v13, v174, v5, v13
v_dot2_f32_bf16 v14, v175, v4, v14
v_dot2_f32_bf16 v15, v175, v5, v15
s_add_u32 s63, s63, 294912
buffer_load_dwordx4 v[100:103], v2, s[8:11], s63 offen
s_waitcnt vmcnt(18)
v_dot2_f32_bf16 v8, v176, v4, v8
v_dot2_f32_bf16 v9, v176, v5, v9
v_dot2_f32_bf16 v10, v177, v4, v10
v_dot2_f32_bf16 v11, v177, v5, v11
v_dot2_f32_bf16 v12, v178, v4, v12
v_dot2_f32_bf16 v13, v178, v5, v13
v_dot2_f32_bf16 v14, v179, v4, v14
v_dot2_f32_bf16 v15, v179, v5, v15
s_add_u32 s63, s63, 294912
buffer_load_dwordx4 v[104:107], v2, s[8:11], s63 offen
s_waitcnt vmcnt(18)
v_dot2_f32_bf16 v8, v180, v4, v8
v_dot2_f32_bf16 v9, v180, v5, v9
v_dot2_f32_bf16 v10, v181, v4, v10
v_dot2_f32_bf16 v11, v181, v5, v11
v_dot2_f32_bf16 v12, v182, v4, v12
v_dot2_f32_bf16 v13, v182, v5, v13
v_dot2_f32_bf16 v14, v183, v4, v14
v_dot2_f32_bf16 v15, v183, v5, v15
s_add_u32 s63, s63, 294912
buffer_load_dwordx4 v[108:111], v2, s[8:11], s63 offen
s_waitcnt vmcnt(18)
v_dot2_f32_bf16 v8, v184, v4, v8
v_dot2_f32_bf16 v9, v184, v5, v9
v_dot2_f32_bf16 v10, v185, v4, v10
v_dot2_f32_bf16 v11, v185, v5, v11
v_dot2_f32_bf16 v12, v186, v4, v12
v_dot2_f32_bf16 v13, v186, v5, v13
v_dot2_f32_bf16 v14, v187, v4, v14
v_dot2_f32_bf16 v15, v187, v5, v15
s_add_u32 s63, s63, 294912
buffer_load_dwordx4 v[112:115], v2, s[8:11], s63 offen
s_waitcnt vmcnt(18)
v_dot2_f32_bf16 v8, v188, v4, v8
v_dot2_f32_bf16 v9, v188, v5, v9
v_dot2_f32_bf16 v10, v189, v4, v10
v_dot2_f32_bf16 v11, v189, v5, v11
v_dot2_f32_bf16 v12, v190, v4, v12
v_dot2_f32_bf16 v13, v190, v5, v13
v_dot2_f32_bf16 v14, v191, v4, v14
v_dot2_f32_bf16 v15, v191, v5, v15
s_add_u32 s63, s63, 294912
buffer_load_dwordx4 v[116:119], v2, s[8:11], s63 offen
s_waitcnt vmcnt(18)
v_dot2_f32_bf16 v8, v192, v4, v8
v_dot2_f32_bf16 v9, v192, v5, v9
v_dot2_f32_bf16 v10, v193, v4, v10
v_dot2_f32_bf16 v11, v193, v5, v11
v_dot2_f32_bf16 v12, v194, v4, v12
v_dot2_f32_bf16 v13, v194, v5, v13
v_dot2_f32_bf16 v14, v195, v4, v14
v_dot2_f32_bf16 v15, v195, v5, v15
s_add_u32 s63, s63, 294912
buffer_load_dwordx4 v[120:123], v2, s[8:11], s63 offen
s_waitcnt vmcnt(18)
v_dot2_f32_bf16 v8, v196, v4, v8
v_dot2_f32_bf16 v9, v196, v5, v9
v_dot2_f32_bf16 v10, v197, v4, v10
v_dot2_f32_bf16 v11, v197, v5, v11
v_dot2_f32_bf16 v12, v198, v4, v12
v_dot2_f32_bf16 v13, v198, v5, v13
v_dot2_f32_bf16 v14, v199, v4, v14
v_dot2_f32_bf16 v15, v199, v5, v15
s_add_u32 s63, s63, 294912
buffer_load_dwordx4 v[124:127], v2, s[8:11], s63 offen
s_waitcnt vmcnt(18)
v_dot2_f32_bf16 v8, v200, v4, v8
v_dot2_f32_bf16 v9, v200, v5, v9
v_dot2_f32_bf16 v10, v201, v4, v10
v_dot2_f32_bf16 v11, v201, v5, v11
v_dot2_f32_bf16 v12, v202, v4, v12
v_dot2_f32_bf16 v13, v202, v5, v13
v_dot2_f32_bf16 v14, v203, v4, v14
v_dot2_f32_bf16 v15, v203, v5, v15
s_add_u32 s63, s63, 294912
buffer_load_dwordx4 v[128:131], v2, s[8:11], s63 offen
s_waitcnt vmcnt(18)
v_dot2_f32_bf16 v8, v204, v4, v8
v_dot2_f32_bf16 v9, v204, v5, v9
v_dot2_f32_bf16 v10, v205, v4, v10
v_dot2_f32_bf16 v11, v205, v5, v11
v_dot2_f32_bf16 v12, v206, v4, v12
v_dot2_f32_bf16 v13, v206, v5, v13
v_dot2_f32_bf16 v14, v207, v4, v14
v_dot2_f32_bf16 v15, v207, v5, v15
s_add_u32 s63, s63, 294912
buffer_load_dwordx4 v[132:135], v2, s[8:11], s63 offen
s_waitcnt vmcnt(17)
v_dot2_f32_bf16 v8, v208, v4, v8
v_dot2_f32_bf16 v9, v208, v5, v9
v_dot2_f32_bf16 v10, v209, v4, v10
v_dot2_f32_bf16 v11, v209, v5, v11
v_dot2_f32_bf16 v12, v210, v4, v12
v_dot2_f32_bf16 v13, v210, v5, v13
v_dot2_f32_bf16 v14, v211, v4, v14
v_dot2_f32_bf16 v15, v211, v5, v15
s_waitcnt vmcnt(16)
v_dot2_f32_bf16 v8, v212, v4, v8
v_dot2_f32_bf16 v9, v212, v5, v9
v_dot2_f32_bf16 v10, v213, v4, v10
v_dot2_f32_bf16 v11, v213, v5, v11
v_dot2_f32_bf16 v12, v214, v4, v12
v_dot2_f32_bf16 v13, v214, v5, v13
v_dot2_f32_bf16 v14, v215, v4, v14
v_dot2_f32_bf16 v15, v215, v5, v15
s_waitcnt vmcnt(15)
v_dot2_f32_bf16 v8, v216, v4, v8
v_dot2_f32_bf16 v9, v216, v5, v9
v_dot2_f32_bf16 v10, v217, v4, v10
v_dot2_f32_bf16 v11, v217, v5, v11
v_dot2_f32_bf16 v12, v218, v4, v12
v_dot2_f32_bf16 v13, v218, v5, v13
v_dot2_f32_bf16 v14, v219, v4, v14
v_dot2_f32_bf16 v15, v219, v5, v15
s_waitcnt vmcnt(14)
v_dot2_f32_bf16 v8, v220, v4, v8
v_dot2_f32_bf16 v9, v220, v5, v9
v_dot2_f32_bf16 v10, v221, v4, v10
v_dot2_f32_bf16 v11, v221, v5, v11
v_dot2_f32_bf16 v12, v222, v4, v12
v_dot2_f32_bf16 v13, v222, v5, v13
v_dot2_f32_bf16 v14, v223, v4, v14
v_dot2_f32_bf16 v15, v223, v5, v15
v_permlane32_swap_b32 v8, v12
v_permlane32_swap_b32 v9, v13
v_permlane32_swap_b32 v10, v14
v_permlane32_swap_b32 v11, v15
v_add_f32 v8, v8, v12
v_add_f32 v9, v9, v13
v_add_f32 v10, v10, v14
v_add_f32 v11, v11, v15
s_nop 0
v_permlane16_swap_b32 v8, v10
v_permlane16_swap_b32 v9, v11
v_add_f32 v8, v8, v10
v_add_f32 v9, v9, v11
s_nop 0
v_add_f32_dpp v8, v8, v8 row_ror:8 row_mask:0xf bank_mask:0xf
v_add_f32_dpp v9, v9, v9 row_ror:8 row_mask:0xf bank_mask:0xf
ds_write_b64 v6, v[8:9] offset:1024
s_waitcnt lgkmcnt(0)
s_barrier
ds_read_b32 v12, v7 offset:1024
ds_read_b32 v13, v7 offset:1280
ds_read_b32 v14, v7 offset:1536
ds_read_b32 v15, v7 offset:1792
s_waitcnt lgkmcnt(2)
v_add_f32 v12, v12, v13
s_waitcnt lgkmcnt(0)
v_add_f32 v14, v14, v15
v_add_f32 v22, v12, v14
s_lshl_b32 s62, s48, 9
s_add_u32 s62, s62, 98304
buffer_store_dwordx2 v[22:23], v20, s[16:19], s62 offen sc1
s_add_u32 s63, s63, 294912
buffer_load_dwordx4 v[136:139], v2, s[8:11], s63 offen
s_add_u32 s63, s63, 294912
buffer_load_dwordx4 v[140:143], v2, s[8:11], s63 offen
s_add_u32 s63, s63, 294912
buffer_load_dwordx4 v[144:147], v2, s[8:11], s63 offen
s_add_u32 s63, s63, 294912
buffer_load_dwordx4 v[148:151], v2, s[8:11], s63 offen
s_mov_b32 s48, s47
s_add_u32 s47, s47, 16
v_mov_b32 v8, 0
v_mov_b32 v9, 0
v_mov_b32 v10, 0
v_mov_b32 v11, 0
v_mov_b32 v12, 0
v_mov_b32 v13, 0
v_mov_b32 v14, 0
v_mov_b32 v15, 0
s_waitcnt vmcnt(18)
v_dot2_f32_bf16 v8, v80, v4, v8
v_dot2_f32_bf16 v9, v80, v5, v9
v_dot2_f32_bf16 v10, v81, v4, v10
v_dot2_f32_bf16 v11, v81, v5, v11
v_dot2_f32_bf16 v12, v82, v4, v12
v_dot2_f32_bf16 v13, v82, v5, v13
v_dot2_f32_bf16 v14, v83, v4, v14
v_dot2_f32_bf16 v15, v83, v5, v15
s_waitcnt vmcnt(17)
v_dot2_f32_bf16 v8, v84, v4, v8
v_dot2_f32_bf16 v9, v84, v5, v9
v_dot2_f32_bf16 v10, v85, v4, v10
v_dot2_f32_bf16 v11, v85, v5, v11
v_dot2_f32_bf16 v12, v86, v4, v12
v_dot2_f32_bf16 v13, v86, v5, v13
v_dot2_f32_bf16 v14, v87, v4, v14
v_dot2_f32_bf16 v15, v87, v5, v15
s_waitcnt vmcnt(16)
v_dot2_f32_bf16 v8, v88, v4, v8
v_dot2_f32_bf16 v9, v88, v5, v9
v_dot2_f32_bf16 v10, v89, v4, v10
v_dot2_f32_bf16 v11, v89, v5, v11
v_dot2_f32_bf16 v12, v90, v4, v12
v_dot2_f32_bf16 v13, v90, v5, v13
v_dot2_f32_bf16 v14, v91, v4, v14
v_dot2_f32_bf16 v15, v91, v5, v15
s_waitcnt vmcnt(15)
v_dot2_f32_bf16 v8, v92, v4, v8
v_dot2_f32_bf16 v9, v92, v5, v9
v_dot2_f32_bf16 v10, v93, v4, v10
v_dot2_f32_bf16 v11, v93, v5, v11
v_dot2_f32_bf16 v12, v94, v4, v12
v_dot2_f32_bf16 v13, v94, v5, v13
v_dot2_f32_bf16 v14, v95, v4, v14
v_dot2_f32_bf16 v15, v95, v5, v15
s_waitcnt vmcnt(14)
v_dot2_f32_bf16 v8, v96, v4, v8
v_dot2_f32_bf16 v9, v96, v5, v9
v_dot2_f32_bf16 v10, v97, v4, v10
v_dot2_f32_bf16 v11, v97, v5, v11
v_dot2_f32_bf16 v12, v98, v4, v12
v_dot2_f32_bf16 v13, v98, v5, v13
v_dot2_f32_bf16 v14, v99, v4, v14
v_dot2_f32_bf16 v15, v99, v5, v15
s_waitcnt vmcnt(13)
v_dot2_f32_bf16 v8, v100, v4, v8
v_dot2_f32_bf16 v9, v100, v5, v9
v_dot2_f32_bf16 v10, v101, v4, v10
v_dot2_f32_bf16 v11, v101, v5, v11
v_dot2_f32_bf16 v12, v102, v4, v12
v_dot2_f32_bf16 v13, v102, v5, v13
v_dot2_f32_bf16 v14, v103, v4, v14
v_dot2_f32_bf16 v15, v103, v5, v15
s_waitcnt vmcnt(12)
v_dot2_f32_bf16 v8, v104, v4, v8
v_dot2_f32_bf16 v9, v104, v5, v9
v_dot2_f32_bf16 v10, v105, v4, v10
v_dot2_f32_bf16 v11, v105, v5, v11
v_dot2_f32_bf16 v12, v106, v4, v12
v_dot2_f32_bf16 v13, v106, v5, v13
v_dot2_f32_bf16 v14, v107, v4, v14
v_dot2_f32_bf16 v15, v107, v5, v15
s_waitcnt vmcnt(11)
v_dot2_f32_bf16 v8, v108, v4, v8
v_dot2_f32_bf16 v9, v108, v5, v9
v_dot2_f32_bf16 v10, v109, v4, v10
v_dot2_f32_bf16 v11, v109, v5, v11
v_dot2_f32_bf16 v12, v110, v4, v12
v_dot2_f32_bf16 v13, v110, v5, v13
v_dot2_f32_bf16 v14, v111, v4, v14
v_dot2_f32_bf16 v15, v111, v5, v15
s_waitcnt vmcnt(10)
v_dot2_f32_bf16 v8, v112, v4, v8
v_dot2_f32_bf16 v9, v112, v5, v9
v_dot2_f32_bf16 v10, v113, v4, v10
v_dot2_f32_bf16 v11, v113, v5, v11
v_dot2_f32_bf16 v12, v114, v4, v12
v_dot2_f32_bf16 v13, v114, v5, v13
v_dot2_f32_bf16 v14, v115, v4, v14
v_dot2_f32_bf16 v15, v115, v5, v15
s_waitcnt vmcnt(9)
v_dot2_f32_bf16 v8, v116, v4, v8
v_dot2_f32_bf16 v9, v116, v5, v9
v_dot2_f32_bf16 v10, v117, v4, v10
v_dot2_f32_bf16 v11, v117, v5, v11
v_dot2_f32_bf16 v12, v118, v4, v12
v_dot2_f32_bf16 v13, v118, v5, v13
v_dot2_f32_bf16 v14, v119, v4, v14
v_dot2_f32_bf16 v15, v119, v5, v15
s_waitcnt vmcnt(8)
v_dot2_f32_bf16 v8, v120, v4, v8
v_dot2_f32_bf16 v9, v120, v5, v9
v_dot2_f32_bf16 v10, v121, v4, v10
v_dot2_f32_bf16 v11, v121, v5, v11
v_dot2_f32_bf16 v12, v122, v4, v12
v_dot2_f32_bf16 v13, v122, v5, v13
v_dot2_f32_bf16 v14, v123, v4, v14
v_dot2_f32_bf16 v15, v123, v5, v15
s_waitcnt vmcnt(7)
v_dot2_f32_bf16 v8, v124, v4, v8
v_dot2_f32_bf16 v9, v124, v5, v9
v_dot2_f32_bf16 v10, v125, v4, v10
v_dot2_f32_bf16 v11, v125, v5, v11
v_dot2_f32_bf16 v12, v126, v4, v12
v_dot2_f32_bf16 v13, v126, v5, v13
v_dot2_f32_bf16 v14, v127, v4, v14
v_dot2_f32_bf16 v15, v127, v5, v15
s_waitcnt vmcnt(6)
v_dot2_f32_bf16 v8, v128, v4, v8
v_dot2_f32_bf16 v9, v128, v5, v9
v_dot2_f32_bf16 v10, v129, v4, v10
v_dot2_f32_bf16 v11, v129, v5, v11
v_dot2_f32_bf16 v12, v130, v4, v12
v_dot2_f32_bf16 v13, v130, v5, v13
v_dot2_f32_bf16 v14, v131, v4, v14
v_dot2_f32_bf16 v15, v131, v5, v15
s_waitcnt vmcnt(5)
v_dot2_f32_bf16 v8, v132, v4, v8
v_dot2_f32_bf16 v9, v132, v5, v9
v_dot2_f32_bf16 v10, v133, v4, v10
v_dot2_f32_bf16 v11, v133, v5, v11
v_dot2_f32_bf16 v12, v134, v4, v12
v_dot2_f32_bf16 v13, v134, v5, v13
v_dot2_f32_bf16 v14, v135, v4, v14
v_dot2_f32_bf16 v15, v135, v5, v15
s_waitcnt vmcnt(3)
v_dot2_f32_bf16 v8, v136, v4, v8
v_dot2_f32_bf16 v9, v136, v5, v9
v_dot2_f32_bf16 v10, v137, v4, v10
v_dot2_f32_bf16 v11, v137, v5, v11
v_dot2_f32_bf16 v12, v138, v4, v12
v_dot2_f32_bf16 v13, v138, v5, v13
v_dot2_f32_bf16 v14, v139, v4, v14
v_dot2_f32_bf16 v15, v139, v5, v15
s_waitcnt vmcnt(2)
v_dot2_f32_bf16 v8, v140, v4, v8
v_dot2_f32_bf16 v9, v140, v5, v9
v_dot2_f32_bf16 v10, v141, v4, v10
v_dot2_f32_bf16 v11, v141, v5, v11
v_dot2_f32_bf16 v12, v142, v4, v12
v_dot2_f32_bf16 v13, v142, v5, v13
v_dot2_f32_bf16 v14, v143, v4, v14
v_dot2_f32_bf16 v15, v143, v5, v15
s_waitcnt vmcnt(1)
v_dot2_f32_bf16 v8, v144, v4, v8
v_dot2_f32_bf16 v9, v144, v5, v9
v_dot2_f32_bf16 v10, v145, v4, v10
v_dot2_f32_bf16 v11, v145, v5, v11
v_dot2_f32_bf16 v12, v146, v4, v12
v_dot2_f32_bf16 v13, v146, v5, v13
v_dot2_f32_bf16 v14, v147, v4, v14
v_dot2_f32_bf16 v15, v147, v5, v15
s_waitcnt vmcnt(0)
v_dot2_f32_bf16 v8, v148, v4, v8
v_dot2_f32_bf16 v9, v148, v5, v9
v_dot2_f32_bf16 v10, v149, v4, v10
v_dot2_f32_bf16 v11, v149, v5, v11
v_dot2_f32_bf16 v12, v150, v4, v12
v_dot2_f32_bf16 v13, v150, v5, v13
v_dot2_f32_bf16 v14, v151, v4, v14
v_dot2_f32_bf16 v15, v151, v5, v15
v_permlane32_swap_b32 v8, v12
v_permlane32_swap_b32 v9, v13
v_permlane32_swap_b32 v10, v14
v_permlane32_swap_b32 v11, v15
v_add_f32 v8, v8, v12
v_add_f32 v9, v9, v13
v_add_f32 v10, v10, v14
v_add_f32 v11, v11, v15
s_nop 0
v_permlane16_swap_b32 v8, v10
v_permlane16_swap_b32 v9, v11
v_add_f32 v8, v8, v10
v_add_f32 v9, v9, v11
s_nop 0
v_add_f32_dpp v8, v8, v8 row_ror:8 row_mask:0xf bank_mask:0xf
v_add_f32_dpp v9, v9, v9 row_ror:8 row_mask:0xf bank_mask:0xf
ds_write_b64 v6, v[8:9] offset:0
s_waitcnt lgkmcnt(0)
s_barrier
ds_read_b32 v12, v7 offset:0
ds_read_b32 v13, v7 offset:256
ds_read_b32 v14, v7 offset:512
ds_read_b32 v15, v7 offset:768
s_waitcnt lgkmcnt(2)
v_add_f32 v12, v12, v13
s_waitcnt lgkmcnt(0)
v_add_f32 v14, v14, v15
v_add_f32 v22, v12, v14
s_lshl_b32 s62, s48, 9
s_add_u32 s62, s62, 98304
s_cmp_lt_u32 s48, 72
s_cselect_b32 s62, s62, 98304
s_cselect_b32 s61, 0, 0x80000000
v_or_b32 v20, s61, v20
buffer_store_dwordx2 v[22:23], v20, s[16:19], s62 offen sc1
v_mov_b32 v34, v26
s_mov_b32 s36, s40
s_mov_b32 s37, s41
s_mov_b32 s38, 663552
s_mov_b32 s39, 0x20000
s_mov_b32 s24, s42
s_mov_b32 s25, s43
s_mov_b32 s26, 663552
s_mov_b32 s27, 0x20000
v_add_u32 v25, 3080192, v24
s_mov_b32 s62, 17
L_ps:
buffer_load_dwordx4 v[28:31], v25, s[12:15], 0 offen
v_add_u32 v25, 65536, v25
buffer_load_dwordx4 v[28:31], v25, s[12:15], 0 offen
v_add_u32 v25, 65536, v25
s_sub_u32 s62, s62, 1
s_cmp_lg_u32 s62, 0
s_cbranch_scc1 L_ps
s_waitcnt vmcnt(0)
v_mov_b32 v26, v34
s_cmp_eq_u32 s46, 0
s_cbranch_scc0 L_pend
s_cmp_eq_u32 s44, 0
s_cbranch_scc0 L_pend
s_mov_b32 s62, 65536
buffer_load_dword v80, v1, s[16:19], s62 offen offset:12 sc1
buffer_load_dword v81, v1, s[16:19], s62 offen offset:1036 sc1
buffer_load_dword v82, v1, s[16:19], s62 offen offset:2060 sc1
buffer_load_dword v83, v1, s[16:19], s62 offen offset:3084 sc1
s_add_u32 s62, s62, 4096
buffer_load_dword v84, v1, s[16:19], s62 offen offset:12 sc1
buffer_load_dword v85, v1, s[16:19], s62 offen offset:1036 sc1
buffer_load_dword v86, v1, s[16:19], s62 offen offset:2060 sc1
buffer_load_dword v87, v1, s[16:19], s62 offen offset:3084 sc1
s_add_u32 s62, s62, 4096
buffer_load_dword v88, v1, s[16:19], s62 offen offset:12 sc1
buffer_load_dword v89, v1, s[16:19], s62 offen offset:1036 sc1
buffer_load_dword v90, v1, s[16:19], s62 offen offset:2060 sc1
buffer_load_dword v91, v1, s[16:19], s62 offen offset:3084 sc1
s_add_u32 s62, s62, 4096
buffer_load_dword v92, v1, s[16:19], s62 offen offset:12 sc1
buffer_load_dword v93, v1, s[16:19], s62 offen offset:1036 sc1
buffer_load_dword v94, v1, s[16:19], s62 offen offset:2060 sc1
buffer_load_dword v95, v1, s[16:19], s62 offen offset:3084 sc1
s_add_u32 s62, s62, 4096
buffer_load_dword v96, v1, s[16:19], s62 offen offset:12 sc1
buffer_load_dword v97, v1, s[16:19], s62 offen offset:1036 sc1
buffer_load_dword v98, v1, s[16:19], s62 offen offset:2060 sc1
buffer_load_dword v99, v1, s[16:19], s62 offen offset:3084 sc1
s_add_u32 s62, s62, 4096
buffer_load_dword v100, v1, s[16:19], s62 offen offset:12 sc1
buffer_load_dword v101, v1, s[16:19], s62 offen offset:1036 sc1
buffer_load_dword v102, v1, s[16:19], s62 offen offset:2060 sc1
buffer_load_dword v103, v1, s[16:19], s62 offen offset:3084 sc1
s_add_u32 s62, s62, 4096
buffer_load_dword v104, v1, s[16:19], s62 offen offset:12 sc1
buffer_load_dword v105, v1, s[16:19], s62 offen offset:1036 sc1
buffer_load_dword v106, v1, s[16:19], s62 offen offset:2060 sc1
buffer_load_dword v107, v1, s[16:19], s62 offen offset:3084 sc1
s_add_u32 s62, s62, 4096
buffer_load_dword v108, v1, s[16:19], s62 offen offset:12 sc1
buffer_load_dword v109, v1, s[16:19], s62 offen offset:1036 sc1
buffer_load_dword v110, v1, s[16:19], s62 offen offset:2060 sc1
buffer_load_dword v111, v1, s[16:19], s62 offen offset:3084 sc1
s_add_u32 s62, s62, 4096
s_mov_b64 s[64:65], 0
s_waitcnt vmcnt(31)
v_cmp_ne_u32 vcc, s45, v80
s_nop 0
s_or_b64 s[64:65], s[64:65], vcc
s_waitcnt vmcnt(30)
v_cmp_ne_u32 vcc, s45, v81
s_nop 0
s_or_b64 s[64:65], s[64:65], vcc
s_waitcnt vmcnt(29)
v_cmp_ne_u32 vcc, s45, v82
s_nop 0
s_or_b64 s[64:65], s[64:65], vcc
s_waitcnt vmcnt(28)
v_cmp_ne_u32 vcc, s45, v83
s_nop 0
s_or_b64 s[64:65], s[64:65], vcc
s_waitcnt vmcnt(27)
v_cmp_ne_u32 vcc, s45, v84
s_nop 0
s_or_b64 s[64:65], s[64:65], vcc
s_waitcnt vmcnt(26)
v_cmp_ne_u32 vcc, s45, v85
s_nop 0
s_or_b64 s[64:65], s[64:65], vcc
s_waitcnt vmcnt(25)
v_cmp_ne_u32 vcc, s45, v86
s_nop 0
s_or_b64 s[64:65], s[64:65], vcc
s_waitcnt vmcnt(24)
v_cmp_ne_u32 vcc, s45, v87
s_nop 0
s_or_b64 s[64:65], s[64:65], vcc
s_waitcnt vmcnt(23)
v_cmp_ne_u32 vcc, s45, v88
s_nop 0
s_or_b64 s[64:65], s[64:65], vcc
s_waitcnt vmcnt(22)
v_cmp_ne_u32 vcc, s45, v89
s_nop 0
s_or_b64 s[64:65], s[64:65], vcc
s_waitcnt vmcnt(21)
v_cmp_ne_u32 vcc, s45, v90
s_nop 0
s_or_b64 s[64:65], s[64:65], vcc
s_waitcnt vmcnt(20)
v_cmp_ne_u32 vcc, s45, v91
s_nop 0
s_or_b64 s[64:65], s[64:65], vcc
s_waitcnt vmcnt(19)
v_cmp_ne_u32 vcc, s45, v92
s_nop 0
s_or_b64 s[64:65], s[64:65], vcc
s_waitcnt vmcnt(18)
v_cmp_ne_u32 vcc, s45, v93
s_nop 0
s_or_b64 s[64:65], s[64:65], vcc
s_waitcnt vmcnt(17)
v_cmp_ne_u32 vcc, s45, v94
s_nop 0
s_or_b64 s[64:65], s[64:65], vcc
s_waitcnt vmcnt(16)
v_cmp_ne_u32 vcc, s45, v95
s_nop 0
s_or_b64 s[64:65], s[64:65], vcc
s_waitcnt vmcnt(15)
v_cmp_ne_u32 vcc, s45, v96
s_nop 0
s_or_b64 s[64:65], s[64:65], vcc
s_waitcnt vmcnt(14)
v_cmp_ne_u32 vcc, s45, v97
s_nop 0
s_or_b64 s[64:65], s[64:65], vcc
s_waitcnt vmcnt(13)
v_cmp_ne_u32 vcc, s45, v98
s_nop 0
s_or_b64 s[64:65], s[64:65], vcc
s_waitcnt vmcnt(12)
v_cmp_ne_u32 vcc, s45, v99
s_nop 0
s_or_b64 s[64:65], s[64:65], vcc
s_waitcnt vmcnt(11)
v_cmp_ne_u32 vcc, s45, v100
s_nop 0
s_or_b64 s[64:65], s[64:65], vcc
s_waitcnt vmcnt(10)
v_cmp_ne_u32 vcc, s45, v101
s_nop 0
s_or_b64 s[64:65], s[64:65], vcc
s_waitcnt vmcnt(9)
v_cmp_ne_u32 vcc, s45, v102
s_nop 0
s_or_b64 s[64:65], s[64:65], vcc
s_waitcnt vmcnt(8)
v_cmp_ne_u32 vcc, s45, v103
s_nop 0
s_or_b64 s[64:65], s[64:65], vcc
s_waitcnt vmcnt(7)
v_cmp_ne_u32 vcc, s45, v104
s_nop 0
s_or_b64 s[64:65], s[64:65], vcc
s_waitcnt vmcnt(6)
v_cmp_ne_u32 vcc, s45, v105
s_nop 0
s_or_b64 s[64:65], s[64:65], vcc
s_waitcnt vmcnt(5)
v_cmp_ne_u32 vcc, s45, v106
s_nop 0
s_or_b64 s[64:65], s[64:65], vcc
s_waitcnt vmcnt(4)
v_cmp_ne_u32 vcc, s45, v107
s_nop 0
s_or_b64 s[64:65], s[64:65], vcc
s_waitcnt vmcnt(3)
v_cmp_ne_u32 vcc, s45, v108
s_nop 0
s_or_b64 s[64:65], s[64:65], vcc
s_waitcnt vmcnt(2)
v_cmp_ne_u32 vcc, s45, v109
s_nop 0
s_or_b64 s[64:65], s[64:65], vcc
s_waitcnt vmcnt(1)
v_cmp_ne_u32 vcc, s45, v110
s_nop 0
s_or_b64 s[64:65], s[64:65], vcc
s_waitcnt vmcnt(0)
v_cmp_ne_u32 vcc, s45, v111
s_nop 0
s_or_b64 s[64:65], s[64:65], vcc
s_cbranch_scc1 ep_slow
ep_ok:
v_mov_b32 v8, s45
buffer_store_dword v8, v26, s[16:19], 0 offen sc1
L_pend:
s_waitcnt vmcnt(0)
s_endpgm
stM_slow:
s_mov_b32 s70, 20000
stM_loop:
buffer_load_dwordx4 v[244:247], v242, s[16:19], 0 offen offset:0 sc1
buffer_load_dwordx4 v[248:251], v242, s[16:19], 0 offen offset:256 sc1
s_waitcnt vmcnt(0)
v_cmp_ne_u32 vcc, s45, v247
v_cmp_ne_u32 s[64:65], s45, v251
s_nop 0
s_or_b64 vcc, vcc, s[64:65]
s_cbranch_scc0 stM_ok
s_sub_u32 s70, s70, 1
s_cmp_eq_u32 s70, 0
s_cbranch_scc0 stM_loop
s_branch stM_ok
csM0_slow:
s_mov_b32 s70, 20000
csM0_loop:
buffer_load_dwordx2 v[68:69], v70, s[16:19], 0 offen sc1
s_waitcnt vmcnt(0)
v_cmp_ne_u32 vcc, s45, v69
s_nop 0
s_cmp_lg_u64 vcc, 0
s_cbranch_scc0 csM0_ok
s_sub_u32 s70, s70, 1
s_cmp_eq_u32 s70, 0
s_cbranch_scc0 csM0_loop
s_branch csM0_ok
csM1_slow:
s_mov_b32 s70, 20000
csM1_loop:
buffer_load_dwordx2 v[68:69], v70, s[16:19], 0 offen sc1
s_waitcnt vmcnt(0)
v_cmp_ne_u32 vcc, s45, v69
s_nop 0
s_cmp_lg_u64 vcc, 0
s_cbranch_scc0 csM1_ok
s_sub_u32 s70, s70, 1
s_cmp_eq_u32 s70, 0
s_cbranch_scc0 csM1_loop
s_branch csM1_ok
csM2_slow:
s_mov_b32 s70, 20000
csM2_loop:
buffer_load_dwordx2 v[68:69], v70, s[16:19], 0 offen sc1
s_waitcnt vmcnt(0)
v_cmp_ne_u32 vcc, s45, v69
s_nop 0
s_cmp_lg_u64 vcc, 0
s_cbranch_scc0 csM2_ok
s_sub_u32 s70, s70, 1
s_cmp_eq_u32 s70, 0
s_cbranch_scc0 csM2_loop
s_branch csM2_ok
fh1_slow:
s_mov_b32 s70, 20000
fh1_loop:
s_add_u32 s63, s73, 0
s_load_dwordx8 s[52:59], s[16:17], s63 glc
s_waitcnt lgkmcnt(0)
s_xor_b64 s[52:53], s[52:53], s[42:43]
s_xor_b64 s[54:55], s[54:55], s[42:43]
s_or_b64 s[52:53], s[52:53], s[54:55]
s_xor_b64 s[56:57], s[56:57], s[42:43]
s_or_b64 s[52:53], s[52:53], s[56:57]
s_cbranch_scc0 fh1_ok
s_sub_u32 s70, s70, 1
s_cmp_eq_u32 s70, 0
s_cbranch_scc0 fh1_loop
s_branch fh1_ok
fh2_slow:
s_mov_b32 s70, 20000
fh2_loop:
s_add_u32 s63, s73, 32
s_load_dwordx8 s[52:59], s[16:17], s63 glc
s_waitcnt lgkmcnt(0)
s_cmp_lg_u64 s[56:57], s[42:43]
s_cbranch_scc0 fh2_ok
s_sub_u32 s70, s70, 1
s_cmp_eq_u32 s70, 0
s_cbranch_scc0 fh2_loop
s_branch fh2_ok
fh3_slow:
s_mov_b32 s70, 20000
fh3_loop:
s_add_u32 s63, s73, 64
s_load_dwordx8 s[52:59], s[16:17], s63 glc
s_waitcnt lgkmcnt(0)
s_xor_b64 s[52:53], s[52:53], s[42:43]
s_xor_b64 s[54:55], s[54:55], s[42:43]
s_or_b64 s[52:53], s[52:53], s[54:55]
s_xor_b64 s[56:57], s[56:57], s[42:43]
s_or_b64 s[52:53], s[52:53], s[56:57]
s_cbranch_scc0 fh3_ok
s_sub_u32 s70, s70, 1
s_cmp_eq_u32 s70, 0
s_cbranch_scc0 fh3_loop
s_branch fh3_ok
fh4_slow:
s_mov_b32 s70, 20000
fh4_loop:
s_add_u32 s63, s73, 32
s_load_dwordx8 s[52:59], s[16:17], s63 glc
s_waitcnt lgkmcnt(0)
s_xor_b64 s[52:53], s[52:53], s[42:43]
s_xor_b64 s[54:55], s[54:55], s[42:43]
s_or_b64 s[52:53], s[52:53], s[54:55]
s_xor_b64 s[56:57], s[56:57], s[42:43]
s_or_b64 s[52:53], s[52:53], s[56:57]
s_cbranch_scc0 fh4_ok
s_sub_u32 s70, s70, 1
s_cmp_eq_u32 s70, 0
s_cbranch_scc0 fh4_loop
s_branch fh4_ok
fp1_slow:
s_mov_b32 s70, 20000
fp1_loop:
s_add_u32 s63, s96, 0
s_load_dwordx8 s[52:59], s[16:17], s63 glc
s_waitcnt lgkmcnt(0)
s_xor_b64 s[52:53], s[52:53], s[42:43]
s_xor_b64 s[54:55], s[54:55], s[42:43]
s_or_b64 s[52:53], s[52:53], s[54:55]
s_xor_b32 s56, s56, s45
s_or_b32 s52, s52, s56
s_or_b32 s52, s52, s53
s_cbranch_scc0 fp1_ok
s_sub_u32 s70, s70, 1
s_cmp_eq_u32 s70, 0
s_cbranch_scc0 fp1_loop
s_branch fp1_ok
fp2_slow:
s_mov_b32 s70, 20000
fp2_loop:
fp2_p:
s_add_u32 s99, s0, 1020
s_load_dword s52, s[16:17], s99 glc
s_add_u32 s99, s0, 55292
s_load_dword s53, s[16:17], s99 glc
s_add_u32 s99, s0, 109564
s_load_dword s54, s[16:17], s99 glc
s_add_u32 s99, s0, 163836
s_load_dword s55, s[16:17], s99 glc
s_add_u32 s99, s0, 218108
s_load_dword s56, s[16:17], s99 glc
s_waitcnt lgkmcnt(0)
s_max_u32 s52, s52, s53
s_max_u32 s54, s54, s55
s_max_u32 s52, s52, s56
s_max_u32 s52, s52, s54
s_cmp_eq_u32 s52, -1
s_cbranch_scc0 fp2_q
s_sub_u32 s70, s70, 1
s_cmp_gt_i32 s70, 1
s_cbranch_scc1 fp2_p
s_mov_b32 s70, 1
fp2_q:
s_add_u32 s93, s0, 0
buffer_load_dwordx4 v[136:139], v1, s[16:19], s93 offen offset:0 sc1
s_add_u32 s93, s0, 54272
buffer_load_dwordx4 v[140:143], v1, s[16:19], s93 offen offset:0 sc1
s_add_u32 s93, s0, 108544
buffer_load_dwordx4 v[144:147], v1, s[16:19], s93 offen offset:0 sc1
s_add_u32 s93, s0, 162816
buffer_load_dwordx4 v[148:151], v1, s[16:19], s93 offen offset:0 sc1
s_add_u32 s93, s0, 217088
buffer_load_dwordx4 v[152:155], v1, s[16:19], s93 offen offset:0 sc1
s_waitcnt vmcnt(0)
v_max3_u32 v88, v136, v137, v138
v_max3_u32 v89, v139, v140, v141
v_max3_u32 v88, v88, v142, v143
v_max3_u32 v89, v89, v144, v145
v_max3_u32 v88, v88, v146, v147
v_max3_u32 v89, v89, v148, v149
v_max3_u32 v88, v88, v150, v151
v_max3_u32 v89, v89, v152, v153
v_max3_u32 v88, v88, v154, v155
v_max_u32 v88, v88, v89
v_cmp_eq_u32 vcc, -1, v88
s_nop 0
s_cmp_lg_u64 vcc, 0
s_cbranch_scc0 fp2_ok
s_sub_u32 s70, s70, 1
s_cmp_eq_u32 s70, 0
s_cbranch_scc0 fp2_loop
s_branch fp2_ok
stSS_slow:
s_mov_b32 s70, 20000
stSS_loop:
buffer_load_dwordx4 v[244:247], v242, s[16:19], 0 offen offset:0 sc1
buffer_load_dwordx4 v[248:251], v242, s[16:19], 0 offen offset:256 sc1
s_waitcnt vmcnt(0)
v_cmp_ne_u32 vcc, s45, v247
v_cmp_ne_u32 s[64:65], s45, v251
s_nop 0
s_or_b64 vcc, vcc, s[64:65]
s_cbranch_scc0 stSS_ok
s_sub_u32 s70, s70, 1
s_cmp_eq_u32 s70, 0
s_cbranch_scc0 stSS_loop
s_branch stSS_ok
csS0S_slow:
s_mov_b32 s70, 20000
csS0S_loop:
buffer_load_dwordx2 v[68:69], v70, s[16:19], 0 offen sc1
s_waitcnt vmcnt(0)
v_cmp_ne_u32 vcc, s45, v69
s_nop 0
s_cmp_lg_u64 vcc, 0
s_cbranch_scc0 csS0S_ok
s_sub_u32 s70, s70, 1
s_cmp_eq_u32 s70, 0
s_cbranch_scc0 csS0S_loop
s_branch csS0S_ok
csS1S_slow:
s_mov_b32 s70, 20000
csS1S_loop:
buffer_load_dwordx2 v[68:69], v70, s[16:19], 0 offen sc1
s_waitcnt vmcnt(0)
v_cmp_ne_u32 vcc, s45, v69
s_nop 0
s_cmp_lg_u64 vcc, 0
s_cbranch_scc0 csS1S_ok
s_sub_u32 s70, s70, 1
s_cmp_eq_u32 s70, 0
s_cbranch_scc0 csS1S_loop
s_branch csS1S_ok
csS2S_slow:
s_mov_b32 s70, 20000
csS2S_loop:
buffer_load_dwordx2 v[68:69], v70, s[16:19], 0 offen sc1
s_waitcnt vmcnt(0)
v_cmp_ne_u32 vcc, s45, v69
s_nop 0
s_cmp_lg_u64 vcc, 0
s_cbranch_scc0 csS2S_ok
s_sub_u32 s70, s70, 1
s_cmp_eq_u32 s70, 0
s_cbranch_scc0 csS2S_loop
s_branch csS2S_ok
fh1S_slow:
s_mov_b32 s70, 20000
fh1S_loop:
s_add_u32 s63, s73, 0
s_load_dwordx8 s[52:59], s[16:17], s63 glc
s_waitcnt lgkmcnt(0)
s_xor_b64 s[52:53], s[52:53], s[42:43]
s_xor_b64 s[54:55], s[54:55], s[42:43]
s_or_b64 s[52:53], s[52:53], s[54:55]
s_xor_b64 s[56:57], s[56:57], s[42:43]
s_or_b64 s[52:53], s[52:53], s[56:57]
s_cbranch_scc0 fh1S_ok
s_sub_u32 s70, s70, 1
s_cmp_eq_u32 s70, 0
s_cbranch_scc0 fh1S_loop
s_branch fh1S_ok
fh2S_slow:
s_mov_b32 s70, 20000
fh2S_loop:
s_add_u32 s63, s73, 32
s_load_dwordx8 s[52:59], s[16:17], s63 glc
s_waitcnt lgkmcnt(0)
s_cmp_lg_u64 s[56:57], s[42:43]
s_cbranch_scc0 fh2S_ok
s_sub_u32 s70, s70, 1
s_cmp_eq_u32 s70, 0
s_cbranch_scc0 fh2S_loop
s_branch fh2S_ok
carSS_slow:
s_mov_b32 s70, 20000
carSS_loop:
buffer_load_dwordx4 v[68:71], v55, s[16:19], s66 offen sc1
buffer_load_dwordx4 v[72:75], v56, s[16:19], s66 offen sc1
buffer_load_dwordx4 v[76:79], v57, s[16:19], s66 offen sc1
buffer_load_dwordx4 v[40:43], v66, s[16:19], s66 offen sc1
s_waitcnt vmcnt(0)
v_cmp_le_i32 s[68:69], 0, v54
v_cmp_ne_u32 vcc, s45, v70
s_nop 0
s_and_b64 s[78:79], vcc, s[68:69]
v_cmp_le_i32 s[68:69], 2, v54
v_cmp_ne_u32 vcc, s45, v74
s_nop 0
s_and_b64 vcc, vcc, s[68:69]
s_or_b64 s[78:79], s[78:79], vcc
v_cmp_le_i32 s[68:69], 4, v54
v_cmp_ne_u32 vcc, s45, v78
s_nop 0
s_and_b64 vcc, vcc, s[68:69]
s_or_b64 s[78:79], s[78:79], vcc
v_cmp_le_i32 s[68:69], 6, v54
v_cmp_ne_u32 vcc, s45, v42
s_nop 0
s_and_b64 vcc, vcc, s[68:69]
s_or_b64 s[78:79], s[78:79], vcc
s_cbranch_scc0 carSS_ok
s_sub_u32 s70, s70, 1
s_cmp_eq_u32 s70, 0
s_cbranch_scc0 carSS_loop
s_branch carSS_ok
ep_slow:
s_mov_b32 s70, 20000
ep_loop:
s_mov_b32 s62, 65536
buffer_load_dword v80, v1, s[16:19], s62 offen offset:12 sc1
buffer_load_dword v81, v1, s[16:19], s62 offen offset:1036 sc1
buffer_load_dword v82, v1, s[16:19], s62 offen offset:2060 sc1
buffer_load_dword v83, v1, s[16:19], s62 offen offset:3084 sc1
s_add_u32 s62, s62, 4096
buffer_load_dword v84, v1, s[16:19], s62 offen offset:12 sc1
buffer_load_dword v85, v1, s[16:19], s62 offen offset:1036 sc1
buffer_load_dword v86, v1, s[16:19], s62 offen offset:2060 sc1
buffer_load_dword v87, v1, s[16:19], s62 offen offset:3084 sc1
s_add_u32 s62, s62, 4096
buffer_load_dword v88, v1, s[16:19], s62 offen offset:12 sc1
buffer_load_dword v89, v1, s[16:19], s62 offen offset:1036 sc1
buffer_load_dword v90, v1, s[16:19], s62 offen offset:2060 sc1
buffer_load_dword v91, v1, s[16:19], s62 offen offset:3084 sc1
s_add_u32 s62, s62, 4096
buffer_load_dword v92, v1, s[16:19], s62 offen offset:12 sc1
buffer_load_dword v93, v1, s[16:19], s62 offen offset:1036 sc1
buffer_load_dword v94, v1, s[16:19], s62 offen offset:2060 sc1
buffer_load_dword v95, v1, s[16:19], s62 offen offset:3084 sc1
s_add_u32 s62, s62, 4096
buffer_load_dword v96, v1, s[16:19], s62 offen offset:12 sc1
buffer_load_dword v97, v1, s[16:19], s62 offen offset:1036 sc1
buffer_load_dword v98, v1, s[16:19], s62 offen offset:2060 sc1
buffer_load_dword v99, v1, s[16:19], s62 offen offset:3084 sc1
s_add_u32 s62, s62, 4096
buffer_load_dword v100, v1, s[16:19], s62 offen offset:12 sc1
buffer_load_dword v101, v1, s[16:19], s62 offen offset:1036 sc1
buffer_load_dword v102, v1, s[16:19], s62 offen offset:2060 sc1
buffer_load_dword v103, v1, s[16:19], s62 offen offset:3084 sc1
s_add_u32 s62, s62, 4096
buffer_load_dword v104, v1, s[16:19], s62 offen offset:12 sc1
buffer_load_dword v105, v1, s[16:19], s62 offen offset:1036 sc1
buffer_load_dword v106, v1, s[16:19], s62 offen offset:2060 sc1
buffer_load_dword v107, v1, s[16:19], s62 offen offset:3084 sc1
s_add_u32 s62, s62, 4096
buffer_load_dword v108, v1, s[16:19], s62 offen offset:12 sc1
buffer_load_dword v109, v1, s[16:19], s62 offen offset:1036 sc1
buffer_load_dword v110, v1, s[16:19], s62 offen offset:2060 sc1
buffer_load_dword v111, v1, s[16:19], s62 offen offset:3084 sc1
s_add_u32 s62, s62, 4096
s_waitcnt vmcnt(0)
s_mov_b64 s[64:65], 0
v_cmp_ne_u32 vcc, s45, v80
s_nop 0
s_or_b64 s[64:65], s[64:65], vcc
v_cmp_ne_u32 vcc, s45, v81
s_nop 0
s_or_b64 s[64:65], s[64:65], vcc
v_cmp_ne_u32 vcc, s45, v82
s_nop 0
s_or_b64 s[64:65], s[64:65], vcc
v_cmp_ne_u32 vcc, s45, v83
s_nop 0
s_or_b64 s[64:65], s[64:65], vcc
v_cmp_ne_u32 vcc, s45, v84
s_nop 0
s_or_b64 s[64:65], s[64:65], vcc
v_cmp_ne_u32 vcc, s45, v85
s_nop 0
s_or_b64 s[64:65], s[64:65], vcc
v_cmp_ne_u32 vcc, s45, v86
s_nop 0
s_or_b64 s[64:65], s[64:65], vcc
v_cmp_ne_u32 vcc, s45, v87
s_nop 0
s_or_b64 s[64:65], s[64:65], vcc
v_cmp_ne_u32 vcc, s45, v88
s_nop 0
s_or_b64 s[64:65], s[64:65], vcc
v_cmp_ne_u32 vcc, s45, v89
s_nop 0
s_or_b64 s[64:65], s[64:65], vcc
v_cmp_ne_u32 vcc, s45, v90
s_nop 0
s_or_b64 s[64:65], s[64:65], vcc
v_cmp_ne_u32 vcc, s45, v91
s_nop 0
s_or_b64 s[64:65], s[64:65], vcc
v_cmp_ne_u32 vcc, s45, v92
s_nop 0
s_or_b64 s[64:65], s[64:65], vcc
v_cmp_ne_u32 vcc, s45, v93
s_nop 0
s_or_b64 s[64:65], s[64:65], vcc
v_cmp_ne_u32 vcc, s45, v94
s_nop 0
s_or_b64 s[64:65], s[64:65], vcc
v_cmp_ne_u32 vcc, s45, v95
s_nop 0
s_or_b64 s[64:65], s[64:65], vcc
v_cmp_ne_u32 vcc, s45, v96
s_nop 0
s_or_b64 s[64:65], s[64:65], vcc
v_cmp_ne_u32 vcc, s45, v97
s_nop 0
s_or_b64 s[64:65], s[64:65], vcc
v_cmp_ne_u32 vcc, s45, v98
s_nop 0
s_or_b64 s[64:65], s[64:65], vcc
v_cmp_ne_u32 vcc, s45, v99
s_nop 0
s_or_b64 s[64:65], s[64:65], vcc
v_cmp_ne_u32 vcc, s45, v100
s_nop 0
s_or_b64 s[64:65], s[64:65], vcc
v_cmp_ne_u32 vcc, s45, v101
s_nop 0
s_or_b64 s[64:65], s[64:65], vcc
v_cmp_ne_u32 vcc, s45, v102
s_nop 0
s_or_b64 s[64:65], s[64:65], vcc
v_cmp_ne_u32 vcc, s45, v103
s_nop 0
s_or_b64 s[64:65], s[64:65], vcc
v_cmp_ne_u32 vcc, s45, v104
s_nop 0
s_or_b64 s[64:65], s[64:65], vcc
v_cmp_ne_u32 vcc, s45, v105
s_nop 0
s_or_b64 s[64:65], s[64:65], vcc
v_cmp_ne_u32 vcc, s45, v106
s_nop 0
s_or_b64 s[64:65], s[64:65], vcc
v_cmp_ne_u32 vcc, s45, v107
s_nop 0
s_or_b64 s[64:65], s[64:65], vcc
v_cmp_ne_u32 vcc, s45, v108
s_nop 0
s_or_b64 s[64:65], s[64:65], vcc
v_cmp_ne_u32 vcc, s45, v109
s_nop 0
s_or_b64 s[64:65], s[64:65], vcc
v_cmp_ne_u32 vcc, s45, v110
s_nop 0
s_or_b64 s[64:65], s[64:65], vcc
v_cmp_ne_u32 vcc, s45, v111
s_nop 0
s_or_b64 s[64:65], s[64:65], vcc
s_cbranch_scc0 ep_ok
s_sub_u32 s70, s70, 1
s_cmp_eq_u32 s70, 0
s_cbranch_scc0 ep_loop
s_branch ep_ok
L_end:
s_endpgm
.section .rodata,"a"
.p2align 6
.amdhsa_kernel parallel_sum__ssm_conv_s5__mixer_channel_mlp__prompt_kernel
  .amdhsa_next_free_vgpr 512
  .amdhsa_next_free_sgpr 102
  .amdhsa_accum_offset 256
  .amdhsa_group_segment_fixed_size 0
  .amdhsa_kernarg_size 136
  .amdhsa_user_sgpr_count 2
  .amdhsa_user_sgpr_kernarg_segment_ptr 1
  .amdhsa_system_sgpr_workgroup_id_x 1
.end_amdhsa_kernel
```
